```python
import torch

def _softmax(x, axis=-1):
    return torch.softmax(x, dim=axis)
def _gelu(x):
    return torch.nn.functional.gelu(x, approximate="tanh")
def _silu(x):
    return torch.nn.functional.silu(x)
def _sigmoid(x):
    return torch.sigmoid(x)
def _layernorm(x, axis=-1, eps=1e-5):
    m = x.mean(dim=axis, keepdim=True)
    v = x.var(dim=axis, keepdim=True, unbiased=False)
    return (x - m) / torch.sqrt(v + eps)
def _scatter_add(tgt, idx, src, axis=0):
    return tgt.clone().index_add_(axis, idx, src)
def _segment_sum(src, seg, n):
    out = torch.zeros((n,) + src.shape[1:], dtype=src.dtype)
    return out.index_add_(0, seg, src)
def _pad(x, pw):
    flat = tuple(v for pair in reversed(pw) for v in pair)
    return torch.nn.functional.pad(x, flat)

kernel_name = 'concat_heads__mha_block_cached__mha_block_cached__near_ridge'

def setup_inputs():

    _w = (lambda a: (lambda t: t.to(torch.bfloat16) if t.is_floating_point() else t)(torch.as_tensor(a)))
    def _A_setup():
        B, Sq, D = 8, 160, 1024
        H, Sk, Dh = 32, 512, 128
        return {
            "x": _w((lambda *s: torch.randn(*s, dtype=torch.bfloat16) * 0.8)(B, Sq, D)),
            "k_cache": _w((lambda *s: torch.randn(*s, dtype=torch.bfloat16) * 0.8)(B, H, Sk, Dh)),
            "v_cache": _w((lambda *s: torch.randn(*s, dtype=torch.bfloat16) * 0.05)(B, H, Sk, Dh)),
            "wq": _w((lambda *s: torch.randn(*s, dtype=torch.bfloat16) * 0.8)(D, H * Dh) * (D ** -0.5)),
            "wo": _w((lambda *s: torch.randn(*s, dtype=torch.bfloat16) * 0.05)(H * Dh, D) * ((H * Dh) ** -0.5)),
        }
    _A_in = _A_setup()

    def _B_setup():
        B, Sq, D = 8, 160, 1024
        H, Sk, Dh = 32, 512, 128
        return {
            "x": _w((lambda *s: torch.randn(*s, dtype=torch.bfloat16) * 0.8)(B, Sq, D)),
            "k_cache": _w((lambda *s: torch.randn(*s, dtype=torch.bfloat16) * 0.8)(B, H, Sk, Dh)),
            "v_cache": _w((lambda *s: torch.randn(*s, dtype=torch.bfloat16) * 0.05)(B, H, Sk, Dh)),
            "wq": _w((lambda *s: torch.randn(*s, dtype=torch.bfloat16) * 0.8)(D, H * Dh) * (D ** -0.5)),
            "wo": _w((lambda *s: torch.randn(*s, dtype=torch.bfloat16) * 0.05)(H * Dh, D) * ((H * Dh) ** -0.5)),
        }
    _B_in = _B_setup()

    return {
        "A_x": _A_in["x"],
        "A_k_cache": _A_in["k_cache"],
        "A_v_cache": _A_in["v_cache"],
        "A_wq": _A_in["wq"],
        "A_wo": _A_in["wo"],
        "B_x": _B_in["x"],
        "B_k_cache": _B_in["k_cache"],
        "B_v_cache": _B_in["v_cache"],
        "B_wq": _B_in["wq"],
        "B_wo": _B_in["wo"],
    }

def reference(A_x, A_k_cache, A_v_cache, A_wq, A_wo, B_x, B_k_cache, B_v_cache, B_wq, B_wo):
    def _A_ref(x, k_cache, v_cache, wq, wo):
        B, Sq, D = x.shape
        H, Dh = 32, 128
        q = (lambda x, *d: x.permute(*d))((x @ wq).reshape(B, Sq, H, Dh), 0, 2, 1, 3)
        scores = torch.einsum("bhqd,bhkd->bhqk", q, k_cache) * (Dh ** -0.5)
        p = _softmax(scores, axis=-1)
        o = torch.einsum("bhqk,bhkd->bhqd", p, v_cache)
        return (lambda x, *d: x.permute(*d))(o, 0, 2, 1, 3).reshape(B, Sq, H * Dh) @ wo

    def _B_ref(x, k_cache, v_cache, wq, wo):
        B, Sq, D = x.shape
        H, Dh = 32, 128
        q = (lambda x, *d: x.permute(*d))((x @ wq).reshape(B, Sq, H, Dh), 0, 2, 1, 3)
        scores = torch.einsum("bhqd,bhkd->bhqk", q, k_cache) * (Dh ** -0.5)
        p = _softmax(scores, axis=-1)
        o = torch.einsum("bhqk,bhkd->bhqd", p, v_cache)
        return (lambda x, *d: x.permute(*d))(o, 0, 2, 1, 3).reshape(B, Sq, H * Dh) @ wo

    a = _A_ref(A_x, A_k_cache, A_v_cache, A_wq, A_wo)
    b = _B_ref(B_x, B_k_cache, B_v_cache, B_wq, B_wo)
    return torch.concatenate([a, b], axis=-1)
```

```asm
; @launch grid=(256,1,1) block=(256,1,1) lds=163840
.amdgcn_target "amdgcn-amd-amdhsa--gfx950"
.text
.globl concat_heads__mha_block_cached__mha_block_cached__near_ridge_kernel
.p2align 8
.type concat_heads__mha_block_cached__mha_block_cached__near_ridge_kernel,@function
concat_heads__mha_block_cached__mha_block_cached__near_ridge_kernel:
L_code0:
    s_cmp_ge_u32 s2, 256
    s_cbranch_scc1 L_end
    s_xor_b32 s3, s2, 0
    s_and_b32 s56, s3, 7
    s_lshr_b32 s57, s3, 3
    s_lshr_b32 s60, s56, 2
    s_mul_i32 s58, s60, 40
    s_add_u32 s46, s0, s58
    s_addc_u32 s47, s1, 0
    s_load_dwordx8 s[48:55], s[46:47], 0
    s_load_dwordx4 s[64:67], s[0:1], 88
    s_load_dwordx2 s[68:69], s[46:47], 32
    s_load_dwordx2 s[94:95], s[0:1], 80
    s_bfe_u32 s61, s56, 0x10001
    s_lshl_b32 s61, s61, 2
    s_and_b32 s58, s57, 3
    s_add_u32 s61, s61, s58
    s_lshr_b32 s59, s57, 2
    s_and_b32 s62, s56, 1
    s_lshl_b32 s62, s62, 3
    s_add_u32 s62, s62, s59
    s_add_u32 s25, s58, s59
    v_and_b32 v22, 63, v0
    v_lshrrev_b32 v23, 6, v0
    s_nop 0
    v_readfirstlane_b32 s24, v23
    v_bfe_u32 v24, v22, 2, 3
    v_lshlrev_b32 v24, 11, v24
    v_lshrrev_b32 v25, 5, v22
    v_lshl_add_u32 v24, v25, 6, v24
    v_mul_u32_u24 v25, 81920, v23
    v_add_u32 v24, v24, v25
    v_and_b32 v25, 3, v22
    v_and_b32 v26, 1, v23
    v_lshlrev_b32 v26, 1, v26
    v_xor_b32 v25, v25, v26
    v_lshl_add_u32 v1, v25, 4, v24
    v_xor_b32 v2, 32, v1
    v_bfe_u32 v24, v22, 4, 1
    v_bfe_u32 v25, v22, 2, 2
    v_lshl_add_u32 v25, v24, 3, v25
    v_lshlrev_b32 v25, 13, v25
    v_lshrrev_b32 v26, 5, v22
    v_lshl_add_u32 v25, v26, 6, v25
    v_and_b32 v26, 3, v22
    v_lshlrev_b32 v24, 1, v24
    v_xor_b32 v26, v26, v24
    v_lshl_add_u32 v25, v26, 4, v25
    v_lshl_add_u32 v3, v23, 7, v25
    s_mul_i32 s30, s24, 5120
    s_lshl_b32 s31, s24, 13
    s_add_u32 s31, s31, 20480
    s_mul_i32 s56, s61, 327680
    s_lshl_b32 s58, s62, 9
    s_sub_u32 s57, 8388608, s58
    s_waitcnt lgkmcnt(0)
    s_add_u32 s48, s48, s56
    s_addc_u32 s49, s49, 0
    s_mov_b32 s4, s48
    s_and_b32 s5, s49, 0xffff
    s_mov_b32 s6, 327680
    s_mov_b32 s7, 0x20000
    s_add_u32 s54, s54, s58
    s_addc_u32 s55, s55, 0
    s_mov_b32 s8, s54
    s_and_b32 s9, s55, 0xffff
    s_mov_b32 s10, s57
    s_mov_b32 s11, 0x20000
    s_lshl_b32 s56, s61, 22
    s_lshl_b32 s57, s62, 18
    s_add_u32 s56, s56, s57
    s_add_u32 s50, s50, s56
    s_addc_u32 s51, s51, 0
    s_add_u32 s52, s52, s56
    s_addc_u32 s53, s53, 0
    s_load_dword s48, s[50:51], 0
    s_load_dword s49, s[52:53], 0
    s_add_u32 s28, s25, 0
    s_and_b32 s28, s28, 1
    s_lshl_b32 s26, s28, 7
    s_lshl_b32 s27, s28, 19
    s_add_u32 m0, s31, 0
    s_add_u32 s29, s27, 0
    buffer_load_dwordx4 v3, s[8:11], s29 offen lds
    s_add_u32 m0, s30, 0
    s_add_u32 s29, s26, 0
    buffer_load_dwordx4 v1, s[4:7], s29 offen lds
    s_add_u32 m0, s31, 1024
    s_add_u32 s29, s27, 32768
    buffer_load_dwordx4 v3, s[8:11], s29 offen lds
    s_add_u32 m0, s30, 1024
    s_add_u32 s29, s26, 16384
    buffer_load_dwordx4 v2, s[4:7], s29 offen lds
    s_add_u32 m0, s31, 2048
    s_add_u32 s29, s27, 131072
    buffer_load_dwordx4 v3, s[8:11], s29 offen lds
    s_add_u32 m0, s30, 2048
    s_add_u32 s29, s26, 32768
    buffer_load_dwordx4 v1, s[4:7], s29 offen lds
    s_add_u32 m0, s31, 3072
    s_add_u32 s29, s27, 163840
    buffer_load_dwordx4 v3, s[8:11], s29 offen lds
    s_add_u32 m0, s30, 3072
    s_add_u32 s29, s26, 49152
    buffer_load_dwordx4 v2, s[4:7], s29 offen lds
    s_add_u32 m0, s30, 4096
    s_add_u32 s29, s26, 65536
    buffer_load_dwordx4 v1, s[4:7], s29 offen lds
    s_add_u32 m0, s31, 4096
    s_add_u32 s29, s27, 262144
    buffer_load_dwordx4 v3, s[8:11], s29 offen lds
    s_add_u32 m0, s31, 5120
    s_add_u32 s29, s27, 294912
    buffer_load_dwordx4 v3, s[8:11], s29 offen lds
    s_add_u32 m0, s31, 6144
    s_add_u32 s29, s27, 393216
    buffer_load_dwordx4 v3, s[8:11], s29 offen lds
    s_add_u32 m0, s31, 7168
    s_add_u32 s29, s27, 425984
    buffer_load_dwordx4 v3, s[8:11], s29 offen lds
    s_mov_b32 s34, s66
    s_mov_b32 s35, s67
    s_mov_b32 s40, s64
    s_and_b32 s41, s65, 0xffff
    s_mov_b32 s42, 256
    s_mov_b32 s43, 0x20000
    s_add_u32 s58, s34, 0x2000000
    s_addc_u32 s59, s35, 0
    s_mov_b32 s36, s58
    s_and_b32 s37, s59, 0xffff
    s_mov_b32 s38, 0x4000
    s_mov_b32 s39, 0x20000
    s_lshl_b32 s56, s60, 3
    s_add_u32 s56, s56, s61
    s_lshl_b32 s57, s56, 4
    s_add_u32 s57, s57, s62
    s_lshl_b32 s57, s57, 2
    s_add_u32 s57, s57, s24
    s_lshl_b32 s63, s57, 2
    s_lshl_b32 s56, s56, 3
    s_and_b32 s57, s62, 7
    s_add_u32 s64, s56, s57
    s_lshl_b32 s57, s64, 2
    s_add_u32 s57, s57, s24
    s_lshl_b32 s57, s57, 2
    s_add_u32 s65, s57, 0x2000
    s_bitcmp1_b32 s62, 3
    s_cselect_b32 s56, 0x8000, s65
    v_mov_b32 v31, 0x7ffffff0
    v_cmp_ne_u32 vcc, 0, v22
    s_nop 1
    v_cndmask_b32 v31, 0, v31
    v_mov_b32 v24, 0
    s_getreg_b32 s66, hwreg(HW_REG_XCC_ID, 0, 4)
    v_mov_b32 v25, s66
    buffer_store_dword v25, v31, s[36:39], s63 offen sc1
    buffer_store_dword v24, v31, s[36:39], s56 offen sc1
    s_getpc_b64 s[58:59]
L_pc:
    s_sub_u32 s58, s58, L_pc - L_code0
    s_subb_u32 s59, s59, 0
    s_mov_b32 s44, s58
    s_and_b32 s45, s59, 0xffff
    s_mov_b32 s46, 0
    s_mov_b32 s47, 0x20000
    s_lshr_b32 s56, s2, 3
    s_lshl_b32 s56, s56, 7
    v_lshlrev_b32 v24, 12, v0
    v_add_u32 v24, s56, v24
    v_mov_b32 v29, 0x7ffffff0
    v_cmp_gt_u32 vcc, 32, v0
    s_nop 1
    v_cndmask_b32 v29, v29, v24
    s_mov_b32 s28, (L_code0 - L_code0) & 0xffffff80
    s_mov_b32 s46, L_att - L_code0
    buffer_load_dword v30, v29, s[44:47], s28 offen
    v_bfe_u32 v24, v22, 3, 1
    v_and_b32 v25, 7, v22
    v_lshlrev_b32 v25, 6, v25
    v_lshl_add_u32 v25, v24, 10, v25
    v_lshrrev_b32 v26, 4, v22
    v_lshlrev_b32 v24, 1, v24
    v_xor_b32 v26, v26, v24
    v_lshl_add_u32 v25, v26, 4, v25
    v_and_b32 v24, 1, v23
    v_mul_u32_u24 v24, 10240, v24
    v_add_u32 v4, v24, v25
    v_add_u32 v5, 53248, v4
    v_add_u32 v6, 106496, v4
    v_lshrrev_b32 v24, 5, v22
    v_lshlrev_b32 v24, 11, v24
    v_bfe_u32 v25, v22, 2, 2
    v_lshl_add_u32 v24, v25, 6, v24
    v_bfe_u32 v25, v22, 4, 1
    v_mul_u32_u24 v25, 288, v25
    v_add_u32 v24, v24, v25
    v_and_b32 v25, 3, v22
    v_lshl_add_u32 v24, v25, 3, v24
    v_lshrrev_b32 v25, 1, v23
    v_lshl_add_u32 v24, v25, 14, v24
    v_add_u32 v7, 20480, v24
    v_xor_b32 v8, 32, v7
    v_add_u32 v9, 53248, v7
    v_add_u32 v10, 53248, v8
    v_add_u32 v11, 106496, v7
    v_add_u32 v12, 106496, v8
    v_bfe_u32 v24, v22, 2, 2
    v_lshlrev_b32 v24, 8, v24
    v_lshrrev_b32 v25, 4, v22
    v_lshl_add_u32 v24, v25, 6, v24
    v_and_b32 v25, 3, v22
    v_lshl_add_u32 v24, v25, 4, v24
    v_lshrrev_b32 v25, 1, v23
    v_lshl_add_u32 v24, v25, 17, v24
    v_and_b32 v25, 1, v23
    v_lshl_add_u32 v13, v25, 12, v24
    v_xor_b32 v14, 16, v13
    v_xor_b32 v15, 32, v13
    v_xor_b32 v16, 48, v13
    v_bfe_u32 v24, v22, 2, 2
    v_and_b32 v25, 3, v22
    v_lshlrev_b32 v25, 6, v25
    v_lshl_add_u32 v25, v24, 10, v25
    v_lshrrev_b32 v26, 5, v22
    v_xor_b32 v26, v26, v24
    v_lshl_add_u32 v25, v26, 4, v25
    v_bfe_u32 v26, v22, 4, 1
    v_lshl_add_u32 v25, v26, 3, v25
    v_lshrrev_b32 v27, 1, v23
    v_lshl_add_u32 v25, v27, 13, v25
    v_add_u32 v17, 65536, v25
    v_xor_b32 v18, 32, v17
    v_lshrrev_b32 v24, 4, v22
    v_lshlrev_b32 v24, 10, v24
    v_bfe_u32 v25, v22, 2, 2
    v_lshl_add_u32 v24, v25, 6, v24
    v_bfe_u32 v25, v22, 4, 1
    v_lshl_add_u32 v24, v25, 5, v24
    v_and_b32 v25, 3, v22
    v_lshl_add_u32 v24, v25, 3, v24
    v_lshl_add_u32 v24, v27, 13, v24
    v_add_u32 v19, 81920, v24
    v_xor_b32 v20, 32, v19
    v_mul_u32_u24 v24, 40960, v27
    v_and_b32 v25, 1, v23
    v_mul_u32_u24 v25, 5120, v25
    v_lshl_add_u32 v24, v22, 4, v24
    v_add_u32 v21, v24, v25
    v_lshlrev_b32 v24, 12, v23
    v_lshl_add_u32 v28, v22, 4, v24
    v_mov_b32 v24, 0x3f803f80
    v_accvgpr_write_b32 a180, v24
    v_accvgpr_write_b32 a181, v24
    v_accvgpr_write_b32 a182, v24
    v_accvgpr_write_b32 a183, v24
    v_and_b32 v24, 1, v22
    v_lshlrev_b32 v24, 4, v24
    v_mov_b32 v25, 0x3f80
    v_lshlrev_b32 v24, v24, v25
    v_bfe_u32 v25, v22, 3, 1
    v_lshrrev_b32 v26, 4, v22
    v_sub_u32 v25, v26, v25
    v_bfe_u32 v26, v22, 1, 2
    v_lshl_add_u32 v25, v25, 2, v26
    v_cmp_eq_u32 vcc, 0, v25
    s_nop 1
    v_cndmask_b32 v26, 0, v24
    v_accvgpr_write_b32 a248, v26
    v_cmp_eq_u32 vcc, 1, v25
    s_nop 1
    v_cndmask_b32 v26, 0, v24
    v_accvgpr_write_b32 a249, v26
    v_cmp_eq_u32 vcc, 2, v25
    s_nop 1
    v_cndmask_b32 v26, 0, v24
    v_accvgpr_write_b32 a250, v26
    v_cmp_eq_u32 vcc, 3, v25
    s_nop 1
    v_cndmask_b32 v26, 0, v24
    v_accvgpr_write_b32 a251, v26
    v_cmp_eq_u32 vcc, 8, v25
    s_nop 1
    v_cndmask_b32 v26, 0, v24
    v_accvgpr_write_b32 a252, v26
    v_cmp_eq_u32 vcc, 9, v25
    s_nop 1
    v_cndmask_b32 v26, 0, v24
    v_accvgpr_write_b32 a253, v26
    v_cmp_eq_u32 vcc, 10, v25
    s_nop 1
    v_cndmask_b32 v26, 0, v24
    v_accvgpr_write_b32 a254, v26
    v_cmp_eq_u32 vcc, 11, v25
    s_nop 1
    v_cndmask_b32 v26, 0, v24
    v_accvgpr_write_b32 a255, v26
    s_mov_b32 s12, s50
    s_and_b32 s13, s51, 0xffff
    s_mov_b32 s14, 262144
    s_mov_b32 s15, 0x20000
    s_mov_b32 s16, s52
    s_and_b32 s17, s53, 0xffff
    s_mov_b32 s18, 262144
    s_mov_b32 s19, 0x20000
    s_lshl_b32 s56, s60, 3
    s_add_u32 s56, s56, s61
    s_mul_i32 s56, s56, 1310720
    s_add_u32 s58, s34, s56
    s_addc_u32 s59, s35, 0
    s_mov_b32 s20, s58
    s_and_b32 s21, s59, 0xffff
    s_mov_b32 s22, 1310720
    s_mov_b32 s23, 0x20000
    s_mul_i32 s33, s62, 81920
    s_lshl_b32 s32, s24, 12
    s_bitcmp1_b32 s66, 0
    s_cselect_b32 s67, 0x28000, 0
    s_cselect_b32 s3, 0x100000, 0
    s_cselect_b32 s101, 0, 0x100000
    s_cselect_b64 s[54:55], -1, 0
    s_add_u32 s28, s25, 1
    s_and_b32 s28, s28, 1
    s_lshl_b32 s26, s28, 7
    s_lshl_b32 s27, s28, 19
    s_add_u32 m0, s30, 53248
    s_add_u32 s29, s26, 0
    buffer_load_dwordx4 v1, s[4:7], s29 offen lds
    s_add_u32 m0, s31, 53248
    s_add_u32 s29, s27, 0
    buffer_load_dwordx4 v3, s[8:11], s29 offen lds
    s_add_u32 m0, s31, 54272
    s_add_u32 s29, s27, 32768
    buffer_load_dwordx4 v3, s[8:11], s29 offen lds
    s_add_u32 m0, s30, 54272
    s_add_u32 s29, s26, 16384
    buffer_load_dwordx4 v2, s[4:7], s29 offen lds
    s_add_u32 m0, s31, 55296
    s_add_u32 s29, s27, 131072
    buffer_load_dwordx4 v3, s[8:11], s29 offen lds
    s_add_u32 m0, s31, 56320
    s_add_u32 s29, s27, 163840
    buffer_load_dwordx4 v3, s[8:11], s29 offen lds
    s_add_u32 m0, s30, 55296
    s_add_u32 s29, s26, 32768
    buffer_load_dwordx4 v1, s[4:7], s29 offen lds
    s_waitcnt vmcnt(14)
    s_barrier
    ds_read_b128 a[0:3], v4
    ds_read_b64_tr_b16 a[80:81], v7
    ds_read_b64_tr_b16 a[82:83], v7 offset:1024
    ds_read_b128 a[4:7], v4 offset:2048
    ds_read_b128 a[8:11], v4 offset:4096
    ds_read_b128 a[12:15], v4 offset:6144
    ds_read_b128 a[16:19], v4 offset:8192
    ds_read_b64_tr_b16 a[84:85], v8
    ds_read_b64_tr_b16 a[86:87], v8 offset:1024
    ds_read_b64_tr_b16 a[88:89], v7 offset:512
    ds_read_b64_tr_b16 a[90:91], v7 offset:1536
    ds_read_b64_tr_b16 a[92:93], v8 offset:512
    ds_read_b64_tr_b16 a[94:95], v8 offset:1536
    ds_read_b64_tr_b16 a[96:97], v7 offset:8192
    ds_read_b64_tr_b16 a[98:99], v7 offset:9216
    s_add_u32 m0, s31, 57344
    s_add_u32 s29, s27, 262144
    buffer_load_dwordx4 v3, s[8:11], s29 offen lds
    s_add_u32 m0, s30, 56320
    s_add_u32 s29, s26, 49152
    buffer_load_dwordx4 v2, s[4:7], s29 offen lds
    s_add_u32 m0, s31, 58368
    s_add_u32 s29, s27, 294912
    buffer_load_dwordx4 v3, s[8:11], s29 offen lds
    s_add_u32 m0, s31, 59392
    s_add_u32 s29, s27, 393216
    buffer_load_dwordx4 v3, s[8:11], s29 offen lds
    s_waitcnt lgkmcnt(0)
    v_mfma_f32_16x16x32_bf16 v[96:99], a[80:83], a[0:3], 0
    s_add_u32 m0, s30, 57344
    s_add_u32 s29, s26, 65536
    ds_read_b64_tr_b16 a[100:101], v8 offset:8192
    ds_read_b64_tr_b16 a[102:103], v8 offset:9216
    v_mfma_f32_16x16x32_bf16 v[128:131], a[80:83], a[4:7], 0
    buffer_load_dwordx4 v1, s[4:7], s29 offen lds
    v_mfma_f32_16x16x32_bf16 v[160:163], a[80:83], a[8:11], 0
    s_add_u32 m0, s31, 60416
    s_add_u32 s29, s27, 425984
    v_mfma_f32_16x16x32_bf16 v[192:195], a[80:83], a[12:15], 0
    buffer_load_dwordx4 v3, s[8:11], s29 offen lds
    v_mfma_f32_16x16x32_bf16 v[224:227], a[80:83], a[16:19], 0
    s_add_u32 s28, s25, 0
    s_and_b32 s28, s28, 1
    s_or_b32 s28, s28, 2
    v_mfma_f32_16x16x32_bf16 v[228:231], a[84:87], a[16:19], 0
    ds_read_b64_tr_b16 a[80:81], v7 offset:8704
    ds_read_b64_tr_b16 a[82:83], v7 offset:9728
    v_mfma_f32_16x16x32_bf16 v[196:199], a[84:87], a[12:15], 0
    s_lshl_b32 s26, s28, 7
    s_lshl_b32 s27, s28, 19
    v_mfma_f32_16x16x32_bf16 v[164:167], a[84:87], a[8:11], 0
    s_add_u32 m0, s30, 106496
    s_add_u32 s29, s26, 0
    v_mfma_f32_16x16x32_bf16 v[132:135], a[84:87], a[4:7], 0
    buffer_load_dwordx4 v1, s[4:7], s29 offen lds
    v_mfma_f32_16x16x32_bf16 v[100:103], a[84:87], a[0:3], 0
    v_mfma_f32_16x16x32_bf16 v[104:107], a[88:91], a[0:3], 0
    ds_read_b64_tr_b16 a[84:85], v8 offset:8704
    ds_read_b64_tr_b16 a[86:87], v8 offset:9728
    v_mfma_f32_16x16x32_bf16 v[136:139], a[88:91], a[4:7], 0
    s_add_u32 m0, s31, 106496
    v_mfma_f32_16x16x32_bf16 v[168:171], a[88:91], a[8:11], 0
    s_add_u32 s29, s27, 0
    ds_read_b128 a[20:23], v4 offset:512
    v_mfma_f32_16x16x32_bf16 v[200:203], a[88:91], a[12:15], 0
    buffer_load_dwordx4 v3, s[8:11], s29 offen lds
    v_mfma_f32_16x16x32_bf16 v[232:235], a[88:91], a[16:19], 0
    s_waitcnt vmcnt(18)
    s_barrier
    v_mfma_f32_16x16x32_bf16 v[236:239], a[92:95], a[16:19], 0
    ds_read_b64_tr_b16 a[88:89], v7 offset:4096
    ds_read_b64_tr_b16 a[90:91], v7 offset:5120
    v_mfma_f32_16x16x32_bf16 v[204:207], a[92:95], a[12:15], 0
    s_add_u32 m0, s31, 107520
    v_mfma_f32_16x16x32_bf16 v[172:175], a[92:95], a[8:11], 0
    s_add_u32 s29, s27, 32768
    ds_read_b128 a[24:27], v4 offset:2560
    v_mfma_f32_16x16x32_bf16 v[140:143], a[92:95], a[4:7], 0
    buffer_load_dwordx4 v3, s[8:11], s29 offen lds
    v_mfma_f32_16x16x32_bf16 v[108:111], a[92:95], a[0:3], 0
    v_mfma_f32_16x16x32_bf16 v[112:115], a[96:99], a[0:3], 0
    ds_read_b64_tr_b16 a[92:93], v8 offset:4096
    ds_read_b64_tr_b16 a[94:95], v8 offset:5120
    v_mfma_f32_16x16x32_bf16 v[144:147], a[96:99], a[4:7], 0
    s_add_u32 m0, s30, 107520
    v_mfma_f32_16x16x32_bf16 v[176:179], a[96:99], a[8:11], 0
    s_add_u32 s29, s26, 16384
    ds_read_b128 a[28:31], v4 offset:4608
    v_mfma_f32_16x16x32_bf16 v[208:211], a[96:99], a[12:15], 0
    buffer_load_dwordx4 v2, s[4:7], s29 offen lds
    v_mfma_f32_16x16x32_bf16 v[240:243], a[96:99], a[16:19], 0
    s_waitcnt lgkmcnt(11)
    v_mfma_f32_16x16x32_bf16 v[244:247], a[100:103], a[16:19], 0
    ds_read_b64_tr_b16 a[96:97], v7 offset:4608
    ds_read_b64_tr_b16 a[98:99], v7 offset:5632
    v_mfma_f32_16x16x32_bf16 v[212:215], a[100:103], a[12:15], 0
    s_add_u32 m0, s31, 108544
    v_mfma_f32_16x16x32_bf16 v[180:183], a[100:103], a[8:11], 0
    s_add_u32 s29, s27, 131072
    ds_read_b128 a[32:35], v4 offset:6656
    v_mfma_f32_16x16x32_bf16 v[148:151], a[100:103], a[4:7], 0
    buffer_load_dwordx4 v3, s[8:11], s29 offen lds
    v_mfma_f32_16x16x32_bf16 v[116:119], a[100:103], a[0:3], 0
    s_waitcnt lgkmcnt(12)
    v_mfma_f32_16x16x32_bf16 v[120:123], a[80:83], a[0:3], 0
    ds_read_b64_tr_b16 a[100:101], v8 offset:4608
    ds_read_b64_tr_b16 a[102:103], v8 offset:5632
    v_mfma_f32_16x16x32_bf16 v[152:155], a[80:83], a[4:7], 0
    s_add_u32 m0, s31, 109568
    v_mfma_f32_16x16x32_bf16 v[184:187], a[80:83], a[8:11], 0
    s_add_u32 s29, s27, 163840
    ds_read_b128 a[36:39], v4 offset:8704
    v_mfma_f32_16x16x32_bf16 v[216:219], a[80:83], a[12:15], 0
    buffer_load_dwordx4 v3, s[8:11], s29 offen lds
    v_mfma_f32_16x16x32_bf16 v[248:251], a[80:83], a[16:19], 0
    s_waitcnt lgkmcnt(13)
    v_mfma_f32_16x16x32_bf16 v[252:255], a[84:87], a[16:19], 0
    ds_read_b64_tr_b16 a[80:81], v7 offset:12288
    ds_read_b64_tr_b16 a[82:83], v7 offset:13312
    v_mfma_f32_16x16x32_bf16 v[220:223], a[84:87], a[12:15], 0
    s_add_u32 m0, s30, 108544
    v_mfma_f32_16x16x32_bf16 v[188:191], a[84:87], a[8:11], 0
    s_add_u32 s29, s26, 32768
    v_mfma_f32_16x16x32_bf16 v[156:159], a[84:87], a[4:7], 0
    buffer_load_dwordx4 v1, s[4:7], s29 offen lds
    v_mfma_f32_16x16x32_bf16 v[124:127], a[84:87], a[0:3], 0
    s_waitcnt lgkmcnt(12)
    v_mfma_f32_16x16x32_bf16 v[96:99], a[88:91], a[20:23], v[96:99]
    s_waitcnt lgkmcnt(11)
    ds_read_b64_tr_b16 a[84:85], v8 offset:12288
    ds_read_b64_tr_b16 a[86:87], v8 offset:13312
    v_mfma_f32_16x16x32_bf16 v[128:131], a[88:91], a[24:27], v[128:131]
    s_waitcnt lgkmcnt(10)
    s_add_u32 m0, s31, 110592
    v_mfma_f32_16x16x32_bf16 v[160:163], a[88:91], a[28:31], v[160:163]
    s_waitcnt lgkmcnt(7)
    s_add_u32 s29, s27, 262144
    v_mfma_f32_16x16x32_bf16 v[192:195], a[88:91], a[32:35], v[192:195]
    s_waitcnt lgkmcnt(4)
    buffer_load_dwordx4 v3, s[8:11], s29 offen lds
    v_mfma_f32_16x16x32_bf16 v[224:227], a[88:91], a[36:39], v[224:227]
    v_mfma_f32_16x16x32_bf16 v[228:231], a[92:95], a[36:39], v[228:231]
    ds_read_b64_tr_b16 a[88:89], v7 offset:12800
    ds_read_b64_tr_b16 a[90:91], v7 offset:13824
    v_mfma_f32_16x16x32_bf16 v[196:199], a[92:95], a[32:35], v[196:199]
    s_add_u32 m0, s30, 109568
    v_mfma_f32_16x16x32_bf16 v[164:167], a[92:95], a[28:31], v[164:167]
    s_add_u32 s29, s26, 49152
    v_mfma_f32_16x16x32_bf16 v[132:135], a[92:95], a[24:27], v[132:135]
    buffer_load_dwordx4 v2, s[4:7], s29 offen lds
    v_mfma_f32_16x16x32_bf16 v[100:103], a[92:95], a[20:23], v[100:103]
    v_mfma_f32_16x16x32_bf16 v[104:107], a[96:99], a[20:23], v[104:107]
    ds_read_b64_tr_b16 a[92:93], v8 offset:12800
    ds_read_b64_tr_b16 a[94:95], v8 offset:13824
    v_mfma_f32_16x16x32_bf16 v[136:139], a[96:99], a[24:27], v[136:139]
    s_add_u32 m0, s31, 111616
    v_mfma_f32_16x16x32_bf16 v[168:171], a[96:99], a[28:31], v[168:171]
    s_add_u32 s29, s27, 294912
    v_mfma_f32_16x16x32_bf16 v[200:203], a[96:99], a[32:35], v[200:203]
    buffer_load_dwordx4 v3, s[8:11], s29 offen lds
    v_mfma_f32_16x16x32_bf16 v[232:235], a[96:99], a[36:39], v[232:235]
    v_mfma_f32_16x16x32_bf16 v[236:239], a[100:103], a[36:39], v[236:239]
    v_mfma_f32_16x16x32_bf16 v[204:207], a[100:103], a[32:35], v[204:207]
    s_add_u32 m0, s31, 112640
    v_mfma_f32_16x16x32_bf16 v[172:175], a[100:103], a[28:31], v[172:175]
    s_add_u32 s29, s27, 393216
    v_mfma_f32_16x16x32_bf16 v[140:143], a[100:103], a[24:27], v[140:143]
    s_waitcnt vmcnt(10) lgkmcnt(0)
    s_barrier
    buffer_load_dwordx4 v3, s[8:11], s29 offen lds
    v_mfma_f32_16x16x32_bf16 v[108:111], a[100:103], a[20:23], v[108:111]
    ds_read_b128 a[40:43], v5
    ds_read_b128 a[60:63], v5 offset:512
    v_mfma_f32_16x16x32_bf16 v[112:115], a[80:83], a[20:23], v[112:115]
    ds_read_b64_tr_b16 a[96:97], v9
    ds_read_b64_tr_b16 a[98:99], v9 offset:1024
    v_mfma_f32_16x16x32_bf16 v[144:147], a[80:83], a[24:27], v[144:147]
    ds_read_b64_tr_b16 a[100:101], v9 offset:4096
    ds_read_b64_tr_b16 a[102:103], v9 offset:5120
    v_mfma_f32_16x16x32_bf16 v[176:179], a[80:83], a[28:31], v[176:179]
    ds_read_b128 a[64:67], v5 offset:2560
    ds_read_b128 a[44:47], v5 offset:2048
    v_mfma_f32_16x16x32_bf16 v[208:211], a[80:83], a[32:35], v[208:211]
    ds_read_b128 a[48:51], v5 offset:4096
    ds_read_b128 a[68:71], v5 offset:4608
    v_mfma_f32_16x16x32_bf16 v[240:243], a[80:83], a[36:39], v[240:243]
    s_add_u32 m0, s30, 110592
    ds_read_b128 a[72:75], v5 offset:6656
    ds_read_b128 a[52:55], v5 offset:6144
    v_mfma_f32_16x16x32_bf16 v[244:247], a[84:87], a[36:39], v[244:247]
    s_add_u32 s29, s26, 65536
    ds_read_b128 a[56:59], v5 offset:8192
    ds_read_b128 a[76:79], v5 offset:8704
    v_mfma_f32_16x16x32_bf16 v[212:215], a[84:87], a[32:35], v[212:215]
    buffer_load_dwordx4 v1, s[4:7], s29 offen lds
    v_mfma_f32_16x16x32_bf16 v[180:183], a[84:87], a[28:31], v[180:183]
    s_add_u32 m0, s31, 113664
    s_add_u32 s29, s27, 425984
    v_mfma_f32_16x16x32_bf16 v[148:151], a[84:87], a[24:27], v[148:151]
    buffer_load_dwordx4 v3, s[8:11], s29 offen lds
    v_mfma_f32_16x16x32_bf16 v[116:119], a[84:87], a[20:23], v[116:119]
    s_add_u32 s28, s25, 1
    s_and_b32 s28, s28, 1
    s_or_b32 s28, s28, 2
    s_lshl_b32 s26, s28, 7
    v_mfma_f32_16x16x32_bf16 v[120:123], a[88:91], a[20:23], v[120:123]
    ds_read_b64_tr_b16 a[84:85], v10 offset:4096
    ds_read_b64_tr_b16 a[86:87], v10 offset:5120
    v_mfma_f32_16x16x32_bf16 v[152:155], a[88:91], a[24:27], v[152:155]
    ds_read_b64_tr_b16 a[80:81], v10
    ds_read_b64_tr_b16 a[82:83], v10 offset:1024
    v_mfma_f32_16x16x32_bf16 v[184:187], a[88:91], a[28:31], v[184:187]
    s_lshl_b32 s27, s28, 19
    s_add_u32 m0, s30, 0
    s_add_u32 s29, s26, 0
    v_mfma_f32_16x16x32_bf16 v[216:219], a[88:91], a[32:35], v[216:219]
    buffer_load_dwordx4 v1, s[4:7], s29 offen lds
    v_mfma_f32_16x16x32_bf16 v[248:251], a[88:91], a[36:39], v[248:251]
    v_mfma_f32_16x16x32_bf16 v[252:255], a[92:95], a[36:39], v[252:255]
    v_mfma_f32_16x16x32_bf16 v[220:223], a[92:95], a[32:35], v[220:223]
    s_add_u32 m0, s31, 0
    v_mfma_f32_16x16x32_bf16 v[188:191], a[92:95], a[28:31], v[188:191]
    s_add_u32 s29, s27, 0
    v_mfma_f32_16x16x32_bf16 v[156:159], a[92:95], a[24:27], v[156:159]
    buffer_load_dwordx4 v3, s[8:11], s29 offen lds
    v_mfma_f32_16x16x32_bf16 v[124:127], a[92:95], a[20:23], v[124:127]
    s_waitcnt lgkmcnt(14)
    s_add_u32 m0, s31, 1024
    v_mfma_f32_16x16x32_bf16 v[96:99], a[96:99], a[40:43], v[96:99]
    s_waitcnt lgkmcnt(12)
    ds_read_b64_tr_b16 a[88:89], v9 offset:512
    ds_read_b64_tr_b16 a[90:91], v9 offset:1536
    v_mfma_f32_16x16x32_bf16 v[96:99], a[100:103], a[60:63], v[96:99]
    s_waitcnt lgkmcnt(13)
    ds_read_b64_tr_b16 a[92:93], v9 offset:4608
    ds_read_b64_tr_b16 a[94:95], v9 offset:5632
    v_mfma_f32_16x16x32_bf16 v[128:131], a[100:103], a[64:67], v[128:131]
    s_waitcnt lgkmcnt(14)
    s_add_u32 s29, s27, 32768
    v_mfma_f32_16x16x32_bf16 v[128:131], a[96:99], a[44:47], v[128:131]
    s_waitcnt lgkmcnt(13)
    buffer_load_dwordx4 v3, s[8:11], s29 offen lds
    v_mfma_f32_16x16x32_bf16 v[160:163], a[96:99], a[48:51], v[160:163]
    s_waitcnt lgkmcnt(12)
    v_mfma_f32_16x16x32_bf16 v[160:163], a[100:103], a[68:71], v[160:163]
    s_waitcnt lgkmcnt(11)
    v_mfma_f32_16x16x32_bf16 v[192:195], a[100:103], a[72:75], v[192:195]
    s_waitcnt lgkmcnt(10)
    s_add_u32 m0, s30, 1024
    v_mfma_f32_16x16x32_bf16 v[192:195], a[96:99], a[52:55], v[192:195]
    s_waitcnt lgkmcnt(9)
    s_add_u32 s29, s26, 16384
    v_mfma_f32_16x16x32_bf16 v[224:227], a[96:99], a[56:59], v[224:227]
    s_waitcnt lgkmcnt(8)
    buffer_load_dwordx4 v2, s[4:7], s29 offen lds
    v_mfma_f32_16x16x32_bf16 v[224:227], a[100:103], a[76:79], v[224:227]
    s_waitcnt lgkmcnt(6)
    s_add_u32 m0, s31, 2048
    v_mfma_f32_16x16x32_bf16 v[228:231], a[84:87], a[76:79], v[228:231]
    s_waitcnt lgkmcnt(4)
    ds_read_b64_tr_b16 a[100:101], v10 offset:4608
    ds_read_b64_tr_b16 a[102:103], v10 offset:5632
    v_mfma_f32_16x16x32_bf16 v[228:231], a[80:83], a[56:59], v[228:231]
    ds_read_b64_tr_b16 a[96:97], v10 offset:512
    ds_read_b64_tr_b16 a[98:99], v10 offset:1536
    v_mfma_f32_16x16x32_bf16 v[196:199], a[80:83], a[52:55], v[196:199]
    s_add_u32 s29, s27, 131072
    v_mfma_f32_16x16x32_bf16 v[196:199], a[84:87], a[72:75], v[196:199]
    buffer_load_dwordx4 v3, s[8:11], s29 offen lds
    v_mfma_f32_16x16x32_bf16 v[164:167], a[84:87], a[68:71], v[164:167]
    v_mfma_f32_16x16x32_bf16 v[164:167], a[80:83], a[48:51], v[164:167]
    v_mfma_f32_16x16x32_bf16 v[132:135], a[80:83], a[44:47], v[132:135]
    s_add_u32 m0, s31, 3072
    v_mfma_f32_16x16x32_bf16 v[132:135], a[84:87], a[64:67], v[132:135]
    s_add_u32 s29, s27, 163840
    v_mfma_f32_16x16x32_bf16 v[100:103], a[84:87], a[60:63], v[100:103]
    buffer_load_dwordx4 v3, s[8:11], s29 offen lds
    v_mfma_f32_16x16x32_bf16 v[100:103], a[80:83], a[40:43], v[100:103]
    s_waitcnt lgkmcnt(6)
    s_add_u32 m0, s30, 2048
    v_mfma_f32_16x16x32_bf16 v[104:107], a[88:91], a[40:43], v[104:107]
    s_waitcnt lgkmcnt(4)
    ds_read_b64_tr_b16 a[80:81], v9 offset:8192
    ds_read_b64_tr_b16 a[82:83], v9 offset:9216
    v_mfma_f32_16x16x32_bf16 v[104:107], a[92:95], a[60:63], v[104:107]
    ds_read_b64_tr_b16 a[84:85], v9 offset:12288
    ds_read_b64_tr_b16 a[86:87], v9 offset:13312
    v_mfma_f32_16x16x32_bf16 v[136:139], a[92:95], a[64:67], v[136:139]
    s_add_u32 s29, s26, 32768
    v_mfma_f32_16x16x32_bf16 v[136:139], a[88:91], a[44:47], v[136:139]
    buffer_load_dwordx4 v1, s[4:7], s29 offen lds
    v_mfma_f32_16x16x32_bf16 v[168:171], a[88:91], a[48:51], v[168:171]
    v_mfma_f32_16x16x32_bf16 v[168:171], a[92:95], a[68:71], v[168:171]
    v_mfma_f32_16x16x32_bf16 v[200:203], a[92:95], a[72:75], v[200:203]
    s_add_u32 m0, s31, 4096
    v_mfma_f32_16x16x32_bf16 v[200:203], a[88:91], a[52:55], v[200:203]
    s_add_u32 s29, s27, 262144
    v_mfma_f32_16x16x32_bf16 v[232:235], a[88:91], a[56:59], v[232:235]
    buffer_load_dwordx4 v3, s[8:11], s29 offen lds
    v_mfma_f32_16x16x32_bf16 v[232:235], a[92:95], a[76:79], v[232:235]
    s_waitcnt lgkmcnt(6)
    s_add_u32 m0, s30, 3072
    v_mfma_f32_16x16x32_bf16 v[236:239], a[100:103], a[76:79], v[236:239]
    s_waitcnt lgkmcnt(4)
    ds_read_b64_tr_b16 a[92:93], v10 offset:12288
    ds_read_b64_tr_b16 a[94:95], v10 offset:13312
    v_mfma_f32_16x16x32_bf16 v[236:239], a[96:99], a[56:59], v[236:239]
    ds_read_b64_tr_b16 a[88:89], v10 offset:8192
    ds_read_b64_tr_b16 a[90:91], v10 offset:9216
    v_mfma_f32_16x16x32_bf16 v[204:207], a[96:99], a[52:55], v[204:207]
    s_add_u32 s29, s26, 49152
    v_mfma_f32_16x16x32_bf16 v[204:207], a[100:103], a[72:75], v[204:207]
    buffer_load_dwordx4 v2, s[4:7], s29 offen lds
    v_mfma_f32_16x16x32_bf16 v[172:175], a[100:103], a[68:71], v[172:175]
    v_mfma_f32_16x16x32_bf16 v[172:175], a[96:99], a[48:51], v[172:175]
    v_mfma_f32_16x16x32_bf16 v[140:143], a[96:99], a[44:47], v[140:143]
    s_add_u32 m0, s31, 5120
    v_mfma_f32_16x16x32_bf16 v[140:143], a[100:103], a[64:67], v[140:143]
    s_add_u32 s29, s27, 294912
    v_mfma_f32_16x16x32_bf16 v[108:111], a[100:103], a[60:63], v[108:111]
    buffer_load_dwordx4 v3, s[8:11], s29 offen lds
    v_mfma_f32_16x16x32_bf16 v[108:111], a[96:99], a[40:43], v[108:111]
    s_waitcnt lgkmcnt(6)
    s_add_u32 m0, s31, 6144
    v_mfma_f32_16x16x32_bf16 v[112:115], a[80:83], a[40:43], v[112:115]
    s_waitcnt lgkmcnt(4)
    ds_read_b64_tr_b16 a[96:97], v9 offset:8704
    ds_read_b64_tr_b16 a[98:99], v9 offset:9728
    v_mfma_f32_16x16x32_bf16 v[112:115], a[84:87], a[60:63], v[112:115]
    ds_read_b64_tr_b16 a[100:101], v9 offset:12800
    ds_read_b64_tr_b16 a[102:103], v9 offset:13824
    v_mfma_f32_16x16x32_bf16 v[144:147], a[84:87], a[64:67], v[144:147]
    s_add_u32 s29, s27, 393216
    v_mfma_f32_16x16x32_bf16 v[144:147], a[80:83], a[44:47], v[144:147]
    buffer_load_dwordx4 v3, s[8:11], s29 offen lds
    v_mfma_f32_16x16x32_bf16 v[176:179], a[80:83], a[48:51], v[176:179]
    v_mfma_f32_16x16x32_bf16 v[176:179], a[84:87], a[68:71], v[176:179]
    v_mfma_f32_16x16x32_bf16 v[208:211], a[84:87], a[72:75], v[208:211]
    v_mfma_f32_16x16x32_bf16 v[208:211], a[80:83], a[52:55], v[208:211]
    s_add_u32 m0, s30, 4096
    v_mfma_f32_16x16x32_bf16 v[240:243], a[80:83], a[56:59], v[240:243]
    s_add_u32 s29, s26, 65536
    v_mfma_f32_16x16x32_bf16 v[240:243], a[84:87], a[76:79], v[240:243]
    s_waitcnt lgkmcnt(6)
    buffer_load_dwordx4 v1, s[4:7], s29 offen lds
    v_mfma_f32_16x16x32_bf16 v[244:247], a[92:95], a[76:79], v[244:247]
    s_waitcnt lgkmcnt(4)
    ds_read_b64_tr_b16 a[84:85], v10 offset:12800
    ds_read_b64_tr_b16 a[86:87], v10 offset:13824
    v_mfma_f32_16x16x32_bf16 v[244:247], a[88:91], a[56:59], v[244:247]
    ds_read_b64_tr_b16 a[80:81], v10 offset:8704
    ds_read_b64_tr_b16 a[82:83], v10 offset:9728
    v_mfma_f32_16x16x32_bf16 v[212:215], a[88:91], a[52:55], v[212:215]
    v_mfma_f32_16x16x32_bf16 v[212:215], a[92:95], a[72:75], v[212:215]
    s_add_u32 m0, s31, 7168
    v_mfma_f32_16x16x32_bf16 v[180:183], a[92:95], a[68:71], v[180:183]
    s_add_u32 s29, s27, 425984
    v_mfma_f32_16x16x32_bf16 v[180:183], a[88:91], a[48:51], v[180:183]
    buffer_load_dwordx4 v3, s[8:11], s29 offen lds
    v_mfma_f32_16x16x32_bf16 v[148:151], a[88:91], a[44:47], v[148:151]
    s_add_u32 s28, s25, 0
    s_and_b32 s28, s28, 1
    s_or_b32 s28, s28, 4
    s_lshl_b32 s26, s28, 7
    v_mfma_f32_16x16x32_bf16 v[148:151], a[92:95], a[64:67], v[148:151]
    s_lshl_b32 s27, s28, 19
    s_add_u32 m0, s30, 53248
    s_add_u32 s29, s26, 0
    v_mfma_f32_16x16x32_bf16 v[116:119], a[92:95], a[60:63], v[116:119]
    s_waitcnt vmcnt(13) lgkmcnt(0)
    s_barrier
    v_mfma_f32_16x16x32_bf16 v[116:119], a[88:91], a[40:43], v[116:119]
    ds_read_b128 a[0:3], v6
    ds_read_b128 a[20:23], v6 offset:512
    v_mfma_f32_16x16x32_bf16 v[120:123], a[96:99], a[40:43], v[120:123]
    ds_read_b64_tr_b16 a[88:89], v11
    ds_read_b64_tr_b16 a[90:91], v11 offset:1024
    v_mfma_f32_16x16x32_bf16 v[120:123], a[100:103], a[60:63], v[120:123]
    ds_read_b64_tr_b16 a[92:93], v11 offset:4096
    ds_read_b64_tr_b16 a[94:95], v11 offset:5120
    v_mfma_f32_16x16x32_bf16 v[152:155], a[100:103], a[64:67], v[152:155]
    ds_read_b128 a[24:27], v6 offset:2560
    ds_read_b128 a[4:7], v6 offset:2048
    v_mfma_f32_16x16x32_bf16 v[152:155], a[96:99], a[44:47], v[152:155]
    ds_read_b128 a[8:11], v6 offset:4096
    ds_read_b128 a[28:31], v6 offset:4608
    v_mfma_f32_16x16x32_bf16 v[184:187], a[96:99], a[48:51], v[184:187]
    ds_read_b128 a[32:35], v6 offset:6656
    ds_read_b128 a[12:15], v6 offset:6144
    v_mfma_f32_16x16x32_bf16 v[184:187], a[100:103], a[68:71], v[184:187]
    ds_read_b128 a[16:19], v6 offset:8192
    ds_read_b128 a[36:39], v6 offset:8704
    v_mfma_f32_16x16x32_bf16 v[216:219], a[100:103], a[72:75], v[216:219]
    buffer_load_dwordx4 v1, s[4:7], s29 offen lds
    v_mfma_f32_16x16x32_bf16 v[216:219], a[96:99], a[52:55], v[216:219]
    v_mfma_f32_16x16x32_bf16 v[248:251], a[96:99], a[56:59], v[248:251]
    s_add_u32 m0, s31, 53248
    v_mfma_f32_16x16x32_bf16 v[248:251], a[100:103], a[76:79], v[248:251]
    s_add_u32 s29, s27, 0
    v_mfma_f32_16x16x32_bf16 v[252:255], a[84:87], a[76:79], v[252:255]
    ds_read_b64_tr_b16 a[100:101], v12 offset:4096
    ds_read_b64_tr_b16 a[102:103], v12 offset:5120
    v_mfma_f32_16x16x32_bf16 v[252:255], a[80:83], a[56:59], v[252:255]
    ds_read_b64_tr_b16 a[96:97], v12
    ds_read_b64_tr_b16 a[98:99], v12 offset:1024
    v_mfma_f32_16x16x32_bf16 v[220:223], a[80:83], a[52:55], v[220:223]
    buffer_load_dwordx4 v3, s[8:11], s29 offen lds
    v_mfma_f32_16x16x32_bf16 v[220:223], a[84:87], a[72:75], v[220:223]
    v_mfma_f32_16x16x32_bf16 v[188:191], a[84:87], a[68:71], v[188:191]
    s_add_u32 m0, s31, 54272
    v_mfma_f32_16x16x32_bf16 v[188:191], a[80:83], a[48:51], v[188:191]
    s_add_u32 s29, s27, 32768
    v_mfma_f32_16x16x32_bf16 v[156:159], a[80:83], a[44:47], v[156:159]
    buffer_load_dwordx4 v3, s[8:11], s29 offen lds
    v_mfma_f32_16x16x32_bf16 v[156:159], a[84:87], a[64:67], v[156:159]
    v_mfma_f32_16x16x32_bf16 v[124:127], a[84:87], a[60:63], v[124:127]
    s_add_u32 m0, s30, 54272
    v_mfma_f32_16x16x32_bf16 v[124:127], a[80:83], a[40:43], v[124:127]
    s_waitcnt lgkmcnt(14)
    s_add_u32 s29, s26, 16384
    v_mfma_f32_16x16x32_bf16 v[96:99], a[88:91], a[0:3], v[96:99]
    s_waitcnt lgkmcnt(12)
    ds_read_b64_tr_b16 a[80:81], v11 offset:512
    ds_read_b64_tr_b16 a[82:83], v11 offset:1536
    v_mfma_f32_16x16x32_bf16 v[96:99], a[92:95], a[20:23], v[96:99]
    s_waitcnt lgkmcnt(13)
    ds_read_b64_tr_b16 a[84:85], v11 offset:4608
    ds_read_b64_tr_b16 a[86:87], v11 offset:5632
    v_mfma_f32_16x16x32_bf16 v[128:131], a[92:95], a[24:27], v[128:131]
    s_waitcnt lgkmcnt(14)
    buffer_load_dwordx4 v2, s[4:7], s29 offen lds
    v_mfma_f32_16x16x32_bf16 v[128:131], a[88:91], a[4:7], v[128:131]
    s_waitcnt lgkmcnt(13)
    v_mfma_f32_16x16x32_bf16 v[160:163], a[88:91], a[8:11], v[160:163]
    s_waitcnt lgkmcnt(12)
    s_add_u32 m0, s31, 55296
    v_mfma_f32_16x16x32_bf16 v[160:163], a[92:95], a[28:31], v[160:163]
    s_waitcnt lgkmcnt(11)
    s_add_u32 s29, s27, 131072
    v_mfma_f32_16x16x32_bf16 v[192:195], a[92:95], a[32:35], v[192:195]
    s_waitcnt lgkmcnt(10)
    buffer_load_dwordx4 v3, s[8:11], s29 offen lds
    v_mfma_f32_16x16x32_bf16 v[192:195], a[88:91], a[12:15], v[192:195]
    s_waitcnt lgkmcnt(9)
    v_mfma_f32_16x16x32_bf16 v[224:227], a[88:91], a[16:19], v[224:227]
    s_waitcnt lgkmcnt(8)
    s_add_u32 m0, s31, 56320
    v_mfma_f32_16x16x32_bf16 v[224:227], a[92:95], a[36:39], v[224:227]
    s_waitcnt lgkmcnt(6)
    s_add_u32 s29, s27, 163840
    v_mfma_f32_16x16x32_bf16 v[228:231], a[100:103], a[36:39], v[228:231]
    s_waitcnt lgkmcnt(4)
    ds_read_b64_tr_b16 a[92:93], v12 offset:4608
    ds_read_b64_tr_b16 a[94:95], v12 offset:5632
    v_mfma_f32_16x16x32_bf16 v[228:231], a[96:99], a[16:19], v[228:231]
    ds_read_b64_tr_b16 a[88:89], v12 offset:512
    ds_read_b64_tr_b16 a[90:91], v12 offset:1536
    v_mfma_f32_16x16x32_bf16 v[196:199], a[96:99], a[12:15], v[196:199]
    buffer_load_dwordx4 v3, s[8:11], s29 offen lds
    v_mfma_f32_16x16x32_bf16 v[196:199], a[100:103], a[32:35], v[196:199]
    v_mfma_f32_16x16x32_bf16 v[164:167], a[100:103], a[28:31], v[164:167]
    s_add_u32 m0, s30, 55296
    v_mfma_f32_16x16x32_bf16 v[164:167], a[96:99], a[8:11], v[164:167]
    s_add_u32 s29, s26, 32768
    v_mfma_f32_16x16x32_bf16 v[132:135], a[96:99], a[4:7], v[132:135]
    buffer_load_dwordx4 v1, s[4:7], s29 offen lds
    v_mfma_f32_16x16x32_bf16 v[132:135], a[100:103], a[24:27], v[132:135]
    v_mfma_f32_16x16x32_bf16 v[100:103], a[100:103], a[20:23], v[100:103]
    s_add_u32 m0, s31, 57344
    v_mfma_f32_16x16x32_bf16 v[100:103], a[96:99], a[0:3], v[100:103]
    s_waitcnt lgkmcnt(6)
    s_add_u32 s29, s27, 262144
    v_mfma_f32_16x16x32_bf16 v[104:107], a[80:83], a[0:3], v[104:107]
    s_waitcnt lgkmcnt(4)
    ds_read_b64_tr_b16 a[96:97], v11 offset:8192
    ds_read_b64_tr_b16 a[98:99], v11 offset:9216
    v_mfma_f32_16x16x32_bf16 v[104:107], a[84:87], a[20:23], v[104:107]
    ds_read_b64_tr_b16 a[100:101], v11 offset:12288
    ds_read_b64_tr_b16 a[102:103], v11 offset:13312
    v_mfma_f32_16x16x32_bf16 v[136:139], a[84:87], a[24:27], v[136:139]
    buffer_load_dwordx4 v3, s[8:11], s29 offen lds
    v_mfma_f32_16x16x32_bf16 v[136:139], a[80:83], a[4:7], v[136:139]
    v_mfma_f32_16x16x32_bf16 v[168:171], a[80:83], a[8:11], v[168:171]
    s_add_u32 m0, s30, 56320
    v_mfma_f32_16x16x32_bf16 v[168:171], a[84:87], a[28:31], v[168:171]
    s_add_u32 s29, s26, 49152
    v_mfma_f32_16x16x32_bf16 v[200:203], a[84:87], a[32:35], v[200:203]
    buffer_load_dwordx4 v2, s[4:7], s29 offen lds
    v_mfma_f32_16x16x32_bf16 v[200:203], a[80:83], a[12:15], v[200:203]
    v_mfma_f32_16x16x32_bf16 v[232:235], a[80:83], a[16:19], v[232:235]
    s_add_u32 m0, s31, 58368
    v_mfma_f32_16x16x32_bf16 v[232:235], a[84:87], a[36:39], v[232:235]
    s_waitcnt lgkmcnt(6)
    s_add_u32 s29, s27, 294912
    v_mfma_f32_16x16x32_bf16 v[236:239], a[92:95], a[36:39], v[236:239]
    s_waitcnt lgkmcnt(4)
    ds_read_b64_tr_b16 a[84:85], v12 offset:12288
    ds_read_b64_tr_b16 a[86:87], v12 offset:13312
    v_mfma_f32_16x16x32_bf16 v[236:239], a[88:91], a[16:19], v[236:239]
    ds_read_b64_tr_b16 a[80:81], v12 offset:8192
    ds_read_b64_tr_b16 a[82:83], v12 offset:9216
    v_mfma_f32_16x16x32_bf16 v[204:207], a[88:91], a[12:15], v[204:207]
    buffer_load_dwordx4 v3, s[8:11], s29 offen lds
    v_mfma_f32_16x16x32_bf16 v[204:207], a[92:95], a[32:35], v[204:207]
    v_mfma_f32_16x16x32_bf16 v[172:175], a[92:95], a[28:31], v[172:175]
    s_add_u32 m0, s31, 59392
    v_mfma_f32_16x16x32_bf16 v[172:175], a[88:91], a[8:11], v[172:175]
    s_add_u32 s29, s27, 393216
    v_mfma_f32_16x16x32_bf16 v[140:143], a[88:91], a[4:7], v[140:143]
    buffer_load_dwordx4 v3, s[8:11], s29 offen lds
    v_mfma_f32_16x16x32_bf16 v[140:143], a[92:95], a[24:27], v[140:143]
    v_mfma_f32_16x16x32_bf16 v[108:111], a[92:95], a[20:23], v[108:111]
    s_add_u32 m0, s30, 57344
    v_mfma_f32_16x16x32_bf16 v[108:111], a[88:91], a[0:3], v[108:111]
    s_waitcnt lgkmcnt(6)
    s_add_u32 s29, s26, 65536
    v_mfma_f32_16x16x32_bf16 v[112:115], a[96:99], a[0:3], v[112:115]
    s_waitcnt lgkmcnt(4)
    ds_read_b64_tr_b16 a[88:89], v11 offset:8704
    ds_read_b64_tr_b16 a[90:91], v11 offset:9728
    v_mfma_f32_16x16x32_bf16 v[112:115], a[100:103], a[20:23], v[112:115]
    ds_read_b64_tr_b16 a[92:93], v11 offset:12800
    ds_read_b64_tr_b16 a[94:95], v11 offset:13824
    v_mfma_f32_16x16x32_bf16 v[144:147], a[100:103], a[24:27], v[144:147]
    buffer_load_dwordx4 v1, s[4:7], s29 offen lds
    v_mfma_f32_16x16x32_bf16 v[144:147], a[96:99], a[4:7], v[144:147]
    v_mfma_f32_16x16x32_bf16 v[176:179], a[96:99], a[8:11], v[176:179]
    s_add_u32 m0, s31, 60416
    v_mfma_f32_16x16x32_bf16 v[176:179], a[100:103], a[28:31], v[176:179]
    s_add_u32 s29, s27, 425984
    v_mfma_f32_16x16x32_bf16 v[208:211], a[100:103], a[32:35], v[208:211]
    buffer_load_dwordx4 v3, s[8:11], s29 offen lds
    v_mfma_f32_16x16x32_bf16 v[208:211], a[96:99], a[12:15], v[208:211]
    v_mfma_f32_16x16x32_bf16 v[240:243], a[96:99], a[16:19], v[240:243]
    v_mfma_f32_16x16x32_bf16 v[240:243], a[100:103], a[36:39], v[240:243]
    s_waitcnt lgkmcnt(6)
    v_mfma_f32_16x16x32_bf16 v[244:247], a[84:87], a[36:39], v[244:247]
    s_waitcnt lgkmcnt(4)
    ds_read_b64_tr_b16 a[100:101], v12 offset:12800
    ds_read_b64_tr_b16 a[102:103], v12 offset:13824
    v_mfma_f32_16x16x32_bf16 v[244:247], a[80:83], a[16:19], v[244:247]
    ds_read_b64_tr_b16 a[96:97], v12 offset:8704
    ds_read_b64_tr_b16 a[98:99], v12 offset:9728
    v_mfma_f32_16x16x32_bf16 v[212:215], a[80:83], a[12:15], v[212:215]
    v_mfma_f32_16x16x32_bf16 v[212:215], a[84:87], a[32:35], v[212:215]
    v_mfma_f32_16x16x32_bf16 v[180:183], a[84:87], a[28:31], v[180:183]
    v_mfma_f32_16x16x32_bf16 v[180:183], a[80:83], a[8:11], v[180:183]
    s_add_u32 s28, s25, 1
    s_and_b32 s28, s28, 1
    s_or_b32 s28, s28, 4
    v_mfma_f32_16x16x32_bf16 v[148:151], a[80:83], a[4:7], v[148:151]
    s_lshl_b32 s26, s28, 7
    s_lshl_b32 s27, s28, 19
    v_mfma_f32_16x16x32_bf16 v[148:151], a[84:87], a[24:27], v[148:151]
    s_add_u32 m0, s30, 106496
    s_add_u32 s29, s26, 0
    v_mfma_f32_16x16x32_bf16 v[116:119], a[84:87], a[20:23], v[116:119]
    s_waitcnt vmcnt(13) lgkmcnt(0)
    s_barrier
    v_mfma_f32_16x16x32_bf16 v[116:119], a[80:83], a[0:3], v[116:119]
    ds_read_b128 a[40:43], v4
    ds_read_b128 a[60:63], v4 offset:512
    v_mfma_f32_16x16x32_bf16 v[120:123], a[88:91], a[0:3], v[120:123]
    ds_read_b64_tr_b16 a[80:81], v7
    ds_read_b64_tr_b16 a[82:83], v7 offset:1024
    v_mfma_f32_16x16x32_bf16 v[120:123], a[92:95], a[20:23], v[120:123]
    ds_read_b64_tr_b16 a[84:85], v7 offset:4096
    ds_read_b64_tr_b16 a[86:87], v7 offset:5120
    v_mfma_f32_16x16x32_bf16 v[152:155], a[92:95], a[24:27], v[152:155]
    ds_read_b128 a[64:67], v4 offset:2560
    ds_read_b128 a[44:47], v4 offset:2048
    v_mfma_f32_16x16x32_bf16 v[152:155], a[88:91], a[4:7], v[152:155]
    ds_read_b128 a[48:51], v4 offset:4096
    ds_read_b128 a[68:71], v4 offset:4608
    v_mfma_f32_16x16x32_bf16 v[184:187], a[88:91], a[8:11], v[184:187]
    ds_read_b128 a[72:75], v4 offset:6656
    ds_read_b128 a[52:55], v4 offset:6144
    v_mfma_f32_16x16x32_bf16 v[184:187], a[92:95], a[28:31], v[184:187]
    ds_read_b128 a[56:59], v4 offset:8192
    ds_read_b128 a[76:79], v4 offset:8704
    v_mfma_f32_16x16x32_bf16 v[216:219], a[92:95], a[32:35], v[216:219]
    buffer_load_dwordx4 v1, s[4:7], s29 offen lds
    v_mfma_f32_16x16x32_bf16 v[216:219], a[88:91], a[12:15], v[216:219]
    v_mfma_f32_16x16x32_bf16 v[248:251], a[88:91], a[16:19], v[248:251]
    s_add_u32 m0, s31, 106496
    v_mfma_f32_16x16x32_bf16 v[248:251], a[92:95], a[36:39], v[248:251]
    s_add_u32 s29, s27, 0
    v_mfma_f32_16x16x32_bf16 v[252:255], a[100:103], a[36:39], v[252:255]
    ds_read_b64_tr_b16 a[92:93], v8 offset:4096
    ds_read_b64_tr_b16 a[94:95], v8 offset:5120
    v_mfma_f32_16x16x32_bf16 v[252:255], a[96:99], a[16:19], v[252:255]
    ds_read_b64_tr_b16 a[88:89], v8
    ds_read_b64_tr_b16 a[90:91], v8 offset:1024
    v_mfma_f32_16x16x32_bf16 v[220:223], a[96:99], a[12:15], v[220:223]
    buffer_load_dwordx4 v3, s[8:11], s29 offen lds
    v_mfma_f32_16x16x32_bf16 v[220:223], a[100:103], a[32:35], v[220:223]
    v_mfma_f32_16x16x32_bf16 v[188:191], a[100:103], a[28:31], v[188:191]
    s_add_u32 m0, s31, 107520
    v_mfma_f32_16x16x32_bf16 v[188:191], a[96:99], a[8:11], v[188:191]
    s_add_u32 s29, s27, 32768
    v_mfma_f32_16x16x32_bf16 v[156:159], a[96:99], a[4:7], v[156:159]
    buffer_load_dwordx4 v3, s[8:11], s29 offen lds
    v_mfma_f32_16x16x32_bf16 v[156:159], a[100:103], a[24:27], v[156:159]
    v_mfma_f32_16x16x32_bf16 v[124:127], a[100:103], a[20:23], v[124:127]
    s_add_u32 m0, s30, 107520
    v_mfma_f32_16x16x32_bf16 v[124:127], a[96:99], a[0:3], v[124:127]
    s_waitcnt lgkmcnt(14)
    s_add_u32 s29, s26, 16384
    v_mfma_f32_16x16x32_bf16 v[96:99], a[80:83], a[40:43], v[96:99]
    s_waitcnt lgkmcnt(12)
    ds_read_b64_tr_b16 a[96:97], v7 offset:512
    ds_read_b64_tr_b16 a[98:99], v7 offset:1536
    v_mfma_f32_16x16x32_bf16 v[96:99], a[84:87], a[60:63], v[96:99]
    s_waitcnt lgkmcnt(13)
    ds_read_b64_tr_b16 a[100:101], v7 offset:4608
    ds_read_b64_tr_b16 a[102:103], v7 offset:5632
    v_mfma_f32_16x16x32_bf16 v[128:131], a[84:87], a[64:67], v[128:131]
    s_waitcnt lgkmcnt(14)
    buffer_load_dwordx4 v2, s[4:7], s29 offen lds
    v_mfma_f32_16x16x32_bf16 v[128:131], a[80:83], a[44:47], v[128:131]
    s_waitcnt lgkmcnt(13)
    v_mfma_f32_16x16x32_bf16 v[160:163], a[80:83], a[48:51], v[160:163]
    s_waitcnt lgkmcnt(12)
    s_add_u32 m0, s31, 108544
    v_mfma_f32_16x16x32_bf16 v[160:163], a[84:87], a[68:71], v[160:163]
    s_waitcnt lgkmcnt(11)
    s_add_u32 s29, s27, 131072
    v_mfma_f32_16x16x32_bf16 v[192:195], a[84:87], a[72:75], v[192:195]
    s_waitcnt lgkmcnt(10)
    buffer_load_dwordx4 v3, s[8:11], s29 offen lds
    v_mfma_f32_16x16x32_bf16 v[192:195], a[80:83], a[52:55], v[192:195]
    s_waitcnt lgkmcnt(9)
    v_mfma_f32_16x16x32_bf16 v[224:227], a[80:83], a[56:59], v[224:227]
    s_waitcnt lgkmcnt(8)
    s_add_u32 m0, s31, 109568
    v_mfma_f32_16x16x32_bf16 v[224:227], a[84:87], a[76:79], v[224:227]
    s_waitcnt lgkmcnt(6)
    s_add_u32 s29, s27, 163840
    v_mfma_f32_16x16x32_bf16 v[228:231], a[92:95], a[76:79], v[228:231]
    s_waitcnt lgkmcnt(4)
    ds_read_b64_tr_b16 a[84:85], v8 offset:4608
    ds_read_b64_tr_b16 a[86:87], v8 offset:5632
    v_mfma_f32_16x16x32_bf16 v[228:231], a[88:91], a[56:59], v[228:231]
    ds_read_b64_tr_b16 a[80:81], v8 offset:512
    ds_read_b64_tr_b16 a[82:83], v8 offset:1536
    v_mfma_f32_16x16x32_bf16 v[196:199], a[88:91], a[52:55], v[196:199]
    buffer_load_dwordx4 v3, s[8:11], s29 offen lds
    v_mfma_f32_16x16x32_bf16 v[196:199], a[92:95], a[72:75], v[196:199]
    v_mfma_f32_16x16x32_bf16 v[164:167], a[92:95], a[68:71], v[164:167]
    s_add_u32 m0, s30, 108544
    v_mfma_f32_16x16x32_bf16 v[164:167], a[88:91], a[48:51], v[164:167]
    s_add_u32 s29, s26, 32768
    v_mfma_f32_16x16x32_bf16 v[132:135], a[88:91], a[44:47], v[132:135]
    buffer_load_dwordx4 v1, s[4:7], s29 offen lds
    v_mfma_f32_16x16x32_bf16 v[132:135], a[92:95], a[64:67], v[132:135]
    v_mfma_f32_16x16x32_bf16 v[100:103], a[92:95], a[60:63], v[100:103]
    s_add_u32 m0, s31, 110592
    v_mfma_f32_16x16x32_bf16 v[100:103], a[88:91], a[40:43], v[100:103]
    s_waitcnt lgkmcnt(6)
    s_add_u32 s29, s27, 262144
    v_mfma_f32_16x16x32_bf16 v[104:107], a[96:99], a[40:43], v[104:107]
    s_waitcnt lgkmcnt(4)
    ds_read_b64_tr_b16 a[88:89], v7 offset:8192
    ds_read_b64_tr_b16 a[90:91], v7 offset:9216
    v_mfma_f32_16x16x32_bf16 v[104:107], a[100:103], a[60:63], v[104:107]
    ds_read_b64_tr_b16 a[92:93], v7 offset:12288
    ds_read_b64_tr_b16 a[94:95], v7 offset:13312
    v_mfma_f32_16x16x32_bf16 v[136:139], a[100:103], a[64:67], v[136:139]
    buffer_load_dwordx4 v3, s[8:11], s29 offen lds
    v_mfma_f32_16x16x32_bf16 v[136:139], a[96:99], a[44:47], v[136:139]
    v_mfma_f32_16x16x32_bf16 v[168:171], a[96:99], a[48:51], v[168:171]
    v_mfma_f32_16x16x32_bf16 v[168:171], a[100:103], a[68:71], v[168:171]
    s_add_u32 m0, s30, 109568
    v_mfma_f32_16x16x32_bf16 v[200:203], a[100:103], a[72:75], v[200:203]
    s_add_u32 s29, s26, 49152
    v_mfma_f32_16x16x32_bf16 v[200:203], a[96:99], a[52:55], v[200:203]
    buffer_load_dwordx4 v2, s[4:7], s29 offen lds
    v_mfma_f32_16x16x32_bf16 v[232:235], a[96:99], a[56:59], v[232:235]
    v_mfma_f32_16x16x32_bf16 v[232:235], a[100:103], a[76:79], v[232:235]
    s_waitcnt lgkmcnt(6)
    s_add_u32 m0, s31, 111616
    v_mfma_f32_16x16x32_bf16 v[236:239], a[84:87], a[76:79], v[236:239]
    s_waitcnt lgkmcnt(4)
    ds_read_b64_tr_b16 a[100:101], v8 offset:12288
    ds_read_b64_tr_b16 a[102:103], v8 offset:13312
    v_mfma_f32_16x16x32_bf16 v[236:239], a[80:83], a[56:59], v[236:239]
    ds_read_b64_tr_b16 a[96:97], v8 offset:8192
    ds_read_b64_tr_b16 a[98:99], v8 offset:9216
    v_mfma_f32_16x16x32_bf16 v[204:207], a[80:83], a[52:55], v[204:207]
    s_add_u32 s29, s27, 294912
    v_mfma_f32_16x16x32_bf16 v[204:207], a[84:87], a[72:75], v[204:207]
    buffer_load_dwordx4 v3, s[8:11], s29 offen lds
    v_mfma_f32_16x16x32_bf16 v[172:175], a[84:87], a[68:71], v[172:175]
    v_mfma_f32_16x16x32_bf16 v[172:175], a[80:83], a[48:51], v[172:175]
    v_mfma_f32_16x16x32_bf16 v[140:143], a[80:83], a[44:47], v[140:143]
    v_mfma_f32_16x16x32_bf16 v[140:143], a[84:87], a[64:67], v[140:143]
    s_add_u32 m0, s31, 112640
    v_mfma_f32_16x16x32_bf16 v[108:111], a[84:87], a[60:63], v[108:111]
    s_add_u32 s29, s27, 393216
    v_mfma_f32_16x16x32_bf16 v[108:111], a[80:83], a[40:43], v[108:111]
    s_waitcnt lgkmcnt(6)
    buffer_load_dwordx4 v3, s[8:11], s29 offen lds
    v_mfma_f32_16x16x32_bf16 v[112:115], a[88:91], a[40:43], v[112:115]
    s_waitcnt lgkmcnt(4)
    ds_read_b64_tr_b16 a[80:81], v7 offset:8704
    ds_read_b64_tr_b16 a[82:83], v7 offset:9728
    v_mfma_f32_16x16x32_bf16 v[112:115], a[92:95], a[60:63], v[112:115]
    ds_read_b64_tr_b16 a[84:85], v7 offset:12800
    ds_read_b64_tr_b16 a[86:87], v7 offset:13824
    v_mfma_f32_16x16x32_bf16 v[144:147], a[92:95], a[64:67], v[144:147]
    v_mfma_f32_16x16x32_bf16 v[144:147], a[88:91], a[44:47], v[144:147]
    s_add_u32 m0, s30, 110592
    v_mfma_f32_16x16x32_bf16 v[176:179], a[88:91], a[48:51], v[176:179]
    s_add_u32 s29, s26, 65536
    v_mfma_f32_16x16x32_bf16 v[176:179], a[92:95], a[68:71], v[176:179]
    buffer_load_dwordx4 v1, s[4:7], s29 offen lds
    v_mfma_f32_16x16x32_bf16 v[208:211], a[92:95], a[72:75], v[208:211]
    v_mfma_f32_16x16x32_bf16 v[208:211], a[88:91], a[52:55], v[208:211]
    v_mfma_f32_16x16x32_bf16 v[240:243], a[88:91], a[56:59], v[240:243]
    s_add_u32 m0, s31, 113664
    v_mfma_f32_16x16x32_bf16 v[240:243], a[92:95], a[76:79], v[240:243]
    s_waitcnt lgkmcnt(6)
    s_add_u32 s29, s27, 425984
    v_mfma_f32_16x16x32_bf16 v[244:247], a[100:103], a[76:79], v[244:247]
    s_waitcnt lgkmcnt(4)
    ds_read_b64_tr_b16 a[92:93], v8 offset:12800
    ds_read_b64_tr_b16 a[94:95], v8 offset:13824
    v_mfma_f32_16x16x32_bf16 v[244:247], a[96:99], a[56:59], v[244:247]
    ds_read_b64_tr_b16 a[88:89], v8 offset:8704
    ds_read_b64_tr_b16 a[90:91], v8 offset:9728
    v_mfma_f32_16x16x32_bf16 v[212:215], a[96:99], a[52:55], v[212:215]
    buffer_load_dwordx4 v3, s[8:11], s29 offen lds
    v_mfma_f32_16x16x32_bf16 v[212:215], a[100:103], a[72:75], v[212:215]
    v_mfma_f32_16x16x32_bf16 v[180:183], a[100:103], a[68:71], v[180:183]
    v_mfma_f32_16x16x32_bf16 v[180:183], a[96:99], a[48:51], v[180:183]
    s_add_u32 s28, s25, 0
    s_and_b32 s28, s28, 1
    s_or_b32 s28, s28, 6
    v_mfma_f32_16x16x32_bf16 v[148:151], a[96:99], a[44:47], v[148:151]
    s_lshl_b32 s26, s28, 7
    s_lshl_b32 s27, s28, 19
    v_mfma_f32_16x16x32_bf16 v[148:151], a[100:103], a[64:67], v[148:151]
    s_add_u32 m0, s30, 0
    s_add_u32 s29, s26, 0
    v_mfma_f32_16x16x32_bf16 v[116:119], a[100:103], a[60:63], v[116:119]
    s_waitcnt vmcnt(13) lgkmcnt(0)
    s_barrier
    v_mfma_f32_16x16x32_bf16 v[116:119], a[96:99], a[40:43], v[116:119]
    ds_read_b128 a[0:3], v5
    ds_read_b128 a[20:23], v5 offset:512
    v_mfma_f32_16x16x32_bf16 v[120:123], a[80:83], a[40:43], v[120:123]
    ds_read_b64_tr_b16 a[96:97], v9
    ds_read_b64_tr_b16 a[98:99], v9 offset:1024
    v_mfma_f32_16x16x32_bf16 v[120:123], a[84:87], a[60:63], v[120:123]
    ds_read_b64_tr_b16 a[100:101], v9 offset:4096
    ds_read_b64_tr_b16 a[102:103], v9 offset:5120
    v_mfma_f32_16x16x32_bf16 v[152:155], a[84:87], a[64:67], v[152:155]
    ds_read_b128 a[24:27], v5 offset:2560
    ds_read_b128 a[4:7], v5 offset:2048
    v_mfma_f32_16x16x32_bf16 v[152:155], a[80:83], a[44:47], v[152:155]
    ds_read_b128 a[8:11], v5 offset:4096
    ds_read_b128 a[28:31], v5 offset:4608
    v_mfma_f32_16x16x32_bf16 v[184:187], a[80:83], a[48:51], v[184:187]
    ds_read_b128 a[32:35], v5 offset:6656
    ds_read_b128 a[12:15], v5 offset:6144
    v_mfma_f32_16x16x32_bf16 v[184:187], a[84:87], a[68:71], v[184:187]
    ds_read_b128 a[16:19], v5 offset:8192
    ds_read_b128 a[36:39], v5 offset:8704
    v_mfma_f32_16x16x32_bf16 v[216:219], a[84:87], a[72:75], v[216:219]
    buffer_load_dwordx4 v1, s[4:7], s29 offen lds
    v_mfma_f32_16x16x32_bf16 v[216:219], a[80:83], a[52:55], v[216:219]
    v_mfma_f32_16x16x32_bf16 v[248:251], a[80:83], a[56:59], v[248:251]
    s_add_u32 m0, s31, 0
    v_mfma_f32_16x16x32_bf16 v[248:251], a[84:87], a[76:79], v[248:251]
    s_add_u32 s29, s27, 0
    v_mfma_f32_16x16x32_bf16 v[252:255], a[92:95], a[76:79], v[252:255]
    ds_read_b64_tr_b16 a[84:85], v10 offset:4096
    ds_read_b64_tr_b16 a[86:87], v10 offset:5120
    v_mfma_f32_16x16x32_bf16 v[252:255], a[88:91], a[56:59], v[252:255]
    ds_read_b64_tr_b16 a[80:81], v10
    ds_read_b64_tr_b16 a[82:83], v10 offset:1024
    v_mfma_f32_16x16x32_bf16 v[220:223], a[88:91], a[52:55], v[220:223]
    buffer_load_dwordx4 v3, s[8:11], s29 offen lds
    v_mfma_f32_16x16x32_bf16 v[220:223], a[92:95], a[72:75], v[220:223]
    v_mfma_f32_16x16x32_bf16 v[188:191], a[92:95], a[68:71], v[188:191]
    s_add_u32 m0, s31, 1024
    v_mfma_f32_16x16x32_bf16 v[188:191], a[88:91], a[48:51], v[188:191]
    s_add_u32 s29, s27, 32768
    v_mfma_f32_16x16x32_bf16 v[156:159], a[88:91], a[44:47], v[156:159]
    buffer_load_dwordx4 v3, s[8:11], s29 offen lds
    v_mfma_f32_16x16x32_bf16 v[156:159], a[92:95], a[64:67], v[156:159]
    v_mfma_f32_16x16x32_bf16 v[124:127], a[92:95], a[60:63], v[124:127]
    s_add_u32 m0, s30, 1024
    v_mfma_f32_16x16x32_bf16 v[124:127], a[88:91], a[40:43], v[124:127]
    s_waitcnt lgkmcnt(14)
    s_add_u32 s29, s26, 16384
    v_mfma_f32_16x16x32_bf16 v[96:99], a[96:99], a[0:3], v[96:99]
    s_waitcnt lgkmcnt(12)
    ds_read_b64_tr_b16 a[88:89], v9 offset:512
    ds_read_b64_tr_b16 a[90:91], v9 offset:1536
    v_mfma_f32_16x16x32_bf16 v[96:99], a[100:103], a[20:23], v[96:99]
    s_waitcnt lgkmcnt(13)
    ds_read_b64_tr_b16 a[92:93], v9 offset:4608
    ds_read_b64_tr_b16 a[94:95], v9 offset:5632
    v_mfma_f32_16x16x32_bf16 v[128:131], a[100:103], a[24:27], v[128:131]
    s_waitcnt lgkmcnt(14)
    buffer_load_dwordx4 v2, s[4:7], s29 offen lds
    v_mfma_f32_16x16x32_bf16 v[128:131], a[96:99], a[4:7], v[128:131]
    s_waitcnt lgkmcnt(13)
    v_mfma_f32_16x16x32_bf16 v[160:163], a[96:99], a[8:11], v[160:163]
    s_waitcnt lgkmcnt(12)
    s_add_u32 m0, s31, 2048
    v_mfma_f32_16x16x32_bf16 v[160:163], a[100:103], a[28:31], v[160:163]
    s_waitcnt lgkmcnt(11)
    s_add_u32 s29, s27, 131072
    v_mfma_f32_16x16x32_bf16 v[192:195], a[100:103], a[32:35], v[192:195]
    s_waitcnt lgkmcnt(10)
    buffer_load_dwordx4 v3, s[8:11], s29 offen lds
    v_mfma_f32_16x16x32_bf16 v[192:195], a[96:99], a[12:15], v[192:195]
    s_waitcnt lgkmcnt(9)
    v_mfma_f32_16x16x32_bf16 v[224:227], a[96:99], a[16:19], v[224:227]
    s_waitcnt lgkmcnt(8)
    s_add_u32 m0, s31, 3072
    v_mfma_f32_16x16x32_bf16 v[224:227], a[100:103], a[36:39], v[224:227]
    s_waitcnt lgkmcnt(6)
    s_add_u32 s29, s27, 163840
    v_mfma_f32_16x16x32_bf16 v[228:231], a[84:87], a[36:39], v[228:231]
    s_waitcnt lgkmcnt(4)
    ds_read_b64_tr_b16 a[100:101], v10 offset:4608
    ds_read_b64_tr_b16 a[102:103], v10 offset:5632
    v_mfma_f32_16x16x32_bf16 v[228:231], a[80:83], a[16:19], v[228:231]
    ds_read_b64_tr_b16 a[96:97], v10 offset:512
    ds_read_b64_tr_b16 a[98:99], v10 offset:1536
    v_mfma_f32_16x16x32_bf16 v[196:199], a[80:83], a[12:15], v[196:199]
    buffer_load_dwordx4 v3, s[8:11], s29 offen lds
    v_mfma_f32_16x16x32_bf16 v[196:199], a[84:87], a[32:35], v[196:199]
    v_mfma_f32_16x16x32_bf16 v[164:167], a[84:87], a[28:31], v[164:167]
    s_add_u32 m0, s30, 2048
    v_mfma_f32_16x16x32_bf16 v[164:167], a[80:83], a[8:11], v[164:167]
    s_add_u32 s29, s26, 32768
    v_mfma_f32_16x16x32_bf16 v[132:135], a[80:83], a[4:7], v[132:135]
    buffer_load_dwordx4 v1, s[4:7], s29 offen lds
    v_mfma_f32_16x16x32_bf16 v[132:135], a[84:87], a[24:27], v[132:135]
    v_mfma_f32_16x16x32_bf16 v[100:103], a[84:87], a[20:23], v[100:103]
    s_add_u32 m0, s31, 4096
    v_mfma_f32_16x16x32_bf16 v[100:103], a[80:83], a[0:3], v[100:103]
    s_waitcnt lgkmcnt(6)
    s_add_u32 s29, s27, 262144
    v_mfma_f32_16x16x32_bf16 v[104:107], a[88:91], a[0:3], v[104:107]
    s_waitcnt lgkmcnt(4)
    ds_read_b64_tr_b16 a[80:81], v9 offset:8192
    ds_read_b64_tr_b16 a[82:83], v9 offset:9216
    v_mfma_f32_16x16x32_bf16 v[104:107], a[92:95], a[20:23], v[104:107]
    ds_read_b64_tr_b16 a[84:85], v9 offset:12288
    ds_read_b64_tr_b16 a[86:87], v9 offset:13312
    v_mfma_f32_16x16x32_bf16 v[136:139], a[92:95], a[24:27], v[136:139]
    buffer_load_dwordx4 v3, s[8:11], s29 offen lds
    v_mfma_f32_16x16x32_bf16 v[136:139], a[88:91], a[4:7], v[136:139]
    v_mfma_f32_16x16x32_bf16 v[168:171], a[88:91], a[8:11], v[168:171]
    s_add_u32 m0, s30, 3072
    v_mfma_f32_16x16x32_bf16 v[168:171], a[92:95], a[28:31], v[168:171]
    s_add_u32 s29, s26, 49152
    v_mfma_f32_16x16x32_bf16 v[200:203], a[92:95], a[32:35], v[200:203]
    buffer_load_dwordx4 v2, s[4:7], s29 offen lds
    v_mfma_f32_16x16x32_bf16 v[200:203], a[88:91], a[12:15], v[200:203]
    v_mfma_f32_16x16x32_bf16 v[232:235], a[88:91], a[16:19], v[232:235]
    s_add_u32 m0, s31, 5120
    v_mfma_f32_16x16x32_bf16 v[232:235], a[92:95], a[36:39], v[232:235]
    s_waitcnt lgkmcnt(6)
    s_add_u32 s29, s27, 294912
    v_mfma_f32_16x16x32_bf16 v[236:239], a[100:103], a[36:39], v[236:239]
    s_waitcnt lgkmcnt(4)
    ds_read_b64_tr_b16 a[92:93], v10 offset:12288
    ds_read_b64_tr_b16 a[94:95], v10 offset:13312
    v_mfma_f32_16x16x32_bf16 v[236:239], a[96:99], a[16:19], v[236:239]
    ds_read_b64_tr_b16 a[88:89], v10 offset:8192
    ds_read_b64_tr_b16 a[90:91], v10 offset:9216
    v_mfma_f32_16x16x32_bf16 v[204:207], a[96:99], a[12:15], v[204:207]
    buffer_load_dwordx4 v3, s[8:11], s29 offen lds
    v_mfma_f32_16x16x32_bf16 v[204:207], a[100:103], a[32:35], v[204:207]
    v_mfma_f32_16x16x32_bf16 v[172:175], a[100:103], a[28:31], v[172:175]
    s_add_u32 m0, s31, 6144
    v_mfma_f32_16x16x32_bf16 v[172:175], a[96:99], a[8:11], v[172:175]
    s_add_u32 s29, s27, 393216
    v_mfma_f32_16x16x32_bf16 v[140:143], a[96:99], a[4:7], v[140:143]
    buffer_load_dwordx4 v3, s[8:11], s29 offen lds
    v_mfma_f32_16x16x32_bf16 v[140:143], a[100:103], a[24:27], v[140:143]
    v_mfma_f32_16x16x32_bf16 v[108:111], a[100:103], a[20:23], v[108:111]
    s_add_u32 m0, s30, 4096
    v_mfma_f32_16x16x32_bf16 v[108:111], a[96:99], a[0:3], v[108:111]
    s_waitcnt lgkmcnt(6)
    s_add_u32 s29, s26, 65536
    v_mfma_f32_16x16x32_bf16 v[112:115], a[80:83], a[0:3], v[112:115]
    s_waitcnt lgkmcnt(4)
    ds_read_b64_tr_b16 a[96:97], v9 offset:8704
    ds_read_b64_tr_b16 a[98:99], v9 offset:9728
    v_mfma_f32_16x16x32_bf16 v[112:115], a[84:87], a[20:23], v[112:115]
    ds_read_b64_tr_b16 a[100:101], v9 offset:12800
    ds_read_b64_tr_b16 a[102:103], v9 offset:13824
    v_mfma_f32_16x16x32_bf16 v[144:147], a[84:87], a[24:27], v[144:147]
    buffer_load_dwordx4 v1, s[4:7], s29 offen lds
    v_mfma_f32_16x16x32_bf16 v[144:147], a[80:83], a[4:7], v[144:147]
    v_mfma_f32_16x16x32_bf16 v[176:179], a[80:83], a[8:11], v[176:179]
    s_add_u32 m0, s31, 7168
    v_mfma_f32_16x16x32_bf16 v[176:179], a[84:87], a[28:31], v[176:179]
    s_add_u32 s29, s27, 425984
    v_mfma_f32_16x16x32_bf16 v[208:211], a[84:87], a[32:35], v[208:211]
    buffer_load_dwordx4 v3, s[8:11], s29 offen lds
    v_mfma_f32_16x16x32_bf16 v[208:211], a[80:83], a[12:15], v[208:211]
    v_mfma_f32_16x16x32_bf16 v[240:243], a[80:83], a[16:19], v[240:243]
    v_mfma_f32_16x16x32_bf16 v[240:243], a[84:87], a[36:39], v[240:243]
    s_waitcnt lgkmcnt(6)
    s_add_u32 s100, s101, 32768
    v_mfma_f32_16x16x32_bf16 v[244:247], a[92:95], a[36:39], v[244:247]
    s_waitcnt lgkmcnt(4)
    ds_read_b64_tr_b16 a[84:85], v10 offset:12800
    ds_read_b64_tr_b16 a[86:87], v10 offset:13824
    v_mfma_f32_16x16x32_bf16 v[244:247], a[88:91], a[16:19], v[244:247]
    ds_read_b64_tr_b16 a[80:81], v10 offset:8704
    ds_read_b64_tr_b16 a[82:83], v10 offset:9728
    v_mfma_f32_16x16x32_bf16 v[212:215], a[88:91], a[12:15], v[212:215]
    buffer_load_dwordx4 a[104:107], v13, s[12:15], s100 offen nt
    v_mfma_f32_16x16x32_bf16 v[212:215], a[92:95], a[32:35], v[212:215]
    v_mfma_f32_16x16x32_bf16 v[180:183], a[92:95], a[28:31], v[180:183]
    v_mfma_f32_16x16x32_bf16 v[180:183], a[88:91], a[8:11], v[180:183]
    v_mfma_f32_16x16x32_bf16 v[148:151], a[88:91], a[4:7], v[148:151]
    buffer_load_dwordx4 a[108:111], v14, s[12:15], s100 offen offset:1024 nt
    v_mfma_f32_16x16x32_bf16 v[148:151], a[92:95], a[24:27], v[148:151]
    s_add_u32 s28, s25, 1
    s_and_b32 s28, s28, 1
    s_or_b32 s28, s28, 6
    s_lshl_b32 s26, s28, 7
    s_lshl_b32 s27, s28, 19
    s_add_u32 m0, s30, 53248
    s_add_u32 s29, s26, 0
    v_mfma_f32_16x16x32_bf16 v[116:119], a[92:95], a[20:23], v[116:119]
    s_waitcnt vmcnt(15) lgkmcnt(0)
    s_barrier
    v_mfma_f32_16x16x32_bf16 v[116:119], a[88:91], a[0:3], v[116:119]
    ds_read_b128 a[40:43], v6
    ds_read_b128 a[60:63], v6 offset:512
    v_mfma_f32_16x16x32_bf16 v[120:123], a[96:99], a[0:3], v[120:123]
    ds_read_b64_tr_b16 a[88:89], v11
    ds_read_b64_tr_b16 a[90:91], v11 offset:1024
    v_mfma_f32_16x16x32_bf16 v[120:123], a[100:103], a[20:23], v[120:123]
    ds_read_b64_tr_b16 a[92:93], v11 offset:4096
    ds_read_b64_tr_b16 a[94:95], v11 offset:5120
    v_mfma_f32_16x16x32_bf16 v[152:155], a[100:103], a[24:27], v[152:155]
    ds_read_b128 a[64:67], v6 offset:2560
    ds_read_b128 a[44:47], v6 offset:2048
    v_mfma_f32_16x16x32_bf16 v[152:155], a[96:99], a[4:7], v[152:155]
    ds_read_b128 a[48:51], v6 offset:4096
    ds_read_b128 a[68:71], v6 offset:4608
    v_mfma_f32_16x16x32_bf16 v[184:187], a[96:99], a[8:11], v[184:187]
    ds_read_b128 a[72:75], v6 offset:6656
    ds_read_b128 a[52:55], v6 offset:6144
    v_mfma_f32_16x16x32_bf16 v[184:187], a[100:103], a[28:31], v[184:187]
    ds_read_b128 a[56:59], v6 offset:8192
    ds_read_b128 a[76:79], v6 offset:8704
    v_mfma_f32_16x16x32_bf16 v[216:219], a[100:103], a[32:35], v[216:219]
    buffer_load_dwordx4 v1, s[4:7], s29 offen lds
    v_mfma_f32_16x16x32_bf16 v[216:219], a[96:99], a[12:15], v[216:219]
    v_mfma_f32_16x16x32_bf16 v[248:251], a[96:99], a[16:19], v[248:251]
    s_add_u32 m0, s31, 53248
    v_mfma_f32_16x16x32_bf16 v[248:251], a[100:103], a[36:39], v[248:251]
    s_add_u32 s29, s27, 0
    v_mfma_f32_16x16x32_bf16 v[252:255], a[84:87], a[36:39], v[252:255]
    ds_read_b64_tr_b16 a[100:101], v12 offset:4096
    ds_read_b64_tr_b16 a[102:103], v12 offset:5120
    v_mfma_f32_16x16x32_bf16 v[252:255], a[80:83], a[16:19], v[252:255]
    ds_read_b64_tr_b16 a[96:97], v12
    ds_read_b64_tr_b16 a[98:99], v12 offset:1024
    v_mfma_f32_16x16x32_bf16 v[220:223], a[80:83], a[12:15], v[220:223]
    buffer_load_dwordx4 v3, s[8:11], s29 offen lds
    v_mfma_f32_16x16x32_bf16 v[220:223], a[84:87], a[32:35], v[220:223]
    v_mfma_f32_16x16x32_bf16 v[188:191], a[84:87], a[28:31], v[188:191]
    s_add_u32 m0, s31, 54272
    v_mfma_f32_16x16x32_bf16 v[188:191], a[80:83], a[8:11], v[188:191]
    s_add_u32 s29, s27, 32768
    v_mfma_f32_16x16x32_bf16 v[156:159], a[80:83], a[4:7], v[156:159]
    buffer_load_dwordx4 v3, s[8:11], s29 offen lds
    v_mfma_f32_16x16x32_bf16 v[156:159], a[84:87], a[24:27], v[156:159]
    v_mfma_f32_16x16x32_bf16 v[124:127], a[84:87], a[20:23], v[124:127]
    s_add_u32 m0, s30, 54272
    v_mfma_f32_16x16x32_bf16 v[124:127], a[80:83], a[0:3], v[124:127]
    s_waitcnt lgkmcnt(14)
    s_add_u32 s29, s26, 16384
    v_mfma_f32_16x16x32_bf16 v[96:99], a[88:91], a[40:43], v[96:99]
    s_waitcnt lgkmcnt(12)
    ds_read_b64_tr_b16 a[80:81], v11 offset:512
    ds_read_b64_tr_b16 a[82:83], v11 offset:1536
    v_mfma_f32_16x16x32_bf16 v[96:99], a[92:95], a[60:63], v[96:99]
    s_waitcnt lgkmcnt(13)
    ds_read_b64_tr_b16 a[84:85], v11 offset:4608
    ds_read_b64_tr_b16 a[86:87], v11 offset:5632
    v_mfma_f32_16x16x32_bf16 v[128:131], a[92:95], a[64:67], v[128:131]
    s_waitcnt lgkmcnt(14)
    buffer_load_dwordx4 v2, s[4:7], s29 offen lds
    v_mfma_f32_16x16x32_bf16 v[128:131], a[88:91], a[44:47], v[128:131]
    s_waitcnt lgkmcnt(13)
    v_mfma_f32_16x16x32_bf16 v[160:163], a[88:91], a[48:51], v[160:163]
    s_waitcnt lgkmcnt(12)
    s_add_u32 m0, s31, 55296
    v_mfma_f32_16x16x32_bf16 v[160:163], a[92:95], a[68:71], v[160:163]
    s_waitcnt lgkmcnt(11)
    s_add_u32 s29, s27, 131072
    v_mfma_f32_16x16x32_bf16 v[192:195], a[92:95], a[72:75], v[192:195]
    s_waitcnt lgkmcnt(10)
    buffer_load_dwordx4 v3, s[8:11], s29 offen lds
    v_mfma_f32_16x16x32_bf16 v[192:195], a[88:91], a[52:55], v[192:195]
    s_waitcnt lgkmcnt(9)
    v_mfma_f32_16x16x32_bf16 v[224:227], a[88:91], a[56:59], v[224:227]
    s_waitcnt lgkmcnt(8)
    s_add_u32 m0, s31, 56320
    v_mfma_f32_16x16x32_bf16 v[224:227], a[92:95], a[76:79], v[224:227]
    s_waitcnt lgkmcnt(6)
    s_add_u32 s29, s27, 163840
    v_mfma_f32_16x16x32_bf16 v[228:231], a[100:103], a[76:79], v[228:231]
    s_waitcnt lgkmcnt(4)
    ds_read_b64_tr_b16 a[92:93], v12 offset:4608
    ds_read_b64_tr_b16 a[94:95], v12 offset:5632
    v_mfma_f32_16x16x32_bf16 v[228:231], a[96:99], a[56:59], v[228:231]
    ds_read_b64_tr_b16 a[88:89], v12 offset:512
    ds_read_b64_tr_b16 a[90:91], v12 offset:1536
    v_mfma_f32_16x16x32_bf16 v[196:199], a[96:99], a[52:55], v[196:199]
    buffer_load_dwordx4 v3, s[8:11], s29 offen lds
    v_mfma_f32_16x16x32_bf16 v[196:199], a[100:103], a[72:75], v[196:199]
    v_mfma_f32_16x16x32_bf16 v[164:167], a[100:103], a[68:71], v[164:167]
    s_add_u32 m0, s30, 55296
    v_mfma_f32_16x16x32_bf16 v[164:167], a[96:99], a[48:51], v[164:167]
    s_add_u32 s29, s26, 32768
    v_mfma_f32_16x16x32_bf16 v[132:135], a[96:99], a[44:47], v[132:135]
    buffer_load_dwordx4 v1, s[4:7], s29 offen lds
    v_mfma_f32_16x16x32_bf16 v[132:135], a[100:103], a[64:67], v[132:135]
    v_mfma_f32_16x16x32_bf16 v[100:103], a[100:103], a[60:63], v[100:103]
    s_add_u32 m0, s31, 57344
    v_mfma_f32_16x16x32_bf16 v[100:103], a[96:99], a[40:43], v[100:103]
    s_waitcnt lgkmcnt(6)
    s_add_u32 s29, s27, 262144
    v_mfma_f32_16x16x32_bf16 v[104:107], a[80:83], a[40:43], v[104:107]
    s_waitcnt lgkmcnt(4)
    ds_read_b64_tr_b16 a[96:97], v11 offset:8192
    ds_read_b64_tr_b16 a[98:99], v11 offset:9216
    v_mfma_f32_16x16x32_bf16 v[104:107], a[84:87], a[60:63], v[104:107]
    ds_read_b64_tr_b16 a[100:101], v11 offset:12288
    ds_read_b64_tr_b16 a[102:103], v11 offset:13312
    v_mfma_f32_16x16x32_bf16 v[136:139], a[84:87], a[64:67], v[136:139]
    buffer_load_dwordx4 v3, s[8:11], s29 offen lds
    v_mfma_f32_16x16x32_bf16 v[136:139], a[80:83], a[44:47], v[136:139]
    v_mfma_f32_16x16x32_bf16 v[168:171], a[80:83], a[48:51], v[168:171]
    s_add_u32 m0, s30, 56320
    v_mfma_f32_16x16x32_bf16 v[168:171], a[84:87], a[68:71], v[168:171]
    s_add_u32 s29, s26, 49152
    v_mfma_f32_16x16x32_bf16 v[200:203], a[84:87], a[72:75], v[200:203]
    buffer_load_dwordx4 v2, s[4:7], s29 offen lds
    v_mfma_f32_16x16x32_bf16 v[200:203], a[80:83], a[52:55], v[200:203]
    v_mfma_f32_16x16x32_bf16 v[232:235], a[80:83], a[56:59], v[232:235]
    s_add_u32 m0, s31, 58368
    v_mfma_f32_16x16x32_bf16 v[232:235], a[84:87], a[76:79], v[232:235]
    s_waitcnt lgkmcnt(6)
    s_add_u32 s29, s27, 294912
    v_mfma_f32_16x16x32_bf16 v[236:239], a[92:95], a[76:79], v[236:239]
    s_waitcnt lgkmcnt(4)
    ds_read_b64_tr_b16 a[84:85], v12 offset:12288
    ds_read_b64_tr_b16 a[86:87], v12 offset:13312
    v_mfma_f32_16x16x32_bf16 v[236:239], a[88:91], a[56:59], v[236:239]
    ds_read_b64_tr_b16 a[80:81], v12 offset:8192
    ds_read_b64_tr_b16 a[82:83], v12 offset:9216
    v_mfma_f32_16x16x32_bf16 v[204:207], a[88:91], a[52:55], v[204:207]
    buffer_load_dwordx4 v3, s[8:11], s29 offen lds
    v_mfma_f32_16x16x32_bf16 v[204:207], a[92:95], a[72:75], v[204:207]
    v_mfma_f32_16x16x32_bf16 v[172:175], a[92:95], a[68:71], v[172:175]
    v_mfma_f32_16x16x32_bf16 v[172:175], a[88:91], a[48:51], v[172:175]
    s_add_u32 m0, s31, 59392
    v_mfma_f32_16x16x32_bf16 v[140:143], a[88:91], a[44:47], v[140:143]
    s_add_u32 s29, s27, 393216
    v_mfma_f32_16x16x32_bf16 v[140:143], a[92:95], a[64:67], v[140:143]
    buffer_load_dwordx4 v3, s[8:11], s29 offen lds
    v_mfma_f32_16x16x32_bf16 v[108:111], a[92:95], a[60:63], v[108:111]
    v_mfma_f32_16x16x32_bf16 v[108:111], a[88:91], a[40:43], v[108:111]
    s_waitcnt lgkmcnt(6)
    s_add_u32 m0, s30, 57344
    v_mfma_f32_16x16x32_bf16 v[112:115], a[96:99], a[40:43], v[112:115]
    s_waitcnt lgkmcnt(4)
    ds_read_b64_tr_b16 a[88:89], v11 offset:8704
    ds_read_b64_tr_b16 a[90:91], v11 offset:9728
    v_mfma_f32_16x16x32_bf16 v[112:115], a[100:103], a[60:63], v[112:115]
    ds_read_b64_tr_b16 a[92:93], v11 offset:12800
    ds_read_b64_tr_b16 a[94:95], v11 offset:13824
    v_mfma_f32_16x16x32_bf16 v[144:147], a[100:103], a[64:67], v[144:147]
    s_add_u32 s29, s26, 65536
    v_mfma_f32_16x16x32_bf16 v[144:147], a[96:99], a[44:47], v[144:147]
    buffer_load_dwordx4 v1, s[4:7], s29 offen lds
    v_mfma_f32_16x16x32_bf16 v[176:179], a[96:99], a[48:51], v[176:179]
    v_mfma_f32_16x16x32_bf16 v[176:179], a[100:103], a[68:71], v[176:179]
    v_mfma_f32_16x16x32_bf16 v[208:211], a[100:103], a[72:75], v[208:211]
    v_mfma_f32_16x16x32_bf16 v[208:211], a[96:99], a[52:55], v[208:211]
    s_add_u32 m0, s31, 60416
    v_mfma_f32_16x16x32_bf16 v[240:243], a[96:99], a[56:59], v[240:243]
    s_add_u32 s29, s27, 425984
    v_mfma_f32_16x16x32_bf16 v[240:243], a[100:103], a[76:79], v[240:243]
    s_waitcnt lgkmcnt(6)
    buffer_load_dwordx4 v3, s[8:11], s29 offen lds
    v_mfma_f32_16x16x32_bf16 v[244:247], a[84:87], a[76:79], v[244:247]
    s_waitcnt lgkmcnt(4)
    ds_read_b64_tr_b16 a[100:101], v12 offset:12800
    ds_read_b64_tr_b16 a[102:103], v12 offset:13824
    v_mfma_f32_16x16x32_bf16 v[244:247], a[80:83], a[56:59], v[244:247]
    ds_read_b64_tr_b16 a[96:97], v12 offset:8704
    ds_read_b64_tr_b16 a[98:99], v12 offset:9728
    v_mfma_f32_16x16x32_bf16 v[212:215], a[80:83], a[52:55], v[212:215]
    v_mfma_f32_16x16x32_bf16 v[212:215], a[84:87], a[72:75], v[212:215]
    v_mfma_f32_16x16x32_bf16 v[180:183], a[84:87], a[68:71], v[180:183]
    v_mfma_f32_16x16x32_bf16 v[180:183], a[80:83], a[48:51], v[180:183]
    s_add_u32 s28, s25, 0
    s_and_b32 s28, s28, 1
    s_or_b32 s28, s28, 8
    v_mfma_f32_16x16x32_bf16 v[148:151], a[80:83], a[44:47], v[148:151]
    s_lshl_b32 s26, s28, 7
    s_lshl_b32 s27, s28, 19
    v_mfma_f32_16x16x32_bf16 v[148:151], a[84:87], a[64:67], v[148:151]
    s_add_u32 m0, s30, 106496
    s_add_u32 s29, s26, 0
    v_mfma_f32_16x16x32_bf16 v[116:119], a[84:87], a[60:63], v[116:119]
    s_waitcnt vmcnt(15) lgkmcnt(0)
    s_barrier
    v_mfma_f32_16x16x32_bf16 v[116:119], a[80:83], a[40:43], v[116:119]
    ds_read_b128 a[0:3], v4
    ds_read_b128 a[20:23], v4 offset:512
    v_mfma_f32_16x16x32_bf16 v[120:123], a[88:91], a[40:43], v[120:123]
    ds_read_b64_tr_b16 a[80:81], v7
    ds_read_b64_tr_b16 a[82:83], v7 offset:1024
    v_mfma_f32_16x16x32_bf16 v[120:123], a[92:95], a[60:63], v[120:123]
    ds_read_b64_tr_b16 a[84:85], v7 offset:4096
    ds_read_b64_tr_b16 a[86:87], v7 offset:5120
    v_mfma_f32_16x16x32_bf16 v[152:155], a[92:95], a[64:67], v[152:155]
    ds_read_b128 a[24:27], v4 offset:2560
    ds_read_b128 a[4:7], v4 offset:2048
    v_mfma_f32_16x16x32_bf16 v[152:155], a[88:91], a[44:47], v[152:155]
    ds_read_b128 a[8:11], v4 offset:4096
    ds_read_b128 a[28:31], v4 offset:4608
    v_mfma_f32_16x16x32_bf16 v[184:187], a[88:91], a[48:51], v[184:187]
    ds_read_b128 a[32:35], v4 offset:6656
    ds_read_b128 a[12:15], v4 offset:6144
    v_mfma_f32_16x16x32_bf16 v[184:187], a[92:95], a[68:71], v[184:187]
    ds_read_b128 a[16:19], v4 offset:8192
    ds_read_b128 a[36:39], v4 offset:8704
    v_mfma_f32_16x16x32_bf16 v[216:219], a[92:95], a[72:75], v[216:219]
    buffer_load_dwordx4 v1, s[4:7], s29 offen lds
    v_mfma_f32_16x16x32_bf16 v[216:219], a[88:91], a[52:55], v[216:219]
    v_mfma_f32_16x16x32_bf16 v[248:251], a[88:91], a[56:59], v[248:251]
    s_add_u32 m0, s31, 106496
    v_mfma_f32_16x16x32_bf16 v[248:251], a[92:95], a[76:79], v[248:251]
    s_add_u32 s29, s27, 0
    v_mfma_f32_16x16x32_bf16 v[252:255], a[100:103], a[76:79], v[252:255]
    ds_read_b64_tr_b16 a[92:93], v8 offset:4096
    ds_read_b64_tr_b16 a[94:95], v8 offset:5120
    v_mfma_f32_16x16x32_bf16 v[252:255], a[96:99], a[56:59], v[252:255]
    ds_read_b64_tr_b16 a[88:89], v8
    ds_read_b64_tr_b16 a[90:91], v8 offset:1024
    v_mfma_f32_16x16x32_bf16 v[220:223], a[96:99], a[52:55], v[220:223]
    buffer_load_dwordx4 v3, s[8:11], s29 offen lds
    v_mfma_f32_16x16x32_bf16 v[220:223], a[100:103], a[72:75], v[220:223]
    v_mfma_f32_16x16x32_bf16 v[188:191], a[100:103], a[68:71], v[188:191]
    s_add_u32 m0, s31, 107520
    v_mfma_f32_16x16x32_bf16 v[188:191], a[96:99], a[48:51], v[188:191]
    s_add_u32 s29, s27, 32768
    v_mfma_f32_16x16x32_bf16 v[156:159], a[96:99], a[44:47], v[156:159]
    buffer_load_dwordx4 v3, s[8:11], s29 offen lds
    v_mfma_f32_16x16x32_bf16 v[156:159], a[100:103], a[64:67], v[156:159]
    v_mfma_f32_16x16x32_bf16 v[124:127], a[100:103], a[60:63], v[124:127]
    s_add_u32 m0, s30, 107520
    v_mfma_f32_16x16x32_bf16 v[124:127], a[96:99], a[40:43], v[124:127]
    s_waitcnt lgkmcnt(14)
    s_add_u32 s29, s26, 16384
    v_mfma_f32_16x16x32_bf16 v[96:99], a[80:83], a[0:3], v[96:99]
    s_waitcnt lgkmcnt(12)
    ds_read_b64_tr_b16 a[96:97], v7 offset:512
    ds_read_b64_tr_b16 a[98:99], v7 offset:1536
    v_mfma_f32_16x16x32_bf16 v[96:99], a[84:87], a[20:23], v[96:99]
    s_waitcnt lgkmcnt(13)
    ds_read_b64_tr_b16 a[100:101], v7 offset:4608
    ds_read_b64_tr_b16 a[102:103], v7 offset:5632
    v_mfma_f32_16x16x32_bf16 v[128:131], a[84:87], a[24:27], v[128:131]
    s_waitcnt lgkmcnt(14)
    buffer_load_dwordx4 v2, s[4:7], s29 offen lds
    v_mfma_f32_16x16x32_bf16 v[128:131], a[80:83], a[4:7], v[128:131]
    s_waitcnt lgkmcnt(13)
    v_mfma_f32_16x16x32_bf16 v[160:163], a[80:83], a[8:11], v[160:163]
    s_waitcnt lgkmcnt(12)
    s_add_u32 m0, s31, 108544
    v_mfma_f32_16x16x32_bf16 v[160:163], a[84:87], a[28:31], v[160:163]
    s_waitcnt lgkmcnt(11)
    s_add_u32 s29, s27, 131072
    v_mfma_f32_16x16x32_bf16 v[192:195], a[84:87], a[32:35], v[192:195]
    s_waitcnt lgkmcnt(10)
    buffer_load_dwordx4 v3, s[8:11], s29 offen lds
    v_mfma_f32_16x16x32_bf16 v[192:195], a[80:83], a[12:15], v[192:195]
    s_waitcnt lgkmcnt(9)
    v_mfma_f32_16x16x32_bf16 v[224:227], a[80:83], a[16:19], v[224:227]
    s_waitcnt lgkmcnt(8)
    s_add_u32 m0, s31, 109568
    v_mfma_f32_16x16x32_bf16 v[224:227], a[84:87], a[36:39], v[224:227]
    s_waitcnt lgkmcnt(6)
    s_add_u32 s29, s27, 163840
    v_mfma_f32_16x16x32_bf16 v[228:231], a[92:95], a[36:39], v[228:231]
    s_waitcnt lgkmcnt(4)
    ds_read_b64_tr_b16 a[84:85], v8 offset:4608
    ds_read_b64_tr_b16 a[86:87], v8 offset:5632
    v_mfma_f32_16x16x32_bf16 v[228:231], a[88:91], a[16:19], v[228:231]
    ds_read_b64_tr_b16 a[80:81], v8 offset:512
    ds_read_b64_tr_b16 a[82:83], v8 offset:1536
    v_mfma_f32_16x16x32_bf16 v[196:199], a[88:91], a[12:15], v[196:199]
    buffer_load_dwordx4 v3, s[8:11], s29 offen lds
    v_mfma_f32_16x16x32_bf16 v[196:199], a[92:95], a[32:35], v[196:199]
    v_mfma_f32_16x16x32_bf16 v[164:167], a[92:95], a[28:31], v[164:167]
    s_add_u32 m0, s30, 108544
    v_mfma_f32_16x16x32_bf16 v[164:167], a[88:91], a[8:11], v[164:167]
    s_add_u32 s29, s26, 32768
    v_mfma_f32_16x16x32_bf16 v[132:135], a[88:91], a[4:7], v[132:135]
    buffer_load_dwordx4 v1, s[4:7], s29 offen lds
    v_mfma_f32_16x16x32_bf16 v[132:135], a[92:95], a[24:27], v[132:135]
    v_mfma_f32_16x16x32_bf16 v[100:103], a[92:95], a[20:23], v[100:103]
    s_add_u32 m0, s31, 110592
    v_mfma_f32_16x16x32_bf16 v[100:103], a[88:91], a[0:3], v[100:103]
    s_waitcnt lgkmcnt(6)
    s_add_u32 s29, s27, 262144
    v_mfma_f32_16x16x32_bf16 v[104:107], a[96:99], a[0:3], v[104:107]
    s_waitcnt lgkmcnt(4)
    ds_read_b64_tr_b16 a[88:89], v7 offset:8192
    ds_read_b64_tr_b16 a[90:91], v7 offset:9216
    v_mfma_f32_16x16x32_bf16 v[104:107], a[100:103], a[20:23], v[104:107]
    ds_read_b64_tr_b16 a[92:93], v7 offset:12288
    ds_read_b64_tr_b16 a[94:95], v7 offset:13312
    v_mfma_f32_16x16x32_bf16 v[136:139], a[100:103], a[24:27], v[136:139]
    buffer_load_dwordx4 v3, s[8:11], s29 offen lds
    v_mfma_f32_16x16x32_bf16 v[136:139], a[96:99], a[4:7], v[136:139]
    v_mfma_f32_16x16x32_bf16 v[168:171], a[96:99], a[8:11], v[168:171]
    s_add_u32 m0, s30, 109568
    v_mfma_f32_16x16x32_bf16 v[168:171], a[100:103], a[28:31], v[168:171]
    s_add_u32 s29, s26, 49152
    v_mfma_f32_16x16x32_bf16 v[200:203], a[100:103], a[32:35], v[200:203]
    buffer_load_dwordx4 v2, s[4:7], s29 offen lds
    v_mfma_f32_16x16x32_bf16 v[200:203], a[96:99], a[12:15], v[200:203]
    v_mfma_f32_16x16x32_bf16 v[232:235], a[96:99], a[16:19], v[232:235]
    s_add_u32 m0, s31, 111616
    v_mfma_f32_16x16x32_bf16 v[232:235], a[100:103], a[36:39], v[232:235]
    s_waitcnt lgkmcnt(6)
    s_add_u32 s29, s27, 294912
    v_mfma_f32_16x16x32_bf16 v[236:239], a[84:87], a[36:39], v[236:239]
    s_waitcnt lgkmcnt(4)
    ds_read_b64_tr_b16 a[100:101], v8 offset:12288
    ds_read_b64_tr_b16 a[102:103], v8 offset:13312
    v_mfma_f32_16x16x32_bf16 v[236:239], a[80:83], a[16:19], v[236:239]
    ds_read_b64_tr_b16 a[96:97], v8 offset:8192
    ds_read_b64_tr_b16 a[98:99], v8 offset:9216
    v_mfma_f32_16x16x32_bf16 v[204:207], a[80:83], a[12:15], v[204:207]
    buffer_load_dwordx4 v3, s[8:11], s29 offen lds
    v_mfma_f32_16x16x32_bf16 v[204:207], a[84:87], a[32:35], v[204:207]
    v_mfma_f32_16x16x32_bf16 v[172:175], a[84:87], a[28:31], v[172:175]
    s_add_u32 m0, s31, 112640
    v_mfma_f32_16x16x32_bf16 v[172:175], a[80:83], a[8:11], v[172:175]
    s_add_u32 s29, s27, 393216
    v_mfma_f32_16x16x32_bf16 v[140:143], a[80:83], a[4:7], v[140:143]
    buffer_load_dwordx4 v3, s[8:11], s29 offen lds
    v_mfma_f32_16x16x32_bf16 v[140:143], a[84:87], a[24:27], v[140:143]
    v_mfma_f32_16x16x32_bf16 v[108:111], a[84:87], a[20:23], v[108:111]
    s_add_u32 m0, s30, 110592
    v_mfma_f32_16x16x32_bf16 v[108:111], a[80:83], a[0:3], v[108:111]
    s_waitcnt lgkmcnt(6)
    s_add_u32 s29, s26, 65536
    v_mfma_f32_16x16x32_bf16 v[112:115], a[88:91], a[0:3], v[112:115]
    s_waitcnt lgkmcnt(4)
    ds_read_b64_tr_b16 a[80:81], v7 offset:8704
    ds_read_b64_tr_b16 a[82:83], v7 offset:9728
    v_mfma_f32_16x16x32_bf16 v[112:115], a[92:95], a[20:23], v[112:115]
    ds_read_b64_tr_b16 a[84:85], v7 offset:12800
    ds_read_b64_tr_b16 a[86:87], v7 offset:13824
    v_mfma_f32_16x16x32_bf16 v[144:147], a[92:95], a[24:27], v[144:147]
    buffer_load_dwordx4 v1, s[4:7], s29 offen lds
    v_mfma_f32_16x16x32_bf16 v[144:147], a[88:91], a[4:7], v[144:147]
    v_mfma_f32_16x16x32_bf16 v[176:179], a[88:91], a[8:11], v[176:179]
    s_add_u32 m0, s31, 113664
    v_mfma_f32_16x16x32_bf16 v[176:179], a[92:95], a[28:31], v[176:179]
    s_add_u32 s29, s27, 425984
    v_mfma_f32_16x16x32_bf16 v[208:211], a[92:95], a[32:35], v[208:211]
    buffer_load_dwordx4 v3, s[8:11], s29 offen lds
    v_mfma_f32_16x16x32_bf16 v[208:211], a[88:91], a[12:15], v[208:211]
    v_mfma_f32_16x16x32_bf16 v[240:243], a[88:91], a[16:19], v[240:243]
    v_mfma_f32_16x16x32_bf16 v[240:243], a[92:95], a[36:39], v[240:243]
    s_waitcnt lgkmcnt(6)
    v_mfma_f32_16x16x32_bf16 v[244:247], a[100:103], a[36:39], v[244:247]
    s_waitcnt lgkmcnt(4)
    ds_read_b64_tr_b16 a[92:93], v8 offset:12800
    ds_read_b64_tr_b16 a[94:95], v8 offset:13824
    v_mfma_f32_16x16x32_bf16 v[244:247], a[96:99], a[16:19], v[244:247]
    ds_read_b64_tr_b16 a[88:89], v8 offset:8704
    ds_read_b64_tr_b16 a[90:91], v8 offset:9728
    v_mfma_f32_16x16x32_bf16 v[212:215], a[96:99], a[12:15], v[212:215]
    buffer_load_dwordx4 a[112:115], v15, s[12:15], s100 offen offset:2048 nt
    v_mfma_f32_16x16x32_bf16 v[212:215], a[100:103], a[32:35], v[212:215]
    v_mfma_f32_16x16x32_bf16 v[180:183], a[100:103], a[28:31], v[180:183]
    v_mfma_f32_16x16x32_bf16 v[180:183], a[96:99], a[8:11], v[180:183]
    v_mfma_f32_16x16x32_bf16 v[148:151], a[96:99], a[4:7], v[148:151]
    buffer_load_dwordx4 a[116:119], v16, s[12:15], s100 offen offset:3072 nt
    v_mfma_f32_16x16x32_bf16 v[148:151], a[100:103], a[24:27], v[148:151]
    s_add_u32 s28, s25, 1
    s_and_b32 s28, s28, 1
    s_or_b32 s28, s28, 8
    s_lshl_b32 s26, s28, 7
    s_lshl_b32 s27, s28, 19
    s_add_u32 m0, s30, 0
    s_add_u32 s29, s26, 0
    v_mfma_f32_16x16x32_bf16 v[116:119], a[100:103], a[20:23], v[116:119]
    s_waitcnt vmcnt(15) lgkmcnt(0)
    s_barrier
    v_mfma_f32_16x16x32_bf16 v[116:119], a[96:99], a[0:3], v[116:119]
    ds_read_b128 a[40:43], v5
    ds_read_b128 a[60:63], v5 offset:512
    v_mfma_f32_16x16x32_bf16 v[120:123], a[80:83], a[0:3], v[120:123]
    ds_read_b64_tr_b16 a[96:97], v9
    ds_read_b64_tr_b16 a[98:99], v9 offset:1024
    v_mfma_f32_16x16x32_bf16 v[120:123], a[84:87], a[20:23], v[120:123]
    ds_read_b64_tr_b16 a[100:101], v9 offset:4096
    ds_read_b64_tr_b16 a[102:103], v9 offset:5120
    v_mfma_f32_16x16x32_bf16 v[152:155], a[84:87], a[24:27], v[152:155]
    ds_read_b128 a[64:67], v5 offset:2560
    ds_read_b128 a[44:47], v5 offset:2048
    v_mfma_f32_16x16x32_bf16 v[152:155], a[80:83], a[4:7], v[152:155]
    ds_read_b128 a[48:51], v5 offset:4096
    ds_read_b128 a[68:71], v5 offset:4608
    v_mfma_f32_16x16x32_bf16 v[184:187], a[80:83], a[8:11], v[184:187]
    ds_read_b128 a[72:75], v5 offset:6656
    ds_read_b128 a[52:55], v5 offset:6144
    v_mfma_f32_16x16x32_bf16 v[184:187], a[84:87], a[28:31], v[184:187]
    ds_read_b128 a[56:59], v5 offset:8192
    ds_read_b128 a[76:79], v5 offset:8704
    v_mfma_f32_16x16x32_bf16 v[216:219], a[84:87], a[32:35], v[216:219]
    buffer_load_dwordx4 v1, s[4:7], s29 offen lds
    v_mfma_f32_16x16x32_bf16 v[216:219], a[80:83], a[12:15], v[216:219]
    v_mfma_f32_16x16x32_bf16 v[248:251], a[80:83], a[16:19], v[248:251]
    s_add_u32 m0, s31, 0
    v_mfma_f32_16x16x32_bf16 v[248:251], a[84:87], a[36:39], v[248:251]
    s_add_u32 s29, s27, 0
    v_mfma_f32_16x16x32_bf16 v[252:255], a[92:95], a[36:39], v[252:255]
    ds_read_b64_tr_b16 a[84:85], v10 offset:4096
    ds_read_b64_tr_b16 a[86:87], v10 offset:5120
    v_mfma_f32_16x16x32_bf16 v[252:255], a[88:91], a[16:19], v[252:255]
    ds_read_b64_tr_b16 a[80:81], v10
    ds_read_b64_tr_b16 a[82:83], v10 offset:1024
    v_mfma_f32_16x16x32_bf16 v[220:223], a[88:91], a[12:15], v[220:223]
    buffer_load_dwordx4 v3, s[8:11], s29 offen lds
    v_mfma_f32_16x16x32_bf16 v[220:223], a[92:95], a[32:35], v[220:223]
    v_mfma_f32_16x16x32_bf16 v[188:191], a[92:95], a[28:31], v[188:191]
    s_add_u32 m0, s31, 1024
    v_mfma_f32_16x16x32_bf16 v[188:191], a[88:91], a[8:11], v[188:191]
    s_add_u32 s29, s27, 32768
    v_mfma_f32_16x16x32_bf16 v[156:159], a[88:91], a[4:7], v[156:159]
    buffer_load_dwordx4 v3, s[8:11], s29 offen lds
    v_mfma_f32_16x16x32_bf16 v[156:159], a[92:95], a[24:27], v[156:159]
    v_mfma_f32_16x16x32_bf16 v[124:127], a[92:95], a[20:23], v[124:127]
    s_add_u32 m0, s30, 1024
    v_mfma_f32_16x16x32_bf16 v[124:127], a[88:91], a[0:3], v[124:127]
    s_waitcnt lgkmcnt(14)
    s_add_u32 s29, s26, 16384
    v_mfma_f32_16x16x32_bf16 v[96:99], a[96:99], a[40:43], v[96:99]
    s_waitcnt lgkmcnt(12)
    ds_read_b64_tr_b16 a[88:89], v9 offset:512
    ds_read_b64_tr_b16 a[90:91], v9 offset:1536
    v_mfma_f32_16x16x32_bf16 v[96:99], a[100:103], a[60:63], v[96:99]
    s_waitcnt lgkmcnt(13)
    ds_read_b64_tr_b16 a[92:93], v9 offset:4608
    ds_read_b64_tr_b16 a[94:95], v9 offset:5632
    v_mfma_f32_16x16x32_bf16 v[128:131], a[100:103], a[64:67], v[128:131]
    s_waitcnt lgkmcnt(14)
    buffer_load_dwordx4 v2, s[4:7], s29 offen lds
    v_mfma_f32_16x16x32_bf16 v[128:131], a[96:99], a[44:47], v[128:131]
    s_waitcnt lgkmcnt(13)
    v_mfma_f32_16x16x32_bf16 v[160:163], a[96:99], a[48:51], v[160:163]
    s_waitcnt lgkmcnt(12)
    s_add_u32 m0, s31, 2048
    v_mfma_f32_16x16x32_bf16 v[160:163], a[100:103], a[68:71], v[160:163]
    s_waitcnt lgkmcnt(11)
    s_add_u32 s29, s27, 131072
    v_mfma_f32_16x16x32_bf16 v[192:195], a[100:103], a[72:75], v[192:195]
    s_waitcnt lgkmcnt(10)
    buffer_load_dwordx4 v3, s[8:11], s29 offen lds
    v_mfma_f32_16x16x32_bf16 v[192:195], a[96:99], a[52:55], v[192:195]
    s_waitcnt lgkmcnt(9)
    v_mfma_f32_16x16x32_bf16 v[224:227], a[96:99], a[56:59], v[224:227]
    s_waitcnt lgkmcnt(8)
    s_add_u32 m0, s31, 3072
    v_mfma_f32_16x16x32_bf16 v[224:227], a[100:103], a[76:79], v[224:227]
    s_waitcnt lgkmcnt(6)
    s_add_u32 s29, s27, 163840
    v_mfma_f32_16x16x32_bf16 v[228:231], a[84:87], a[76:79], v[228:231]
    s_waitcnt lgkmcnt(4)
    ds_read_b64_tr_b16 a[100:101], v10 offset:4608
    ds_read_b64_tr_b16 a[102:103], v10 offset:5632
    v_mfma_f32_16x16x32_bf16 v[228:231], a[80:83], a[56:59], v[228:231]
    ds_read_b64_tr_b16 a[96:97], v10 offset:512
    ds_read_b64_tr_b16 a[98:99], v10 offset:1536
    v_mfma_f32_16x16x32_bf16 v[196:199], a[80:83], a[52:55], v[196:199]
    buffer_load_dwordx4 v3, s[8:11], s29 offen lds
    v_mfma_f32_16x16x32_bf16 v[196:199], a[84:87], a[72:75], v[196:199]
    v_mfma_f32_16x16x32_bf16 v[164:167], a[84:87], a[68:71], v[164:167]
    s_add_u32 m0, s30, 2048
    v_mfma_f32_16x16x32_bf16 v[164:167], a[80:83], a[48:51], v[164:167]
    s_add_u32 s29, s26, 32768
    v_mfma_f32_16x16x32_bf16 v[132:135], a[80:83], a[44:47], v[132:135]
    buffer_load_dwordx4 v1, s[4:7], s29 offen lds
    v_mfma_f32_16x16x32_bf16 v[132:135], a[84:87], a[64:67], v[132:135]
    v_mfma_f32_16x16x32_bf16 v[100:103], a[84:87], a[60:63], v[100:103]
    s_add_u32 m0, s31, 4096
    v_mfma_f32_16x16x32_bf16 v[100:103], a[80:83], a[40:43], v[100:103]
    s_waitcnt lgkmcnt(6)
    s_add_u32 s29, s27, 262144
    v_mfma_f32_16x16x32_bf16 v[104:107], a[88:91], a[40:43], v[104:107]
    s_waitcnt lgkmcnt(4)
    ds_read_b64_tr_b16 a[80:81], v9 offset:8192
    ds_read_b64_tr_b16 a[82:83], v9 offset:9216
    v_mfma_f32_16x16x32_bf16 v[104:107], a[92:95], a[60:63], v[104:107]
    ds_read_b64_tr_b16 a[84:85], v9 offset:12288
    ds_read_b64_tr_b16 a[86:87], v9 offset:13312
    v_mfma_f32_16x16x32_bf16 v[136:139], a[92:95], a[64:67], v[136:139]
    buffer_load_dwordx4 v3, s[8:11], s29 offen lds
    v_mfma_f32_16x16x32_bf16 v[136:139], a[88:91], a[44:47], v[136:139]
    v_mfma_f32_16x16x32_bf16 v[168:171], a[88:91], a[48:51], v[168:171]
    s_add_u32 m0, s30, 3072
    v_mfma_f32_16x16x32_bf16 v[168:171], a[92:95], a[68:71], v[168:171]
    s_add_u32 s29, s26, 49152
    v_mfma_f32_16x16x32_bf16 v[200:203], a[92:95], a[72:75], v[200:203]
    buffer_load_dwordx4 v2, s[4:7], s29 offen lds
    v_mfma_f32_16x16x32_bf16 v[200:203], a[88:91], a[52:55], v[200:203]
    v_mfma_f32_16x16x32_bf16 v[232:235], a[88:91], a[56:59], v[232:235]
    s_add_u32 m0, s31, 5120
    v_mfma_f32_16x16x32_bf16 v[232:235], a[92:95], a[76:79], v[232:235]
    s_waitcnt lgkmcnt(6)
    s_add_u32 s29, s27, 294912
    v_mfma_f32_16x16x32_bf16 v[236:239], a[100:103], a[76:79], v[236:239]
    s_waitcnt lgkmcnt(4)
    ds_read_b64_tr_b16 a[92:93], v10 offset:12288
    ds_read_b64_tr_b16 a[94:95], v10 offset:13312
    v_mfma_f32_16x16x32_bf16 v[236:239], a[96:99], a[56:59], v[236:239]
    ds_read_b64_tr_b16 a[88:89], v10 offset:8192
    ds_read_b64_tr_b16 a[90:91], v10 offset:9216
    v_mfma_f32_16x16x32_bf16 v[204:207], a[96:99], a[52:55], v[204:207]
    buffer_load_dwordx4 v3, s[8:11], s29 offen lds
    v_mfma_f32_16x16x32_bf16 v[204:207], a[100:103], a[72:75], v[204:207]
    v_mfma_f32_16x16x32_bf16 v[172:175], a[100:103], a[68:71], v[172:175]
    v_mfma_f32_16x16x32_bf16 v[172:175], a[96:99], a[48:51], v[172:175]
    s_add_u32 m0, s31, 6144
    v_mfma_f32_16x16x32_bf16 v[140:143], a[96:99], a[44:47], v[140:143]
    s_add_u32 s29, s27, 393216
    v_mfma_f32_16x16x32_bf16 v[140:143], a[100:103], a[64:67], v[140:143]
    buffer_load_dwordx4 v3, s[8:11], s29 offen lds
    v_mfma_f32_16x16x32_bf16 v[108:111], a[100:103], a[60:63], v[108:111]
    v_mfma_f32_16x16x32_bf16 v[108:111], a[96:99], a[40:43], v[108:111]
    s_waitcnt lgkmcnt(6)
    s_add_u32 m0, s30, 4096
    v_mfma_f32_16x16x32_bf16 v[112:115], a[80:83], a[40:43], v[112:115]
    s_waitcnt lgkmcnt(4)
    ds_read_b64_tr_b16 a[96:97], v9 offset:8704
    ds_read_b64_tr_b16 a[98:99], v9 offset:9728
    v_mfma_f32_16x16x32_bf16 v[112:115], a[84:87], a[60:63], v[112:115]
    ds_read_b64_tr_b16 a[100:101], v9 offset:12800
    ds_read_b64_tr_b16 a[102:103], v9 offset:13824
    v_mfma_f32_16x16x32_bf16 v[144:147], a[84:87], a[64:67], v[144:147]
    s_add_u32 s29, s26, 65536
    v_mfma_f32_16x16x32_bf16 v[144:147], a[80:83], a[44:47], v[144:147]
    buffer_load_dwordx4 v1, s[4:7], s29 offen lds
    v_mfma_f32_16x16x32_bf16 v[176:179], a[80:83], a[48:51], v[176:179]
    v_mfma_f32_16x16x32_bf16 v[176:179], a[84:87], a[68:71], v[176:179]
    v_mfma_f32_16x16x32_bf16 v[208:211], a[84:87], a[72:75], v[208:211]
    v_mfma_f32_16x16x32_bf16 v[208:211], a[80:83], a[52:55], v[208:211]
    s_add_u32 m0, s31, 7168
    v_mfma_f32_16x16x32_bf16 v[240:243], a[80:83], a[56:59], v[240:243]
    s_add_u32 s29, s27, 425984
    v_mfma_f32_16x16x32_bf16 v[240:243], a[84:87], a[76:79], v[240:243]
    s_waitcnt lgkmcnt(6)
    buffer_load_dwordx4 v3, s[8:11], s29 offen lds
    v_mfma_f32_16x16x32_bf16 v[244:247], a[92:95], a[76:79], v[244:247]
    s_waitcnt lgkmcnt(4)
    ds_read_b64_tr_b16 a[84:85], v10 offset:12800
    ds_read_b64_tr_b16 a[86:87], v10 offset:13824
    v_mfma_f32_16x16x32_bf16 v[244:247], a[88:91], a[56:59], v[244:247]
    ds_read_b64_tr_b16 a[80:81], v10 offset:8704
    ds_read_b64_tr_b16 a[82:83], v10 offset:9728
    v_mfma_f32_16x16x32_bf16 v[212:215], a[88:91], a[52:55], v[212:215]
    v_mfma_f32_16x16x32_bf16 v[212:215], a[92:95], a[72:75], v[212:215]
    v_mfma_f32_16x16x32_bf16 v[180:183], a[92:95], a[68:71], v[180:183]
    v_mfma_f32_16x16x32_bf16 v[180:183], a[88:91], a[48:51], v[180:183]
    s_add_u32 s28, s25, 0
    s_and_b32 s28, s28, 1
    s_or_b32 s28, s28, 10
    v_mfma_f32_16x16x32_bf16 v[148:151], a[88:91], a[44:47], v[148:151]
    s_lshl_b32 s26, s28, 7
    s_lshl_b32 s27, s28, 19
    v_mfma_f32_16x16x32_bf16 v[148:151], a[92:95], a[64:67], v[148:151]
    s_add_u32 m0, s30, 53248
    s_add_u32 s29, s26, 0
    v_mfma_f32_16x16x32_bf16 v[116:119], a[92:95], a[60:63], v[116:119]
    s_waitcnt vmcnt(15) lgkmcnt(0)
    s_barrier
    v_mfma_f32_16x16x32_bf16 v[116:119], a[88:91], a[40:43], v[116:119]
    ds_read_b128 a[0:3], v6
    ds_read_b128 a[20:23], v6 offset:512
    v_mfma_f32_16x16x32_bf16 v[120:123], a[96:99], a[40:43], v[120:123]
    ds_read_b64_tr_b16 a[88:89], v11
    ds_read_b64_tr_b16 a[90:91], v11 offset:1024
    v_mfma_f32_16x16x32_bf16 v[120:123], a[100:103], a[60:63], v[120:123]
    ds_read_b64_tr_b16 a[92:93], v11 offset:4096
    ds_read_b64_tr_b16 a[94:95], v11 offset:5120
    v_mfma_f32_16x16x32_bf16 v[152:155], a[100:103], a[64:67], v[152:155]
    ds_read_b128 a[24:27], v6 offset:2560
    ds_read_b128 a[4:7], v6 offset:2048
    v_mfma_f32_16x16x32_bf16 v[152:155], a[96:99], a[44:47], v[152:155]
    ds_read_b128 a[8:11], v6 offset:4096
    ds_read_b128 a[28:31], v6 offset:4608
    v_mfma_f32_16x16x32_bf16 v[184:187], a[96:99], a[48:51], v[184:187]
    ds_read_b128 a[32:35], v6 offset:6656
    ds_read_b128 a[12:15], v6 offset:6144
    v_mfma_f32_16x16x32_bf16 v[184:187], a[100:103], a[68:71], v[184:187]
    ds_read_b128 a[16:19], v6 offset:8192
    ds_read_b128 a[36:39], v6 offset:8704
    v_mfma_f32_16x16x32_bf16 v[216:219], a[100:103], a[72:75], v[216:219]
    buffer_load_dwordx4 v1, s[4:7], s29 offen lds
    v_mfma_f32_16x16x32_bf16 v[216:219], a[96:99], a[52:55], v[216:219]
    v_mfma_f32_16x16x32_bf16 v[248:251], a[96:99], a[56:59], v[248:251]
    s_add_u32 m0, s31, 53248
    v_mfma_f32_16x16x32_bf16 v[248:251], a[100:103], a[76:79], v[248:251]
    s_add_u32 s29, s27, 0
    v_mfma_f32_16x16x32_bf16 v[252:255], a[84:87], a[76:79], v[252:255]
    ds_read_b64_tr_b16 a[100:101], v12 offset:4096
    ds_read_b64_tr_b16 a[102:103], v12 offset:5120
    v_mfma_f32_16x16x32_bf16 v[252:255], a[80:83], a[56:59], v[252:255]
    ds_read_b64_tr_b16 a[96:97], v12
    ds_read_b64_tr_b16 a[98:99], v12 offset:1024
    v_mfma_f32_16x16x32_bf16 v[220:223], a[80:83], a[52:55], v[220:223]
    buffer_load_dwordx4 v3, s[8:11], s29 offen lds
    v_mfma_f32_16x16x32_bf16 v[220:223], a[84:87], a[72:75], v[220:223]
    v_mfma_f32_16x16x32_bf16 v[188:191], a[84:87], a[68:71], v[188:191]
    s_add_u32 m0, s31, 54272
    v_mfma_f32_16x16x32_bf16 v[188:191], a[80:83], a[48:51], v[188:191]
    s_add_u32 s29, s27, 32768
    v_mfma_f32_16x16x32_bf16 v[156:159], a[80:83], a[44:47], v[156:159]
    buffer_load_dwordx4 v3, s[8:11], s29 offen lds
    v_mfma_f32_16x16x32_bf16 v[156:159], a[84:87], a[64:67], v[156:159]
    v_mfma_f32_16x16x32_bf16 v[124:127], a[84:87], a[60:63], v[124:127]
    s_add_u32 m0, s30, 54272
    v_mfma_f32_16x16x32_bf16 v[124:127], a[80:83], a[40:43], v[124:127]
    s_waitcnt lgkmcnt(14)
    s_add_u32 s29, s26, 16384
    v_mfma_f32_16x16x32_bf16 v[96:99], a[88:91], a[0:3], v[96:99]
    s_waitcnt lgkmcnt(12)
    ds_read_b64_tr_b16 a[80:81], v11 offset:512
    ds_read_b64_tr_b16 a[82:83], v11 offset:1536
    v_mfma_f32_16x16x32_bf16 v[96:99], a[92:95], a[20:23], v[96:99]
    s_waitcnt lgkmcnt(13)
    ds_read_b64_tr_b16 a[84:85], v11 offset:4608
    ds_read_b64_tr_b16 a[86:87], v11 offset:5632
    v_mfma_f32_16x16x32_bf16 v[128:131], a[92:95], a[24:27], v[128:131]
    s_waitcnt lgkmcnt(14)
    buffer_load_dwordx4 v2, s[4:7], s29 offen lds
    v_mfma_f32_16x16x32_bf16 v[128:131], a[88:91], a[4:7], v[128:131]
    s_waitcnt lgkmcnt(13)
    v_mfma_f32_16x16x32_bf16 v[160:163], a[88:91], a[8:11], v[160:163]
    s_waitcnt lgkmcnt(12)
    s_add_u32 m0, s31, 55296
    v_mfma_f32_16x16x32_bf16 v[160:163], a[92:95], a[28:31], v[160:163]
    s_waitcnt lgkmcnt(11)
    s_add_u32 s29, s27, 131072
    v_mfma_f32_16x16x32_bf16 v[192:195], a[92:95], a[32:35], v[192:195]
    s_waitcnt lgkmcnt(10)
    buffer_load_dwordx4 v3, s[8:11], s29 offen lds
    v_mfma_f32_16x16x32_bf16 v[192:195], a[88:91], a[12:15], v[192:195]
    s_waitcnt lgkmcnt(9)
    v_mfma_f32_16x16x32_bf16 v[224:227], a[88:91], a[16:19], v[224:227]
    s_waitcnt lgkmcnt(8)
    s_add_u32 m0, s31, 56320
    v_mfma_f32_16x16x32_bf16 v[224:227], a[92:95], a[36:39], v[224:227]
    s_waitcnt lgkmcnt(6)
    s_add_u32 s29, s27, 163840
    v_mfma_f32_16x16x32_bf16 v[228:231], a[100:103], a[36:39], v[228:231]
    s_waitcnt lgkmcnt(4)
    ds_read_b64_tr_b16 a[92:93], v12 offset:4608
    ds_read_b64_tr_b16 a[94:95], v12 offset:5632
    v_mfma_f32_16x16x32_bf16 v[228:231], a[96:99], a[16:19], v[228:231]
    ds_read_b64_tr_b16 a[88:89], v12 offset:512
    ds_read_b64_tr_b16 a[90:91], v12 offset:1536
    v_mfma_f32_16x16x32_bf16 v[196:199], a[96:99], a[12:15], v[196:199]
    buffer_load_dwordx4 v3, s[8:11], s29 offen lds
    v_mfma_f32_16x16x32_bf16 v[196:199], a[100:103], a[32:35], v[196:199]
    v_mfma_f32_16x16x32_bf16 v[164:167], a[100:103], a[28:31], v[164:167]
    s_add_u32 m0, s30, 55296
    v_mfma_f32_16x16x32_bf16 v[164:167], a[96:99], a[8:11], v[164:167]
    s_add_u32 s29, s26, 32768
    v_mfma_f32_16x16x32_bf16 v[132:135], a[96:99], a[4:7], v[132:135]
    buffer_load_dwordx4 v1, s[4:7], s29 offen lds
    v_mfma_f32_16x16x32_bf16 v[132:135], a[100:103], a[24:27], v[132:135]
    v_mfma_f32_16x16x32_bf16 v[100:103], a[100:103], a[20:23], v[100:103]
    s_add_u32 m0, s31, 57344
    v_mfma_f32_16x16x32_bf16 v[100:103], a[96:99], a[0:3], v[100:103]
    s_waitcnt lgkmcnt(6)
    s_add_u32 s29, s27, 262144
    v_mfma_f32_16x16x32_bf16 v[104:107], a[80:83], a[0:3], v[104:107]
    s_waitcnt lgkmcnt(4)
    ds_read_b64_tr_b16 a[96:97], v11 offset:8192
    ds_read_b64_tr_b16 a[98:99], v11 offset:9216
    v_mfma_f32_16x16x32_bf16 v[104:107], a[84:87], a[20:23], v[104:107]
    ds_read_b64_tr_b16 a[100:101], v11 offset:12288
    ds_read_b64_tr_b16 a[102:103], v11 offset:13312
    v_mfma_f32_16x16x32_bf16 v[136:139], a[84:87], a[24:27], v[136:139]
    buffer_load_dwordx4 v3, s[8:11], s29 offen lds
    v_mfma_f32_16x16x32_bf16 v[136:139], a[80:83], a[4:7], v[136:139]
    v_mfma_f32_16x16x32_bf16 v[168:171], a[80:83], a[8:11], v[168:171]
    s_add_u32 m0, s30, 56320
    v_mfma_f32_16x16x32_bf16 v[168:171], a[84:87], a[28:31], v[168:171]
    s_add_u32 s29, s26, 49152
    v_mfma_f32_16x16x32_bf16 v[200:203], a[84:87], a[32:35], v[200:203]
    buffer_load_dwordx4 v2, s[4:7], s29 offen lds
    v_mfma_f32_16x16x32_bf16 v[200:203], a[80:83], a[12:15], v[200:203]
    v_mfma_f32_16x16x32_bf16 v[232:235], a[80:83], a[16:19], v[232:235]
    s_add_u32 m0, s31, 58368
    v_mfma_f32_16x16x32_bf16 v[232:235], a[84:87], a[36:39], v[232:235]
    s_waitcnt lgkmcnt(6)
    s_add_u32 s29, s27, 294912
    v_mfma_f32_16x16x32_bf16 v[236:239], a[92:95], a[36:39], v[236:239]
    s_waitcnt lgkmcnt(4)
    ds_read_b64_tr_b16 a[84:85], v12 offset:12288
    ds_read_b64_tr_b16 a[86:87], v12 offset:13312
    v_mfma_f32_16x16x32_bf16 v[236:239], a[88:91], a[16:19], v[236:239]
    ds_read_b64_tr_b16 a[80:81], v12 offset:8192
    ds_read_b64_tr_b16 a[82:83], v12 offset:9216
    v_mfma_f32_16x16x32_bf16 v[204:207], a[88:91], a[12:15], v[204:207]
    buffer_load_dwordx4 v3, s[8:11], s29 offen lds
    v_mfma_f32_16x16x32_bf16 v[204:207], a[92:95], a[32:35], v[204:207]
    v_mfma_f32_16x16x32_bf16 v[172:175], a[92:95], a[28:31], v[172:175]
    s_add_u32 m0, s31, 59392
    v_mfma_f32_16x16x32_bf16 v[172:175], a[88:91], a[8:11], v[172:175]
    s_add_u32 s29, s27, 393216
    v_mfma_f32_16x16x32_bf16 v[140:143], a[88:91], a[4:7], v[140:143]
    buffer_load_dwordx4 v3, s[8:11], s29 offen lds
    v_mfma_f32_16x16x32_bf16 v[140:143], a[92:95], a[24:27], v[140:143]
    v_mfma_f32_16x16x32_bf16 v[108:111], a[92:95], a[20:23], v[108:111]
    s_add_u32 m0, s30, 57344
    v_mfma_f32_16x16x32_bf16 v[108:111], a[88:91], a[0:3], v[108:111]
    s_waitcnt lgkmcnt(6)
    s_add_u32 s29, s26, 65536
    v_mfma_f32_16x16x32_bf16 v[112:115], a[96:99], a[0:3], v[112:115]
    s_waitcnt lgkmcnt(4)
    ds_read_b64_tr_b16 a[88:89], v11 offset:8704
    ds_read_b64_tr_b16 a[90:91], v11 offset:9728
    v_mfma_f32_16x16x32_bf16 v[112:115], a[100:103], a[20:23], v[112:115]
    ds_read_b64_tr_b16 a[92:93], v11 offset:12800
    ds_read_b64_tr_b16 a[94:95], v11 offset:13824
    v_mfma_f32_16x16x32_bf16 v[144:147], a[100:103], a[24:27], v[144:147]
    buffer_load_dwordx4 v1, s[4:7], s29 offen lds
    v_mfma_f32_16x16x32_bf16 v[144:147], a[96:99], a[4:7], v[144:147]
    v_mfma_f32_16x16x32_bf16 v[176:179], a[96:99], a[8:11], v[176:179]
    s_add_u32 m0, s31, 60416
    v_mfma_f32_16x16x32_bf16 v[176:179], a[100:103], a[28:31], v[176:179]
    s_add_u32 s29, s27, 425984
    v_mfma_f32_16x16x32_bf16 v[208:211], a[100:103], a[32:35], v[208:211]
    buffer_load_dwordx4 v3, s[8:11], s29 offen lds
    v_mfma_f32_16x16x32_bf16 v[208:211], a[96:99], a[12:15], v[208:211]
    v_mfma_f32_16x16x32_bf16 v[240:243], a[96:99], a[16:19], v[240:243]
    v_mfma_f32_16x16x32_bf16 v[240:243], a[100:103], a[36:39], v[240:243]
    s_waitcnt lgkmcnt(6)
    s_add_u32 s100, s101, 32768
    v_mfma_f32_16x16x32_bf16 v[244:247], a[84:87], a[36:39], v[244:247]
    s_waitcnt lgkmcnt(4)
    ds_read_b64_tr_b16 a[100:101], v12 offset:12800
    ds_read_b64_tr_b16 a[102:103], v12 offset:13824
    v_mfma_f32_16x16x32_bf16 v[244:247], a[80:83], a[16:19], v[244:247]
    ds_read_b64_tr_b16 a[96:97], v12 offset:8704
    ds_read_b64_tr_b16 a[98:99], v12 offset:9728
    v_mfma_f32_16x16x32_bf16 v[212:215], a[80:83], a[12:15], v[212:215]
    buffer_load_dwordx4 a[120:123], v13, s[16:19], s100 offen nt
    v_mfma_f32_16x16x32_bf16 v[212:215], a[84:87], a[32:35], v[212:215]
    v_mfma_f32_16x16x32_bf16 v[180:183], a[84:87], a[28:31], v[180:183]
    v_mfma_f32_16x16x32_bf16 v[180:183], a[80:83], a[8:11], v[180:183]
    v_mfma_f32_16x16x32_bf16 v[148:151], a[80:83], a[4:7], v[148:151]
    buffer_load_dwordx4 a[124:127], v15, s[16:19], s100 offen offset:1024 nt
    v_mfma_f32_16x16x32_bf16 v[148:151], a[84:87], a[24:27], v[148:151]
    s_add_u32 s28, s25, 1
    s_and_b32 s28, s28, 1
    s_or_b32 s28, s28, 10
    s_lshl_b32 s26, s28, 7
    s_lshl_b32 s27, s28, 19
    s_add_u32 m0, s30, 106496
    s_add_u32 s29, s26, 0
    v_mfma_f32_16x16x32_bf16 v[116:119], a[84:87], a[20:23], v[116:119]
    s_waitcnt vmcnt(15) lgkmcnt(0)
    s_barrier
    v_mfma_f32_16x16x32_bf16 v[116:119], a[80:83], a[0:3], v[116:119]
    ds_read_b128 a[40:43], v4
    ds_read_b128 a[60:63], v4 offset:512
    v_mfma_f32_16x16x32_bf16 v[120:123], a[88:91], a[0:3], v[120:123]
    ds_read_b64_tr_b16 a[80:81], v7
    ds_read_b64_tr_b16 a[82:83], v7 offset:1024
    v_mfma_f32_16x16x32_bf16 v[120:123], a[92:95], a[20:23], v[120:123]
    ds_read_b64_tr_b16 a[84:85], v7 offset:4096
    ds_read_b64_tr_b16 a[86:87], v7 offset:5120
    v_mfma_f32_16x16x32_bf16 v[152:155], a[92:95], a[24:27], v[152:155]
    ds_read_b128 a[64:67], v4 offset:2560
    ds_read_b128 a[44:47], v4 offset:2048
    v_mfma_f32_16x16x32_bf16 v[152:155], a[88:91], a[4:7], v[152:155]
    ds_read_b128 a[48:51], v4 offset:4096
    ds_read_b128 a[68:71], v4 offset:4608
    v_mfma_f32_16x16x32_bf16 v[184:187], a[88:91], a[8:11], v[184:187]
    ds_read_b128 a[72:75], v4 offset:6656
    ds_read_b128 a[52:55], v4 offset:6144
    v_mfma_f32_16x16x32_bf16 v[184:187], a[92:95], a[28:31], v[184:187]
    ds_read_b128 a[56:59], v4 offset:8192
    ds_read_b128 a[76:79], v4 offset:8704
    v_mfma_f32_16x16x32_bf16 v[216:219], a[92:95], a[32:35], v[216:219]
    buffer_load_dwordx4 v1, s[4:7], s29 offen lds
    v_mfma_f32_16x16x32_bf16 v[216:219], a[88:91], a[12:15], v[216:219]
    v_mfma_f32_16x16x32_bf16 v[248:251], a[88:91], a[16:19], v[248:251]
    s_add_u32 m0, s31, 106496
    v_mfma_f32_16x16x32_bf16 v[248:251], a[92:95], a[36:39], v[248:251]
    s_add_u32 s29, s27, 0
    v_mfma_f32_16x16x32_bf16 v[252:255], a[100:103], a[36:39], v[252:255]
    ds_read_b64_tr_b16 a[92:93], v8 offset:4096
    ds_read_b64_tr_b16 a[94:95], v8 offset:5120
    v_mfma_f32_16x16x32_bf16 v[252:255], a[96:99], a[16:19], v[252:255]
    ds_read_b64_tr_b16 a[88:89], v8
    ds_read_b64_tr_b16 a[90:91], v8 offset:1024
    v_mfma_f32_16x16x32_bf16 v[220:223], a[96:99], a[12:15], v[220:223]
    buffer_load_dwordx4 v3, s[8:11], s29 offen lds
    v_mfma_f32_16x16x32_bf16 v[220:223], a[100:103], a[32:35], v[220:223]
    v_mfma_f32_16x16x32_bf16 v[188:191], a[100:103], a[28:31], v[188:191]
    s_add_u32 m0, s31, 107520
    v_mfma_f32_16x16x32_bf16 v[188:191], a[96:99], a[8:11], v[188:191]
    s_add_u32 s29, s27, 32768
    v_mfma_f32_16x16x32_bf16 v[156:159], a[96:99], a[4:7], v[156:159]
    buffer_load_dwordx4 v3, s[8:11], s29 offen lds
    v_mfma_f32_16x16x32_bf16 v[156:159], a[100:103], a[24:27], v[156:159]
    v_mfma_f32_16x16x32_bf16 v[124:127], a[100:103], a[20:23], v[124:127]
    s_add_u32 m0, s30, 107520
    v_mfma_f32_16x16x32_bf16 v[124:127], a[96:99], a[0:3], v[124:127]
    s_waitcnt lgkmcnt(14)
    s_add_u32 s29, s26, 16384
    v_mfma_f32_16x16x32_bf16 v[96:99], a[80:83], a[40:43], v[96:99]
    s_waitcnt lgkmcnt(12)
    ds_read_b64_tr_b16 a[96:97], v7 offset:512
    ds_read_b64_tr_b16 a[98:99], v7 offset:1536
    v_mfma_f32_16x16x32_bf16 v[96:99], a[84:87], a[60:63], v[96:99]
    s_waitcnt lgkmcnt(13)
    ds_read_b64_tr_b16 a[100:101], v7 offset:4608
    ds_read_b64_tr_b16 a[102:103], v7 offset:5632
    v_mfma_f32_16x16x32_bf16 v[128:131], a[84:87], a[64:67], v[128:131]
    s_waitcnt lgkmcnt(14)
    buffer_load_dwordx4 v2, s[4:7], s29 offen lds
    v_mfma_f32_16x16x32_bf16 v[128:131], a[80:83], a[44:47], v[128:131]
    s_waitcnt lgkmcnt(13)
    v_mfma_f32_16x16x32_bf16 v[160:163], a[80:83], a[48:51], v[160:163]
    s_waitcnt lgkmcnt(12)
    s_add_u32 m0, s31, 108544
    v_mfma_f32_16x16x32_bf16 v[160:163], a[84:87], a[68:71], v[160:163]
    s_waitcnt lgkmcnt(11)
    s_add_u32 s29, s27, 131072
    v_mfma_f32_16x16x32_bf16 v[192:195], a[84:87], a[72:75], v[192:195]
    s_waitcnt lgkmcnt(10)
    buffer_load_dwordx4 v3, s[8:11], s29 offen lds
    v_mfma_f32_16x16x32_bf16 v[192:195], a[80:83], a[52:55], v[192:195]
    s_waitcnt lgkmcnt(9)
    v_mfma_f32_16x16x32_bf16 v[224:227], a[80:83], a[56:59], v[224:227]
    s_waitcnt lgkmcnt(8)
    s_add_u32 m0, s31, 109568
    v_mfma_f32_16x16x32_bf16 v[224:227], a[84:87], a[76:79], v[224:227]
    s_waitcnt lgkmcnt(6)
    s_add_u32 s29, s27, 163840
    v_mfma_f32_16x16x32_bf16 v[228:231], a[92:95], a[76:79], v[228:231]
    s_waitcnt lgkmcnt(4)
    ds_read_b64_tr_b16 a[84:85], v8 offset:4608
    ds_read_b64_tr_b16 a[86:87], v8 offset:5632
    v_mfma_f32_16x16x32_bf16 v[228:231], a[88:91], a[56:59], v[228:231]
    ds_read_b64_tr_b16 a[80:81], v8 offset:512
    ds_read_b64_tr_b16 a[82:83], v8 offset:1536
    v_mfma_f32_16x16x32_bf16 v[196:199], a[88:91], a[52:55], v[196:199]
    buffer_load_dwordx4 v3, s[8:11], s29 offen lds
    v_mfma_f32_16x16x32_bf16 v[196:199], a[92:95], a[72:75], v[196:199]
    v_mfma_f32_16x16x32_bf16 v[164:167], a[92:95], a[68:71], v[164:167]
    s_add_u32 m0, s30, 108544
    v_mfma_f32_16x16x32_bf16 v[164:167], a[88:91], a[48:51], v[164:167]
    s_add_u32 s29, s26, 32768
    v_mfma_f32_16x16x32_bf16 v[132:135], a[88:91], a[44:47], v[132:135]
    buffer_load_dwordx4 v1, s[4:7], s29 offen lds
    v_mfma_f32_16x16x32_bf16 v[132:135], a[92:95], a[64:67], v[132:135]
    v_mfma_f32_16x16x32_bf16 v[100:103], a[92:95], a[60:63], v[100:103]
    s_add_u32 m0, s31, 110592
    v_mfma_f32_16x16x32_bf16 v[100:103], a[88:91], a[40:43], v[100:103]
    s_waitcnt lgkmcnt(6)
    s_add_u32 s29, s27, 262144
    v_mfma_f32_16x16x32_bf16 v[104:107], a[96:99], a[40:43], v[104:107]
    s_waitcnt lgkmcnt(4)
    ds_read_b64_tr_b16 a[88:89], v7 offset:8192
    ds_read_b64_tr_b16 a[90:91], v7 offset:9216
    v_mfma_f32_16x16x32_bf16 v[104:107], a[100:103], a[60:63], v[104:107]
    ds_read_b64_tr_b16 a[92:93], v7 offset:12288
    ds_read_b64_tr_b16 a[94:95], v7 offset:13312
    v_mfma_f32_16x16x32_bf16 v[136:139], a[100:103], a[64:67], v[136:139]
    buffer_load_dwordx4 v3, s[8:11], s29 offen lds
    v_mfma_f32_16x16x32_bf16 v[136:139], a[96:99], a[44:47], v[136:139]
    v_mfma_f32_16x16x32_bf16 v[168:171], a[96:99], a[48:51], v[168:171]
    s_add_u32 m0, s30, 109568
    v_mfma_f32_16x16x32_bf16 v[168:171], a[100:103], a[68:71], v[168:171]
    s_add_u32 s29, s26, 49152
    v_mfma_f32_16x16x32_bf16 v[200:203], a[100:103], a[72:75], v[200:203]
    buffer_load_dwordx4 v2, s[4:7], s29 offen lds
    v_mfma_f32_16x16x32_bf16 v[200:203], a[96:99], a[52:55], v[200:203]
    v_mfma_f32_16x16x32_bf16 v[232:235], a[96:99], a[56:59], v[232:235]
    s_add_u32 m0, s31, 111616
    v_mfma_f32_16x16x32_bf16 v[232:235], a[100:103], a[76:79], v[232:235]
    s_waitcnt lgkmcnt(6)
    s_add_u32 s29, s27, 294912
    v_mfma_f32_16x16x32_bf16 v[236:239], a[84:87], a[76:79], v[236:239]
    s_waitcnt lgkmcnt(4)
    ds_read_b64_tr_b16 a[100:101], v8 offset:12288
    ds_read_b64_tr_b16 a[102:103], v8 offset:13312
    v_mfma_f32_16x16x32_bf16 v[236:239], a[80:83], a[56:59], v[236:239]
    ds_read_b64_tr_b16 a[96:97], v8 offset:8192
    ds_read_b64_tr_b16 a[98:99], v8 offset:9216
    v_mfma_f32_16x16x32_bf16 v[204:207], a[80:83], a[52:55], v[204:207]
    buffer_load_dwordx4 v3, s[8:11], s29 offen lds
    v_mfma_f32_16x16x32_bf16 v[204:207], a[84:87], a[72:75], v[204:207]
    v_mfma_f32_16x16x32_bf16 v[172:175], a[84:87], a[68:71], v[172:175]
    v_mfma_f32_16x16x32_bf16 v[172:175], a[80:83], a[48:51], v[172:175]
    s_add_u32 m0, s31, 112640
    v_mfma_f32_16x16x32_bf16 v[140:143], a[80:83], a[44:47], v[140:143]
    s_add_u32 s29, s27, 393216
    v_mfma_f32_16x16x32_bf16 v[140:143], a[84:87], a[64:67], v[140:143]
    buffer_load_dwordx4 v3, s[8:11], s29 offen lds
    v_mfma_f32_16x16x32_bf16 v[108:111], a[84:87], a[60:63], v[108:111]
    v_mfma_f32_16x16x32_bf16 v[108:111], a[80:83], a[40:43], v[108:111]
    s_waitcnt lgkmcnt(6)
    s_add_u32 m0, s30, 110592
    v_mfma_f32_16x16x32_bf16 v[112:115], a[88:91], a[40:43], v[112:115]
    s_waitcnt lgkmcnt(4)
    ds_read_b64_tr_b16 a[80:81], v7 offset:8704
    ds_read_b64_tr_b16 a[82:83], v7 offset:9728
    v_mfma_f32_16x16x32_bf16 v[112:115], a[92:95], a[60:63], v[112:115]
    ds_read_b64_tr_b16 a[84:85], v7 offset:12800
    ds_read_b64_tr_b16 a[86:87], v7 offset:13824
    v_mfma_f32_16x16x32_bf16 v[144:147], a[92:95], a[64:67], v[144:147]
    s_add_u32 s29, s26, 65536
    v_mfma_f32_16x16x32_bf16 v[144:147], a[88:91], a[44:47], v[144:147]
    buffer_load_dwordx4 v1, s[4:7], s29 offen lds
    v_mfma_f32_16x16x32_bf16 v[176:179], a[88:91], a[48:51], v[176:179]
    v_mfma_f32_16x16x32_bf16 v[176:179], a[92:95], a[68:71], v[176:179]
    v_mfma_f32_16x16x32_bf16 v[208:211], a[92:95], a[72:75], v[208:211]
    v_mfma_f32_16x16x32_bf16 v[208:211], a[88:91], a[52:55], v[208:211]
    s_add_u32 m0, s31, 113664
    v_mfma_f32_16x16x32_bf16 v[240:243], a[88:91], a[56:59], v[240:243]
    s_add_u32 s29, s27, 425984
    v_mfma_f32_16x16x32_bf16 v[240:243], a[92:95], a[76:79], v[240:243]
    s_waitcnt lgkmcnt(6)
    buffer_load_dwordx4 v3, s[8:11], s29 offen lds
    v_mfma_f32_16x16x32_bf16 v[244:247], a[100:103], a[76:79], v[244:247]
    s_waitcnt lgkmcnt(4)
    ds_read_b64_tr_b16 a[92:93], v8 offset:12800
    ds_read_b64_tr_b16 a[94:95], v8 offset:13824
    v_mfma_f32_16x16x32_bf16 v[244:247], a[96:99], a[56:59], v[244:247]
    ds_read_b64_tr_b16 a[88:89], v8 offset:8704
    ds_read_b64_tr_b16 a[90:91], v8 offset:9728
    v_mfma_f32_16x16x32_bf16 v[212:215], a[96:99], a[52:55], v[212:215]
    v_mfma_f32_16x16x32_bf16 v[212:215], a[100:103], a[72:75], v[212:215]
    v_mfma_f32_16x16x32_bf16 v[180:183], a[100:103], a[68:71], v[180:183]
    v_mfma_f32_16x16x32_bf16 v[180:183], a[96:99], a[48:51], v[180:183]
    s_add_u32 s28, s25, 0
    s_and_b32 s28, s28, 1
    s_or_b32 s28, s28, 12
    v_mfma_f32_16x16x32_bf16 v[148:151], a[96:99], a[44:47], v[148:151]
    s_lshl_b32 s26, s28, 7
    s_lshl_b32 s27, s28, 19
    v_mfma_f32_16x16x32_bf16 v[148:151], a[100:103], a[64:67], v[148:151]
    s_add_u32 m0, s30, 0
    s_add_u32 s29, s26, 0
    v_mfma_f32_16x16x32_bf16 v[116:119], a[100:103], a[60:63], v[116:119]
    s_waitcnt vmcnt(15) lgkmcnt(0)
    s_barrier
    v_mfma_f32_16x16x32_bf16 v[116:119], a[96:99], a[40:43], v[116:119]
    ds_read_b128 a[0:3], v5
    ds_read_b128 a[20:23], v5 offset:512
    v_mfma_f32_16x16x32_bf16 v[120:123], a[80:83], a[40:43], v[120:123]
    ds_read_b64_tr_b16 a[96:97], v9
    ds_read_b64_tr_b16 a[98:99], v9 offset:1024
    v_mfma_f32_16x16x32_bf16 v[120:123], a[84:87], a[60:63], v[120:123]
    ds_read_b64_tr_b16 a[100:101], v9 offset:4096
    ds_read_b64_tr_b16 a[102:103], v9 offset:5120
    v_mfma_f32_16x16x32_bf16 v[152:155], a[84:87], a[64:67], v[152:155]
    ds_read_b128 a[24:27], v5 offset:2560
    ds_read_b128 a[4:7], v5 offset:2048
    v_mfma_f32_16x16x32_bf16 v[152:155], a[80:83], a[44:47], v[152:155]
    ds_read_b128 a[8:11], v5 offset:4096
    ds_read_b128 a[28:31], v5 offset:4608
    v_mfma_f32_16x16x32_bf16 v[184:187], a[80:83], a[48:51], v[184:187]
    ds_read_b128 a[32:35], v5 offset:6656
    ds_read_b128 a[12:15], v5 offset:6144
    v_mfma_f32_16x16x32_bf16 v[184:187], a[84:87], a[68:71], v[184:187]
    ds_read_b128 a[16:19], v5 offset:8192
    ds_read_b128 a[36:39], v5 offset:8704
    v_mfma_f32_16x16x32_bf16 v[216:219], a[84:87], a[72:75], v[216:219]
    buffer_load_dwordx4 v1, s[4:7], s29 offen lds
    v_mfma_f32_16x16x32_bf16 v[216:219], a[80:83], a[52:55], v[216:219]
    v_mfma_f32_16x16x32_bf16 v[248:251], a[80:83], a[56:59], v[248:251]
    s_add_u32 m0, s31, 0
    v_mfma_f32_16x16x32_bf16 v[248:251], a[84:87], a[76:79], v[248:251]
    s_add_u32 s29, s27, 0
    v_mfma_f32_16x16x32_bf16 v[252:255], a[92:95], a[76:79], v[252:255]
    ds_read_b64_tr_b16 a[84:85], v10 offset:4096
    ds_read_b64_tr_b16 a[86:87], v10 offset:5120
    v_mfma_f32_16x16x32_bf16 v[252:255], a[88:91], a[56:59], v[252:255]
    ds_read_b64_tr_b16 a[80:81], v10
    ds_read_b64_tr_b16 a[82:83], v10 offset:1024
    v_mfma_f32_16x16x32_bf16 v[220:223], a[88:91], a[52:55], v[220:223]
    buffer_load_dwordx4 v3, s[8:11], s29 offen lds
    v_mfma_f32_16x16x32_bf16 v[220:223], a[92:95], a[72:75], v[220:223]
    v_mfma_f32_16x16x32_bf16 v[188:191], a[92:95], a[68:71], v[188:191]
    s_add_u32 m0, s31, 1024
    v_mfma_f32_16x16x32_bf16 v[188:191], a[88:91], a[48:51], v[188:191]
    s_add_u32 s29, s27, 32768
    v_mfma_f32_16x16x32_bf16 v[156:159], a[88:91], a[44:47], v[156:159]
    buffer_load_dwordx4 v3, s[8:11], s29 offen lds
    v_mfma_f32_16x16x32_bf16 v[156:159], a[92:95], a[64:67], v[156:159]
    v_mfma_f32_16x16x32_bf16 v[124:127], a[92:95], a[60:63], v[124:127]
    s_add_u32 m0, s30, 1024
    v_mfma_f32_16x16x32_bf16 v[124:127], a[88:91], a[40:43], v[124:127]
    s_waitcnt lgkmcnt(14)
    s_add_u32 s29, s26, 16384
    v_mfma_f32_16x16x32_bf16 v[96:99], a[96:99], a[0:3], v[96:99]
    s_waitcnt lgkmcnt(12)
    ds_read_b64_tr_b16 a[88:89], v9 offset:512
    ds_read_b64_tr_b16 a[90:91], v9 offset:1536
    v_mfma_f32_16x16x32_bf16 v[96:99], a[100:103], a[20:23], v[96:99]
    s_waitcnt lgkmcnt(13)
    ds_read_b64_tr_b16 a[92:93], v9 offset:4608
    ds_read_b64_tr_b16 a[94:95], v9 offset:5632
    v_mfma_f32_16x16x32_bf16 v[128:131], a[100:103], a[24:27], v[128:131]
    s_waitcnt lgkmcnt(14)
    buffer_load_dwordx4 v2, s[4:7], s29 offen lds
    v_mfma_f32_16x16x32_bf16 v[128:131], a[96:99], a[4:7], v[128:131]
    s_waitcnt lgkmcnt(13)
    v_mfma_f32_16x16x32_bf16 v[160:163], a[96:99], a[8:11], v[160:163]
    s_waitcnt lgkmcnt(12)
    s_add_u32 m0, s31, 2048
    v_mfma_f32_16x16x32_bf16 v[160:163], a[100:103], a[28:31], v[160:163]
    s_waitcnt lgkmcnt(11)
    s_add_u32 s29, s27, 131072
    v_mfma_f32_16x16x32_bf16 v[192:195], a[100:103], a[32:35], v[192:195]
    s_waitcnt lgkmcnt(10)
    buffer_load_dwordx4 v3, s[8:11], s29 offen lds
    v_mfma_f32_16x16x32_bf16 v[192:195], a[96:99], a[12:15], v[192:195]
    s_waitcnt lgkmcnt(9)
    v_mfma_f32_16x16x32_bf16 v[224:227], a[96:99], a[16:19], v[224:227]
    s_waitcnt lgkmcnt(8)
    s_add_u32 m0, s31, 3072
    v_mfma_f32_16x16x32_bf16 v[224:227], a[100:103], a[36:39], v[224:227]
    s_waitcnt lgkmcnt(6)
    s_add_u32 s29, s27, 163840
    v_mfma_f32_16x16x32_bf16 v[228:231], a[84:87], a[36:39], v[228:231]
    s_waitcnt lgkmcnt(4)
    ds_read_b64_tr_b16 a[100:101], v10 offset:4608
    ds_read_b64_tr_b16 a[102:103], v10 offset:5632
    v_mfma_f32_16x16x32_bf16 v[228:231], a[80:83], a[16:19], v[228:231]
    ds_read_b64_tr_b16 a[96:97], v10 offset:512
    ds_read_b64_tr_b16 a[98:99], v10 offset:1536
    v_mfma_f32_16x16x32_bf16 v[196:199], a[80:83], a[12:15], v[196:199]
    buffer_load_dwordx4 v3, s[8:11], s29 offen lds
    v_mfma_f32_16x16x32_bf16 v[196:199], a[84:87], a[32:35], v[196:199]
    v_mfma_f32_16x16x32_bf16 v[164:167], a[84:87], a[28:31], v[164:167]
    s_add_u32 m0, s30, 2048
    v_mfma_f32_16x16x32_bf16 v[164:167], a[80:83], a[8:11], v[164:167]
    s_add_u32 s29, s26, 32768
    v_mfma_f32_16x16x32_bf16 v[132:135], a[80:83], a[4:7], v[132:135]
    buffer_load_dwordx4 v1, s[4:7], s29 offen lds
    v_mfma_f32_16x16x32_bf16 v[132:135], a[84:87], a[24:27], v[132:135]
    v_mfma_f32_16x16x32_bf16 v[100:103], a[84:87], a[20:23], v[100:103]
    s_add_u32 m0, s31, 4096
    v_mfma_f32_16x16x32_bf16 v[100:103], a[80:83], a[0:3], v[100:103]
    s_waitcnt lgkmcnt(6)
    s_add_u32 s29, s27, 262144
    v_mfma_f32_16x16x32_bf16 v[104:107], a[88:91], a[0:3], v[104:107]
    s_waitcnt lgkmcnt(4)
    ds_read_b64_tr_b16 a[80:81], v9 offset:8192
    ds_read_b64_tr_b16 a[82:83], v9 offset:9216
    v_mfma_f32_16x16x32_bf16 v[104:107], a[92:95], a[20:23], v[104:107]
    ds_read_b64_tr_b16 a[84:85], v9 offset:12288
    ds_read_b64_tr_b16 a[86:87], v9 offset:13312
    v_mfma_f32_16x16x32_bf16 v[136:139], a[92:95], a[24:27], v[136:139]
    buffer_load_dwordx4 v3, s[8:11], s29 offen lds
    v_mfma_f32_16x16x32_bf16 v[136:139], a[88:91], a[4:7], v[136:139]
    v_mfma_f32_16x16x32_bf16 v[168:171], a[88:91], a[8:11], v[168:171]
    s_add_u32 m0, s30, 3072
    v_mfma_f32_16x16x32_bf16 v[168:171], a[92:95], a[28:31], v[168:171]
    s_add_u32 s29, s26, 49152
    v_mfma_f32_16x16x32_bf16 v[200:203], a[92:95], a[32:35], v[200:203]
    buffer_load_dwordx4 v2, s[4:7], s29 offen lds
    v_mfma_f32_16x16x32_bf16 v[200:203], a[88:91], a[12:15], v[200:203]
    v_mfma_f32_16x16x32_bf16 v[232:235], a[88:91], a[16:19], v[232:235]
    s_add_u32 m0, s31, 5120
    v_mfma_f32_16x16x32_bf16 v[232:235], a[92:95], a[36:39], v[232:235]
    s_waitcnt lgkmcnt(6)
    s_add_u32 s29, s27, 294912
    v_mfma_f32_16x16x32_bf16 v[236:239], a[100:103], a[36:39], v[236:239]
    s_waitcnt lgkmcnt(4)
    ds_read_b64_tr_b16 a[92:93], v10 offset:12288
    ds_read_b64_tr_b16 a[94:95], v10 offset:13312
    v_mfma_f32_16x16x32_bf16 v[236:239], a[96:99], a[16:19], v[236:239]
    ds_read_b64_tr_b16 a[88:89], v10 offset:8192
    ds_read_b64_tr_b16 a[90:91], v10 offset:9216
    v_mfma_f32_16x16x32_bf16 v[204:207], a[96:99], a[12:15], v[204:207]
    buffer_load_dwordx4 v3, s[8:11], s29 offen lds
    v_mfma_f32_16x16x32_bf16 v[204:207], a[100:103], a[32:35], v[204:207]
    v_mfma_f32_16x16x32_bf16 v[172:175], a[100:103], a[28:31], v[172:175]
    s_add_u32 m0, s31, 6144
    v_mfma_f32_16x16x32_bf16 v[172:175], a[96:99], a[8:11], v[172:175]
    s_add_u32 s29, s27, 393216
    v_mfma_f32_16x16x32_bf16 v[140:143], a[96:99], a[4:7], v[140:143]
    buffer_load_dwordx4 v3, s[8:11], s29 offen lds
    v_mfma_f32_16x16x32_bf16 v[140:143], a[100:103], a[24:27], v[140:143]
    v_mfma_f32_16x16x32_bf16 v[108:111], a[100:103], a[20:23], v[108:111]
    s_add_u32 m0, s30, 4096
    v_mfma_f32_16x16x32_bf16 v[108:111], a[96:99], a[0:3], v[108:111]
    s_waitcnt lgkmcnt(6)
    s_add_u32 s29, s26, 65536
    v_mfma_f32_16x16x32_bf16 v[112:115], a[80:83], a[0:3], v[112:115]
    s_waitcnt lgkmcnt(4)
    ds_read_b64_tr_b16 a[96:97], v9 offset:8704
    ds_read_b64_tr_b16 a[98:99], v9 offset:9728
    v_mfma_f32_16x16x32_bf16 v[112:115], a[84:87], a[20:23], v[112:115]
    ds_read_b64_tr_b16 a[100:101], v9 offset:12800
    ds_read_b64_tr_b16 a[102:103], v9 offset:13824
    v_mfma_f32_16x16x32_bf16 v[144:147], a[84:87], a[24:27], v[144:147]
    buffer_load_dwordx4 v1, s[4:7], s29 offen lds
    v_mfma_f32_16x16x32_bf16 v[144:147], a[80:83], a[4:7], v[144:147]
    v_mfma_f32_16x16x32_bf16 v[176:179], a[80:83], a[8:11], v[176:179]
    s_add_u32 m0, s31, 7168
    v_mfma_f32_16x16x32_bf16 v[176:179], a[84:87], a[28:31], v[176:179]
    s_add_u32 s29, s27, 425984
    v_mfma_f32_16x16x32_bf16 v[208:211], a[84:87], a[32:35], v[208:211]
    buffer_load_dwordx4 v3, s[8:11], s29 offen lds
    v_mfma_f32_16x16x32_bf16 v[208:211], a[80:83], a[12:15], v[208:211]
    v_mfma_f32_16x16x32_bf16 v[240:243], a[80:83], a[16:19], v[240:243]
    v_mfma_f32_16x16x32_bf16 v[240:243], a[84:87], a[36:39], v[240:243]
    s_waitcnt lgkmcnt(6)
    v_mfma_f32_16x16x32_bf16 v[244:247], a[92:95], a[36:39], v[244:247]
    s_waitcnt lgkmcnt(4)
    ds_read_b64_tr_b16 a[84:85], v10 offset:12800
    ds_read_b64_tr_b16 a[86:87], v10 offset:13824
    v_mfma_f32_16x16x32_bf16 v[244:247], a[88:91], a[16:19], v[244:247]
    ds_read_b64_tr_b16 a[80:81], v10 offset:8704
    ds_read_b64_tr_b16 a[82:83], v10 offset:9728
    v_mfma_f32_16x16x32_bf16 v[212:215], a[88:91], a[12:15], v[212:215]
    buffer_load_dwordx4 a[128:131], v13, s[16:19], s100 offen offset:2048 nt
    v_mfma_f32_16x16x32_bf16 v[212:215], a[92:95], a[32:35], v[212:215]
    v_mfma_f32_16x16x32_bf16 v[180:183], a[92:95], a[28:31], v[180:183]
    v_mfma_f32_16x16x32_bf16 v[180:183], a[88:91], a[8:11], v[180:183]
    v_mfma_f32_16x16x32_bf16 v[148:151], a[88:91], a[4:7], v[148:151]
    buffer_load_dwordx4 a[132:135], v15, s[16:19], s100 offen offset:3072 nt
    v_mfma_f32_16x16x32_bf16 v[148:151], a[92:95], a[24:27], v[148:151]
    s_add_u32 s28, s25, 1
    s_and_b32 s28, s28, 1
    s_or_b32 s28, s28, 12
    s_lshl_b32 s26, s28, 7
    s_lshl_b32 s27, s28, 19
    s_add_u32 m0, s30, 53248
    s_add_u32 s29, s26, 0
    v_mfma_f32_16x16x32_bf16 v[116:119], a[92:95], a[20:23], v[116:119]
    s_waitcnt vmcnt(15) lgkmcnt(0)
    s_barrier
    v_mfma_f32_16x16x32_bf16 v[116:119], a[88:91], a[0:3], v[116:119]
    ds_read_b128 a[40:43], v6
    ds_read_b128 a[60:63], v6 offset:512
    v_mfma_f32_16x16x32_bf16 v[120:123], a[96:99], a[0:3], v[120:123]
    ds_read_b64_tr_b16 a[88:89], v11
    ds_read_b64_tr_b16 a[90:91], v11 offset:1024
    v_mfma_f32_16x16x32_bf16 v[120:123], a[100:103], a[20:23], v[120:123]
    ds_read_b64_tr_b16 a[92:93], v11 offset:4096
    ds_read_b64_tr_b16 a[94:95], v11 offset:5120
    v_mfma_f32_16x16x32_bf16 v[152:155], a[100:103], a[24:27], v[152:155]
    ds_read_b128 a[64:67], v6 offset:2560
    ds_read_b128 a[44:47], v6 offset:2048
    v_mfma_f32_16x16x32_bf16 v[152:155], a[96:99], a[4:7], v[152:155]
    ds_read_b128 a[48:51], v6 offset:4096
    ds_read_b128 a[68:71], v6 offset:4608
    v_mfma_f32_16x16x32_bf16 v[184:187], a[96:99], a[8:11], v[184:187]
    ds_read_b128 a[72:75], v6 offset:6656
    ds_read_b128 a[52:55], v6 offset:6144
    v_mfma_f32_16x16x32_bf16 v[184:187], a[100:103], a[28:31], v[184:187]
    ds_read_b128 a[56:59], v6 offset:8192
    ds_read_b128 a[76:79], v6 offset:8704
    v_mfma_f32_16x16x32_bf16 v[216:219], a[100:103], a[32:35], v[216:219]
    buffer_load_dwordx4 v1, s[4:7], s29 offen lds
    v_mfma_f32_16x16x32_bf16 v[216:219], a[96:99], a[12:15], v[216:219]
    v_mfma_f32_16x16x32_bf16 v[248:251], a[96:99], a[16:19], v[248:251]
    s_add_u32 m0, s31, 53248
    v_mfma_f32_16x16x32_bf16 v[248:251], a[100:103], a[36:39], v[248:251]
    s_add_u32 s29, s27, 0
    v_mfma_f32_16x16x32_bf16 v[252:255], a[84:87], a[36:39], v[252:255]
    ds_read_b64_tr_b16 a[100:101], v12 offset:4096
    ds_read_b64_tr_b16 a[102:103], v12 offset:5120
    v_mfma_f32_16x16x32_bf16 v[252:255], a[80:83], a[16:19], v[252:255]
    ds_read_b64_tr_b16 a[96:97], v12
    ds_read_b64_tr_b16 a[98:99], v12 offset:1024
    v_mfma_f32_16x16x32_bf16 v[220:223], a[80:83], a[12:15], v[220:223]
    buffer_load_dwordx4 v3, s[8:11], s29 offen lds
    v_mfma_f32_16x16x32_bf16 v[220:223], a[84:87], a[32:35], v[220:223]
    v_mfma_f32_16x16x32_bf16 v[188:191], a[84:87], a[28:31], v[188:191]
    s_add_u32 m0, s31, 54272
    v_mfma_f32_16x16x32_bf16 v[188:191], a[80:83], a[8:11], v[188:191]
    s_add_u32 s29, s27, 32768
    v_mfma_f32_16x16x32_bf16 v[156:159], a[80:83], a[4:7], v[156:159]
    buffer_load_dwordx4 v3, s[8:11], s29 offen lds
    v_mfma_f32_16x16x32_bf16 v[156:159], a[84:87], a[24:27], v[156:159]
    v_mfma_f32_16x16x32_bf16 v[124:127], a[84:87], a[20:23], v[124:127]
    s_add_u32 m0, s30, 54272
    v_mfma_f32_16x16x32_bf16 v[124:127], a[80:83], a[0:3], v[124:127]
    s_waitcnt lgkmcnt(14)
    s_add_u32 s29, s26, 16384
    v_mfma_f32_16x16x32_bf16 v[96:99], a[88:91], a[40:43], v[96:99]
    s_waitcnt lgkmcnt(12)
    ds_read_b64_tr_b16 a[80:81], v11 offset:512
    ds_read_b64_tr_b16 a[82:83], v11 offset:1536
    v_mfma_f32_16x16x32_bf16 v[96:99], a[92:95], a[60:63], v[96:99]
    s_waitcnt lgkmcnt(13)
    ds_read_b64_tr_b16 a[84:85], v11 offset:4608
    ds_read_b64_tr_b16 a[86:87], v11 offset:5632
    v_mfma_f32_16x16x32_bf16 v[128:131], a[92:95], a[64:67], v[128:131]
    s_waitcnt lgkmcnt(14)
    buffer_load_dwordx4 v2, s[4:7], s29 offen lds
    v_mfma_f32_16x16x32_bf16 v[128:131], a[88:91], a[44:47], v[128:131]
    s_waitcnt lgkmcnt(13)
    v_mfma_f32_16x16x32_bf16 v[160:163], a[88:91], a[48:51], v[160:163]
    s_waitcnt lgkmcnt(12)
    s_add_u32 m0, s31, 55296
    v_mfma_f32_16x16x32_bf16 v[160:163], a[92:95], a[68:71], v[160:163]
    s_waitcnt lgkmcnt(11)
    s_add_u32 s29, s27, 131072
    v_mfma_f32_16x16x32_bf16 v[192:195], a[92:95], a[72:75], v[192:195]
    s_waitcnt lgkmcnt(10)
    buffer_load_dwordx4 v3, s[8:11], s29 offen lds
    v_mfma_f32_16x16x32_bf16 v[192:195], a[88:91], a[52:55], v[192:195]
    s_waitcnt lgkmcnt(9)
    v_mfma_f32_16x16x32_bf16 v[224:227], a[88:91], a[56:59], v[224:227]
    s_waitcnt lgkmcnt(8)
    s_add_u32 m0, s31, 56320
    v_mfma_f32_16x16x32_bf16 v[224:227], a[92:95], a[76:79], v[224:227]
    s_waitcnt lgkmcnt(6)
    s_add_u32 s29, s27, 163840
    v_mfma_f32_16x16x32_bf16 v[228:231], a[100:103], a[76:79], v[228:231]
    s_waitcnt lgkmcnt(4)
    ds_read_b64_tr_b16 a[92:93], v12 offset:4608
    ds_read_b64_tr_b16 a[94:95], v12 offset:5632
    v_mfma_f32_16x16x32_bf16 v[228:231], a[96:99], a[56:59], v[228:231]
    ds_read_b64_tr_b16 a[88:89], v12 offset:512
    ds_read_b64_tr_b16 a[90:91], v12 offset:1536
    v_mfma_f32_16x16x32_bf16 v[196:199], a[96:99], a[52:55], v[196:199]
    buffer_load_dwordx4 v3, s[8:11], s29 offen lds
    v_mfma_f32_16x16x32_bf16 v[196:199], a[100:103], a[72:75], v[196:199]
    v_mfma_f32_16x16x32_bf16 v[164:167], a[100:103], a[68:71], v[164:167]
    s_add_u32 m0, s30, 55296
    v_mfma_f32_16x16x32_bf16 v[164:167], a[96:99], a[48:51], v[164:167]
    s_add_u32 s29, s26, 32768
    v_mfma_f32_16x16x32_bf16 v[132:135], a[96:99], a[44:47], v[132:135]
    buffer_load_dwordx4 v1, s[4:7], s29 offen lds
    v_mfma_f32_16x16x32_bf16 v[132:135], a[100:103], a[64:67], v[132:135]
    v_mfma_f32_16x16x32_bf16 v[100:103], a[100:103], a[60:63], v[100:103]
    s_add_u32 m0, s31, 57344
    v_mfma_f32_16x16x32_bf16 v[100:103], a[96:99], a[40:43], v[100:103]
    s_waitcnt lgkmcnt(6)
    s_add_u32 s29, s27, 262144
    v_mfma_f32_16x16x32_bf16 v[104:107], a[80:83], a[40:43], v[104:107]
    s_waitcnt lgkmcnt(4)
    ds_read_b64_tr_b16 a[96:97], v11 offset:8192
    ds_read_b64_tr_b16 a[98:99], v11 offset:9216
    v_mfma_f32_16x16x32_bf16 v[104:107], a[84:87], a[60:63], v[104:107]
    ds_read_b64_tr_b16 a[100:101], v11 offset:12288
    ds_read_b64_tr_b16 a[102:103], v11 offset:13312
    v_mfma_f32_16x16x32_bf16 v[136:139], a[84:87], a[64:67], v[136:139]
    buffer_load_dwordx4 v3, s[8:11], s29 offen lds
    v_mfma_f32_16x16x32_bf16 v[136:139], a[80:83], a[44:47], v[136:139]
    v_mfma_f32_16x16x32_bf16 v[168:171], a[80:83], a[48:51], v[168:171]
    s_add_u32 m0, s30, 56320
    v_mfma_f32_16x16x32_bf16 v[168:171], a[84:87], a[68:71], v[168:171]
    s_add_u32 s29, s26, 49152
    v_mfma_f32_16x16x32_bf16 v[200:203], a[84:87], a[72:75], v[200:203]
    buffer_load_dwordx4 v2, s[4:7], s29 offen lds
    v_mfma_f32_16x16x32_bf16 v[200:203], a[80:83], a[52:55], v[200:203]
    v_mfma_f32_16x16x32_bf16 v[232:235], a[80:83], a[56:59], v[232:235]
    s_add_u32 m0, s31, 58368
    v_mfma_f32_16x16x32_bf16 v[232:235], a[84:87], a[76:79], v[232:235]
    s_waitcnt lgkmcnt(6)
    s_add_u32 s29, s27, 294912
    v_mfma_f32_16x16x32_bf16 v[236:239], a[92:95], a[76:79], v[236:239]
    s_waitcnt lgkmcnt(4)
    ds_read_b64_tr_b16 a[84:85], v12 offset:12288
    ds_read_b64_tr_b16 a[86:87], v12 offset:13312
    v_mfma_f32_16x16x32_bf16 v[236:239], a[88:91], a[56:59], v[236:239]
    ds_read_b64_tr_b16 a[80:81], v12 offset:8192
    ds_read_b64_tr_b16 a[82:83], v12 offset:9216
    v_mfma_f32_16x16x32_bf16 v[204:207], a[88:91], a[52:55], v[204:207]
    buffer_load_dwordx4 v3, s[8:11], s29 offen lds
    v_mfma_f32_16x16x32_bf16 v[204:207], a[92:95], a[72:75], v[204:207]
    v_mfma_f32_16x16x32_bf16 v[172:175], a[92:95], a[68:71], v[172:175]
    v_mfma_f32_16x16x32_bf16 v[172:175], a[88:91], a[48:51], v[172:175]
    s_add_u32 m0, s31, 59392
    v_mfma_f32_16x16x32_bf16 v[140:143], a[88:91], a[44:47], v[140:143]
    s_add_u32 s29, s27, 393216
    v_mfma_f32_16x16x32_bf16 v[140:143], a[92:95], a[64:67], v[140:143]
    buffer_load_dwordx4 v3, s[8:11], s29 offen lds
    v_mfma_f32_16x16x32_bf16 v[108:111], a[92:95], a[60:63], v[108:111]
    v_mfma_f32_16x16x32_bf16 v[108:111], a[88:91], a[40:43], v[108:111]
    s_waitcnt lgkmcnt(6)
    s_add_u32 m0, s30, 57344
    v_mfma_f32_16x16x32_bf16 v[112:115], a[96:99], a[40:43], v[112:115]
    s_waitcnt lgkmcnt(4)
    ds_read_b64_tr_b16 a[88:89], v11 offset:8704
    ds_read_b64_tr_b16 a[90:91], v11 offset:9728
    v_mfma_f32_16x16x32_bf16 v[112:115], a[100:103], a[60:63], v[112:115]
    ds_read_b64_tr_b16 a[92:93], v11 offset:12800
    ds_read_b64_tr_b16 a[94:95], v11 offset:13824
    v_mfma_f32_16x16x32_bf16 v[144:147], a[100:103], a[64:67], v[144:147]
    s_add_u32 s29, s26, 65536
    v_mfma_f32_16x16x32_bf16 v[144:147], a[96:99], a[44:47], v[144:147]
    buffer_load_dwordx4 v1, s[4:7], s29 offen lds
    v_mfma_f32_16x16x32_bf16 v[176:179], a[96:99], a[48:51], v[176:179]
    v_mfma_f32_16x16x32_bf16 v[176:179], a[100:103], a[68:71], v[176:179]
    v_mfma_f32_16x16x32_bf16 v[208:211], a[100:103], a[72:75], v[208:211]
    v_mfma_f32_16x16x32_bf16 v[208:211], a[96:99], a[52:55], v[208:211]
    s_add_u32 m0, s31, 60416
    v_mfma_f32_16x16x32_bf16 v[240:243], a[96:99], a[56:59], v[240:243]
    s_add_u32 s29, s27, 425984
    v_mfma_f32_16x16x32_bf16 v[240:243], a[100:103], a[76:79], v[240:243]
    s_waitcnt lgkmcnt(6)
    buffer_load_dwordx4 v3, s[8:11], s29 offen lds
    v_mfma_f32_16x16x32_bf16 v[244:247], a[84:87], a[76:79], v[244:247]
    s_waitcnt lgkmcnt(4)
    ds_read_b64_tr_b16 a[100:101], v12 offset:12800
    ds_read_b64_tr_b16 a[102:103], v12 offset:13824
    v_mfma_f32_16x16x32_bf16 v[244:247], a[80:83], a[56:59], v[244:247]
    ds_read_b64_tr_b16 a[96:97], v12 offset:8704
    ds_read_b64_tr_b16 a[98:99], v12 offset:9728
    v_mfma_f32_16x16x32_bf16 v[212:215], a[80:83], a[52:55], v[212:215]
    v_mfma_f32_16x16x32_bf16 v[212:215], a[84:87], a[72:75], v[212:215]
    v_mfma_f32_16x16x32_bf16 v[180:183], a[84:87], a[68:71], v[180:183]
    v_mfma_f32_16x16x32_bf16 v[180:183], a[80:83], a[48:51], v[180:183]
    s_add_u32 s28, s25, 0
    s_and_b32 s28, s28, 1
    s_or_b32 s28, s28, 14
    v_mfma_f32_16x16x32_bf16 v[148:151], a[80:83], a[44:47], v[148:151]
    s_lshl_b32 s26, s28, 7
    s_lshl_b32 s27, s28, 19
    v_mfma_f32_16x16x32_bf16 v[148:151], a[84:87], a[64:67], v[148:151]
    s_add_u32 m0, s30, 106496
    s_add_u32 s29, s26, 0
    v_mfma_f32_16x16x32_bf16 v[116:119], a[84:87], a[60:63], v[116:119]
    s_waitcnt vmcnt(15) lgkmcnt(0)
    s_barrier
    v_mfma_f32_16x16x32_bf16 v[116:119], a[80:83], a[40:43], v[116:119]
    ds_read_b128 a[0:3], v4
    ds_read_b128 a[20:23], v4 offset:512
    v_mfma_f32_16x16x32_bf16 v[120:123], a[88:91], a[40:43], v[120:123]
    ds_read_b64_tr_b16 a[80:81], v7
    ds_read_b64_tr_b16 a[82:83], v7 offset:1024
    v_mfma_f32_16x16x32_bf16 v[120:123], a[92:95], a[60:63], v[120:123]
    ds_read_b64_tr_b16 a[84:85], v7 offset:4096
    ds_read_b64_tr_b16 a[86:87], v7 offset:5120
    v_mfma_f32_16x16x32_bf16 v[152:155], a[92:95], a[64:67], v[152:155]
    ds_read_b128 a[24:27], v4 offset:2560
    ds_read_b128 a[4:7], v4 offset:2048
    v_mfma_f32_16x16x32_bf16 v[152:155], a[88:91], a[44:47], v[152:155]
    ds_read_b128 a[8:11], v4 offset:4096
    ds_read_b128 a[28:31], v4 offset:4608
    v_mfma_f32_16x16x32_bf16 v[184:187], a[88:91], a[48:51], v[184:187]
    ds_read_b128 a[32:35], v4 offset:6656
    ds_read_b128 a[12:15], v4 offset:6144
    v_mfma_f32_16x16x32_bf16 v[184:187], a[92:95], a[68:71], v[184:187]
    ds_read_b128 a[16:19], v4 offset:8192
    ds_read_b128 a[36:39], v4 offset:8704
    v_mfma_f32_16x16x32_bf16 v[216:219], a[92:95], a[72:75], v[216:219]
    buffer_load_dwordx4 v1, s[4:7], s29 offen lds
    v_mfma_f32_16x16x32_bf16 v[216:219], a[88:91], a[52:55], v[216:219]
    v_mfma_f32_16x16x32_bf16 v[248:251], a[88:91], a[56:59], v[248:251]
    s_add_u32 m0, s31, 106496
    v_mfma_f32_16x16x32_bf16 v[248:251], a[92:95], a[76:79], v[248:251]
    s_add_u32 s29, s27, 0
    v_mfma_f32_16x16x32_bf16 v[252:255], a[100:103], a[76:79], v[252:255]
    ds_read_b64_tr_b16 a[92:93], v8 offset:4096
    ds_read_b64_tr_b16 a[94:95], v8 offset:5120
    v_mfma_f32_16x16x32_bf16 v[252:255], a[96:99], a[56:59], v[252:255]
    ds_read_b64_tr_b16 a[88:89], v8
    ds_read_b64_tr_b16 a[90:91], v8 offset:1024
    v_mfma_f32_16x16x32_bf16 v[220:223], a[96:99], a[52:55], v[220:223]
    buffer_load_dwordx4 v3, s[8:11], s29 offen lds
    v_mfma_f32_16x16x32_bf16 v[220:223], a[100:103], a[72:75], v[220:223]
    v_mfma_f32_16x16x32_bf16 v[188:191], a[100:103], a[68:71], v[188:191]
    s_add_u32 m0, s31, 107520
    v_mfma_f32_16x16x32_bf16 v[188:191], a[96:99], a[48:51], v[188:191]
    s_add_u32 s29, s27, 32768
    v_mfma_f32_16x16x32_bf16 v[156:159], a[96:99], a[44:47], v[156:159]
    buffer_load_dwordx4 v3, s[8:11], s29 offen lds
    v_mfma_f32_16x16x32_bf16 v[156:159], a[100:103], a[64:67], v[156:159]
    v_mfma_f32_16x16x32_bf16 v[124:127], a[100:103], a[60:63], v[124:127]
    s_add_u32 m0, s30, 107520
    v_mfma_f32_16x16x32_bf16 v[124:127], a[96:99], a[40:43], v[124:127]
    s_waitcnt lgkmcnt(14)
    s_add_u32 s29, s26, 16384
    v_mfma_f32_16x16x32_bf16 v[96:99], a[80:83], a[0:3], v[96:99]
    s_waitcnt lgkmcnt(12)
    ds_read_b64_tr_b16 a[96:97], v7 offset:512
    ds_read_b64_tr_b16 a[98:99], v7 offset:1536
    v_mfma_f32_16x16x32_bf16 v[96:99], a[84:87], a[20:23], v[96:99]
    s_waitcnt lgkmcnt(13)
    ds_read_b64_tr_b16 a[100:101], v7 offset:4608
    ds_read_b64_tr_b16 a[102:103], v7 offset:5632
    v_mfma_f32_16x16x32_bf16 v[128:131], a[84:87], a[24:27], v[128:131]
    s_waitcnt lgkmcnt(14)
    buffer_load_dwordx4 v2, s[4:7], s29 offen lds
    v_mfma_f32_16x16x32_bf16 v[128:131], a[80:83], a[4:7], v[128:131]
    s_waitcnt lgkmcnt(13)
    v_mfma_f32_16x16x32_bf16 v[160:163], a[80:83], a[8:11], v[160:163]
    s_waitcnt lgkmcnt(12)
    s_add_u32 m0, s31, 108544
    v_mfma_f32_16x16x32_bf16 v[160:163], a[84:87], a[28:31], v[160:163]
    s_waitcnt lgkmcnt(11)
    s_add_u32 s29, s27, 131072
    v_mfma_f32_16x16x32_bf16 v[192:195], a[84:87], a[32:35], v[192:195]
    s_waitcnt lgkmcnt(10)
    buffer_load_dwordx4 v3, s[8:11], s29 offen lds
    v_mfma_f32_16x16x32_bf16 v[192:195], a[80:83], a[12:15], v[192:195]
    s_waitcnt lgkmcnt(9)
    v_mfma_f32_16x16x32_bf16 v[224:227], a[80:83], a[16:19], v[224:227]
    s_waitcnt lgkmcnt(8)
    s_add_u32 m0, s31, 109568
    v_mfma_f32_16x16x32_bf16 v[224:227], a[84:87], a[36:39], v[224:227]
    s_waitcnt lgkmcnt(6)
    s_add_u32 s29, s27, 163840
    v_mfma_f32_16x16x32_bf16 v[228:231], a[92:95], a[36:39], v[228:231]
    s_waitcnt lgkmcnt(4)
    ds_read_b64_tr_b16 a[84:85], v8 offset:4608
    ds_read_b64_tr_b16 a[86:87], v8 offset:5632
    v_mfma_f32_16x16x32_bf16 v[228:231], a[88:91], a[16:19], v[228:231]
    ds_read_b64_tr_b16 a[80:81], v8 offset:512
    ds_read_b64_tr_b16 a[82:83], v8 offset:1536
    v_mfma_f32_16x16x32_bf16 v[196:199], a[88:91], a[12:15], v[196:199]
    buffer_load_dwordx4 v3, s[8:11], s29 offen lds
    v_mfma_f32_16x16x32_bf16 v[196:199], a[92:95], a[32:35], v[196:199]
    v_mfma_f32_16x16x32_bf16 v[164:167], a[92:95], a[28:31], v[164:167]
    s_add_u32 m0, s30, 108544
    v_mfma_f32_16x16x32_bf16 v[164:167], a[88:91], a[8:11], v[164:167]
    s_add_u32 s29, s26, 32768
    v_mfma_f32_16x16x32_bf16 v[132:135], a[88:91], a[4:7], v[132:135]
    buffer_load_dwordx4 v1, s[4:7], s29 offen lds
    v_mfma_f32_16x16x32_bf16 v[132:135], a[92:95], a[24:27], v[132:135]
    v_mfma_f32_16x16x32_bf16 v[100:103], a[92:95], a[20:23], v[100:103]
    s_add_u32 m0, s31, 110592
    v_mfma_f32_16x16x32_bf16 v[100:103], a[88:91], a[0:3], v[100:103]
    s_waitcnt lgkmcnt(6)
    s_add_u32 s29, s27, 262144
    v_mfma_f32_16x16x32_bf16 v[104:107], a[96:99], a[0:3], v[104:107]
    s_waitcnt lgkmcnt(4)
    ds_read_b64_tr_b16 a[88:89], v7 offset:8192
    ds_read_b64_tr_b16 a[90:91], v7 offset:9216
    v_mfma_f32_16x16x32_bf16 v[104:107], a[100:103], a[20:23], v[104:107]
    ds_read_b64_tr_b16 a[92:93], v7 offset:12288
    ds_read_b64_tr_b16 a[94:95], v7 offset:13312
    v_mfma_f32_16x16x32_bf16 v[136:139], a[100:103], a[24:27], v[136:139]
    buffer_load_dwordx4 v3, s[8:11], s29 offen lds
    v_mfma_f32_16x16x32_bf16 v[136:139], a[96:99], a[4:7], v[136:139]
    v_mfma_f32_16x16x32_bf16 v[168:171], a[96:99], a[8:11], v[168:171]
    s_add_u32 m0, s30, 109568
    v_mfma_f32_16x16x32_bf16 v[168:171], a[100:103], a[28:31], v[168:171]
    s_add_u32 s29, s26, 49152
    v_mfma_f32_16x16x32_bf16 v[200:203], a[100:103], a[32:35], v[200:203]
    buffer_load_dwordx4 v2, s[4:7], s29 offen lds
    v_mfma_f32_16x16x32_bf16 v[200:203], a[96:99], a[12:15], v[200:203]
    v_mfma_f32_16x16x32_bf16 v[232:235], a[96:99], a[16:19], v[232:235]
    s_add_u32 m0, s31, 111616
    v_mfma_f32_16x16x32_bf16 v[232:235], a[100:103], a[36:39], v[232:235]
    s_waitcnt lgkmcnt(6)
    s_add_u32 s29, s27, 294912
    v_mfma_f32_16x16x32_bf16 v[236:239], a[84:87], a[36:39], v[236:239]
    s_waitcnt lgkmcnt(4)
    ds_read_b64_tr_b16 a[100:101], v8 offset:12288
    ds_read_b64_tr_b16 a[102:103], v8 offset:13312
    v_mfma_f32_16x16x32_bf16 v[236:239], a[80:83], a[16:19], v[236:239]
    ds_read_b64_tr_b16 a[96:97], v8 offset:8192
    ds_read_b64_tr_b16 a[98:99], v8 offset:9216
    v_mfma_f32_16x16x32_bf16 v[204:207], a[80:83], a[12:15], v[204:207]
    buffer_load_dwordx4 v3, s[8:11], s29 offen lds
    v_mfma_f32_16x16x32_bf16 v[204:207], a[84:87], a[32:35], v[204:207]
    v_mfma_f32_16x16x32_bf16 v[172:175], a[84:87], a[28:31], v[172:175]
    s_add_u32 m0, s31, 112640
    v_mfma_f32_16x16x32_bf16 v[172:175], a[80:83], a[8:11], v[172:175]
    s_add_u32 s29, s27, 393216
    v_mfma_f32_16x16x32_bf16 v[140:143], a[80:83], a[4:7], v[140:143]
    buffer_load_dwordx4 v3, s[8:11], s29 offen lds
    v_mfma_f32_16x16x32_bf16 v[140:143], a[84:87], a[24:27], v[140:143]
    v_mfma_f32_16x16x32_bf16 v[108:111], a[84:87], a[20:23], v[108:111]
    s_add_u32 m0, s30, 110592
    v_mfma_f32_16x16x32_bf16 v[108:111], a[80:83], a[0:3], v[108:111]
    s_waitcnt lgkmcnt(6)
    s_add_u32 s29, s26, 65536
    v_mfma_f32_16x16x32_bf16 v[112:115], a[88:91], a[0:3], v[112:115]
    s_waitcnt lgkmcnt(4)
    ds_read_b64_tr_b16 a[80:81], v7 offset:8704
    ds_read_b64_tr_b16 a[82:83], v7 offset:9728
    v_mfma_f32_16x16x32_bf16 v[112:115], a[92:95], a[20:23], v[112:115]
    ds_read_b64_tr_b16 a[84:85], v7 offset:12800
    ds_read_b64_tr_b16 a[86:87], v7 offset:13824
    v_mfma_f32_16x16x32_bf16 v[144:147], a[92:95], a[24:27], v[144:147]
    buffer_load_dwordx4 v1, s[4:7], s29 offen lds
    v_mfma_f32_16x16x32_bf16 v[144:147], a[88:91], a[4:7], v[144:147]
    v_mfma_f32_16x16x32_bf16 v[176:179], a[88:91], a[8:11], v[176:179]
    s_add_u32 m0, s31, 113664
    v_mfma_f32_16x16x32_bf16 v[176:179], a[92:95], a[28:31], v[176:179]
    s_add_u32 s29, s27, 425984
    v_mfma_f32_16x16x32_bf16 v[208:211], a[92:95], a[32:35], v[208:211]
    buffer_load_dwordx4 v3, s[8:11], s29 offen lds
    v_mfma_f32_16x16x32_bf16 v[208:211], a[88:91], a[12:15], v[208:211]
    v_mfma_f32_16x16x32_bf16 v[240:243], a[88:91], a[16:19], v[240:243]
    v_mfma_f32_16x16x32_bf16 v[240:243], a[92:95], a[36:39], v[240:243]
    s_waitcnt lgkmcnt(6)
    v_mfma_f32_16x16x32_bf16 v[244:247], a[100:103], a[36:39], v[244:247]
    s_waitcnt lgkmcnt(4)
    ds_read_b64_tr_b16 a[92:93], v8 offset:12800
    ds_read_b64_tr_b16 a[94:95], v8 offset:13824
    v_mfma_f32_16x16x32_bf16 v[244:247], a[96:99], a[16:19], v[244:247]
    ds_read_b64_tr_b16 a[88:89], v8 offset:8704
    ds_read_b64_tr_b16 a[90:91], v8 offset:9728
    v_mfma_f32_16x16x32_bf16 v[212:215], a[96:99], a[12:15], v[212:215]
    v_mfma_f32_16x16x32_bf16 v[212:215], a[100:103], a[32:35], v[212:215]
    v_mfma_f32_16x16x32_bf16 v[180:183], a[100:103], a[28:31], v[180:183]
    v_mfma_f32_16x16x32_bf16 v[180:183], a[96:99], a[8:11], v[180:183]
    s_add_u32 s28, s25, 1
    s_and_b32 s28, s28, 1
    s_or_b32 s28, s28, 14
    v_mfma_f32_16x16x32_bf16 v[148:151], a[96:99], a[4:7], v[148:151]
    s_lshl_b32 s26, s28, 7
    s_lshl_b32 s27, s28, 19
    v_mfma_f32_16x16x32_bf16 v[148:151], a[100:103], a[24:27], v[148:151]
    s_add_u32 m0, s30, 0
    s_add_u32 s29, s26, 0
    v_mfma_f32_16x16x32_bf16 v[116:119], a[100:103], a[20:23], v[116:119]
    s_waitcnt vmcnt(13) lgkmcnt(0)
    s_barrier
    v_mfma_f32_16x16x32_bf16 v[116:119], a[96:99], a[0:3], v[116:119]
    ds_read_b128 a[40:43], v5
    ds_read_b128 a[60:63], v5 offset:512
    v_mfma_f32_16x16x32_bf16 v[120:123], a[80:83], a[0:3], v[120:123]
    ds_read_b64_tr_b16 a[96:97], v9
    ds_read_b64_tr_b16 a[98:99], v9 offset:1024
    v_mfma_f32_16x16x32_bf16 v[120:123], a[84:87], a[20:23], v[120:123]
    ds_read_b64_tr_b16 a[100:101], v9 offset:4096
    ds_read_b64_tr_b16 a[102:103], v9 offset:5120
    v_mfma_f32_16x16x32_bf16 v[152:155], a[84:87], a[24:27], v[152:155]
    ds_read_b128 a[64:67], v5 offset:2560
    ds_read_b128 a[44:47], v5 offset:2048
    v_mfma_f32_16x16x32_bf16 v[152:155], a[80:83], a[4:7], v[152:155]
    ds_read_b128 a[48:51], v5 offset:4096
    ds_read_b128 a[68:71], v5 offset:4608
    v_mfma_f32_16x16x32_bf16 v[184:187], a[80:83], a[8:11], v[184:187]
    ds_read_b128 a[72:75], v5 offset:6656
    ds_read_b128 a[52:55], v5 offset:6144
    v_mfma_f32_16x16x32_bf16 v[184:187], a[84:87], a[28:31], v[184:187]
    ds_read_b128 a[56:59], v5 offset:8192
    ds_read_b128 a[76:79], v5 offset:8704
    v_mfma_f32_16x16x32_bf16 v[216:219], a[84:87], a[32:35], v[216:219]
    buffer_load_dwordx4 v1, s[4:7], s29 offen lds
    v_mfma_f32_16x16x32_bf16 v[216:219], a[80:83], a[12:15], v[216:219]
    v_mfma_f32_16x16x32_bf16 v[248:251], a[80:83], a[16:19], v[248:251]
    s_add_u32 m0, s31, 0
    v_mfma_f32_16x16x32_bf16 v[248:251], a[84:87], a[36:39], v[248:251]
    s_add_u32 s29, s27, 0
    v_mfma_f32_16x16x32_bf16 v[252:255], a[92:95], a[36:39], v[252:255]
    ds_read_b64_tr_b16 a[84:85], v10 offset:4096
    ds_read_b64_tr_b16 a[86:87], v10 offset:5120
    v_mfma_f32_16x16x32_bf16 v[252:255], a[88:91], a[16:19], v[252:255]
    ds_read_b64_tr_b16 a[80:81], v10
    ds_read_b64_tr_b16 a[82:83], v10 offset:1024
    v_mfma_f32_16x16x32_bf16 v[220:223], a[88:91], a[12:15], v[220:223]
    buffer_load_dwordx4 v3, s[8:11], s29 offen lds
    v_mfma_f32_16x16x32_bf16 v[220:223], a[92:95], a[32:35], v[220:223]
    v_mfma_f32_16x16x32_bf16 v[188:191], a[92:95], a[28:31], v[188:191]
    s_add_u32 m0, s31, 1024
    v_mfma_f32_16x16x32_bf16 v[188:191], a[88:91], a[8:11], v[188:191]
    s_add_u32 s29, s27, 32768
    v_mfma_f32_16x16x32_bf16 v[156:159], a[88:91], a[4:7], v[156:159]
    buffer_load_dwordx4 v3, s[8:11], s29 offen lds
    v_mfma_f32_16x16x32_bf16 v[156:159], a[92:95], a[24:27], v[156:159]
    v_mfma_f32_16x16x32_bf16 v[124:127], a[92:95], a[20:23], v[124:127]
    s_add_u32 m0, s30, 1024
    v_mfma_f32_16x16x32_bf16 v[124:127], a[88:91], a[0:3], v[124:127]
    s_waitcnt lgkmcnt(14)
    s_add_u32 s29, s26, 16384
    v_mfma_f32_16x16x32_bf16 v[96:99], a[96:99], a[40:43], v[96:99]
    s_waitcnt lgkmcnt(12)
    ds_read_b64_tr_b16 a[88:89], v9 offset:512
    ds_read_b64_tr_b16 a[90:91], v9 offset:1536
    v_mfma_f32_16x16x32_bf16 v[96:99], a[100:103], a[60:63], v[96:99]
    s_waitcnt lgkmcnt(13)
    ds_read_b64_tr_b16 a[92:93], v9 offset:4608
    ds_read_b64_tr_b16 a[94:95], v9 offset:5632
    v_mfma_f32_16x16x32_bf16 v[128:131], a[100:103], a[64:67], v[128:131]
    s_waitcnt lgkmcnt(14)
    buffer_load_dwordx4 v2, s[4:7], s29 offen lds
    v_mfma_f32_16x16x32_bf16 v[128:131], a[96:99], a[44:47], v[128:131]
    s_waitcnt lgkmcnt(13)
    v_mfma_f32_16x16x32_bf16 v[160:163], a[96:99], a[48:51], v[160:163]
    s_waitcnt lgkmcnt(12)
    s_add_u32 m0, s31, 2048
    v_mfma_f32_16x16x32_bf16 v[160:163], a[100:103], a[68:71], v[160:163]
    s_waitcnt lgkmcnt(11)
    s_add_u32 s29, s27, 131072
    v_mfma_f32_16x16x32_bf16 v[192:195], a[100:103], a[72:75], v[192:195]
    s_waitcnt lgkmcnt(10)
    buffer_load_dwordx4 v3, s[8:11], s29 offen lds
    v_mfma_f32_16x16x32_bf16 v[192:195], a[96:99], a[52:55], v[192:195]
    s_waitcnt lgkmcnt(9)
    v_mfma_f32_16x16x32_bf16 v[224:227], a[96:99], a[56:59], v[224:227]
    s_waitcnt lgkmcnt(8)
    s_add_u32 m0, s31, 3072
    v_mfma_f32_16x16x32_bf16 v[224:227], a[100:103], a[76:79], v[224:227]
    s_waitcnt lgkmcnt(6)
    s_add_u32 s29, s27, 163840
    v_mfma_f32_16x16x32_bf16 v[228:231], a[84:87], a[76:79], v[228:231]
    s_waitcnt lgkmcnt(4)
    ds_read_b64_tr_b16 a[100:101], v10 offset:4608
    ds_read_b64_tr_b16 a[102:103], v10 offset:5632
    v_mfma_f32_16x16x32_bf16 v[228:231], a[80:83], a[56:59], v[228:231]
    ds_read_b64_tr_b16 a[96:97], v10 offset:512
    ds_read_b64_tr_b16 a[98:99], v10 offset:1536
    v_mfma_f32_16x16x32_bf16 v[196:199], a[80:83], a[52:55], v[196:199]
    buffer_load_dwordx4 v3, s[8:11], s29 offen lds
    v_mfma_f32_16x16x32_bf16 v[196:199], a[84:87], a[72:75], v[196:199]
    v_mfma_f32_16x16x32_bf16 v[164:167], a[84:87], a[68:71], v[164:167]
    s_add_u32 m0, s30, 2048
    v_mfma_f32_16x16x32_bf16 v[164:167], a[80:83], a[48:51], v[164:167]
    s_add_u32 s29, s26, 32768
    v_mfma_f32_16x16x32_bf16 v[132:135], a[80:83], a[44:47], v[132:135]
    buffer_load_dwordx4 v1, s[4:7], s29 offen lds
    v_mfma_f32_16x16x32_bf16 v[132:135], a[84:87], a[64:67], v[132:135]
    v_mfma_f32_16x16x32_bf16 v[100:103], a[84:87], a[60:63], v[100:103]
    s_add_u32 m0, s31, 4096
    v_mfma_f32_16x16x32_bf16 v[100:103], a[80:83], a[40:43], v[100:103]
    s_waitcnt lgkmcnt(6)
    s_add_u32 s29, s27, 262144
    v_mfma_f32_16x16x32_bf16 v[104:107], a[88:91], a[40:43], v[104:107]
    s_waitcnt lgkmcnt(4)
    ds_read_b64_tr_b16 a[80:81], v9 offset:8192
    ds_read_b64_tr_b16 a[82:83], v9 offset:9216
    v_mfma_f32_16x16x32_bf16 v[104:107], a[92:95], a[60:63], v[104:107]
    ds_read_b64_tr_b16 a[84:85], v9 offset:12288
    ds_read_b64_tr_b16 a[86:87], v9 offset:13312
    v_mfma_f32_16x16x32_bf16 v[136:139], a[92:95], a[64:67], v[136:139]
    buffer_load_dwordx4 v3, s[8:11], s29 offen lds
    v_mfma_f32_16x16x32_bf16 v[136:139], a[88:91], a[44:47], v[136:139]
    v_mfma_f32_16x16x32_bf16 v[168:171], a[88:91], a[48:51], v[168:171]
    v_mfma_f32_16x16x32_bf16 v[168:171], a[92:95], a[68:71], v[168:171]
    s_add_u32 m0, s30, 3072
    v_mfma_f32_16x16x32_bf16 v[200:203], a[92:95], a[72:75], v[200:203]
    s_add_u32 s29, s26, 49152
    v_mfma_f32_16x16x32_bf16 v[200:203], a[88:91], a[52:55], v[200:203]
    buffer_load_dwordx4 v2, s[4:7], s29 offen lds
    v_mfma_f32_16x16x32_bf16 v[232:235], a[88:91], a[56:59], v[232:235]
    v_mfma_f32_16x16x32_bf16 v[232:235], a[92:95], a[76:79], v[232:235]
    s_waitcnt lgkmcnt(6)
    s_add_u32 m0, s31, 5120
    v_mfma_f32_16x16x32_bf16 v[236:239], a[100:103], a[76:79], v[236:239]
    s_waitcnt lgkmcnt(4)
    ds_read_b64_tr_b16 a[92:93], v10 offset:12288
    ds_read_b64_tr_b16 a[94:95], v10 offset:13312
    v_mfma_f32_16x16x32_bf16 v[236:239], a[96:99], a[56:59], v[236:239]
    ds_read_b64_tr_b16 a[88:89], v10 offset:8192
    ds_read_b64_tr_b16 a[90:91], v10 offset:9216
    v_mfma_f32_16x16x32_bf16 v[204:207], a[96:99], a[52:55], v[204:207]
    s_add_u32 s29, s27, 294912
    v_mfma_f32_16x16x32_bf16 v[204:207], a[100:103], a[72:75], v[204:207]
    buffer_load_dwordx4 v3, s[8:11], s29 offen lds
    v_mfma_f32_16x16x32_bf16 v[172:175], a[100:103], a[68:71], v[172:175]
    v_mfma_f32_16x16x32_bf16 v[172:175], a[96:99], a[48:51], v[172:175]
    v_mfma_f32_16x16x32_bf16 v[140:143], a[96:99], a[44:47], v[140:143]
    v_mfma_f32_16x16x32_bf16 v[140:143], a[100:103], a[64:67], v[140:143]
    s_add_u32 m0, s31, 6144
    v_mfma_f32_16x16x32_bf16 v[108:111], a[100:103], a[60:63], v[108:111]
    s_add_u32 s29, s27, 393216
    v_mfma_f32_16x16x32_bf16 v[108:111], a[96:99], a[40:43], v[108:111]
    s_waitcnt lgkmcnt(6)
    buffer_load_dwordx4 v3, s[8:11], s29 offen lds
    v_mfma_f32_16x16x32_bf16 v[112:115], a[80:83], a[40:43], v[112:115]
    s_waitcnt lgkmcnt(4)
    ds_read_b64_tr_b16 a[96:97], v9 offset:8704
    ds_read_b64_tr_b16 a[98:99], v9 offset:9728
    v_mfma_f32_16x16x32_bf16 v[112:115], a[84:87], a[60:63], v[112:115]
    ds_read_b64_tr_b16 a[100:101], v9 offset:12800
    ds_read_b64_tr_b16 a[102:103], v9 offset:13824
    v_mfma_f32_16x16x32_bf16 v[144:147], a[84:87], a[64:67], v[144:147]
    v_mfma_f32_16x16x32_bf16 v[144:147], a[80:83], a[44:47], v[144:147]
    s_add_u32 m0, s30, 4096
    v_mfma_f32_16x16x32_bf16 v[176:179], a[80:83], a[48:51], v[176:179]
    s_add_u32 s29, s26, 65536
    v_mfma_f32_16x16x32_bf16 v[176:179], a[84:87], a[68:71], v[176:179]
    buffer_load_dwordx4 v1, s[4:7], s29 offen lds
    v_mfma_f32_16x16x32_bf16 v[208:211], a[84:87], a[72:75], v[208:211]
    v_mfma_f32_16x16x32_bf16 v[208:211], a[80:83], a[52:55], v[208:211]
    v_mfma_f32_16x16x32_bf16 v[240:243], a[80:83], a[56:59], v[240:243]
    s_add_u32 m0, s31, 7168
    v_mfma_f32_16x16x32_bf16 v[240:243], a[84:87], a[76:79], v[240:243]
    s_waitcnt lgkmcnt(6)
    s_add_u32 s29, s27, 425984
    v_mfma_f32_16x16x32_bf16 v[244:247], a[92:95], a[76:79], v[244:247]
    s_waitcnt lgkmcnt(4)
    ds_read_b64_tr_b16 a[84:85], v10 offset:12800
    ds_read_b64_tr_b16 a[86:87], v10 offset:13824
    v_mfma_f32_16x16x32_bf16 v[244:247], a[88:91], a[56:59], v[244:247]
    ds_read_b64_tr_b16 a[80:81], v10 offset:8704
    ds_read_b64_tr_b16 a[82:83], v10 offset:9728
    v_mfma_f32_16x16x32_bf16 v[212:215], a[88:91], a[52:55], v[212:215]
    buffer_load_dwordx4 v3, s[8:11], s29 offen lds
    v_mfma_f32_16x16x32_bf16 v[212:215], a[92:95], a[72:75], v[212:215]
    v_mfma_f32_16x16x32_bf16 v[180:183], a[92:95], a[68:71], v[180:183]
    v_mfma_f32_16x16x32_bf16 v[180:183], a[88:91], a[48:51], v[180:183]
    v_mfma_f32_16x16x32_bf16 v[148:151], a[88:91], a[44:47], v[148:151]
    s_mov_b32 s28, (L_att - L_code0) & 0xffffff80
    s_mov_b32 s46, L_out - L_code0
    buffer_load_dword v30, v29, s[44:47], s28 offen
    v_mfma_f32_16x16x32_bf16 v[148:151], a[92:95], a[64:67], v[148:151]
    v_mfma_f32_16x16x32_bf16 v[116:119], a[92:95], a[60:63], v[116:119]
    s_waitcnt vmcnt(14) lgkmcnt(0)
    s_barrier
    v_mfma_f32_16x16x32_bf16 v[116:119], a[88:91], a[40:43], v[116:119]
    ds_read_b128 a[0:3], v6
    ds_read_b128 a[20:23], v6 offset:512
    v_mfma_f32_16x16x32_bf16 v[120:123], a[96:99], a[40:43], v[120:123]
    s_add_u32 m0, s32, 65536
    ds_read_b64_tr_b16 a[88:89], v11
    ds_read_b64_tr_b16 a[90:91], v11 offset:1024
    v_mfma_f32_16x16x32_bf16 v[120:123], a[100:103], a[60:63], v[120:123]
    s_mov_b32 s100, 0
    ds_read_b64_tr_b16 a[92:93], v11 offset:4096
    ds_read_b64_tr_b16 a[94:95], v11 offset:5120
    v_mfma_f32_16x16x32_bf16 v[152:155], a[100:103], a[64:67], v[152:155]
    ds_read_b128 a[24:27], v6 offset:2560
    ds_read_b128 a[4:7], v6 offset:2048
    buffer_load_dwordx4 v13, s[12:15], s100 offen nt lds
    v_mfma_f32_16x16x32_bf16 v[152:155], a[96:99], a[44:47], v[152:155]
    ds_read_b128 a[8:11], v6 offset:4096
    ds_read_b128 a[28:31], v6 offset:4608
    v_mfma_f32_16x16x32_bf16 v[184:187], a[96:99], a[48:51], v[184:187]
    ds_read_b128 a[32:35], v6 offset:6656
    ds_read_b128 a[12:15], v6 offset:6144
    v_mfma_f32_16x16x32_bf16 v[184:187], a[100:103], a[68:71], v[184:187]
    ds_read_b128 a[16:19], v6 offset:8192
    ds_read_b128 a[36:39], v6 offset:8704
    v_mfma_f32_16x16x32_bf16 v[216:219], a[100:103], a[72:75], v[216:219]
    buffer_load_dwordx4 v14, s[12:15], s100 offen offset:1024 nt lds
    v_mfma_f32_16x16x32_bf16 v[216:219], a[96:99], a[52:55], v[216:219]
    v_mfma_f32_16x16x32_bf16 v[248:251], a[96:99], a[56:59], v[248:251]
    v_mfma_f32_16x16x32_bf16 v[248:251], a[100:103], a[76:79], v[248:251]
    v_mfma_f32_16x16x32_bf16 v[252:255], a[84:87], a[76:79], v[252:255]
    ds_read_b64_tr_b16 a[100:101], v12 offset:4096
    ds_read_b64_tr_b16 a[102:103], v12 offset:5120
    v_mfma_f32_16x16x32_bf16 v[252:255], a[80:83], a[56:59], v[252:255]
    ds_read_b64_tr_b16 a[96:97], v12
    ds_read_b64_tr_b16 a[98:99], v12 offset:1024
    v_mfma_f32_16x16x32_bf16 v[220:223], a[80:83], a[52:55], v[220:223]
    buffer_load_dwordx4 v15, s[12:15], s100 offen offset:2048 nt lds
    v_mfma_f32_16x16x32_bf16 v[220:223], a[84:87], a[72:75], v[220:223]
    v_mfma_f32_16x16x32_bf16 v[188:191], a[84:87], a[68:71], v[188:191]
    buffer_load_dwordx4 v16, s[12:15], s100 offen offset:3072 nt lds
    v_mfma_f32_16x16x32_bf16 v[188:191], a[80:83], a[48:51], v[188:191]
    v_mfma_f32_16x16x32_bf16 v[156:159], a[80:83], a[44:47], v[156:159]
    v_mfma_f32_16x16x32_bf16 v[156:159], a[84:87], a[64:67], v[156:159]
    v_mfma_f32_16x16x32_bf16 v[124:127], a[84:87], a[60:63], v[124:127]
    v_mfma_f32_16x16x32_bf16 v[124:127], a[80:83], a[40:43], v[124:127]
    s_waitcnt lgkmcnt(14)
    v_mfma_f32_16x16x32_bf16 v[96:99], a[88:91], a[0:3], v[96:99]
    s_waitcnt lgkmcnt(12)
    ds_read_b64_tr_b16 a[80:81], v11 offset:512
    ds_read_b64_tr_b16 a[82:83], v11 offset:1536
    v_mfma_f32_16x16x32_bf16 v[96:99], a[92:95], a[20:23], v[96:99]
    s_waitcnt lgkmcnt(13)
    ds_read_b64_tr_b16 a[84:85], v11 offset:4608
    ds_read_b64_tr_b16 a[86:87], v11 offset:5632
    v_mfma_f32_16x16x32_bf16 v[128:131], a[92:95], a[24:27], v[128:131]
    s_waitcnt lgkmcnt(14)
    v_mfma_f32_16x16x32_bf16 v[128:131], a[88:91], a[4:7], v[128:131]
    s_waitcnt lgkmcnt(13)
    v_mfma_f32_16x16x32_bf16 v[160:163], a[88:91], a[8:11], v[160:163]
    s_waitcnt lgkmcnt(12)
    v_mfma_f32_16x16x32_bf16 v[160:163], a[92:95], a[28:31], v[160:163]
    s_waitcnt lgkmcnt(11)
    s_add_u32 m0, s32, 81920
    v_mfma_f32_16x16x32_bf16 v[192:195], a[92:95], a[32:35], v[192:195]
    s_waitcnt lgkmcnt(10)
    s_mov_b32 s100, 0
    v_mfma_f32_16x16x32_bf16 v[192:195], a[88:91], a[12:15], v[192:195]
    s_waitcnt lgkmcnt(9)
    buffer_load_dwordx4 v13, s[16:19], s100 offen nt lds
    v_mfma_f32_16x16x32_bf16 v[224:227], a[88:91], a[16:19], v[224:227]
    s_waitcnt lgkmcnt(8)
    v_mfma_f32_16x16x32_bf16 v[224:227], a[92:95], a[36:39], v[224:227]
    s_waitcnt lgkmcnt(6)
    v_mfma_f32_16x16x32_bf16 v[228:231], a[100:103], a[36:39], v[228:231]
    s_waitcnt lgkmcnt(4)
    ds_read_b64_tr_b16 a[92:93], v12 offset:4608
    ds_read_b64_tr_b16 a[94:95], v12 offset:5632
    v_mfma_f32_16x16x32_bf16 v[228:231], a[96:99], a[16:19], v[228:231]
    ds_read_b64_tr_b16 a[88:89], v12 offset:512
    ds_read_b64_tr_b16 a[90:91], v12 offset:1536
    v_mfma_f32_16x16x32_bf16 v[196:199], a[96:99], a[12:15], v[196:199]
    v_mfma_f32_16x16x32_bf16 v[196:199], a[100:103], a[32:35], v[196:199]
    v_mfma_f32_16x16x32_bf16 v[164:167], a[100:103], a[28:31], v[164:167]
    v_mfma_f32_16x16x32_bf16 v[164:167], a[96:99], a[8:11], v[164:167]
    v_mfma_f32_16x16x32_bf16 v[132:135], a[96:99], a[4:7], v[132:135]
    v_mfma_f32_16x16x32_bf16 v[132:135], a[100:103], a[24:27], v[132:135]
    v_mfma_f32_16x16x32_bf16 v[100:103], a[100:103], a[20:23], v[100:103]
    v_mfma_f32_16x16x32_bf16 v[100:103], a[96:99], a[0:3], v[100:103]
    s_waitcnt lgkmcnt(6)
    v_mfma_f32_16x16x32_bf16 v[104:107], a[80:83], a[0:3], v[104:107]
    s_waitcnt lgkmcnt(4)
    ds_read_b64_tr_b16 a[96:97], v11 offset:8192
    ds_read_b64_tr_b16 a[98:99], v11 offset:9216
    v_mfma_f32_16x16x32_bf16 v[104:107], a[84:87], a[20:23], v[104:107]
    ds_read_b64_tr_b16 a[100:101], v11 offset:12288
    ds_read_b64_tr_b16 a[102:103], v11 offset:13312
    v_mfma_f32_16x16x32_bf16 v[136:139], a[84:87], a[24:27], v[136:139]
    buffer_load_dwordx4 v15, s[16:19], s100 offen offset:1024 nt lds
    v_mfma_f32_16x16x32_bf16 v[136:139], a[80:83], a[4:7], v[136:139]
    v_mfma_f32_16x16x32_bf16 v[168:171], a[80:83], a[8:11], v[168:171]
    v_mfma_f32_16x16x32_bf16 v[168:171], a[84:87], a[28:31], v[168:171]
    v_mfma_f32_16x16x32_bf16 v[200:203], a[84:87], a[32:35], v[200:203]
    v_mfma_f32_16x16x32_bf16 v[200:203], a[80:83], a[12:15], v[200:203]
    v_mfma_f32_16x16x32_bf16 v[232:235], a[80:83], a[16:19], v[232:235]
    v_mfma_f32_16x16x32_bf16 v[232:235], a[84:87], a[36:39], v[232:235]
    s_waitcnt lgkmcnt(6)
    v_mfma_f32_16x16x32_bf16 v[236:239], a[92:95], a[36:39], v[236:239]
    s_waitcnt lgkmcnt(4)
    ds_read_b64_tr_b16 a[84:85], v12 offset:12288
    ds_read_b64_tr_b16 a[86:87], v12 offset:13312
    v_mfma_f32_16x16x32_bf16 v[236:239], a[88:91], a[16:19], v[236:239]
    ds_read_b64_tr_b16 a[80:81], v12 offset:8192
    ds_read_b64_tr_b16 a[82:83], v12 offset:9216
    v_mfma_f32_16x16x32_bf16 v[204:207], a[88:91], a[12:15], v[204:207]
    v_mfma_f32_16x16x32_bf16 v[204:207], a[92:95], a[32:35], v[204:207]
    v_mfma_f32_16x16x32_bf16 v[172:175], a[92:95], a[28:31], v[172:175]
    buffer_load_dwordx4 v13, s[16:19], s100 offen offset:2048 nt lds
    v_mfma_f32_16x16x32_bf16 v[172:175], a[88:91], a[8:11], v[172:175]
    v_mfma_f32_16x16x32_bf16 v[140:143], a[88:91], a[4:7], v[140:143]
    v_mfma_f32_16x16x32_bf16 v[140:143], a[92:95], a[24:27], v[140:143]
    v_mfma_f32_16x16x32_bf16 v[108:111], a[92:95], a[20:23], v[108:111]
    v_mfma_f32_16x16x32_bf16 v[108:111], a[88:91], a[0:3], v[108:111]
    s_waitcnt lgkmcnt(6)
    v_mfma_f32_16x16x32_bf16 v[112:115], a[96:99], a[0:3], v[112:115]
    s_waitcnt lgkmcnt(4)
    ds_read_b64_tr_b16 a[88:89], v11 offset:8704
    ds_read_b64_tr_b16 a[90:91], v11 offset:9728
    v_mfma_f32_16x16x32_bf16 v[112:115], a[100:103], a[20:23], v[112:115]
    ds_read_b64_tr_b16 a[92:93], v11 offset:12800
    ds_read_b64_tr_b16 a[94:95], v11 offset:13824
    v_mfma_f32_16x16x32_bf16 v[144:147], a[100:103], a[24:27], v[144:147]
    v_mfma_f32_16x16x32_bf16 v[144:147], a[96:99], a[4:7], v[144:147]
    v_mfma_f32_16x16x32_bf16 v[176:179], a[96:99], a[8:11], v[176:179]
    v_mfma_f32_16x16x32_bf16 v[176:179], a[100:103], a[28:31], v[176:179]
    v_mfma_f32_16x16x32_bf16 v[208:211], a[100:103], a[32:35], v[208:211]
    v_mfma_f32_16x16x32_bf16 v[208:211], a[96:99], a[12:15], v[208:211]
    v_mfma_f32_16x16x32_bf16 v[240:243], a[96:99], a[16:19], v[240:243]
    buffer_load_dwordx4 v15, s[16:19], s100 offen offset:3072 nt lds
    v_mfma_f32_16x16x32_bf16 v[240:243], a[100:103], a[36:39], v[240:243]
    s_waitcnt lgkmcnt(6)
    v_mfma_f32_16x16x32_bf16 v[244:247], a[84:87], a[36:39], v[244:247]
    s_waitcnt lgkmcnt(4)
    ds_read_b64_tr_b16 a[100:101], v12 offset:12800
    ds_read_b64_tr_b16 a[102:103], v12 offset:13824
    v_mfma_f32_16x16x32_bf16 v[244:247], a[80:83], a[16:19], v[244:247]
    ds_read_b64_tr_b16 a[96:97], v12 offset:8704
    ds_read_b64_tr_b16 a[98:99], v12 offset:9728
    v_mfma_f32_16x16x32_bf16 v[212:215], a[80:83], a[12:15], v[212:215]
    v_mfma_f32_16x16x32_bf16 v[212:215], a[84:87], a[32:35], v[212:215]
    v_mfma_f32_16x16x32_bf16 v[180:183], a[84:87], a[28:31], v[180:183]
    v_mfma_f32_16x16x32_bf16 v[180:183], a[80:83], a[8:11], v[180:183]
    v_mfma_f32_16x16x32_bf16 v[148:151], a[80:83], a[4:7], v[148:151]
    v_mfma_f32_16x16x32_bf16 v[148:151], a[84:87], a[24:27], v[148:151]
    v_mfma_f32_16x16x32_bf16 v[116:119], a[84:87], a[20:23], v[116:119]
    s_waitcnt vmcnt(9) lgkmcnt(0)
    s_barrier
    v_mfma_f32_16x16x32_bf16 v[116:119], a[80:83], a[0:3], v[116:119]
    s_add_u32 m0, s32, 98304
    ds_read_b128 a[40:43], v4
    ds_read_b128 a[60:63], v4 offset:512
    v_mfma_f32_16x16x32_bf16 v[120:123], a[88:91], a[0:3], v[120:123]
    s_mov_b32 s100, 8192
    ds_read_b64_tr_b16 a[80:81], v7
    ds_read_b64_tr_b16 a[82:83], v7 offset:1024
    v_mfma_f32_16x16x32_bf16 v[120:123], a[92:95], a[20:23], v[120:123]
    ds_read_b64_tr_b16 a[84:85], v7 offset:4096
    ds_read_b64_tr_b16 a[86:87], v7 offset:5120
    buffer_load_dwordx4 v13, s[12:15], s100 offen nt lds
    v_mfma_f32_16x16x32_bf16 v[152:155], a[92:95], a[24:27], v[152:155]
    ds_read_b128 a[64:67], v4 offset:2560
    ds_read_b128 a[44:47], v4 offset:2048
    v_mfma_f32_16x16x32_bf16 v[152:155], a[88:91], a[4:7], v[152:155]
    ds_read_b128 a[48:51], v4 offset:4096
    ds_read_b128 a[68:71], v4 offset:4608
    v_mfma_f32_16x16x32_bf16 v[184:187], a[88:91], a[8:11], v[184:187]
    ds_read_b128 a[72:75], v4 offset:6656
    ds_read_b128 a[52:55], v4 offset:6144
    v_mfma_f32_16x16x32_bf16 v[184:187], a[92:95], a[28:31], v[184:187]
    ds_read_b128 a[56:59], v4 offset:8192
    ds_read_b128 a[76:79], v4 offset:8704
    v_mfma_f32_16x16x32_bf16 v[216:219], a[92:95], a[32:35], v[216:219]
    v_mfma_f32_16x16x32_bf16 v[216:219], a[88:91], a[12:15], v[216:219]
    v_mfma_f32_16x16x32_bf16 v[248:251], a[88:91], a[16:19], v[248:251]
    v_mfma_f32_16x16x32_bf16 v[248:251], a[92:95], a[36:39], v[248:251]
    v_mfma_f32_16x16x32_bf16 v[252:255], a[100:103], a[36:39], v[252:255]
    ds_read_b64_tr_b16 a[92:93], v8 offset:4096
    ds_read_b64_tr_b16 a[94:95], v8 offset:5120
    v_mfma_f32_16x16x32_bf16 v[252:255], a[96:99], a[16:19], v[252:255]
    ds_read_b64_tr_b16 a[88:89], v8
    ds_read_b64_tr_b16 a[90:91], v8 offset:1024
    v_mfma_f32_16x16x32_bf16 v[220:223], a[96:99], a[12:15], v[220:223]
    v_mfma_f32_16x16x32_bf16 v[220:223], a[100:103], a[32:35], v[220:223]
    v_mfma_f32_16x16x32_bf16 v[188:191], a[100:103], a[28:31], v[188:191]
    v_mfma_f32_16x16x32_bf16 v[188:191], a[96:99], a[8:11], v[188:191]
    buffer_load_dwordx4 v14, s[12:15], s100 offen offset:1024 nt lds
    v_mfma_f32_16x16x32_bf16 v[156:159], a[96:99], a[4:7], v[156:159]
    v_mfma_f32_16x16x32_bf16 v[156:159], a[100:103], a[24:27], v[156:159]
    v_mfma_f32_16x16x32_bf16 v[124:127], a[100:103], a[20:23], v[124:127]
    v_mfma_f32_16x16x32_bf16 v[124:127], a[96:99], a[0:3], v[124:127]
    s_waitcnt lgkmcnt(14)
    v_mfma_f32_16x16x32_bf16 v[96:99], a[80:83], a[40:43], v[96:99]
    s_waitcnt lgkmcnt(12)
    ds_read_b64_tr_b16 a[96:97], v7 offset:512
    ds_read_b64_tr_b16 a[98:99], v7 offset:1536
    v_mfma_f32_16x16x32_bf16 v[96:99], a[84:87], a[60:63], v[96:99]
    s_waitcnt lgkmcnt(13)
    ds_read_b64_tr_b16 a[100:101], v7 offset:4608
    ds_read_b64_tr_b16 a[102:103], v7 offset:5632
    v_mfma_f32_16x16x32_bf16 v[128:131], a[84:87], a[64:67], v[128:131]
    s_waitcnt lgkmcnt(14)
    v_mfma_f32_16x16x32_bf16 v[128:131], a[80:83], a[44:47], v[128:131]
    s_waitcnt lgkmcnt(13)
    v_mfma_f32_16x16x32_bf16 v[160:163], a[80:83], a[48:51], v[160:163]
    s_waitcnt lgkmcnt(12)
    v_mfma_f32_16x16x32_bf16 v[160:163], a[84:87], a[68:71], v[160:163]
    s_waitcnt lgkmcnt(11)
    v_mfma_f32_16x16x32_bf16 v[192:195], a[84:87], a[72:75], v[192:195]
    s_waitcnt lgkmcnt(10)
    v_mfma_f32_16x16x32_bf16 v[192:195], a[80:83], a[52:55], v[192:195]
    s_waitcnt lgkmcnt(9)
    v_mfma_f32_16x16x32_bf16 v[224:227], a[80:83], a[56:59], v[224:227]
    s_waitcnt lgkmcnt(8)
    buffer_load_dwordx4 v15, s[12:15], s100 offen offset:2048 nt lds
    v_mfma_f32_16x16x32_bf16 v[224:227], a[84:87], a[76:79], v[224:227]
    s_waitcnt lgkmcnt(6)
    v_mfma_f32_16x16x32_bf16 v[228:231], a[92:95], a[76:79], v[228:231]
    s_waitcnt lgkmcnt(4)
    ds_read_b64_tr_b16 a[84:85], v8 offset:4608
    ds_read_b64_tr_b16 a[86:87], v8 offset:5632
    v_mfma_f32_16x16x32_bf16 v[228:231], a[88:91], a[56:59], v[228:231]
    ds_read_b64_tr_b16 a[80:81], v8 offset:512
    ds_read_b64_tr_b16 a[82:83], v8 offset:1536
    v_mfma_f32_16x16x32_bf16 v[196:199], a[88:91], a[52:55], v[196:199]
    v_mfma_f32_16x16x32_bf16 v[196:199], a[92:95], a[72:75], v[196:199]
    v_mfma_f32_16x16x32_bf16 v[164:167], a[92:95], a[68:71], v[164:167]
    v_mfma_f32_16x16x32_bf16 v[164:167], a[88:91], a[48:51], v[164:167]
    v_mfma_f32_16x16x32_bf16 v[132:135], a[88:91], a[44:47], v[132:135]
    v_mfma_f32_16x16x32_bf16 v[132:135], a[92:95], a[64:67], v[132:135]
    v_mfma_f32_16x16x32_bf16 v[100:103], a[92:95], a[60:63], v[100:103]
    v_mfma_f32_16x16x32_bf16 v[100:103], a[88:91], a[40:43], v[100:103]
    s_waitcnt lgkmcnt(6)
    v_mfma_f32_16x16x32_bf16 v[104:107], a[96:99], a[40:43], v[104:107]
    s_waitcnt lgkmcnt(4)
    ds_read_b64_tr_b16 a[88:89], v7 offset:8192
    ds_read_b64_tr_b16 a[90:91], v7 offset:9216
    v_mfma_f32_16x16x32_bf16 v[104:107], a[100:103], a[60:63], v[104:107]
    ds_read_b64_tr_b16 a[92:93], v7 offset:12288
    ds_read_b64_tr_b16 a[94:95], v7 offset:13312
    v_mfma_f32_16x16x32_bf16 v[136:139], a[100:103], a[64:67], v[136:139]
    buffer_load_dwordx4 v16, s[12:15], s100 offen offset:3072 nt lds
    v_mfma_f32_16x16x32_bf16 v[136:139], a[96:99], a[44:47], v[136:139]
    v_mfma_f32_16x16x32_bf16 v[168:171], a[96:99], a[48:51], v[168:171]
    v_mfma_f32_16x16x32_bf16 v[168:171], a[100:103], a[68:71], v[168:171]
    v_mfma_f32_16x16x32_bf16 v[200:203], a[100:103], a[72:75], v[200:203]
    v_mfma_f32_16x16x32_bf16 v[200:203], a[96:99], a[52:55], v[200:203]
    v_mfma_f32_16x16x32_bf16 v[232:235], a[96:99], a[56:59], v[232:235]
    v_mfma_f32_16x16x32_bf16 v[232:235], a[100:103], a[76:79], v[232:235]
    s_waitcnt lgkmcnt(6)
    v_mfma_f32_16x16x32_bf16 v[236:239], a[84:87], a[76:79], v[236:239]
    s_waitcnt lgkmcnt(4)
    ds_read_b64_tr_b16 a[100:101], v8 offset:12288
    ds_read_b64_tr_b16 a[102:103], v8 offset:13312
    v_mfma_f32_16x16x32_bf16 v[236:239], a[80:83], a[56:59], v[236:239]
    ds_read_b64_tr_b16 a[96:97], v8 offset:8192
    ds_read_b64_tr_b16 a[98:99], v8 offset:9216
    v_mfma_f32_16x16x32_bf16 v[204:207], a[80:83], a[52:55], v[204:207]
    v_mfma_f32_16x16x32_bf16 v[204:207], a[84:87], a[72:75], v[204:207]
    s_add_u32 m0, s32, 114688
    v_mfma_f32_16x16x32_bf16 v[172:175], a[84:87], a[68:71], v[172:175]
    s_mov_b32 s100, 8192
    v_mfma_f32_16x16x32_bf16 v[172:175], a[80:83], a[48:51], v[172:175]
    buffer_load_dwordx4 v13, s[16:19], s100 offen nt lds
    v_mfma_f32_16x16x32_bf16 v[140:143], a[80:83], a[44:47], v[140:143]
    v_mfma_f32_16x16x32_bf16 v[140:143], a[84:87], a[64:67], v[140:143]
    v_mfma_f32_16x16x32_bf16 v[108:111], a[84:87], a[60:63], v[108:111]
    v_mfma_f32_16x16x32_bf16 v[108:111], a[80:83], a[40:43], v[108:111]
    s_waitcnt lgkmcnt(6)
    v_mfma_f32_16x16x32_bf16 v[112:115], a[88:91], a[40:43], v[112:115]
    s_waitcnt lgkmcnt(4)
    ds_read_b64_tr_b16 a[80:81], v7 offset:8704
    ds_read_b64_tr_b16 a[82:83], v7 offset:9728
    v_mfma_f32_16x16x32_bf16 v[112:115], a[92:95], a[60:63], v[112:115]
    ds_read_b64_tr_b16 a[84:85], v7 offset:12800
    ds_read_b64_tr_b16 a[86:87], v7 offset:13824
    v_mfma_f32_16x16x32_bf16 v[144:147], a[92:95], a[64:67], v[144:147]
    v_mfma_f32_16x16x32_bf16 v[144:147], a[88:91], a[44:47], v[144:147]
    v_mfma_f32_16x16x32_bf16 v[176:179], a[88:91], a[48:51], v[176:179]
    v_mfma_f32_16x16x32_bf16 v[176:179], a[92:95], a[68:71], v[176:179]
    v_mfma_f32_16x16x32_bf16 v[208:211], a[92:95], a[72:75], v[208:211]
    v_mfma_f32_16x16x32_bf16 v[208:211], a[88:91], a[52:55], v[208:211]
    v_mfma_f32_16x16x32_bf16 v[240:243], a[88:91], a[56:59], v[240:243]
    v_mfma_f32_16x16x32_bf16 v[240:243], a[92:95], a[76:79], v[240:243]
    s_waitcnt lgkmcnt(6)
    buffer_load_dwordx4 v15, s[16:19], s100 offen offset:1024 nt lds
    v_mfma_f32_16x16x32_bf16 v[244:247], a[100:103], a[76:79], v[244:247]
    s_waitcnt lgkmcnt(4)
    ds_read_b64_tr_b16 a[92:93], v8 offset:12800
    ds_read_b64_tr_b16 a[94:95], v8 offset:13824
    v_mfma_f32_16x16x32_bf16 v[244:247], a[96:99], a[56:59], v[244:247]
    ds_read_b64_tr_b16 a[88:89], v8 offset:8704
    ds_read_b64_tr_b16 a[90:91], v8 offset:9728
    v_mfma_f32_16x16x32_bf16 v[212:215], a[96:99], a[52:55], v[212:215]
    v_mfma_f32_16x16x32_bf16 v[212:215], a[100:103], a[72:75], v[212:215]
    v_mfma_f32_16x16x32_bf16 v[180:183], a[100:103], a[68:71], v[180:183]
    v_mfma_f32_16x16x32_bf16 v[180:183], a[96:99], a[48:51], v[180:183]
    v_mfma_f32_16x16x32_bf16 v[148:151], a[96:99], a[44:47], v[148:151]
    v_mfma_f32_16x16x32_bf16 v[148:151], a[100:103], a[64:67], v[148:151]
    v_mfma_f32_16x16x32_bf16 v[116:119], a[100:103], a[60:63], v[116:119]
    s_waitcnt vmcnt(10) lgkmcnt(0)
    s_barrier
    v_mfma_f32_16x16x32_bf16 v[116:119], a[96:99], a[40:43], v[116:119]
    v_mfma_f32_16x16x32_bf16 v[120:123], a[80:83], a[40:43], v[120:123]
    v_mfma_f32_16x16x32_bf16 v[120:123], a[84:87], a[60:63], v[120:123]
    v_mfma_f32_16x16x32_bf16 v[152:155], a[84:87], a[64:67], v[152:155]
    buffer_load_dwordx4 v13, s[16:19], s100 offen offset:2048 nt lds
    v_mfma_f32_16x16x32_bf16 v[152:155], a[80:83], a[44:47], v[152:155]
    v_mfma_f32_16x16x32_bf16 v[184:187], a[80:83], a[48:51], v[184:187]
    v_mfma_f32_16x16x32_bf16 v[184:187], a[84:87], a[68:71], v[184:187]
    v_mfma_f32_16x16x32_bf16 v[216:219], a[84:87], a[72:75], v[216:219]
    v_mfma_f32_16x16x32_bf16 v[216:219], a[80:83], a[52:55], v[216:219]
    v_mfma_f32_16x16x32_bf16 v[248:251], a[80:83], a[56:59], v[248:251]
    v_mfma_f32_16x16x32_bf16 v[248:251], a[84:87], a[76:79], v[248:251]
    v_mfma_f32_16x16x32_bf16 v[252:255], a[92:95], a[76:79], v[252:255]
    v_mfma_f32_16x16x32_bf16 v[252:255], a[88:91], a[56:59], v[252:255]
    v_mfma_f32_16x16x32_bf16 v[220:223], a[88:91], a[52:55], v[220:223]
    v_mfma_f32_16x16x32_bf16 v[220:223], a[92:95], a[72:75], v[220:223]
    v_mfma_f32_16x16x32_bf16 v[188:191], a[92:95], a[68:71], v[188:191]
    v_mfma_f32_16x16x32_bf16 v[188:191], a[88:91], a[48:51], v[188:191]
    v_mfma_f32_16x16x32_bf16 v[156:159], a[88:91], a[44:47], v[156:159]
    buffer_load_dwordx4 v15, s[16:19], s100 offen offset:3072 nt lds
    v_mfma_f32_16x16x32_bf16 v[156:159], a[92:95], a[64:67], v[156:159]
    v_mfma_f32_16x16x32_bf16 v[124:127], a[92:95], a[60:63], v[124:127]
    v_mfma_f32_16x16x32_bf16 v[124:127], a[88:91], a[40:43], v[124:127]
L_att:
    s_mov_b32 s56, 0x3e0293ee
    s_mov_b32 s57, 0x3e0293ee
    v_pk_mul_f32 v[96:97], v[96:97], s[56:57]
    v_pk_mul_f32 v[98:99], v[98:99], s[56:57]
    v_add_u32 v25, 32768, v28
    v_pk_mul_f32 v[100:101], v[100:101], s[56:57]
    v_pk_mul_f32 v[102:103], v[102:103], s[56:57]
    v_cvt_pk_bf16_f32 v32, v96, v97
    v_cvt_pk_bf16_f32 v33, v98, v99
    v_cvt_pk_bf16_f32 v34, v100, v101
    v_cvt_pk_bf16_f32 v35, v102, v103
    v_pk_mul_f32 v[104:105], v[104:105], s[56:57]
    v_pk_mul_f32 v[106:107], v[106:107], s[56:57]
    v_pk_mul_f32 v[108:109], v[108:109], s[56:57]
    v_pk_mul_f32 v[110:111], v[110:111], s[56:57]
    v_cvt_pk_bf16_f32 v36, v104, v105
    v_cvt_pk_bf16_f32 v37, v106, v107
    v_cvt_pk_bf16_f32 v38, v108, v109
    v_cvt_pk_bf16_f32 v39, v110, v111
    v_pk_mul_f32 v[112:113], v[112:113], s[56:57]
    v_pk_mul_f32 v[114:115], v[114:115], s[56:57]
    v_pk_mul_f32 v[116:117], v[116:117], s[56:57]
    s_mov_b64 exec, s[54:55]
    ds_write_b128 v25, a[104:107]
    s_mov_b64 exec, -1
    v_pk_mul_f32 v[118:119], v[118:119], s[56:57]
    v_cvt_pk_bf16_f32 v40, v112, v113
    s_add_u32 m0, s32, 131072
    s_mov_b32 s100, 16384
    buffer_load_dwordx4 v13, s[12:15], s100 offen nt lds
    v_cvt_pk_bf16_f32 v41, v114, v115
    v_cvt_pk_bf16_f32 v42, v116, v117
    v_cvt_pk_bf16_f32 v43, v118, v119
    v_pk_mul_f32 v[120:121], v[120:121], s[56:57]
    v_pk_mul_f32 v[122:123], v[122:123], s[56:57]
    v_pk_mul_f32 v[124:125], v[124:125], s[56:57]
    v_pk_mul_f32 v[126:127], v[126:127], s[56:57]
    v_cvt_pk_bf16_f32 v44, v120, v121
    v_cvt_pk_bf16_f32 v45, v122, v123
    v_cvt_pk_bf16_f32 v46, v124, v125
    v_cvt_pk_bf16_f32 v47, v126, v127
    v_pk_mul_f32 v[128:129], v[128:129], s[56:57]
    s_mov_b64 exec, s[54:55]
    ds_write_b128 v25, a[108:111] offset:1024
    s_mov_b64 exec, -1
    v_pk_mul_f32 v[130:131], v[130:131], s[56:57]
    v_pk_mul_f32 v[132:133], v[132:133], s[56:57]
    v_pk_mul_f32 v[134:135], v[134:135], s[56:57]
    v_cvt_pk_bf16_f32 v48, v128, v129
    v_cvt_pk_bf16_f32 v49, v130, v131
    v_cvt_pk_bf16_f32 v50, v132, v133
    v_cvt_pk_bf16_f32 v51, v134, v135
    v_pk_mul_f32 v[136:137], v[136:137], s[56:57]
    v_pk_mul_f32 v[138:139], v[138:139], s[56:57]
    v_pk_mul_f32 v[140:141], v[140:141], s[56:57]
    v_pk_mul_f32 v[142:143], v[142:143], s[56:57]
    buffer_load_dwordx4 v14, s[12:15], s100 offen offset:1024 nt lds
    v_cvt_pk_bf16_f32 v52, v136, v137
    v_cvt_pk_bf16_f32 v53, v138, v139
    v_cvt_pk_bf16_f32 v54, v140, v141
    v_cvt_pk_bf16_f32 v55, v142, v143
    v_pk_mul_f32 v[144:145], v[144:145], s[56:57]
    s_mov_b64 exec, s[54:55]
    ds_write_b128 v25, a[112:115] offset:2048
    s_mov_b64 exec, -1
    v_pk_mul_f32 v[146:147], v[146:147], s[56:57]
    v_pk_mul_f32 v[148:149], v[148:149], s[56:57]
    v_pk_mul_f32 v[150:151], v[150:151], s[56:57]
    v_cvt_pk_bf16_f32 v56, v144, v145
    v_cvt_pk_bf16_f32 v57, v146, v147
    v_cvt_pk_bf16_f32 v58, v148, v149
    v_cvt_pk_bf16_f32 v59, v150, v151
    v_pk_mul_f32 v[152:153], v[152:153], s[56:57]
    v_pk_mul_f32 v[154:155], v[154:155], s[56:57]
    v_pk_mul_f32 v[156:157], v[156:157], s[56:57]
    v_pk_mul_f32 v[158:159], v[158:159], s[56:57]
    v_cvt_pk_bf16_f32 v60, v152, v153
    v_cvt_pk_bf16_f32 v61, v154, v155
    v_cvt_pk_bf16_f32 v62, v156, v157
    v_cvt_pk_bf16_f32 v63, v158, v159
    v_pk_mul_f32 v[160:161], v[160:161], s[56:57]
    v_pk_mul_f32 v[162:163], v[162:163], s[56:57]
    s_mov_b64 exec, s[54:55]
    ds_write_b128 v25, a[116:119] offset:3072
    s_mov_b64 exec, -1
    v_pk_mul_f32 v[164:165], v[164:165], s[56:57]
    v_pk_mul_f32 v[166:167], v[166:167], s[56:57]
    v_cvt_pk_bf16_f32 v64, v160, v161
    buffer_load_dwordx4 v15, s[12:15], s100 offen offset:2048 nt lds
    v_cvt_pk_bf16_f32 v65, v162, v163
    v_cvt_pk_bf16_f32 v66, v164, v165
    v_cvt_pk_bf16_f32 v67, v166, v167
    v_pk_mul_f32 v[168:169], v[168:169], s[56:57]
    v_pk_mul_f32 v[170:171], v[170:171], s[56:57]
    v_pk_mul_f32 v[172:173], v[172:173], s[56:57]
    v_pk_mul_f32 v[174:175], v[174:175], s[56:57]
    v_cvt_pk_bf16_f32 v68, v168, v169
    v_cvt_pk_bf16_f32 v69, v170, v171
    v_cvt_pk_bf16_f32 v70, v172, v173
    v_cvt_pk_bf16_f32 v71, v174, v175
    v_pk_mul_f32 v[176:177], v[176:177], s[56:57]
    v_pk_mul_f32 v[178:179], v[178:179], s[56:57]
    v_pk_mul_f32 v[180:181], v[180:181], s[56:57]
    v_add_u32 v25, 49152, v28
    v_pk_mul_f32 v[182:183], v[182:183], s[56:57]
    v_cvt_pk_bf16_f32 v72, v176, v177
    v_cvt_pk_bf16_f32 v73, v178, v179
    v_cvt_pk_bf16_f32 v74, v180, v181
    v_cvt_pk_bf16_f32 v75, v182, v183
    v_pk_mul_f32 v[184:185], v[184:185], s[56:57]
    v_pk_mul_f32 v[186:187], v[186:187], s[56:57]
    v_pk_mul_f32 v[188:189], v[188:189], s[56:57]
    v_pk_mul_f32 v[190:191], v[190:191], s[56:57]
    v_cvt_pk_bf16_f32 v76, v184, v185
    v_cvt_pk_bf16_f32 v77, v186, v187
    buffer_load_dwordx4 v16, s[12:15], s100 offen offset:3072 nt lds
    v_cvt_pk_bf16_f32 v78, v188, v189
    v_cvt_pk_bf16_f32 v79, v190, v191
    v_pk_mul_f32 v[192:193], v[192:193], s[56:57]
    v_pk_mul_f32 v[194:195], v[194:195], s[56:57]
    v_pk_mul_f32 v[196:197], v[196:197], s[56:57]
    s_mov_b64 exec, s[54:55]
    ds_write_b128 v25, a[120:123]
    s_mov_b64 exec, -1
    v_pk_mul_f32 v[198:199], v[198:199], s[56:57]
    v_cvt_pk_bf16_f32 v80, v192, v193
    v_cvt_pk_bf16_f32 v81, v194, v195
    v_cvt_pk_bf16_f32 v82, v196, v197
    v_cvt_pk_bf16_f32 v83, v198, v199
    v_pk_mul_f32 v[200:201], v[200:201], s[56:57]
    v_pk_mul_f32 v[202:203], v[202:203], s[56:57]
    v_pk_mul_f32 v[204:205], v[204:205], s[56:57]
    v_pk_mul_f32 v[206:207], v[206:207], s[56:57]
    v_cvt_pk_bf16_f32 v84, v200, v201
    v_cvt_pk_bf16_f32 v85, v202, v203
    v_cvt_pk_bf16_f32 v86, v204, v205
    v_cvt_pk_bf16_f32 v87, v206, v207
    v_pk_mul_f32 v[208:209], v[208:209], s[56:57]
    v_pk_mul_f32 v[210:211], v[210:211], s[56:57]
    v_pk_mul_f32 v[212:213], v[212:213], s[56:57]
    v_pk_mul_f32 v[214:215], v[214:215], s[56:57]
    s_mov_b64 exec, s[54:55]
    ds_write_b128 v25, a[124:127] offset:1024
    s_mov_b64 exec, -1
    v_cvt_pk_bf16_f32 v88, v208, v209
    v_cvt_pk_bf16_f32 v89, v210, v211
    v_cvt_pk_bf16_f32 v90, v212, v213
    s_add_u32 m0, s32, 147456
    s_mov_b32 s100, 16384
    buffer_load_dwordx4 v13, s[16:19], s100 offen nt lds
    v_cvt_pk_bf16_f32 v91, v214, v215
    v_pk_mul_f32 v[216:217], v[216:217], s[56:57]
    v_pk_mul_f32 v[218:219], v[218:219], s[56:57]
    v_pk_mul_f32 v[220:221], v[220:221], s[56:57]
    v_pk_mul_f32 v[222:223], v[222:223], s[56:57]
    v_cvt_pk_bf16_f32 v92, v216, v217
    v_cvt_pk_bf16_f32 v93, v218, v219
    v_cvt_pk_bf16_f32 v94, v220, v221
    v_cvt_pk_bf16_f32 v95, v222, v223
    v_pk_mul_f32 v[224:225], v[224:225], s[56:57]
    v_pk_mul_f32 v[226:227], v[226:227], s[56:57]
    s_mov_b64 exec, s[54:55]
    ds_write_b128 v25, a[128:131] offset:2048
    s_mov_b64 exec, -1
    v_pk_mul_f32 v[228:229], v[228:229], s[56:57]
    ds_read_b64 a[184:185], v17
    ds_read_b64 a[186:187], v18
    ds_read_b64 a[188:189], v17 offset:256
    ds_read_b64 a[190:191], v18 offset:256
    ds_read_b64 a[192:193], v17 offset:512
    ds_read_b64 a[194:195], v18 offset:512
    ds_read_b64 a[196:197], v17 offset:768
    ds_read_b64 a[198:199], v18 offset:768
    v_pk_mul_f32 v[230:231], v[230:231], s[56:57]
    v_cvt_pk_bf16_f32 v96, v224, v225
    v_cvt_pk_bf16_f32 v97, v226, v227
    v_cvt_pk_bf16_f32 v98, v228, v229
    v_cvt_pk_bf16_f32 v99, v230, v231
    v_pk_mul_f32 v[232:233], v[232:233], s[56:57]
    v_pk_mul_f32 v[234:235], v[234:235], s[56:57]
    v_pk_mul_f32 v[236:237], v[236:237], s[56:57]
    s_mov_b64 exec, s[54:55]
    ds_write_b128 v25, a[132:135] offset:3072
    s_mov_b64 exec, -1
    v_pk_mul_f32 v[238:239], v[238:239], s[56:57]
    v_cvt_pk_bf16_f32 v100, v232, v233
    v_cvt_pk_bf16_f32 v101, v234, v235
    buffer_load_dwordx4 v15, s[16:19], s100 offen offset:1024 nt lds
    v_cvt_pk_bf16_f32 v102, v236, v237
    v_cvt_pk_bf16_f32 v103, v238, v239
    v_pk_mul_f32 v[240:241], v[240:241], s[56:57]
    v_pk_mul_f32 v[242:243], v[242:243], s[56:57]
    v_pk_mul_f32 v[244:245], v[244:245], s[56:57]
    v_pk_mul_f32 v[246:247], v[246:247], s[56:57]
    v_cvt_pk_bf16_f32 v104, v240, v241
    v_cvt_pk_bf16_f32 v105, v242, v243
    v_cvt_pk_bf16_f32 v106, v244, v245
    v_cvt_pk_bf16_f32 v107, v246, v247
    v_pk_mul_f32 v[248:249], v[248:249], s[56:57]
    v_pk_mul_f32 v[250:251], v[250:251], s[56:57]
    v_pk_mul_f32 v[252:253], v[252:253], s[56:57]
    v_pk_mul_f32 v[254:255], v[254:255], s[56:57]
    v_cvt_pk_bf16_f32 v108, v248, v249
    v_cvt_pk_bf16_f32 v109, v250, v251
    v_cvt_pk_bf16_f32 v110, v252, v253
    v_cvt_pk_bf16_f32 v111, v254, v255
    s_waitcnt lgkmcnt(7)
    v_mfma_f32_16x16x32_bf16 v[112:115], a[184:187], v[32:35], 0
    s_waitcnt lgkmcnt(5)
    ds_read_b64 a[200:201], v17 offset:4096
    ds_read_b64 a[202:203], v18 offset:4096
    v_mfma_f32_16x16x32_bf16 v[112:115], a[188:191], v[36:39], v[112:115]
    s_waitcnt lgkmcnt(5)
    v_mfma_f32_16x16x32_bf16 v[112:115], a[192:195], v[40:43], v[112:115]
    s_waitcnt lgkmcnt(3)
    v_mfma_f32_16x16x32_bf16 v[112:115], a[196:199], v[44:47], v[112:115]
    ds_read_b64 a[204:205], v17 offset:4352
    ds_read_b64 a[206:207], v18 offset:4352
    v_mfma_f32_16x16x32_bf16 v[116:119], a[196:199], v[60:63], 0
    v_mfma_f32_16x16x32_bf16 v[116:119], a[192:195], v[56:59], v[116:119]
    v_mfma_f32_16x16x32_bf16 v[116:119], a[188:191], v[52:55], v[116:119]
    ds_read_b64 a[208:209], v17 offset:4608
    ds_read_b64 a[210:211], v18 offset:4608
    v_mfma_f32_16x16x32_bf16 v[116:119], a[184:187], v[48:51], v[116:119]
    buffer_load_dwordx4 v13, s[16:19], s100 offen offset:2048 nt lds
    v_mfma_f32_16x16x32_bf16 v[120:123], a[184:187], v[64:67], 0
    v_mfma_f32_16x16x32_bf16 v[120:123], a[188:191], v[68:71], v[120:123]
    ds_read_b64 a[212:213], v17 offset:4864
    ds_read_b64 a[214:215], v18 offset:4864
    v_mfma_f32_16x16x32_bf16 v[120:123], a[192:195], v[72:75], v[120:123]
    v_mfma_f32_16x16x32_bf16 v[120:123], a[196:199], v[76:79], v[120:123]
    v_mfma_f32_16x16x32_bf16 v[124:127], a[196:199], v[92:95], 0
    v_mfma_f32_16x16x32_bf16 v[124:127], a[192:195], v[88:91], v[124:127]
    v_mfma_f32_16x16x32_bf16 v[124:127], a[188:191], v[84:87], v[124:127]
    v_mfma_f32_16x16x32_bf16 v[124:127], a[184:187], v[80:83], v[124:127]
    v_mfma_f32_16x16x32_bf16 v[128:131], a[184:187], v[96:99], 0
    v_mfma_f32_16x16x32_bf16 v[128:131], a[188:191], v[100:103], v[128:131]
    buffer_load_dwordx4 v15, s[16:19], s100 offen offset:3072 nt lds
    v_mfma_f32_16x16x32_bf16 v[128:131], a[192:195], v[104:107], v[128:131]
    v_mfma_f32_16x16x32_bf16 v[128:131], a[196:199], v[108:111], v[128:131]
    s_waitcnt lgkmcnt(6)
    v_mfma_f32_16x16x32_bf16 v[132:135], a[200:203], v[32:35], 0
    s_waitcnt lgkmcnt(4)
    v_mfma_f32_16x16x32_bf16 v[132:135], a[204:207], v[36:39], v[132:135]
    s_waitcnt lgkmcnt(2)
    v_mfma_f32_16x16x32_bf16 v[132:135], a[208:211], v[40:43], v[132:135]
    s_waitcnt lgkmcnt(0)
    v_mfma_f32_16x16x32_bf16 v[132:135], a[212:215], v[44:47], v[132:135]
    v_mfma_f32_16x16x32_bf16 v[136:139], a[212:215], v[60:63], 0
    v_mfma_f32_16x16x32_bf16 v[136:139], a[208:211], v[56:59], v[136:139]
    s_add_u32 m0, s32, 0
    v_mfma_f32_16x16x32_bf16 v[136:139], a[204:207], v[52:55], v[136:139]
    s_mov_b32 s100, 24576
    v_add_u32 v17, 32768, v17
    v_add_u32 v18, 32768, v18
    v_mfma_f32_16x16x32_bf16 v[136:139], a[200:203], v[48:51], v[136:139]
    buffer_load_dwordx4 v13, s[12:15], s100 offen nt lds
    v_mfma_f32_16x16x32_bf16 v[140:143], a[200:203], v[64:67], 0
    v_mfma_f32_16x16x32_bf16 v[140:143], a[204:207], v[68:71], v[140:143]
    v_mfma_f32_16x16x32_bf16 v[140:143], a[208:211], v[72:75], v[140:143]
    v_mfma_f32_16x16x32_bf16 v[140:143], a[212:215], v[76:79], v[140:143]
    v_mfma_f32_16x16x32_bf16 v[144:147], a[212:215], v[92:95], 0
    v_mfma_f32_16x16x32_bf16 v[144:147], a[208:211], v[88:91], v[144:147]
    v_mfma_f32_16x16x32_bf16 v[144:147], a[204:207], v[84:87], v[144:147]
    v_mfma_f32_16x16x32_bf16 v[144:147], a[200:203], v[80:83], v[144:147]
    v_mfma_f32_16x16x32_bf16 v[148:151], a[200:203], v[96:99], 0
    v_mfma_f32_16x16x32_bf16 v[148:151], a[204:207], v[100:103], v[148:151]
    v_mfma_f32_16x16x32_bf16 v[148:151], a[208:211], v[104:107], v[148:151]
    v_mfma_f32_16x16x32_bf16 v[148:151], a[212:215], v[108:111], v[148:151]
    v_max3_f32 v192, v112, v113, v114
    v_max3_f32 v193, v115, v132, v133
    v_max3_f32 v192, v192, v134, v135
    v_max_f32 v192, v192, v193
    v_max3_f32 v196, v116, v117, v118
    v_max3_f32 v197, v119, v136, v137
    v_max3_f32 v196, v196, v138, v139
    v_max_f32 v196, v196, v197
    v_max3_f32 v200, v120, v121, v122
    v_max3_f32 v201, v123, v140, v141
    v_max3_f32 v200, v200, v142, v143
    v_max_f32 v200, v200, v201
    v_max3_f32 v204, v124, v125, v126
    v_max3_f32 v205, v127, v144, v145
    v_max3_f32 v204, v204, v146, v147
    v_max_f32 v204, v204, v205
    v_max3_f32 v208, v128, v129, v130
    v_max3_f32 v209, v131, v148, v149
    v_max3_f32 v208, v208, v150, v151
    v_max_f32 v208, v208, v209
    v_mov_b32 v193, v192
    v_mov_b32 v197, v196
    v_mov_b32 v201, v200
    v_mov_b32 v205, v204
    v_mov_b32 v209, v208
    v_permlane32_swap_b32 v192, v193
    v_permlane32_swap_b32 v196, v197
    v_permlane32_swap_b32 v200, v201
    v_permlane32_swap_b32 v204, v205
    v_permlane32_swap_b32 v208, v209
    v_max_f32 v192, v192, v193
    v_max_f32 v196, v196, v197
    v_max_f32 v200, v200, v201
    v_max_f32 v204, v204, v205
    v_max_f32 v208, v208, v209
    v_mov_b32 v193, v192
    v_mov_b32 v197, v196
    v_mov_b32 v201, v200
    v_mov_b32 v205, v204
    v_mov_b32 v209, v208
    v_permlane16_swap_b32 v192, v193
    v_permlane16_swap_b32 v196, v197
    v_permlane16_swap_b32 v200, v201
    v_permlane16_swap_b32 v204, v205
    v_permlane16_swap_b32 v208, v209
    v_max_f32 v192, v192, v193
    v_max_f32 v196, v196, v197
    v_max_f32 v200, v200, v201
    v_max_f32 v204, v204, v205
    v_max_f32 v208, v208, v209
    v_sub_f32 v195, 0, v192
    v_sub_f32 v194, 0, v192
    v_sub_f32 v193, 0, v192
    v_sub_f32 v192, 0, v192
    v_sub_f32 v199, 0, v196
    v_sub_f32 v198, 0, v196
    v_sub_f32 v197, 0, v196
    v_sub_f32 v196, 0, v196
    v_sub_f32 v203, 0, v200
    v_sub_f32 v202, 0, v200
    v_sub_f32 v201, 0, v200
    v_sub_f32 v200, 0, v200
    v_sub_f32 v207, 0, v204
    v_sub_f32 v206, 0, v204
    v_sub_f32 v205, 0, v204
    v_sub_f32 v204, 0, v204
    v_sub_f32 v211, 0, v208
    v_sub_f32 v210, 0, v208
    v_sub_f32 v209, 0, v208
    v_sub_f32 v208, 0, v208
    s_waitcnt vmcnt(13)
    s_barrier
    ds_read_b64 a[184:185], v17
    ds_read_b64 a[186:187], v18
    ds_read_b64 a[188:189], v17 offset:256
    ds_read_b64 a[190:191], v18 offset:256
    ds_read_b64 a[192:193], v17 offset:512
    ds_read_b64 a[194:195], v18 offset:512
    ds_read_b64 a[196:197], v17 offset:768
    ds_read_b64 a[198:199], v18 offset:768
    v_add_f32 v112, v192, v112
    v_add_f32 v113, v192, v113
    v_add_f32 v114, v192, v114
    v_add_f32 v115, v192, v115
    v_add_f32 v116, v196, v116
    v_add_f32 v117, v196, v117
    v_add_f32 v118, v196, v118
    v_add_f32 v119, v196, v119
    v_add_f32 v120, v200, v120
    v_add_f32 v121, v200, v121
    v_add_f32 v122, v200, v122
    v_add_f32 v123, v200, v123
    v_add_f32 v124, v204, v124
    v_add_f32 v125, v204, v125
    v_add_f32 v126, v204, v126
    v_add_f32 v127, v204, v127
    v_add_f32 v128, v208, v128
    v_add_f32 v129, v208, v129
    v_add_f32 v130, v208, v130
    v_add_f32 v131, v208, v131
    v_add_f32 v132, v192, v132
    v_add_f32 v133, v192, v133
    v_add_f32 v134, v192, v134
    v_add_f32 v135, v192, v135
    v_add_f32 v136, v196, v136
    buffer_load_dwordx4 v14, s[12:15], s100 offen offset:1024 nt lds
    v_add_f32 v137, v196, v137
    v_add_f32 v138, v196, v138
    v_add_f32 v139, v196, v139
    v_add_f32 v140, v200, v140
    v_add_f32 v141, v200, v141
    v_add_f32 v142, v200, v142
    v_add_f32 v143, v200, v143
    v_add_f32 v144, v204, v144
    v_add_f32 v145, v204, v145
    v_add_f32 v146, v204, v146
    v_add_f32 v147, v204, v147
    v_add_f32 v148, v208, v148
    v_add_f32 v149, v208, v149
    v_add_f32 v150, v208, v150
    v_add_f32 v151, v208, v151
    v_exp_f32 v112, v112
    v_exp_f32 v113, v113
    v_exp_f32 v114, v114
    v_exp_f32 v115, v115
    v_exp_f32 v116, v116
    v_exp_f32 v117, v117
    v_exp_f32 v118, v118
    v_exp_f32 v119, v119
    v_exp_f32 v120, v120
    v_exp_f32 v121, v121
    v_exp_f32 v122, v122
    v_exp_f32 v123, v123
    buffer_load_dwordx4 v15, s[12:15], s100 offen offset:2048 nt lds
    v_exp_f32 v124, v124
    v_exp_f32 v125, v125
    v_exp_f32 v126, v126
    v_exp_f32 v127, v127
    v_exp_f32 v128, v128
    v_exp_f32 v129, v129
    v_exp_f32 v130, v130
    v_exp_f32 v131, v131
    v_cvt_pk_bf16_f32 v152, v112, v113
    v_cvt_pk_bf16_f32 v153, v114, v115
    v_cvt_pk_bf16_f32 v156, v116, v117
    v_cvt_pk_bf16_f32 v157, v118, v119
    v_cvt_pk_bf16_f32 v160, v120, v121
    v_cvt_pk_bf16_f32 v161, v122, v123
    v_cvt_pk_bf16_f32 v164, v124, v125
    v_cvt_pk_bf16_f32 v165, v126, v127
    v_cvt_pk_bf16_f32 v168, v128, v129
    v_cvt_pk_bf16_f32 v169, v130, v131
    v_exp_f32 v132, v132
    v_exp_f32 v133, v133
    v_exp_f32 v134, v134
    v_exp_f32 v135, v135
    v_exp_f32 v136, v136
    v_exp_f32 v137, v137
    v_exp_f32 v138, v138
    v_exp_f32 v139, v139
    v_exp_f32 v140, v140
    buffer_load_dwordx4 v16, s[12:15], s100 offen offset:3072 nt lds
    v_exp_f32 v141, v141
    v_exp_f32 v142, v142
    v_exp_f32 v143, v143
    v_exp_f32 v144, v144
    v_exp_f32 v145, v145
    v_exp_f32 v146, v146
    v_exp_f32 v147, v147
    v_exp_f32 v148, v148
    v_exp_f32 v149, v149
    v_exp_f32 v150, v150
    v_exp_f32 v151, v151
    v_cvt_pk_bf16_f32 v154, v132, v133
    v_cvt_pk_bf16_f32 v155, v134, v135
    v_cvt_pk_bf16_f32 v158, v136, v137
    v_cvt_pk_bf16_f32 v159, v138, v139
    v_cvt_pk_bf16_f32 v162, v140, v141
    v_cvt_pk_bf16_f32 v163, v142, v143
    v_cvt_pk_bf16_f32 v166, v144, v145
    v_cvt_pk_bf16_f32 v167, v146, v147
    v_cvt_pk_bf16_f32 v170, v148, v149
    v_cvt_pk_bf16_f32 v171, v150, v151
    s_waitcnt lgkmcnt(6)
    v_mfma_f32_16x16x32_bf16 v[112:115], a[184:187], v[32:35], v[192:195]
    s_waitcnt lgkmcnt(4)
    ds_read_b64 a[200:201], v17 offset:4096
    ds_read_b64 a[202:203], v18 offset:4096
    v_mfma_f32_16x16x32_bf16 v[112:115], a[188:191], v[36:39], v[112:115]
    s_waitcnt lgkmcnt(4)
    s_add_u32 m0, s32, 16384
    v_mfma_f32_16x16x32_bf16 v[112:115], a[192:195], v[40:43], v[112:115]
    s_waitcnt lgkmcnt(2)
    s_mov_b32 s100, 24576
    v_mfma_f32_16x16x32_bf16 v[112:115], a[196:199], v[44:47], v[112:115]
    buffer_load_dwordx4 v13, s[16:19], s100 offen nt lds
    v_mfma_f32_16x16x32_bf16 v[116:119], a[196:199], v[60:63], v[196:199]
    ds_read_b64 a[204:205], v17 offset:4352
    ds_read_b64 a[206:207], v18 offset:4352
    v_mfma_f32_16x16x32_bf16 v[116:119], a[192:195], v[56:59], v[116:119]
    v_mfma_f32_16x16x32_bf16 v[116:119], a[188:191], v[52:55], v[116:119]
    v_mfma_f32_16x16x32_bf16 v[116:119], a[184:187], v[48:51], v[116:119]
    s_nop 0
    v_exp_f32 v112, v112
    v_mfma_f32_16x16x32_bf16 v[120:123], a[184:187], v[64:67], v[200:203]
    ds_read_b64 a[208:209], v17 offset:4608
    ds_read_b64 a[210:211], v18 offset:4608
    v_mfma_f32_16x16x32_bf16 v[120:123], a[188:191], v[68:71], v[120:123]
    v_exp_f32 v113, v113
    v_mfma_f32_16x16x32_bf16 v[120:123], a[192:195], v[72:75], v[120:123]
    v_exp_f32 v114, v114
    v_mfma_f32_16x16x32_bf16 v[120:123], a[196:199], v[76:79], v[120:123]
    v_exp_f32 v115, v115
    v_mfma_f32_16x16x32_bf16 v[124:127], a[196:199], v[92:95], v[204:207]
    ds_read_b64 a[212:213], v17 offset:4864
    ds_read_b64 a[214:215], v18 offset:4864
    v_mfma_f32_16x16x32_bf16 v[124:127], a[192:195], v[88:91], v[124:127]
    v_cvt_pk_bf16_f32 v172, v112, v113
    v_cvt_pk_bf16_f32 v173, v114, v115
    v_mfma_f32_16x16x32_bf16 v[124:127], a[188:191], v[84:87], v[124:127]
    buffer_load_dwordx4 v15, s[16:19], s100 offen offset:1024 nt lds
    v_mfma_f32_16x16x32_bf16 v[124:127], a[184:187], v[80:83], v[124:127]
    v_exp_f32 v116, v116
    v_mfma_f32_16x16x32_bf16 v[128:131], a[184:187], v[96:99], v[208:211]
    v_exp_f32 v117, v117
    v_mfma_f32_16x16x32_bf16 v[128:131], a[188:191], v[100:103], v[128:131]
    v_exp_f32 v118, v118
    v_mfma_f32_16x16x32_bf16 v[128:131], a[192:195], v[104:107], v[128:131]
    v_exp_f32 v119, v119
    v_mfma_f32_16x16x32_bf16 v[128:131], a[196:199], v[108:111], v[128:131]
    s_waitcnt lgkmcnt(6)
    v_cvt_pk_bf16_f32 v176, v116, v117
    v_cvt_pk_bf16_f32 v177, v118, v119
    v_mfma_f32_16x16x32_bf16 v[132:135], a[200:203], v[32:35], v[192:195]
    s_waitcnt lgkmcnt(4)
    v_exp_f32 v120, v120
    v_mfma_f32_16x16x32_bf16 v[132:135], a[204:207], v[36:39], v[132:135]
    s_waitcnt lgkmcnt(2)
    v_exp_f32 v121, v121
    v_mfma_f32_16x16x32_bf16 v[132:135], a[208:211], v[40:43], v[132:135]
    s_waitcnt lgkmcnt(0)
    v_add_u32 v17, 32768, v17
    v_cvt_pk_bf16_f32 v180, v120, v121
    v_mfma_f32_16x16x32_bf16 v[132:135], a[212:215], v[44:47], v[132:135]
    v_add_u32 v18, 32768, v18
    v_mfma_f32_16x16x32_bf16 v[136:139], a[212:215], v[60:63], v[196:199]
    v_exp_f32 v122, v122
    v_mfma_f32_16x16x32_bf16 v[136:139], a[208:211], v[56:59], v[136:139]
    v_exp_f32 v123, v123
    v_mfma_f32_16x16x32_bf16 v[136:139], a[204:207], v[52:55], v[136:139]
    buffer_load_dwordx4 v13, s[16:19], s100 offen offset:2048 nt lds
    v_cvt_pk_bf16_f32 v181, v122, v123
    v_mfma_f32_16x16x32_bf16 v[136:139], a[200:203], v[48:51], v[136:139]
    v_exp_f32 v124, v124
    v_mfma_f32_16x16x32_bf16 v[140:143], a[200:203], v[64:67], v[200:203]
    v_exp_f32 v125, v125
    v_mfma_f32_16x16x32_bf16 v[140:143], a[204:207], v[68:71], v[140:143]
    v_exp_f32 v126, v126
    v_mfma_f32_16x16x32_bf16 v[140:143], a[208:211], v[72:75], v[140:143]
    ds_read_b64_tr_b16 v[228:229], v19
    ds_read_b64_tr_b16 v[230:231], v19 offset:4096
    v_mfma_f32_16x16x32_bf16 v[140:143], a[212:215], v[76:79], v[140:143]
    v_exp_f32 v127, v127
    v_mfma_f32_16x16x32_bf16 v[144:147], a[212:215], v[92:95], v[204:207]
    v_cvt_pk_bf16_f32 v184, v124, v125
    v_cvt_pk_bf16_f32 v185, v126, v127
    v_mfma_f32_16x16x32_bf16 v[144:147], a[208:211], v[88:91], v[144:147]
    v_exp_f32 v128, v128
    v_mfma_f32_16x16x32_bf16 v[144:147], a[204:207], v[84:87], v[144:147]
    v_exp_f32 v129, v129
    v_mfma_f32_16x16x32_bf16 v[144:147], a[200:203], v[80:83], v[144:147]
    ds_read_b64_tr_b16 v[232:233], v20
    ds_read_b64_tr_b16 v[234:235], v20 offset:4096
    v_mfma_f32_16x16x32_bf16 v[148:151], a[200:203], v[96:99], v[208:211]
    v_exp_f32 v130, v130
    v_mfma_f32_16x16x32_bf16 v[148:151], a[204:207], v[100:103], v[148:151]
    v_exp_f32 v131, v131
    v_mfma_f32_16x16x32_bf16 v[148:151], a[208:211], v[104:107], v[148:151]
    buffer_load_dwordx4 v15, s[16:19], s100 offen offset:3072 nt lds
    v_cvt_pk_bf16_f32 v188, v128, v129
    v_mfma_f32_16x16x32_bf16 v[148:151], a[212:215], v[108:111], v[148:151]
    v_cvt_pk_bf16_f32 v189, v130, v131
    v_mfma_f32_16x16x32_bf16 a[160:163], a[180:183], v[152:155], 0
    ds_read_b64_tr_b16 v[236:237], v19 offset:256
    ds_read_b64_tr_b16 v[238:239], v19 offset:4352
    v_mfma_f32_16x16x32_bf16 a[164:167], a[180:183], v[156:159], 0
    v_exp_f32 v132, v132
    v_mfma_f32_16x16x32_bf16 a[168:171], a[180:183], v[160:163], 0
    v_exp_f32 v133, v133
    v_mfma_f32_16x16x32_bf16 a[172:175], a[180:183], v[164:167], 0
    v_exp_f32 v134, v134
    v_mfma_f32_16x16x32_bf16 a[176:179], a[180:183], v[168:171], 0
    s_waitcnt lgkmcnt(4)
    v_exp_f32 v135, v135
    v_mfma_f32_16x16x32_bf16 a[0:3], v[228:231], v[152:155], 0
    ds_read_b64_tr_b16 v[240:241], v20 offset:256
    ds_read_b64_tr_b16 v[242:243], v20 offset:4352
    v_mfma_f32_16x16x32_bf16 a[4:7], v[228:231], v[156:159], 0
    v_cvt_pk_bf16_f32 v174, v132, v133
    v_cvt_pk_bf16_f32 v175, v134, v135
    v_mfma_f32_16x16x32_bf16 a[8:11], v[228:231], v[160:163], 0
    s_add_u32 m0, s32, 32768
    s_max_u32 m0, m0, s67
    v_exp_f32 v136, v136
    v_mfma_f32_16x16x32_bf16 a[12:15], v[228:231], v[164:167], 0
    s_add_u32 s100, s3, 32768
    v_exp_f32 v137, v137
    v_mfma_f32_16x16x32_bf16 a[16:19], v[228:231], v[168:171], 0
    s_waitcnt lgkmcnt(4)
    buffer_load_dwordx4 v13, s[12:15], s100 offen nt lds
    v_cvt_pk_bf16_f32 v178, v136, v137
    v_mfma_f32_16x16x32_bf16 a[36:39], v[232:235], v[168:171], 0
    ds_read_b64_tr_b16 v[228:229], v19 offset:512
    ds_read_b64_tr_b16 v[230:231], v19 offset:4608
    v_mfma_f32_16x16x32_bf16 a[32:35], v[232:235], v[164:167], 0
    v_exp_f32 v138, v138
    v_mfma_f32_16x16x32_bf16 a[28:31], v[232:235], v[160:163], 0
    v_exp_f32 v139, v139
    v_mfma_f32_16x16x32_bf16 a[24:27], v[232:235], v[156:159], 0
    v_cvt_pk_bf16_f32 v179, v138, v139
    v_mfma_f32_16x16x32_bf16 a[20:23], v[232:235], v[152:155], 0
    s_waitcnt lgkmcnt(4)
    v_exp_f32 v140, v140
    v_mfma_f32_16x16x32_bf16 a[40:43], v[236:239], v[152:155], 0
    ds_read_b64_tr_b16 v[232:233], v20 offset:512
    ds_read_b64_tr_b16 v[234:235], v20 offset:4608
    v_mfma_f32_16x16x32_bf16 a[44:47], v[236:239], v[156:159], 0
    v_exp_f32 v141, v141
    v_mfma_f32_16x16x32_bf16 a[48:51], v[236:239], v[160:163], 0
    v_exp_f32 v142, v142
    v_mfma_f32_16x16x32_bf16 a[52:55], v[236:239], v[164:167], 0
    v_exp_f32 v143, v143
    v_mfma_f32_16x16x32_bf16 a[56:59], v[236:239], v[168:171], 0
    s_waitcnt lgkmcnt(4)
    v_cvt_pk_bf16_f32 v182, v140, v141
    v_cvt_pk_bf16_f32 v183, v142, v143
    v_mfma_f32_16x16x32_bf16 a[76:79], v[240:243], v[168:171], 0
    ds_read_b64_tr_b16 v[236:237], v19 offset:768
    ds_read_b64_tr_b16 v[238:239], v19 offset:4864
    v_mfma_f32_16x16x32_bf16 a[72:75], v[240:243], v[164:167], 0
    buffer_load_dwordx4 v14, s[12:15], s100 offen offset:1024 nt lds
    v_mfma_f32_16x16x32_bf16 a[68:71], v[240:243], v[160:163], 0
    v_exp_f32 v144, v144
    v_mfma_f32_16x16x32_bf16 a[64:67], v[240:243], v[156:159], 0
    v_exp_f32 v145, v145
    v_mfma_f32_16x16x32_bf16 a[60:63], v[240:243], v[152:155], 0
    s_waitcnt lgkmcnt(4)
    v_exp_f32 v146, v146
    v_mfma_f32_16x16x32_bf16 a[80:83], v[228:231], v[152:155], 0
    ds_read_b64_tr_b16 v[240:241], v20 offset:768
    ds_read_b64_tr_b16 v[242:243], v20 offset:4864
    v_mfma_f32_16x16x32_bf16 a[84:87], v[228:231], v[156:159], 0
    v_exp_f32 v147, v147
    v_mfma_f32_16x16x32_bf16 a[88:91], v[228:231], v[160:163], 0
    v_add_u32 v19, 32768, v19
    v_cvt_pk_bf16_f32 v186, v144, v145
    v_mfma_f32_16x16x32_bf16 a[92:95], v[228:231], v[164:167], 0
    v_add_u32 v20, 32768, v20
    v_cvt_pk_bf16_f32 v187, v146, v147
    v_mfma_f32_16x16x32_bf16 a[96:99], v[228:231], v[168:171], 0
    s_waitcnt vmcnt(14) lgkmcnt(0)
    s_barrier
    v_mfma_f32_16x16x32_bf16 a[116:119], v[232:235], v[168:171], 0
    ds_read_b64 a[184:185], v17
    ds_read_b64 a[186:187], v18
    v_mfma_f32_16x16x32_bf16 a[112:115], v[232:235], v[164:167], 0
    v_exp_f32 v148, v148
    v_mfma_f32_16x16x32_bf16 a[108:111], v[232:235], v[160:163], 0
    v_exp_f32 v149, v149
    v_mfma_f32_16x16x32_bf16 a[104:107], v[232:235], v[156:159], 0
    ds_read_b64 a[188:189], v17 offset:256
    ds_read_b64 a[190:191], v18 offset:256
    v_mfma_f32_16x16x32_bf16 a[100:103], v[232:235], v[152:155], 0
    buffer_load_dwordx4 v15, s[12:15], s100 offen offset:2048 nt lds
    v_cvt_pk_bf16_f32 v190, v148, v149
    v_mfma_f32_16x16x32_bf16 a[120:123], v[236:239], v[152:155], 0
    v_exp_f32 v150, v150
    v_mfma_f32_16x16x32_bf16 a[124:127], v[236:239], v[156:159], 0
    ds_read_b64 a[192:193], v17 offset:512
    ds_read_b64 a[194:195], v18 offset:512
    v_mfma_f32_16x16x32_bf16 a[128:131], v[236:239], v[160:163], 0
    v_exp_f32 v151, v151
    v_mfma_f32_16x16x32_bf16 a[132:135], v[236:239], v[164:167], 0
    v_cvt_pk_bf16_f32 v191, v150, v151
    v_mfma_f32_16x16x32_bf16 a[136:139], v[236:239], v[168:171], 0
    ds_read_b64 a[196:197], v17 offset:768
    ds_read_b64 a[198:199], v18 offset:768
    v_mfma_f32_16x16x32_bf16 a[156:159], v[240:243], v[168:171], 0
    v_mfma_f32_16x16x32_bf16 a[152:155], v[240:243], v[164:167], 0
    v_mfma_f32_16x16x32_bf16 a[148:151], v[240:243], v[160:163], 0
    v_mfma_f32_16x16x32_bf16 a[144:147], v[240:243], v[156:159], 0
    v_mfma_f32_16x16x32_bf16 a[140:143], v[240:243], v[152:155], 0
    s_waitcnt lgkmcnt(6)
    buffer_load_dwordx4 v16, s[12:15], s100 offen offset:3072 nt lds
    v_mfma_f32_16x16x32_bf16 v[112:115], a[184:187], v[32:35], v[192:195]
    s_waitcnt lgkmcnt(4)
    ds_read_b64 a[200:201], v17 offset:4096
    ds_read_b64 a[202:203], v18 offset:4096
    v_mfma_f32_16x16x32_bf16 v[112:115], a[188:191], v[36:39], v[112:115]
    s_waitcnt lgkmcnt(4)
    v_mfma_f32_16x16x32_bf16 v[112:115], a[192:195], v[40:43], v[112:115]
    s_waitcnt lgkmcnt(2)
    v_mfma_f32_16x16x32_bf16 v[112:115], a[196:199], v[44:47], v[112:115]
    v_mfma_f32_16x16x32_bf16 v[116:119], a[196:199], v[60:63], v[196:199]
    ds_read_b64 a[204:205], v17 offset:4352
    ds_read_b64 a[206:207], v18 offset:4352
    v_mfma_f32_16x16x32_bf16 v[116:119], a[192:195], v[56:59], v[116:119]
    v_mfma_f32_16x16x32_bf16 v[116:119], a[188:191], v[52:55], v[116:119]
    v_mfma_f32_16x16x32_bf16 v[116:119], a[184:187], v[48:51], v[116:119]
    s_nop 1
    v_exp_f32 v112, v112
    v_mfma_f32_16x16x32_bf16 v[120:123], a[184:187], v[64:67], v[200:203]
    ds_read_b64 a[208:209], v17 offset:4608
    ds_read_b64 a[210:211], v18 offset:4608
    v_mfma_f32_16x16x32_bf16 v[120:123], a[188:191], v[68:71], v[120:123]
    s_add_u32 m0, s32, 49152
    s_max_u32 m0, m0, s67
    v_exp_f32 v113, v113
    v_mfma_f32_16x16x32_bf16 v[120:123], a[192:195], v[72:75], v[120:123]
    s_add_u32 s100, s3, 32768
    v_exp_f32 v114, v114
    v_mfma_f32_16x16x32_bf16 v[120:123], a[196:199], v[76:79], v[120:123]
    buffer_load_dwordx4 v13, s[16:19], s100 offen nt lds
    v_cvt_pk_bf16_f32 v152, v112, v113
    v_mfma_f32_16x16x32_bf16 v[124:127], a[196:199], v[92:95], v[204:207]
    ds_read_b64 a[212:213], v17 offset:4864
    ds_read_b64 a[214:215], v18 offset:4864
    v_mfma_f32_16x16x32_bf16 v[124:127], a[192:195], v[88:91], v[124:127]
    v_exp_f32 v115, v115
    v_mfma_f32_16x16x32_bf16 v[124:127], a[188:191], v[84:87], v[124:127]
    v_cvt_pk_bf16_f32 v153, v114, v115
    v_mfma_f32_16x16x32_bf16 v[124:127], a[184:187], v[80:83], v[124:127]
    v_exp_f32 v116, v116
    v_mfma_f32_16x16x32_bf16 v[128:131], a[184:187], v[96:99], v[208:211]
    v_exp_f32 v117, v117
    v_mfma_f32_16x16x32_bf16 v[128:131], a[188:191], v[100:103], v[128:131]
    v_exp_f32 v118, v118
    v_mfma_f32_16x16x32_bf16 v[128:131], a[192:195], v[104:107], v[128:131]
    v_exp_f32 v119, v119
    v_mfma_f32_16x16x32_bf16 v[128:131], a[196:199], v[108:111], v[128:131]
    s_waitcnt lgkmcnt(6)
    v_cvt_pk_bf16_f32 v156, v116, v117
    v_cvt_pk_bf16_f32 v157, v118, v119
    v_mfma_f32_16x16x32_bf16 v[132:135], a[200:203], v[32:35], v[192:195]
    s_waitcnt lgkmcnt(4)
    v_exp_f32 v120, v120
    v_mfma_f32_16x16x32_bf16 v[132:135], a[204:207], v[36:39], v[132:135]
    s_waitcnt lgkmcnt(2)
    v_exp_f32 v121, v121
    v_mfma_f32_16x16x32_bf16 v[132:135], a[208:211], v[40:43], v[132:135]
    s_waitcnt lgkmcnt(0)
    v_subrev_u32 v17, 131072, v17
    v_cvt_pk_bf16_f32 v160, v120, v121
    v_mfma_f32_16x16x32_bf16 v[132:135], a[212:215], v[44:47], v[132:135]
    v_subrev_u32 v18, 131072, v18
    buffer_load_dwordx4 v15, s[16:19], s100 offen offset:1024 nt lds
    v_mfma_f32_16x16x32_bf16 v[136:139], a[212:215], v[60:63], v[196:199]
    v_exp_f32 v122, v122
    v_mfma_f32_16x16x32_bf16 v[136:139], a[208:211], v[56:59], v[136:139]
    v_exp_f32 v123, v123
    v_mfma_f32_16x16x32_bf16 v[136:139], a[204:207], v[52:55], v[136:139]
    v_cvt_pk_bf16_f32 v161, v122, v123
    v_mfma_f32_16x16x32_bf16 v[136:139], a[200:203], v[48:51], v[136:139]
    v_exp_f32 v124, v124
    v_mfma_f32_16x16x32_bf16 v[140:143], a[200:203], v[64:67], v[200:203]
    v_exp_f32 v125, v125
    v_mfma_f32_16x16x32_bf16 v[140:143], a[204:207], v[68:71], v[140:143]
    v_exp_f32 v126, v126
    v_mfma_f32_16x16x32_bf16 v[140:143], a[208:211], v[72:75], v[140:143]
    ds_read_b64_tr_b16 v[228:229], v19
    ds_read_b64_tr_b16 v[230:231], v19 offset:4096
    v_mfma_f32_16x16x32_bf16 v[140:143], a[212:215], v[76:79], v[140:143]
    v_exp_f32 v127, v127
    v_mfma_f32_16x16x32_bf16 v[144:147], a[212:215], v[92:95], v[204:207]
    v_cvt_pk_bf16_f32 v164, v124, v125
    v_cvt_pk_bf16_f32 v165, v126, v127
    v_mfma_f32_16x16x32_bf16 v[144:147], a[208:211], v[88:91], v[144:147]
    v_exp_f32 v128, v128
    v_mfma_f32_16x16x32_bf16 v[144:147], a[204:207], v[84:87], v[144:147]
    buffer_load_dwordx4 v13, s[16:19], s100 offen offset:2048 nt lds
    v_mfma_f32_16x16x32_bf16 v[144:147], a[200:203], v[80:83], v[144:147]
    ds_read_b64_tr_b16 v[232:233], v20
    ds_read_b64_tr_b16 v[234:235], v20 offset:4096
    v_mfma_f32_16x16x32_bf16 v[148:151], a[200:203], v[96:99], v[208:211]
    v_exp_f32 v129, v129
    v_mfma_f32_16x16x32_bf16 v[148:151], a[204:207], v[100:103], v[148:151]
    v_exp_f32 v130, v130
    v_mfma_f32_16x16x32_bf16 v[148:151], a[208:211], v[104:107], v[148:151]
    v_exp_f32 v131, v131
    v_mfma_f32_16x16x32_bf16 v[148:151], a[212:215], v[108:111], v[148:151]
    v_cvt_pk_bf16_f32 v168, v128, v129
    v_cvt_pk_bf16_f32 v169, v130, v131
    v_mfma_f32_16x16x32_bf16 a[160:163], a[180:183], v[172:175], a[160:163]
    ds_read_b64_tr_b16 v[236:237], v19 offset:256
    ds_read_b64_tr_b16 v[238:239], v19 offset:4352
    v_mfma_f32_16x16x32_bf16 a[164:167], a[180:183], v[176:179], a[164:167]
    v_mov_b32 v24, 1
    v_mfma_f32_16x16x32_bf16 a[168:171], a[180:183], v[180:183], a[168:171]
    s_lshl_b32 s28, s24, 12
    v_exp_f32 v132, v132
    v_mfma_f32_16x16x32_bf16 a[172:175], a[180:183], v[184:187], a[172:175]
    buffer_atomic_add v24, v31, s[40:43], s28 offen sc1
    v_mfma_f32_16x16x32_bf16 a[176:179], a[180:183], v[188:191], a[176:179]
    s_waitcnt lgkmcnt(4)
    v_exp_f32 v133, v133
    v_mfma_f32_16x16x32_bf16 a[0:3], v[228:231], v[172:175], a[0:3]
    ds_read_b64_tr_b16 v[240:241], v20 offset:256
    ds_read_b64_tr_b16 v[242:243], v20 offset:4352
    v_mfma_f32_16x16x32_bf16 a[4:7], v[228:231], v[176:179], a[4:7]
    buffer_load_dwordx4 v15, s[16:19], s100 offen offset:3072 nt lds
    v_cvt_pk_bf16_f32 v154, v132, v133
    v_mfma_f32_16x16x32_bf16 a[8:11], v[228:231], v[180:183], a[8:11]
    v_exp_f32 v134, v134
    v_mfma_f32_16x16x32_bf16 a[12:15], v[228:231], v[184:187], a[12:15]
    v_exp_f32 v135, v135
    v_mfma_f32_16x16x32_bf16 a[16:19], v[228:231], v[188:191], a[16:19]
    s_waitcnt lgkmcnt(4)
    v_cvt_pk_bf16_f32 v155, v134, v135
    v_mfma_f32_16x16x32_bf16 a[36:39], v[232:235], v[188:191], a[36:39]
    ds_read_b64_tr_b16 v[228:229], v19 offset:512
    ds_read_b64_tr_b16 v[230:231], v19 offset:4608
    v_mfma_f32_16x16x32_bf16 a[32:35], v[232:235], v[184:187], a[32:35]
    v_exp_f32 v136, v136
    v_mfma_f32_16x16x32_bf16 a[28:31], v[232:235], v[180:183], a[28:31]
    v_exp_f32 v137, v137
    v_mfma_f32_16x16x32_bf16 a[24:27], v[232:235], v[176:179], a[24:27]
    v_exp_f32 v138, v138
    v_mfma_f32_16x16x32_bf16 a[20:23], v[232:235], v[172:175], a[20:23]
    s_waitcnt lgkmcnt(4)
    v_exp_f32 v139, v139
    v_mfma_f32_16x16x32_bf16 a[40:43], v[236:239], v[172:175], a[40:43]
    ds_read_b64_tr_b16 v[232:233], v20 offset:512
    ds_read_b64_tr_b16 v[234:235], v20 offset:4608
    v_mfma_f32_16x16x32_bf16 a[44:47], v[236:239], v[176:179], a[44:47]
    s_add_u32 m0, s32, 65536
    v_cvt_pk_bf16_f32 v158, v136, v137
    v_cvt_pk_bf16_f32 v159, v138, v139
    v_mfma_f32_16x16x32_bf16 a[48:51], v[236:239], v[180:183], a[48:51]
    s_mov_b32 s100, 40960
    v_exp_f32 v140, v140
    v_mfma_f32_16x16x32_bf16 a[52:55], v[236:239], v[184:187], a[52:55]
    buffer_load_dwordx4 v13, s[12:15], s100 offen nt lds
    v_mfma_f32_16x16x32_bf16 a[56:59], v[236:239], v[188:191], a[56:59]
    s_waitcnt lgkmcnt(4)
    v_exp_f32 v141, v141
    v_mfma_f32_16x16x32_bf16 a[76:79], v[240:243], v[188:191], a[76:79]
    ds_read_b64_tr_b16 v[236:237], v19 offset:768
    ds_read_b64_tr_b16 v[238:239], v19 offset:4864
    v_mfma_f32_16x16x32_bf16 a[72:75], v[240:243], v[184:187], a[72:75]
    v_exp_f32 v142, v142
    v_mfma_f32_16x16x32_bf16 a[68:71], v[240:243], v[180:183], a[68:71]
    v_exp_f32 v143, v143
    v_mfma_f32_16x16x32_bf16 a[64:67], v[240:243], v[176:179], a[64:67]
    v_cvt_pk_bf16_f32 v162, v140, v141
    v_cvt_pk_bf16_f32 v163, v142, v143
    v_mfma_f32_16x16x32_bf16 a[60:63], v[240:243], v[172:175], a[60:63]
    s_waitcnt lgkmcnt(4)
    v_exp_f32 v144, v144
    v_mfma_f32_16x16x32_bf16 a[80:83], v[228:231], v[172:175], a[80:83]
    ds_read_b64_tr_b16 v[240:241], v20 offset:768
    ds_read_b64_tr_b16 v[242:243], v20 offset:4864
    v_mfma_f32_16x16x32_bf16 a[84:87], v[228:231], v[176:179], a[84:87]
    v_exp_f32 v145, v145
    v_mfma_f32_16x16x32_bf16 a[88:91], v[228:231], v[180:183], a[88:91]
    v_add_u32 v19, 32768, v19
    v_cvt_pk_bf16_f32 v166, v144, v145
    v_mfma_f32_16x16x32_bf16 a[92:95], v[228:231], v[184:187], a[92:95]
    v_add_u32 v20, 32768, v20
    v_mfma_f32_16x16x32_bf16 a[96:99], v[228:231], v[188:191], a[96:99]
    s_waitcnt vmcnt(14) lgkmcnt(0)
    s_barrier
    buffer_load_dwordx4 v14, s[12:15], s100 offen offset:1024 nt lds
    v_mfma_f32_16x16x32_bf16 a[116:119], v[232:235], v[188:191], a[116:119]
    ds_read_b64 a[184:185], v17
    ds_read_b64 a[186:187], v18
    v_mfma_f32_16x16x32_bf16 a[112:115], v[232:235], v[184:187], a[112:115]
    v_exp_f32 v146, v146
    v_mfma_f32_16x16x32_bf16 a[108:111], v[232:235], v[180:183], a[108:111]
    v_exp_f32 v147, v147
    v_mfma_f32_16x16x32_bf16 a[104:107], v[232:235], v[176:179], a[104:107]
    ds_read_b64 a[188:189], v17 offset:256
    ds_read_b64 a[190:191], v18 offset:256
    v_mfma_f32_16x16x32_bf16 a[100:103], v[232:235], v[172:175], a[100:103]
    v_cvt_pk_bf16_f32 v167, v146, v147
    v_mfma_f32_16x16x32_bf16 a[120:123], v[236:239], v[172:175], a[120:123]
    v_exp_f32 v148, v148
    v_mfma_f32_16x16x32_bf16 a[124:127], v[236:239], v[176:179], a[124:127]
    ds_read_b64 a[192:193], v17 offset:512
    ds_read_b64 a[194:195], v18 offset:512
    v_mfma_f32_16x16x32_bf16 a[128:131], v[236:239], v[180:183], a[128:131]
    v_exp_f32 v149, v149
    v_mfma_f32_16x16x32_bf16 a[132:135], v[236:239], v[184:187], a[132:135]
    v_exp_f32 v150, v150
    v_mfma_f32_16x16x32_bf16 a[136:139], v[236:239], v[188:191], a[136:139]
    ds_read_b64 a[196:197], v17 offset:768
    ds_read_b64 a[198:199], v18 offset:768
    v_mfma_f32_16x16x32_bf16 a[156:159], v[240:243], v[188:191], a[156:159]
    v_exp_f32 v151, v151
    v_mfma_f32_16x16x32_bf16 a[152:155], v[240:243], v[184:187], a[152:155]
    buffer_load_dwordx4 v15, s[12:15], s100 offen offset:2048 nt lds
    v_cvt_pk_bf16_f32 v170, v148, v149
    v_mfma_f32_16x16x32_bf16 a[148:151], v[240:243], v[180:183], a[148:151]
    v_cvt_pk_bf16_f32 v171, v150, v151
    v_mfma_f32_16x16x32_bf16 a[144:147], v[240:243], v[176:179], a[144:147]
    v_mfma_f32_16x16x32_bf16 a[140:143], v[240:243], v[172:175], a[140:143]
    s_waitcnt lgkmcnt(6)
    v_mfma_f32_16x16x32_bf16 v[112:115], a[184:187], v[32:35], v[192:195]
    s_waitcnt lgkmcnt(4)
    s_and_b32 s56, s62, 7
    ds_read_b64 a[200:201], v17 offset:4096
    ds_read_b64 a[202:203], v18 offset:4096
    v_mfma_f32_16x16x32_bf16 v[112:115], a[188:191], v[36:39], v[112:115]
    s_waitcnt lgkmcnt(4)
    s_and_b32 s57, s61, 3
    v_lshrrev_b32 v26, 4, v22
    v_mfma_f32_16x16x32_bf16 v[112:115], a[192:195], v[40:43], v[112:115]
    s_waitcnt lgkmcnt(2)
    s_lshl_b32 s57, s57, 1
    v_lshlrev_b32 v26, 6, v26
    v_mfma_f32_16x16x32_bf16 v[112:115], a[196:199], v[44:47], v[112:115]
    s_add_u32 s25, s56, s57
    v_bfe_u32 v27, v22, 2, 2
    v_mfma_f32_16x16x32_bf16 v[116:119], a[196:199], v[60:63], v[196:199]
    s_lshl_b32 s58, s56, 2
    ds_read_b64 a[204:205], v17 offset:4352
    ds_read_b64 a[206:207], v18 offset:4352
    v_mfma_f32_16x16x32_bf16 v[116:119], a[192:195], v[56:59], v[116:119]
    s_lshr_b32 s31, s62, 3
    v_lshl_add_u32 v26, v27, 11, v26
    v_mfma_f32_16x16x32_bf16 v[116:119], a[188:191], v[52:55], v[116:119]
    s_lshl_b32 s31, s31, 6
    v_and_b32 v27, 3, v22
    v_mfma_f32_16x16x32_bf16 v[116:119], a[184:187], v[48:51], v[116:119]
    s_mul_i32 s30, s24, 5120
    v_lshl_add_u32 v26, v27, 4, v26
    v_mfma_f32_16x16x32_bf16 v[120:123], a[184:187], v[64:67], v[200:203]
    s_and_b32 s48, s63, 0xffffff80
    ds_read_b64 a[208:209], v17 offset:4608
    ds_read_b64 a[210:211], v18 offset:4608
    v_mfma_f32_16x16x32_bf16 v[120:123], a[188:191], v[68:71], v[120:123]
    s_lshl_b32 s56, s56, 8
    buffer_load_dwordx4 v16, s[12:15], s100 offen offset:3072 nt lds
    v_lshl_add_u32 v26, v23, 15, v26
    v_mfma_f32_16x16x32_bf16 v[120:123], a[192:195], v[72:75], v[120:123]
    s_add_u32 s68, s68, s56
    s_addc_u32 s69, s69, 0
    v_xor_b32 v27, 32, v26
    v_mfma_f32_16x16x32_bf16 v[120:123], a[196:199], v[76:79], v[120:123]
    s_sub_u32 s57, 8388608, s56
    v_add_u32 v1, 0, v26
    v_mfma_f32_16x16x32_bf16 v[124:127], a[196:199], v[92:95], v[204:207]
    s_mov_b32 s8, s68
    ds_read_b64 a[212:213], v17 offset:4864
    ds_read_b64 a[214:215], v18 offset:4864
    v_mfma_f32_16x16x32_bf16 v[124:127], a[192:195], v[88:91], v[124:127]
    s_and_b32 s9, s69, 0xffff
    v_add_u32 v2, 7168, v27
    v_mfma_f32_16x16x32_bf16 v[124:127], a[188:191], v[84:87], v[124:127]
    s_mov_b32 s10, s57
    v_add_u32 v3, 14336, v26
    v_mfma_f32_16x16x32_bf16 v[124:127], a[184:187], v[80:83], v[124:127]
    s_mov_b32 s11, 0x20000
    v_add_u32 v4, 21504, v27
    v_mfma_f32_16x16x32_bf16 v[128:131], a[184:187], v[96:99], v[208:211]
    s_mul_i32 s57, s61, 655360
    v_mul_u32_u24 v26, 5120, v23
    v_mfma_f32_16x16x32_bf16 v[128:131], a[188:191], v[100:103], v[128:131]
    s_add_u32 m0, s32, 81920
    v_lshl_add_u32 v5, v22, 4, v26
    v_mfma_f32_16x16x32_bf16 v[128:131], a[192:195], v[104:107], v[128:131]
    s_mov_b32 s100, 40960
    v_add_u32 v6, 4096, v5
    v_mfma_f32_16x16x32_bf16 v[128:131], a[196:199], v[108:111], v[128:131]
    s_waitcnt lgkmcnt(6)
    s_add_u32 s56, s56, s57
    buffer_load_dwordx4 v13, s[16:19], s100 offen nt lds
    v_lshrrev_b32 v26, 4, v22
    v_mfma_f32_16x16x32_bf16 v[132:135], a[200:203], v[32:35], v[192:195]
    s_waitcnt lgkmcnt(4)
    s_lshl_b32 s57, s60, 11
    v_lshlrev_b32 v26, 10, v26
    v_mfma_f32_16x16x32_bf16 v[132:135], a[204:207], v[36:39], v[132:135]
    s_waitcnt lgkmcnt(2)
    s_add_u32 s56, s56, s57
    v_bfe_u32 v27, v22, 2, 2
    v_mfma_f32_16x16x32_bf16 v[132:135], a[208:211], v[40:43], v[132:135]
    s_waitcnt lgkmcnt(0)
    s_add_u32 s94, s94, s56
    s_addc_u32 s95, s95, 0
    v_add_u32 v17, 32768, v17
    v_lshl_add_u32 v26, v27, 6, v26
    v_mfma_f32_16x16x32_bf16 v[132:135], a[212:215], v[44:47], v[132:135]
    s_sub_u32 s57, 5242880, s56
    v_add_u32 v18, 32768, v18
    v_bfe_u32 v27, v22, 4, 1
    v_mfma_f32_16x16x32_bf16 v[136:139], a[212:215], v[60:63], v[196:199]
    s_mov_b32 s4, s94
    v_lshl_add_u32 v26, v27, 5, v26
    v_mfma_f32_16x16x32_bf16 v[136:139], a[208:211], v[56:59], v[136:139]
    s_and_b32 s5, s95, 0xffff
    v_and_b32 v27, 3, v22
    v_mfma_f32_16x16x32_bf16 v[136:139], a[204:207], v[52:55], v[136:139]
    s_mov_b32 s6, s57
    v_lshl_add_u32 v26, v27, 3, v26
    v_mfma_f32_16x16x32_bf16 v[136:139], a[200:203], v[48:51], v[136:139]
    s_mov_b32 s7, 0x20000
    v_lshrrev_b32 v27, 1, v23
    v_mfma_f32_16x16x32_bf16 v[140:143], a[200:203], v[64:67], v[200:203]
    s_mul_i32 s56, s64, 40960
    v_lshl_add_u32 v26, v27, 9, v26
    v_mfma_f32_16x16x32_bf16 v[140:143], a[204:207], v[68:71], v[140:143]
    s_add_u32 s56, s56, 0x2800000
    v_add_u32 v7, 81920, v26
    v_mfma_f32_16x16x32_bf16 v[140:143], a[208:211], v[72:75], v[140:143]
    s_add_u32 s50, s34, s56
    s_addc_u32 s51, s35, 0
    ds_read_b64_tr_b16 v[228:229], v19
    ds_read_b64_tr_b16 v[230:231], v19 offset:4096
    v_mfma_f32_16x16x32_bf16 v[140:143], a[212:215], v[76:79], v[140:143]
    s_bitcmp1_b32 s62, 3
    s_cselect_b32 s49, 0, 0x100000
    buffer_load_dwordx4 v15, s[16:19], s100 offen offset:1024 nt lds
    v_xor_b32 v8, 32, v7
    v_mfma_f32_16x16x32_bf16 v[144:147], a[212:215], v[92:95], v[204:207]
    v_and_b32 v26, 1, v23
    v_mfma_f32_16x16x32_bf16 v[144:147], a[208:211], v[88:91], v[144:147]
    v_mul_u32_u24 v26, 5120, v26
    v_mfma_f32_16x16x32_bf16 v[144:147], a[204:207], v[84:87], v[144:147]
    v_lshl_add_u32 v9, v22, 4, v26
    v_mfma_f32_16x16x32_bf16 v[144:147], a[200:203], v[80:83], v[144:147]
    ds_read_b64_tr_b16 v[232:233], v20
    ds_read_b64_tr_b16 v[234:235], v20 offset:4096
    v_mfma_f32_16x16x32_bf16 v[148:151], a[200:203], v[96:99], v[208:211]
    v_add_u32 v10, 40960, v9
    v_mfma_f32_16x16x32_bf16 v[148:151], a[204:207], v[100:103], v[148:151]
    v_and_b32 v26, 1, v23
    v_mfma_f32_16x16x32_bf16 v[148:151], a[208:211], v[104:107], v[148:151]
    v_mul_u32_u24 v26, 80, v26
    v_mfma_f32_16x16x32_bf16 v[148:151], a[212:215], v[108:111], v[148:151]
    v_and_b32 v27, 15, v22
    v_mfma_f32_16x16x32_bf16 a[160:163], a[180:183], v[152:155], a[160:163]
    ds_read_b64_tr_b16 v[236:237], v19 offset:256
    ds_read_b64_tr_b16 v[238:239], v19 offset:4352
    v_mfma_f32_16x16x32_bf16 a[164:167], a[180:183], v[156:159], a[164:167]
    v_add_u32 v26, v26, v27
    v_mfma_f32_16x16x32_bf16 a[168:171], a[180:183], v[160:163], a[168:171]
    v_lshlrev_b32 v26, 12, v26
    v_mfma_f32_16x16x32_bf16 a[172:175], a[180:183], v[164:167], a[172:175]
    buffer_load_dwordx4 v13, s[16:19], s100 offen offset:2048 nt lds
    v_lshrrev_b32 v27, 4, v22
    v_mfma_f32_16x16x32_bf16 a[176:179], a[180:183], v[168:171], a[176:179]
    s_waitcnt lgkmcnt(4)
    v_lshl_add_u32 v26, v27, 4, v26
    v_mfma_f32_16x16x32_bf16 a[0:3], v[228:231], v[152:155], a[0:3]
    ds_read_b64_tr_b16 v[240:241], v20 offset:256
    ds_read_b64_tr_b16 v[242:243], v20 offset:4352
    v_mfma_f32_16x16x32_bf16 a[4:7], v[228:231], v[156:159], a[4:7]
    v_lshrrev_b32 v27, 1, v23
    v_mfma_f32_16x16x32_bf16 a[8:11], v[228:231], v[160:163], a[8:11]
    v_lshl_add_u32 v11, v27, 7, v26
    v_mfma_f32_16x16x32_bf16 a[12:15], v[228:231], v[164:167], a[12:15]
    v_mul_u32_u24 v26, 10240, v23
    v_mfma_f32_16x16x32_bf16 a[16:19], v[228:231], v[168:171], a[16:19]
    s_waitcnt lgkmcnt(4)
    v_lshl_add_u32 v12, v22, 4, v26
    v_mfma_f32_16x16x32_bf16 a[36:39], v[232:235], v[168:171], a[36:39]
    ds_read_b64_tr_b16 v[228:229], v19 offset:512
    ds_read_b64_tr_b16 v[230:231], v19 offset:4608
    v_mfma_f32_16x16x32_bf16 a[32:35], v[232:235], v[164:167], a[32:35]
    v_exp_f32 v112, v112
    v_mfma_f32_16x16x32_bf16 a[28:31], v[232:235], v[160:163], a[28:31]
    v_exp_f32 v113, v113
    v_mfma_f32_16x16x32_bf16 a[24:27], v[232:235], v[156:159], a[24:27]
    v_exp_f32 v114, v114
    v_mfma_f32_16x16x32_bf16 a[20:23], v[232:235], v[152:155], a[20:23]
    s_waitcnt lgkmcnt(4)
    v_exp_f32 v115, v115
    v_mfma_f32_16x16x32_bf16 a[40:43], v[236:239], v[152:155], a[40:43]
    ds_read_b64_tr_b16 v[232:233], v20 offset:512
    ds_read_b64_tr_b16 v[234:235], v20 offset:4608
    v_mfma_f32_16x16x32_bf16 a[44:47], v[236:239], v[156:159], a[44:47]
    buffer_load_dwordx4 v15, s[16:19], s100 offen offset:3072 nt lds
    v_cvt_pk_bf16_f32 v172, v112, v113
    v_mfma_f32_16x16x32_bf16 a[48:51], v[236:239], v[160:163], a[48:51]
    v_cvt_pk_bf16_f32 v173, v114, v115
    v_mfma_f32_16x16x32_bf16 a[52:55], v[236:239], v[164:167], a[52:55]
    v_exp_f32 v116, v116
    v_mfma_f32_16x16x32_bf16 a[56:59], v[236:239], v[168:171], a[56:59]
    s_waitcnt lgkmcnt(4)
    v_exp_f32 v117, v117
    v_mfma_f32_16x16x32_bf16 a[76:79], v[240:243], v[168:171], a[76:79]
    ds_read_b64_tr_b16 v[236:237], v19 offset:768
    ds_read_b64_tr_b16 v[238:239], v19 offset:4864
    v_mfma_f32_16x16x32_bf16 a[72:75], v[240:243], v[164:167], a[72:75]
    v_exp_f32 v118, v118
    v_mfma_f32_16x16x32_bf16 a[68:71], v[240:243], v[160:163], a[68:71]
    v_exp_f32 v119, v119
    v_mfma_f32_16x16x32_bf16 a[64:67], v[240:243], v[156:159], a[64:67]
    v_cvt_pk_bf16_f32 v176, v116, v117
    v_cvt_pk_bf16_f32 v177, v118, v119
    v_mfma_f32_16x16x32_bf16 a[60:63], v[240:243], v[152:155], a[60:63]
    s_waitcnt lgkmcnt(4)
    s_add_u32 m0, s32, 98304
    v_exp_f32 v120, v120
    v_mfma_f32_16x16x32_bf16 a[80:83], v[228:231], v[152:155], a[80:83]
    s_mov_b32 s100, 49152
    ds_read_b64_tr_b16 v[240:241], v20 offset:768
    ds_read_b64_tr_b16 v[242:243], v20 offset:4864
    v_mfma_f32_16x16x32_bf16 a[84:87], v[228:231], v[156:159], a[84:87]
    buffer_load_dwordx4 v13, s[12:15], s100 offen nt lds
    v_mfma_f32_16x16x32_bf16 a[88:91], v[228:231], v[160:163], a[88:91]
    v_subrev_u32 v19, 131072, v19
    v_mfma_f32_16x16x32_bf16 a[92:95], v[228:231], v[164:167], a[92:95]
    v_subrev_u32 v20, 131072, v20
    v_mfma_f32_16x16x32_bf16 a[96:99], v[228:231], v[168:171], a[96:99]
    s_waitcnt vmcnt(14) lgkmcnt(0)
    s_barrier
    v_mfma_f32_16x16x32_bf16 a[116:119], v[232:235], v[168:171], a[116:119]
    ds_read_b64 a[184:185], v17
    ds_read_b64 a[186:187], v18
    v_mfma_f32_16x16x32_bf16 a[112:115], v[232:235], v[164:167], a[112:115]
    v_exp_f32 v121, v121
    v_mfma_f32_16x16x32_bf16 a[108:111], v[232:235], v[160:163], a[108:111]
    v_exp_f32 v122, v122
    v_mfma_f32_16x16x32_bf16 a[104:107], v[232:235], v[156:159], a[104:107]
    ds_read_b64 a[188:189], v17 offset:256
    ds_read_b64 a[190:191], v18 offset:256
    v_mfma_f32_16x16x32_bf16 a[100:103], v[232:235], v[152:155], a[100:103]
    v_exp_f32 v123, v123
    v_mfma_f32_16x16x32_bf16 a[120:123], v[236:239], v[152:155], a[120:123]
    v_cvt_pk_bf16_f32 v180, v120, v121
    v_cvt_pk_bf16_f32 v181, v122, v123
    v_mfma_f32_16x16x32_bf16 a[124:127], v[236:239], v[156:159], a[124:127]
    ds_read_b64 a[192:193], v17 offset:512
    ds_read_b64 a[194:195], v18 offset:512
    v_mfma_f32_16x16x32_bf16 a[128:131], v[236:239], v[160:163], a[128:131]
    v_exp_f32 v124, v124
    v_mfma_f32_16x16x32_bf16 a[132:135], v[236:239], v[164:167], a[132:135]
    buffer_load_dwordx4 v14, s[12:15], s100 offen offset:1024 nt lds
    v_mfma_f32_16x16x32_bf16 a[136:139], v[236:239], v[168:171], a[136:139]
    ds_read_b64 a[196:197], v17 offset:768
    ds_read_b64 a[198:199], v18 offset:768
    v_mfma_f32_16x16x32_bf16 a[156:159], v[240:243], v[168:171], a[156:159]
    v_exp_f32 v125, v125
    v_mfma_f32_16x16x32_bf16 a[152:155], v[240:243], v[164:167], a[152:155]
    v_exp_f32 v126, v126
    v_mfma_f32_16x16x32_bf16 a[148:151], v[240:243], v[160:163], a[148:151]
    v_exp_f32 v127, v127
    v_mfma_f32_16x16x32_bf16 a[144:147], v[240:243], v[156:159], a[144:147]
    v_cvt_pk_bf16_f32 v184, v124, v125
    v_cvt_pk_bf16_f32 v185, v126, v127
    v_mfma_f32_16x16x32_bf16 a[140:143], v[240:243], v[152:155], a[140:143]
    s_waitcnt lgkmcnt(6)
    v_exp_f32 v128, v128
    v_mfma_f32_16x16x32_bf16 v[112:115], a[184:187], v[32:35], v[192:195]
    s_waitcnt lgkmcnt(4)
    ds_read_b64 a[200:201], v17 offset:4096
    ds_read_b64 a[202:203], v18 offset:4096
    v_mfma_f32_16x16x32_bf16 v[112:115], a[188:191], v[36:39], v[112:115]
    s_waitcnt lgkmcnt(4)
    v_exp_f32 v129, v129
    v_mfma_f32_16x16x32_bf16 v[112:115], a[192:195], v[40:43], v[112:115]
    s_waitcnt lgkmcnt(2)
    v_exp_f32 v130, v130
    v_mfma_f32_16x16x32_bf16 v[112:115], a[196:199], v[44:47], v[112:115]
    v_exp_f32 v131, v131
    v_mfma_f32_16x16x32_bf16 v[116:119], a[196:199], v[60:63], v[196:199]
    ds_read_b64 a[204:205], v17 offset:4352
    ds_read_b64 a[206:207], v18 offset:4352
    v_mfma_f32_16x16x32_bf16 v[116:119], a[192:195], v[56:59], v[116:119]
    buffer_load_dwordx4 v15, s[12:15], s100 offen offset:2048 nt lds
    v_cvt_pk_bf16_f32 v188, v128, v129
    v_mfma_f32_16x16x32_bf16 v[116:119], a[188:191], v[52:55], v[116:119]
    v_cvt_pk_bf16_f32 v189, v130, v131
    v_mfma_f32_16x16x32_bf16 v[116:119], a[184:187], v[48:51], v[116:119]
    v_exp_f32 v132, v132
    v_mfma_f32_16x16x32_bf16 v[120:123], a[184:187], v[64:67], v[200:203]
    ds_read_b64 a[208:209], v17 offset:4608
    ds_read_b64 a[210:211], v18 offset:4608
    v_mfma_f32_16x16x32_bf16 v[120:123], a[188:191], v[68:71], v[120:123]
    v_exp_f32 v133, v133
    v_mfma_f32_16x16x32_bf16 v[120:123], a[192:195], v[72:75], v[120:123]
    v_exp_f32 v134, v134
    v_mfma_f32_16x16x32_bf16 v[120:123], a[196:199], v[76:79], v[120:123]
    v_exp_f32 v135, v135
    v_mfma_f32_16x16x32_bf16 v[124:127], a[196:199], v[92:95], v[204:207]
    ds_read_b64 a[212:213], v17 offset:4864
    ds_read_b64 a[214:215], v18 offset:4864
    v_mfma_f32_16x16x32_bf16 v[124:127], a[192:195], v[88:91], v[124:127]
    v_cvt_pk_bf16_f32 v174, v132, v133
    v_cvt_pk_bf16_f32 v175, v134, v135
    v_mfma_f32_16x16x32_bf16 v[124:127], a[188:191], v[84:87], v[124:127]
    v_exp_f32 v136, v136
    v_mfma_f32_16x16x32_bf16 v[124:127], a[184:187], v[80:83], v[124:127]
    v_exp_f32 v137, v137
    v_mfma_f32_16x16x32_bf16 v[128:131], a[184:187], v[96:99], v[208:211]
    buffer_load_dwordx4 v16, s[12:15], s100 offen offset:3072 nt lds
    v_cvt_pk_bf16_f32 v178, v136, v137
    v_mfma_f32_16x16x32_bf16 v[128:131], a[188:191], v[100:103], v[128:131]
    v_exp_f32 v138, v138
    v_mfma_f32_16x16x32_bf16 v[128:131], a[192:195], v[104:107], v[128:131]
    v_exp_f32 v139, v139
    v_mfma_f32_16x16x32_bf16 v[128:131], a[196:199], v[108:111], v[128:131]
    s_waitcnt lgkmcnt(6)
    v_cvt_pk_bf16_f32 v179, v138, v139
    v_mfma_f32_16x16x32_bf16 v[132:135], a[200:203], v[32:35], v[192:195]
    s_waitcnt lgkmcnt(4)
    v_exp_f32 v140, v140
    v_mfma_f32_16x16x32_bf16 v[132:135], a[204:207], v[36:39], v[132:135]
    s_waitcnt lgkmcnt(2)
    v_exp_f32 v141, v141
    v_mfma_f32_16x16x32_bf16 v[132:135], a[208:211], v[40:43], v[132:135]
    s_waitcnt lgkmcnt(0)
    v_add_u32 v17, 32768, v17
    v_cvt_pk_bf16_f32 v182, v140, v141
    v_mfma_f32_16x16x32_bf16 v[132:135], a[212:215], v[44:47], v[132:135]
    v_add_u32 v18, 32768, v18
    v_mfma_f32_16x16x32_bf16 v[136:139], a[212:215], v[60:63], v[196:199]
    v_exp_f32 v142, v142
    v_mfma_f32_16x16x32_bf16 v[136:139], a[208:211], v[56:59], v[136:139]
    v_exp_f32 v143, v143
    v_mfma_f32_16x16x32_bf16 v[136:139], a[204:207], v[52:55], v[136:139]
    s_add_u32 m0, s32, 114688
    v_cvt_pk_bf16_f32 v183, v142, v143
    v_mfma_f32_16x16x32_bf16 v[136:139], a[200:203], v[48:51], v[136:139]
    s_mov_b32 s100, 49152
    v_exp_f32 v144, v144
    v_mfma_f32_16x16x32_bf16 v[140:143], a[200:203], v[64:67], v[200:203]
    buffer_load_dwordx4 v13, s[16:19], s100 offen nt lds
    v_exp_f32 v145, v145
    v_mfma_f32_16x16x32_bf16 v[140:143], a[204:207], v[68:71], v[140:143]
    v_exp_f32 v146, v146
    v_mfma_f32_16x16x32_bf16 v[140:143], a[208:211], v[72:75], v[140:143]
    ds_read_b64_tr_b16 v[228:229], v19
    ds_read_b64_tr_b16 v[230:231], v19 offset:4096
    v_exp_f32 v147, v147
    v_mfma_f32_16x16x32_bf16 v[140:143], a[212:215], v[76:79], v[140:143]
    v_cvt_pk_bf16_f32 v186, v144, v145
    v_cvt_pk_bf16_f32 v187, v146, v147
    v_exp_f32 v148, v148
    v_mfma_f32_16x16x32_bf16 v[144:147], a[212:215], v[92:95], v[204:207]
    v_exp_f32 v149, v149
    v_mfma_f32_16x16x32_bf16 v[144:147], a[208:211], v[88:91], v[144:147]
    v_exp_f32 v150, v150
    v_mfma_f32_16x16x32_bf16 v[144:147], a[204:207], v[84:87], v[144:147]
    v_exp_f32 v151, v151
    v_mfma_f32_16x16x32_bf16 v[144:147], a[200:203], v[80:83], v[144:147]
    ds_read_b64_tr_b16 v[232:233], v20
    ds_read_b64_tr_b16 v[234:235], v20 offset:4096
    v_cvt_pk_bf16_f32 v190, v148, v149
    v_cvt_pk_bf16_f32 v191, v150, v151
    v_mfma_f32_16x16x32_bf16 v[148:151], a[200:203], v[96:99], v[208:211]
    v_exp_f32 v112, v112
    v_mfma_f32_16x16x32_bf16 v[148:151], a[204:207], v[100:103], v[148:151]
    v_exp_f32 v113, v113
    v_mfma_f32_16x16x32_bf16 v[148:151], a[208:211], v[104:107], v[148:151]
    v_exp_f32 v114, v114
    v_mfma_f32_16x16x32_bf16 v[148:151], a[212:215], v[108:111], v[148:151]
    v_exp_f32 v115, v115
    v_mfma_f32_16x16x32_bf16 a[160:163], a[180:183], v[172:175], a[160:163]
    ds_read_b64_tr_b16 v[236:237], v19 offset:256
    ds_read_b64_tr_b16 v[238:239], v19 offset:4352
    v_mfma_f32_16x16x32_bf16 a[164:167], a[180:183], v[176:179], a[164:167]
    buffer_load_dwordx4 v15, s[16:19], s100 offen offset:1024 nt lds
    v_cvt_pk_bf16_f32 v152, v112, v113
    v_mfma_f32_16x16x32_bf16 a[168:171], a[180:183], v[180:183], a[168:171]
    v_cvt_pk_bf16_f32 v153, v114, v115
    v_mfma_f32_16x16x32_bf16 a[172:175], a[180:183], v[184:187], a[172:175]
    v_exp_f32 v116, v116
    v_mfma_f32_16x16x32_bf16 a[176:179], a[180:183], v[188:191], a[176:179]
    s_waitcnt lgkmcnt(4)
    v_exp_f32 v117, v117
    v_mfma_f32_16x16x32_bf16 a[0:3], v[228:231], v[172:175], a[0:3]
    ds_read_b64_tr_b16 v[240:241], v20 offset:256
    ds_read_b64_tr_b16 v[242:243], v20 offset:4352
    v_mfma_f32_16x16x32_bf16 a[4:7], v[228:231], v[176:179], a[4:7]
    v_exp_f32 v118, v118
    v_mfma_f32_16x16x32_bf16 a[8:11], v[228:231], v[180:183], a[8:11]
    v_exp_f32 v119, v119
    v_mfma_f32_16x16x32_bf16 a[12:15], v[228:231], v[184:187], a[12:15]
    v_cvt_pk_bf16_f32 v156, v116, v117
    v_cvt_pk_bf16_f32 v157, v118, v119
    v_mfma_f32_16x16x32_bf16 a[16:19], v[228:231], v[188:191], a[16:19]
    s_waitcnt lgkmcnt(4)
    v_exp_f32 v120, v120
    v_mfma_f32_16x16x32_bf16 a[36:39], v[232:235], v[188:191], a[36:39]
    ds_read_b64_tr_b16 v[228:229], v19 offset:512
    ds_read_b64_tr_b16 v[230:231], v19 offset:4608
    v_mfma_f32_16x16x32_bf16 a[32:35], v[232:235], v[184:187], a[32:35]
    buffer_load_dwordx4 v13, s[16:19], s100 offen offset:2048 nt lds
    v_mfma_f32_16x16x32_bf16 a[28:31], v[232:235], v[180:183], a[28:31]
    v_exp_f32 v121, v121
    v_mfma_f32_16x16x32_bf16 a[24:27], v[232:235], v[176:179], a[24:27]
    v_exp_f32 v122, v122
    v_mfma_f32_16x16x32_bf16 a[20:23], v[232:235], v[172:175], a[20:23]
    s_waitcnt lgkmcnt(4)
    v_exp_f32 v123, v123
    v_mfma_f32_16x16x32_bf16 a[40:43], v[236:239], v[172:175], a[40:43]
    ds_read_b64_tr_b16 v[232:233], v20 offset:512
    ds_read_b64_tr_b16 v[234:235], v20 offset:4608
    v_mfma_f32_16x16x32_bf16 a[44:47], v[236:239], v[176:179], a[44:47]
    v_cvt_pk_bf16_f32 v160, v120, v121
    v_cvt_pk_bf16_f32 v161, v122, v123
    v_mfma_f32_16x16x32_bf16 a[48:51], v[236:239], v[180:183], a[48:51]
    v_exp_f32 v124, v124
    v_mfma_f32_16x16x32_bf16 a[52:55], v[236:239], v[184:187], a[52:55]
    v_exp_f32 v125, v125
    v_mfma_f32_16x16x32_bf16 a[56:59], v[236:239], v[188:191], a[56:59]
    s_waitcnt lgkmcnt(4)
    v_exp_f32 v126, v126
    v_mfma_f32_16x16x32_bf16 a[76:79], v[240:243], v[188:191], a[76:79]
    ds_read_b64_tr_b16 v[236:237], v19 offset:768
    ds_read_b64_tr_b16 v[238:239], v19 offset:4864
    v_mfma_f32_16x16x32_bf16 a[72:75], v[240:243], v[184:187], a[72:75]
    v_exp_f32 v127, v127
    v_mfma_f32_16x16x32_bf16 a[68:71], v[240:243], v[180:183], a[68:71]
    v_cvt_pk_bf16_f32 v164, v124, v125
    v_cvt_pk_bf16_f32 v165, v126, v127
    v_mfma_f32_16x16x32_bf16 a[64:67], v[240:243], v[176:179], a[64:67]
    buffer_load_dwordx4 v15, s[16:19], s100 offen offset:3072 nt lds
    v_mfma_f32_16x16x32_bf16 a[60:63], v[240:243], v[172:175], a[60:63]
    s_waitcnt lgkmcnt(4)
    v_exp_f32 v128, v128
    v_mfma_f32_16x16x32_bf16 a[80:83], v[228:231], v[172:175], a[80:83]
    ds_read_b64_tr_b16 v[240:241], v20 offset:768
    ds_read_b64_tr_b16 v[242:243], v20 offset:4864
    v_mfma_f32_16x16x32_bf16 a[84:87], v[228:231], v[176:179], a[84:87]
    v_exp_f32 v129, v129
    v_mfma_f32_16x16x32_bf16 a[88:91], v[228:231], v[180:183], a[88:91]
    v_add_u32 v19, 32768, v19
    v_cvt_pk_bf16_f32 v168, v128, v129
    v_mfma_f32_16x16x32_bf16 a[92:95], v[228:231], v[184:187], a[92:95]
    v_add_u32 v20, 32768, v20
    v_mfma_f32_16x16x32_bf16 a[96:99], v[228:231], v[188:191], a[96:99]
    s_waitcnt vmcnt(12) lgkmcnt(0)
    s_barrier
    v_mfma_f32_16x16x32_bf16 a[116:119], v[232:235], v[188:191], a[116:119]
    ds_read_b64 a[184:185], v17
    ds_read_b64 a[186:187], v18
    v_mfma_f32_16x16x32_bf16 a[112:115], v[232:235], v[184:187], a[112:115]
    v_exp_f32 v130, v130
    v_mfma_f32_16x16x32_bf16 a[108:111], v[232:235], v[180:183], a[108:111]
    v_exp_f32 v131, v131
    v_mfma_f32_16x16x32_bf16 a[104:107], v[232:235], v[176:179], a[104:107]
    s_add_u32 m0, s32, 131072
    ds_read_b64 a[188:189], v17 offset:256
    ds_read_b64 a[190:191], v18 offset:256
    v_mfma_f32_16x16x32_bf16 a[100:103], v[232:235], v[172:175], a[100:103]
    s_mov_b32 s100, 57344
    v_cvt_pk_bf16_f32 v169, v130, v131
    v_mfma_f32_16x16x32_bf16 a[120:123], v[236:239], v[172:175], a[120:123]
    buffer_load_dwordx4 v13, s[12:15], s100 offen nt lds
    v_mfma_f32_16x16x32_bf16 a[124:127], v[236:239], v[176:179], a[124:127]
    ds_read_b64 a[192:193], v17 offset:512
    ds_read_b64 a[194:195], v18 offset:512
    v_mfma_f32_16x16x32_bf16 a[128:131], v[236:239], v[180:183], a[128:131]
    v_exp_f32 v132, v132
    v_mfma_f32_16x16x32_bf16 a[132:135], v[236:239], v[184:187], a[132:135]
    v_exp_f32 v133, v133
    v_mfma_f32_16x16x32_bf16 a[136:139], v[236:239], v[188:191], a[136:139]
    ds_read_b64 a[196:197], v17 offset:768
    ds_read_b64 a[198:199], v18 offset:768
    v_mfma_f32_16x16x32_bf16 a[156:159], v[240:243], v[188:191], a[156:159]
    v_exp_f32 v134, v134
    v_mfma_f32_16x16x32_bf16 a[152:155], v[240:243], v[184:187], a[152:155]
    v_exp_f32 v135, v135
    v_mfma_f32_16x16x32_bf16 a[148:151], v[240:243], v[180:183], a[148:151]
    v_cvt_pk_bf16_f32 v154, v132, v133
    v_cvt_pk_bf16_f32 v155, v134, v135
    v_mfma_f32_16x16x32_bf16 a[144:147], v[240:243], v[176:179], a[144:147]
    v_exp_f32 v136, v136
    v_mfma_f32_16x16x32_bf16 a[140:143], v[240:243], v[172:175], a[140:143]
    s_waitcnt lgkmcnt(6)
    v_exp_f32 v137, v137
    v_mfma_f32_16x16x32_bf16 v[112:115], a[184:187], v[32:35], v[192:195]
    s_waitcnt lgkmcnt(4)
    ds_read_b64 a[200:201], v17 offset:4096
    ds_read_b64 a[202:203], v18 offset:4096
    v_mfma_f32_16x16x32_bf16 v[112:115], a[188:191], v[36:39], v[112:115]
    s_waitcnt lgkmcnt(4)
    buffer_load_dwordx4 v14, s[12:15], s100 offen offset:1024 nt lds
    v_cvt_pk_bf16_f32 v158, v136, v137
    v_mfma_f32_16x16x32_bf16 v[112:115], a[192:195], v[40:43], v[112:115]
    s_waitcnt lgkmcnt(2)
    v_exp_f32 v138, v138
    v_mfma_f32_16x16x32_bf16 v[112:115], a[196:199], v[44:47], v[112:115]
    v_exp_f32 v139, v139
    v_mfma_f32_16x16x32_bf16 v[116:119], a[196:199], v[60:63], v[196:199]
    ds_read_b64 a[204:205], v17 offset:4352
    ds_read_b64 a[206:207], v18 offset:4352
    v_mfma_f32_16x16x32_bf16 v[116:119], a[192:195], v[56:59], v[116:119]
    v_cvt_pk_bf16_f32 v159, v138, v139
    v_mfma_f32_16x16x32_bf16 v[116:119], a[188:191], v[52:55], v[116:119]
    v_exp_f32 v140, v140
    v_mfma_f32_16x16x32_bf16 v[116:119], a[184:187], v[48:51], v[116:119]
    v_exp_f32 v141, v141
    v_mfma_f32_16x16x32_bf16 v[120:123], a[184:187], v[64:67], v[200:203]
    ds_read_b64 a[208:209], v17 offset:4608
    ds_read_b64 a[210:211], v18 offset:4608
    v_mfma_f32_16x16x32_bf16 v[120:123], a[188:191], v[68:71], v[120:123]
    v_exp_f32 v142, v142
    v_mfma_f32_16x16x32_bf16 v[120:123], a[192:195], v[72:75], v[120:123]
    v_exp_f32 v143, v143
    v_mfma_f32_16x16x32_bf16 v[120:123], a[196:199], v[76:79], v[120:123]
    v_cvt_pk_bf16_f32 v162, v140, v141
    v_cvt_pk_bf16_f32 v163, v142, v143
    v_mfma_f32_16x16x32_bf16 v[124:127], a[196:199], v[92:95], v[204:207]
    ds_read_b64 a[212:213], v17 offset:4864
    ds_read_b64 a[214:215], v18 offset:4864
    v_mfma_f32_16x16x32_bf16 v[124:127], a[192:195], v[88:91], v[124:127]
    buffer_load_dwordx4 v15, s[12:15], s100 offen offset:2048 nt lds
    v_mfma_f32_16x16x32_bf16 v[124:127], a[188:191], v[84:87], v[124:127]
    v_exp_f32 v144, v144
    v_mfma_f32_16x16x32_bf16 v[124:127], a[184:187], v[80:83], v[124:127]
    v_exp_f32 v145, v145
    v_mfma_f32_16x16x32_bf16 v[128:131], a[184:187], v[96:99], v[208:211]
    v_exp_f32 v146, v146
    v_mfma_f32_16x16x32_bf16 v[128:131], a[188:191], v[100:103], v[128:131]
    v_exp_f32 v147, v147
    v_mfma_f32_16x16x32_bf16 v[128:131], a[192:195], v[104:107], v[128:131]
    v_cvt_pk_bf16_f32 v166, v144, v145
    v_cvt_pk_bf16_f32 v167, v146, v147
    v_mfma_f32_16x16x32_bf16 v[128:131], a[196:199], v[108:111], v[128:131]
    s_waitcnt lgkmcnt(6)
    v_exp_f32 v148, v148
    v_mfma_f32_16x16x32_bf16 v[132:135], a[200:203], v[32:35], v[192:195]
    s_waitcnt lgkmcnt(4)
    v_exp_f32 v149, v149
    v_mfma_f32_16x16x32_bf16 v[132:135], a[204:207], v[36:39], v[132:135]
    s_waitcnt lgkmcnt(2)
    v_exp_f32 v150, v150
    v_mfma_f32_16x16x32_bf16 v[132:135], a[208:211], v[40:43], v[132:135]
    s_waitcnt lgkmcnt(0)
    v_add_u32 v17, 32768, v17
    v_cvt_pk_bf16_f32 v170, v148, v149
    v_mfma_f32_16x16x32_bf16 v[132:135], a[212:215], v[44:47], v[132:135]
    v_add_u32 v18, 32768, v18
    v_mfma_f32_16x16x32_bf16 v[136:139], a[212:215], v[60:63], v[196:199]
    v_exp_f32 v151, v151
    v_mfma_f32_16x16x32_bf16 v[136:139], a[208:211], v[56:59], v[136:139]
    buffer_load_dwordx4 v16, s[12:15], s100 offen offset:3072 nt lds
    v_cvt_pk_bf16_f32 v171, v150, v151
    v_mfma_f32_16x16x32_bf16 v[136:139], a[204:207], v[52:55], v[136:139]
    v_exp_f32 v112, v112
    v_mfma_f32_16x16x32_bf16 v[136:139], a[200:203], v[48:51], v[136:139]
    v_exp_f32 v113, v113
    v_mfma_f32_16x16x32_bf16 v[140:143], a[200:203], v[64:67], v[200:203]
    v_exp_f32 v114, v114
    v_mfma_f32_16x16x32_bf16 v[140:143], a[204:207], v[68:71], v[140:143]
    v_exp_f32 v115, v115
    v_mfma_f32_16x16x32_bf16 v[140:143], a[208:211], v[72:75], v[140:143]
    ds_read_b64_tr_b16 v[228:229], v19
    ds_read_b64_tr_b16 v[230:231], v19 offset:4096
    v_mfma_f32_16x16x32_bf16 v[140:143], a[212:215], v[76:79], v[140:143]
    v_cvt_pk_bf16_f32 v172, v112, v113
    v_cvt_pk_bf16_f32 v173, v114, v115
    v_mfma_f32_16x16x32_bf16 v[144:147], a[212:215], v[92:95], v[204:207]
    v_exp_f32 v116, v116
    v_mfma_f32_16x16x32_bf16 v[144:147], a[208:211], v[88:91], v[144:147]
    v_exp_f32 v117, v117
    v_mfma_f32_16x16x32_bf16 v[144:147], a[204:207], v[84:87], v[144:147]
    s_add_u32 m0, s32, 147456
    v_exp_f32 v118, v118
    v_mfma_f32_16x16x32_bf16 v[144:147], a[200:203], v[80:83], v[144:147]
    s_mov_b32 s100, 57344
    ds_read_b64_tr_b16 v[232:233], v20
    ds_read_b64_tr_b16 v[234:235], v20 offset:4096
    v_mfma_f32_16x16x32_bf16 v[148:151], a[200:203], v[96:99], v[208:211]
    buffer_load_dwordx4 v13, s[16:19], s100 offen nt lds
    v_cvt_pk_bf16_f32 v176, v116, v117
    v_mfma_f32_16x16x32_bf16 v[148:151], a[204:207], v[100:103], v[148:151]
    v_exp_f32 v119, v119
    v_mfma_f32_16x16x32_bf16 v[148:151], a[208:211], v[104:107], v[148:151]
    v_cvt_pk_bf16_f32 v177, v118, v119
    v_mfma_f32_16x16x32_bf16 v[148:151], a[212:215], v[108:111], v[148:151]
    v_exp_f32 v120, v120
    v_mfma_f32_16x16x32_bf16 a[160:163], a[180:183], v[152:155], a[160:163]
    ds_read_b64_tr_b16 v[236:237], v19 offset:256
    ds_read_b64_tr_b16 v[238:239], v19 offset:4352
    v_mfma_f32_16x16x32_bf16 a[164:167], a[180:183], v[156:159], a[164:167]
    v_exp_f32 v121, v121
    v_mfma_f32_16x16x32_bf16 a[168:171], a[180:183], v[160:163], a[168:171]
    v_exp_f32 v122, v122
    v_mfma_f32_16x16x32_bf16 a[172:175], a[180:183], v[164:167], a[172:175]
    v_exp_f32 v123, v123
    v_mfma_f32_16x16x32_bf16 a[176:179], a[180:183], v[168:171], a[176:179]
    s_waitcnt lgkmcnt(4)
    v_cvt_pk_bf16_f32 v180, v120, v121
    v_cvt_pk_bf16_f32 v181, v122, v123
    v_mfma_f32_16x16x32_bf16 a[0:3], v[228:231], v[152:155], a[0:3]
    ds_read_b64_tr_b16 v[240:241], v20 offset:256
    ds_read_b64_tr_b16 v[242:243], v20 offset:4352
    v_mfma_f32_16x16x32_bf16 a[4:7], v[228:231], v[156:159], a[4:7]
    v_exp_f32 v124, v124
    v_mfma_f32_16x16x32_bf16 a[8:11], v[228:231], v[160:163], a[8:11]
    v_exp_f32 v125, v125
    v_mfma_f32_16x16x32_bf16 a[12:15], v[228:231], v[164:167], a[12:15]
    buffer_load_dwordx4 v15, s[16:19], s100 offen offset:1024 nt lds
    v_cvt_pk_bf16_f32 v184, v124, v125
    v_mfma_f32_16x16x32_bf16 a[16:19], v[228:231], v[168:171], a[16:19]
    s_waitcnt lgkmcnt(4)
    v_exp_f32 v126, v126
    v_mfma_f32_16x16x32_bf16 a[36:39], v[232:235], v[168:171], a[36:39]
    ds_read_b64_tr_b16 v[228:229], v19 offset:512
    ds_read_b64_tr_b16 v[230:231], v19 offset:4608
    v_mfma_f32_16x16x32_bf16 a[32:35], v[232:235], v[164:167], a[32:35]
    v_exp_f32 v127, v127
    v_mfma_f32_16x16x32_bf16 a[28:31], v[232:235], v[160:163], a[28:31]
    v_cvt_pk_bf16_f32 v185, v126, v127
    v_mfma_f32_16x16x32_bf16 a[24:27], v[232:235], v[156:159], a[24:27]
    v_exp_f32 v128, v128
    v_mfma_f32_16x16x32_bf16 a[20:23], v[232:235], v[152:155], a[20:23]
    s_waitcnt lgkmcnt(4)
    v_exp_f32 v129, v129
    v_mfma_f32_16x16x32_bf16 a[40:43], v[236:239], v[152:155], a[40:43]
    ds_read_b64_tr_b16 v[232:233], v20 offset:512
    ds_read_b64_tr_b16 v[234:235], v20 offset:4608
    v_mfma_f32_16x16x32_bf16 a[44:47], v[236:239], v[156:159], a[44:47]
    v_exp_f32 v130, v130
    v_mfma_f32_16x16x32_bf16 a[48:51], v[236:239], v[160:163], a[48:51]
    v_exp_f32 v131, v131
    v_mfma_f32_16x16x32_bf16 a[52:55], v[236:239], v[164:167], a[52:55]
    v_cvt_pk_bf16_f32 v188, v128, v129
    v_cvt_pk_bf16_f32 v189, v130, v131
    v_mfma_f32_16x16x32_bf16 a[56:59], v[236:239], v[168:171], a[56:59]
    s_waitcnt lgkmcnt(4)
    v_exp_f32 v132, v132
    v_mfma_f32_16x16x32_bf16 a[76:79], v[240:243], v[168:171], a[76:79]
    ds_read_b64_tr_b16 v[236:237], v19 offset:768
    ds_read_b64_tr_b16 v[238:239], v19 offset:4864
    v_mfma_f32_16x16x32_bf16 a[72:75], v[240:243], v[164:167], a[72:75]
    buffer_load_dwordx4 v13, s[16:19], s100 offen offset:2048 nt lds
    v_mfma_f32_16x16x32_bf16 a[68:71], v[240:243], v[160:163], a[68:71]
    v_exp_f32 v133, v133
    v_mfma_f32_16x16x32_bf16 a[64:67], v[240:243], v[156:159], a[64:67]
    v_exp_f32 v134, v134
    v_mfma_f32_16x16x32_bf16 a[60:63], v[240:243], v[152:155], a[60:63]
    s_waitcnt lgkmcnt(4)
    v_exp_f32 v135, v135
    v_mfma_f32_16x16x32_bf16 a[80:83], v[228:231], v[152:155], a[80:83]
    ds_read_b64_tr_b16 v[240:241], v20 offset:768
    ds_read_b64_tr_b16 v[242:243], v20 offset:4864
    v_mfma_f32_16x16x32_bf16 a[84:87], v[228:231], v[156:159], a[84:87]
    v_cvt_pk_bf16_f32 v174, v132, v133
    v_cvt_pk_bf16_f32 v175, v134, v135
    v_mfma_f32_16x16x32_bf16 a[88:91], v[228:231], v[160:163], a[88:91]
    v_add_u32 v19, 32768, v19
    v_mfma_f32_16x16x32_bf16 a[92:95], v[228:231], v[164:167], a[92:95]
    v_add_u32 v20, 32768, v20
    v_mfma_f32_16x16x32_bf16 a[96:99], v[228:231], v[168:171], a[96:99]
    s_waitcnt vmcnt(11) lgkmcnt(0)
    s_barrier
    v_mfma_f32_16x16x32_bf16 a[116:119], v[232:235], v[168:171], a[116:119]
    ds_read_b64 a[184:185], v17
    ds_read_b64 a[186:187], v18
    v_mfma_f32_16x16x32_bf16 a[112:115], v[232:235], v[164:167], a[112:115]
    v_exp_f32 v136, v136
    v_mfma_f32_16x16x32_bf16 a[108:111], v[232:235], v[160:163], a[108:111]
    buffer_load_dwordx4 v15, s[16:19], s100 offen offset:3072 nt lds
    v_mfma_f32_16x16x32_bf16 a[104:107], v[232:235], v[156:159], a[104:107]
    ds_read_b64 a[188:189], v17 offset:256
    ds_read_b64 a[190:191], v18 offset:256
    v_mfma_f32_16x16x32_bf16 a[100:103], v[232:235], v[152:155], a[100:103]
    v_exp_f32 v137, v137
    v_mfma_f32_16x16x32_bf16 a[120:123], v[236:239], v[152:155], a[120:123]
    v_exp_f32 v138, v138
    v_mfma_f32_16x16x32_bf16 a[124:127], v[236:239], v[156:159], a[124:127]
    ds_read_b64 a[192:193], v17 offset:512
    ds_read_b64 a[194:195], v18 offset:512
    v_mfma_f32_16x16x32_bf16 a[128:131], v[236:239], v[160:163], a[128:131]
    v_exp_f32 v139, v139
    v_mfma_f32_16x16x32_bf16 a[132:135], v[236:239], v[164:167], a[132:135]
    v_cvt_pk_bf16_f32 v178, v136, v137
    v_cvt_pk_bf16_f32 v179, v138, v139
    v_mfma_f32_16x16x32_bf16 a[136:139], v[236:239], v[168:171], a[136:139]
    ds_read_b64 a[196:197], v17 offset:768
    ds_read_b64 a[198:199], v18 offset:768
    v_mfma_f32_16x16x32_bf16 a[156:159], v[240:243], v[168:171], a[156:159]
    v_exp_f32 v140, v140
    v_mfma_f32_16x16x32_bf16 a[152:155], v[240:243], v[164:167], a[152:155]
    s_add_u32 m0, s32, 0
    v_exp_f32 v141, v141
    v_mfma_f32_16x16x32_bf16 a[148:151], v[240:243], v[160:163], a[148:151]
    s_mov_b32 s100, 65536
    v_exp_f32 v142, v142
    v_mfma_f32_16x16x32_bf16 a[144:147], v[240:243], v[156:159], a[144:147]
    buffer_load_dwordx4 v13, s[12:15], s100 offen nt lds
    v_cvt_pk_bf16_f32 v182, v140, v141
    v_mfma_f32_16x16x32_bf16 a[140:143], v[240:243], v[152:155], a[140:143]
    s_waitcnt lgkmcnt(6)
    v_exp_f32 v143, v143
    v_mfma_f32_16x16x32_bf16 v[112:115], a[184:187], v[32:35], v[192:195]
    s_waitcnt lgkmcnt(4)
    ds_read_b64 a[200:201], v17 offset:4096
    ds_read_b64 a[202:203], v18 offset:4096
    v_mfma_f32_16x16x32_bf16 v[112:115], a[188:191], v[36:39], v[112:115]
    s_waitcnt lgkmcnt(4)
    v_cvt_pk_bf16_f32 v183, v142, v143
    v_mfma_f32_16x16x32_bf16 v[112:115], a[192:195], v[40:43], v[112:115]
    s_waitcnt lgkmcnt(2)
    v_exp_f32 v144, v144
    v_mfma_f32_16x16x32_bf16 v[112:115], a[196:199], v[44:47], v[112:115]
    v_exp_f32 v145, v145
    v_mfma_f32_16x16x32_bf16 v[116:119], a[196:199], v[60:63], v[196:199]
    ds_read_b64 a[204:205], v17 offset:4352
    ds_read_b64 a[206:207], v18 offset:4352
    v_mfma_f32_16x16x32_bf16 v[116:119], a[192:195], v[56:59], v[116:119]
    v_exp_f32 v146, v146
    v_mfma_f32_16x16x32_bf16 v[116:119], a[188:191], v[52:55], v[116:119]
    v_exp_f32 v147, v147
    v_mfma_f32_16x16x32_bf16 v[116:119], a[184:187], v[48:51], v[116:119]
    v_cvt_pk_bf16_f32 v186, v144, v145
    v_cvt_pk_bf16_f32 v187, v146, v147
    v_mfma_f32_16x16x32_bf16 v[120:123], a[184:187], v[64:67], v[200:203]
    ds_read_b64 a[208:209], v17 offset:4608
    ds_read_b64 a[210:211], v18 offset:4608
    v_mfma_f32_16x16x32_bf16 v[120:123], a[188:191], v[68:71], v[120:123]
    v_exp_f32 v148, v148
    v_mfma_f32_16x16x32_bf16 v[120:123], a[192:195], v[72:75], v[120:123]
    buffer_load_dwordx4 v14, s[12:15], s100 offen offset:1024 nt lds
    v_mfma_f32_16x16x32_bf16 v[120:123], a[196:199], v[76:79], v[120:123]
    v_exp_f32 v149, v149
    v_mfma_f32_16x16x32_bf16 v[124:127], a[196:199], v[92:95], v[204:207]
    ds_read_b64 a[212:213], v17 offset:4864
    ds_read_b64 a[214:215], v18 offset:4864
    v_mfma_f32_16x16x32_bf16 v[124:127], a[192:195], v[88:91], v[124:127]
    v_exp_f32 v150, v150
    v_mfma_f32_16x16x32_bf16 v[124:127], a[188:191], v[84:87], v[124:127]
    v_exp_f32 v151, v151
    v_mfma_f32_16x16x32_bf16 v[124:127], a[184:187], v[80:83], v[124:127]
    v_cvt_pk_bf16_f32 v190, v148, v149
    v_cvt_pk_bf16_f32 v191, v150, v151
    v_mfma_f32_16x16x32_bf16 v[128:131], a[184:187], v[96:99], v[208:211]
    v_exp_f32 v112, v112
    v_mfma_f32_16x16x32_bf16 v[128:131], a[188:191], v[100:103], v[128:131]
    v_exp_f32 v113, v113
    v_mfma_f32_16x16x32_bf16 v[128:131], a[192:195], v[104:107], v[128:131]
    v_exp_f32 v114, v114
    v_mfma_f32_16x16x32_bf16 v[128:131], a[196:199], v[108:111], v[128:131]
    s_waitcnt lgkmcnt(6)
    v_exp_f32 v115, v115
    v_mfma_f32_16x16x32_bf16 v[132:135], a[200:203], v[32:35], v[192:195]
    s_waitcnt lgkmcnt(4)
    v_cvt_pk_bf16_f32 v152, v112, v113
    v_cvt_pk_bf16_f32 v153, v114, v115
    v_mfma_f32_16x16x32_bf16 v[132:135], a[204:207], v[36:39], v[132:135]
    s_waitcnt lgkmcnt(2)
    v_exp_f32 v116, v116
    v_mfma_f32_16x16x32_bf16 v[132:135], a[208:211], v[40:43], v[132:135]
    s_waitcnt lgkmcnt(0)
    v_add_u32 v17, 32768, v17
    buffer_load_dwordx4 v15, s[12:15], s100 offen offset:2048 nt lds
    v_mfma_f32_16x16x32_bf16 v[132:135], a[212:215], v[44:47], v[132:135]
    v_add_u32 v18, 32768, v18
    v_mfma_f32_16x16x32_bf16 v[136:139], a[212:215], v[60:63], v[196:199]
    v_exp_f32 v117, v117
    v_mfma_f32_16x16x32_bf16 v[136:139], a[208:211], v[56:59], v[136:139]
    v_exp_f32 v118, v118
    v_mfma_f32_16x16x32_bf16 v[136:139], a[204:207], v[52:55], v[136:139]
    v_exp_f32 v119, v119
    v_mfma_f32_16x16x32_bf16 v[136:139], a[200:203], v[48:51], v[136:139]
    v_cvt_pk_bf16_f32 v156, v116, v117
    v_cvt_pk_bf16_f32 v157, v118, v119
    v_mfma_f32_16x16x32_bf16 v[140:143], a[200:203], v[64:67], v[200:203]
    v_exp_f32 v120, v120
    v_mfma_f32_16x16x32_bf16 v[140:143], a[204:207], v[68:71], v[140:143]
    v_exp_f32 v121, v121
    v_mfma_f32_16x16x32_bf16 v[140:143], a[208:211], v[72:75], v[140:143]
    ds_read_b64_tr_b16 v[228:229], v19
    ds_read_b64_tr_b16 v[230:231], v19 offset:4096
    v_mfma_f32_16x16x32_bf16 v[140:143], a[212:215], v[76:79], v[140:143]
    v_exp_f32 v122, v122
    v_mfma_f32_16x16x32_bf16 v[144:147], a[212:215], v[92:95], v[204:207]
    v_exp_f32 v123, v123
    v_mfma_f32_16x16x32_bf16 v[144:147], a[208:211], v[88:91], v[144:147]
    buffer_load_dwordx4 v16, s[12:15], s100 offen offset:3072 nt lds
    v_cvt_pk_bf16_f32 v160, v120, v121
    v_mfma_f32_16x16x32_bf16 v[144:147], a[204:207], v[84:87], v[144:147]
    v_cvt_pk_bf16_f32 v161, v122, v123
    v_mfma_f32_16x16x32_bf16 v[144:147], a[200:203], v[80:83], v[144:147]
    ds_read_b64_tr_b16 v[232:233], v20
    ds_read_b64_tr_b16 v[234:235], v20 offset:4096
    v_mfma_f32_16x16x32_bf16 v[148:151], a[200:203], v[96:99], v[208:211]
    v_exp_f32 v124, v124
    v_mfma_f32_16x16x32_bf16 v[148:151], a[204:207], v[100:103], v[148:151]
    v_exp_f32 v125, v125
    v_mfma_f32_16x16x32_bf16 v[148:151], a[208:211], v[104:107], v[148:151]
    v_exp_f32 v126, v126
    v_mfma_f32_16x16x32_bf16 v[148:151], a[212:215], v[108:111], v[148:151]
    v_exp_f32 v127, v127
    v_mfma_f32_16x16x32_bf16 a[160:163], a[180:183], v[172:175], a[160:163]
    ds_read_b64_tr_b16 v[236:237], v19 offset:256
    ds_read_b64_tr_b16 v[238:239], v19 offset:4352
    v_mfma_f32_16x16x32_bf16 a[164:167], a[180:183], v[176:179], a[164:167]
    v_cvt_pk_bf16_f32 v164, v124, v125
    v_cvt_pk_bf16_f32 v165, v126, v127
    v_mfma_f32_16x16x32_bf16 a[168:171], a[180:183], v[180:183], a[168:171]
    v_exp_f32 v128, v128
    v_mfma_f32_16x16x32_bf16 a[172:175], a[180:183], v[184:187], a[172:175]
    s_add_u32 m0, s32, 16384
    v_exp_f32 v129, v129
    v_mfma_f32_16x16x32_bf16 a[176:179], a[180:183], v[188:191], a[176:179]
    s_waitcnt lgkmcnt(4)
    s_mov_b32 s100, 65536
    v_exp_f32 v130, v130
    v_mfma_f32_16x16x32_bf16 a[0:3], v[228:231], v[172:175], a[0:3]
    ds_read_b64_tr_b16 v[240:241], v20 offset:256
    ds_read_b64_tr_b16 v[242:243], v20 offset:4352
    v_mfma_f32_16x16x32_bf16 a[4:7], v[228:231], v[176:179], a[4:7]
    buffer_load_dwordx4 v13, s[16:19], s100 offen nt lds
    v_cvt_pk_bf16_f32 v168, v128, v129
    v_mfma_f32_16x16x32_bf16 a[8:11], v[228:231], v[180:183], a[8:11]
    v_exp_f32 v131, v131
    v_mfma_f32_16x16x32_bf16 a[12:15], v[228:231], v[184:187], a[12:15]
    v_cvt_pk_bf16_f32 v169, v130, v131
    v_mfma_f32_16x16x32_bf16 a[16:19], v[228:231], v[188:191], a[16:19]
    s_waitcnt lgkmcnt(4)
    v_exp_f32 v132, v132
    v_mfma_f32_16x16x32_bf16 a[36:39], v[232:235], v[188:191], a[36:39]
    ds_read_b64_tr_b16 v[228:229], v19 offset:512
    ds_read_b64_tr_b16 v[230:231], v19 offset:4608
    v_mfma_f32_16x16x32_bf16 a[32:35], v[232:235], v[184:187], a[32:35]
    v_exp_f32 v133, v133
    v_mfma_f32_16x16x32_bf16 a[28:31], v[232:235], v[180:183], a[28:31]
    v_exp_f32 v134, v134
    v_mfma_f32_16x16x32_bf16 a[24:27], v[232:235], v[176:179], a[24:27]
    v_exp_f32 v135, v135
    v_mfma_f32_16x16x32_bf16 a[20:23], v[232:235], v[172:175], a[20:23]
    s_waitcnt lgkmcnt(4)
    v_cvt_pk_bf16_f32 v154, v132, v133
    v_cvt_pk_bf16_f32 v155, v134, v135
    v_mfma_f32_16x16x32_bf16 a[40:43], v[236:239], v[172:175], a[40:43]
    ds_read_b64_tr_b16 v[232:233], v20 offset:512
    ds_read_b64_tr_b16 v[234:235], v20 offset:4608
    v_mfma_f32_16x16x32_bf16 a[44:47], v[236:239], v[176:179], a[44:47]
    v_exp_f32 v136, v136
    v_mfma_f32_16x16x32_bf16 a[48:51], v[236:239], v[180:183], a[48:51]
    buffer_load_dwordx4 v15, s[16:19], s100 offen offset:1024 nt lds
    v_mfma_f32_16x16x32_bf16 a[52:55], v[236:239], v[184:187], a[52:55]
    v_exp_f32 v137, v137
    v_mfma_f32_16x16x32_bf16 a[56:59], v[236:239], v[188:191], a[56:59]
    s_waitcnt lgkmcnt(4)
    v_exp_f32 v138, v138
    v_mfma_f32_16x16x32_bf16 a[76:79], v[240:243], v[188:191], a[76:79]
    ds_read_b64_tr_b16 v[236:237], v19 offset:768
    ds_read_b64_tr_b16 v[238:239], v19 offset:4864
    v_mfma_f32_16x16x32_bf16 a[72:75], v[240:243], v[184:187], a[72:75]
    v_exp_f32 v139, v139
    v_mfma_f32_16x16x32_bf16 a[68:71], v[240:243], v[180:183], a[68:71]
    v_cvt_pk_bf16_f32 v158, v136, v137
    v_cvt_pk_bf16_f32 v159, v138, v139
    v_mfma_f32_16x16x32_bf16 a[64:67], v[240:243], v[176:179], a[64:67]
    v_exp_f32 v140, v140
    v_mfma_f32_16x16x32_bf16 a[60:63], v[240:243], v[172:175], a[60:63]
    s_waitcnt lgkmcnt(4)
    v_exp_f32 v141, v141
    v_mfma_f32_16x16x32_bf16 a[80:83], v[228:231], v[172:175], a[80:83]
    ds_read_b64_tr_b16 v[240:241], v20 offset:768
    ds_read_b64_tr_b16 v[242:243], v20 offset:4864
    v_mfma_f32_16x16x32_bf16 a[84:87], v[228:231], v[176:179], a[84:87]
    v_exp_f32 v142, v142
    v_mfma_f32_16x16x32_bf16 a[88:91], v[228:231], v[180:183], a[88:91]
    v_add_u32 v19, 32768, v19
    v_cvt_pk_bf16_f32 v162, v140, v141
    v_mfma_f32_16x16x32_bf16 a[92:95], v[228:231], v[184:187], a[92:95]
    v_add_u32 v20, 32768, v20
    buffer_load_dwordx4 v13, s[16:19], s100 offen offset:2048 nt lds
    v_mfma_f32_16x16x32_bf16 a[96:99], v[228:231], v[188:191], a[96:99]
    s_waitcnt vmcnt(11) lgkmcnt(0)
    s_barrier
    v_mfma_f32_16x16x32_bf16 a[116:119], v[232:235], v[188:191], a[116:119]
    ds_read_b64 a[184:185], v17
    ds_read_b64 a[186:187], v18
    v_mfma_f32_16x16x32_bf16 a[112:115], v[232:235], v[184:187], a[112:115]
    v_exp_f32 v143, v143
    v_mfma_f32_16x16x32_bf16 a[108:111], v[232:235], v[180:183], a[108:111]
    v_cvt_pk_bf16_f32 v163, v142, v143
    v_mfma_f32_16x16x32_bf16 a[104:107], v[232:235], v[176:179], a[104:107]
    ds_read_b64 a[188:189], v17 offset:256
    ds_read_b64 a[190:191], v18 offset:256
    v_mfma_f32_16x16x32_bf16 a[100:103], v[232:235], v[172:175], a[100:103]
    v_exp_f32 v144, v144
    v_mfma_f32_16x16x32_bf16 a[120:123], v[236:239], v[172:175], a[120:123]
    v_exp_f32 v145, v145
    v_mfma_f32_16x16x32_bf16 a[124:127], v[236:239], v[176:179], a[124:127]
    ds_read_b64 a[192:193], v17 offset:512
    ds_read_b64 a[194:195], v18 offset:512
    v_mfma_f32_16x16x32_bf16 a[128:131], v[236:239], v[180:183], a[128:131]
    v_exp_f32 v146, v146
    v_mfma_f32_16x16x32_bf16 a[132:135], v[236:239], v[184:187], a[132:135]
    v_exp_f32 v147, v147
    v_mfma_f32_16x16x32_bf16 a[136:139], v[236:239], v[188:191], a[136:139]
    ds_read_b64 a[196:197], v17 offset:768
    ds_read_b64 a[198:199], v18 offset:768
    v_mfma_f32_16x16x32_bf16 a[156:159], v[240:243], v[188:191], a[156:159]
    buffer_load_dwordx4 v15, s[16:19], s100 offen offset:3072 nt lds
    v_cvt_pk_bf16_f32 v166, v144, v145
    v_mfma_f32_16x16x32_bf16 a[152:155], v[240:243], v[184:187], a[152:155]
    v_cvt_pk_bf16_f32 v167, v146, v147
    v_mfma_f32_16x16x32_bf16 a[148:151], v[240:243], v[180:183], a[148:151]
    v_exp_f32 v148, v148
    v_mfma_f32_16x16x32_bf16 a[144:147], v[240:243], v[176:179], a[144:147]
    v_exp_f32 v149, v149
    v_mfma_f32_16x16x32_bf16 a[140:143], v[240:243], v[172:175], a[140:143]
    s_waitcnt lgkmcnt(6)
    v_exp_f32 v150, v150
    v_mfma_f32_16x16x32_bf16 v[112:115], a[184:187], v[32:35], v[192:195]
    s_waitcnt lgkmcnt(4)
    ds_read_b64 a[200:201], v17 offset:4096
    ds_read_b64 a[202:203], v18 offset:4096
    v_mfma_f32_16x16x32_bf16 v[112:115], a[188:191], v[36:39], v[112:115]
    s_waitcnt lgkmcnt(4)
    v_exp_f32 v151, v151
    v_mfma_f32_16x16x32_bf16 v[112:115], a[192:195], v[40:43], v[112:115]
    s_waitcnt lgkmcnt(2)
    v_cvt_pk_bf16_f32 v170, v148, v149
    v_cvt_pk_bf16_f32 v171, v150, v151
    v_mfma_f32_16x16x32_bf16 v[112:115], a[196:199], v[44:47], v[112:115]
    v_mfma_f32_16x16x32_bf16 v[116:119], a[196:199], v[60:63], v[196:199]
    ds_read_b64 a[204:205], v17 offset:4352
    ds_read_b64 a[206:207], v18 offset:4352
    v_mfma_f32_16x16x32_bf16 v[116:119], a[192:195], v[56:59], v[116:119]
    s_add_u32 m0, s32, 32768
    v_mfma_f32_16x16x32_bf16 v[116:119], a[188:191], v[52:55], v[116:119]
    s_mov_b32 s100, 73728
    v_mfma_f32_16x16x32_bf16 v[116:119], a[184:187], v[48:51], v[116:119]
    buffer_load_dwordx4 v13, s[12:15], s100 offen nt lds
    v_mfma_f32_16x16x32_bf16 v[120:123], a[184:187], v[64:67], v[200:203]
    ds_read_b64 a[208:209], v17 offset:4608
    ds_read_b64 a[210:211], v18 offset:4608
    v_mfma_f32_16x16x32_bf16 v[120:123], a[188:191], v[68:71], v[120:123]
    v_exp_f32 v112, v112
    v_mfma_f32_16x16x32_bf16 v[120:123], a[192:195], v[72:75], v[120:123]
    v_exp_f32 v113, v113
    v_mfma_f32_16x16x32_bf16 v[120:123], a[196:199], v[76:79], v[120:123]
    v_exp_f32 v114, v114
    v_mfma_f32_16x16x32_bf16 v[124:127], a[196:199], v[92:95], v[204:207]
    ds_read_b64 a[212:213], v17 offset:4864
    ds_read_b64 a[214:215], v18 offset:4864
    v_mfma_f32_16x16x32_bf16 v[124:127], a[192:195], v[88:91], v[124:127]
    v_exp_f32 v115, v115
    v_mfma_f32_16x16x32_bf16 v[124:127], a[188:191], v[84:87], v[124:127]
    v_cvt_pk_bf16_f32 v172, v112, v113
    v_cvt_pk_bf16_f32 v173, v114, v115
    v_mfma_f32_16x16x32_bf16 v[124:127], a[184:187], v[80:83], v[124:127]
    v_exp_f32 v116, v116
    v_mfma_f32_16x16x32_bf16 v[128:131], a[184:187], v[96:99], v[208:211]
    v_exp_f32 v117, v117
    v_mfma_f32_16x16x32_bf16 v[128:131], a[188:191], v[100:103], v[128:131]
    v_exp_f32 v118, v118
    v_mfma_f32_16x16x32_bf16 v[128:131], a[192:195], v[104:107], v[128:131]
    buffer_load_dwordx4 v14, s[12:15], s100 offen offset:1024 nt lds
    v_cvt_pk_bf16_f32 v176, v116, v117
    v_mfma_f32_16x16x32_bf16 v[128:131], a[196:199], v[108:111], v[128:131]
    s_waitcnt lgkmcnt(6)
    v_exp_f32 v119, v119
    v_mfma_f32_16x16x32_bf16 v[132:135], a[200:203], v[32:35], v[192:195]
    s_waitcnt lgkmcnt(4)
    v_cvt_pk_bf16_f32 v177, v118, v119
    v_mfma_f32_16x16x32_bf16 v[132:135], a[204:207], v[36:39], v[132:135]
    s_waitcnt lgkmcnt(2)
    v_exp_f32 v120, v120
    v_mfma_f32_16x16x32_bf16 v[132:135], a[208:211], v[40:43], v[132:135]
    s_waitcnt lgkmcnt(0)
    v_subrev_u32 v17, 131072, v17
    v_mfma_f32_16x16x32_bf16 v[132:135], a[212:215], v[44:47], v[132:135]
    v_subrev_u32 v18, 131072, v18
    v_mfma_f32_16x16x32_bf16 v[136:139], a[212:215], v[60:63], v[196:199]
    v_exp_f32 v121, v121
    v_mfma_f32_16x16x32_bf16 v[136:139], a[208:211], v[56:59], v[136:139]
    v_exp_f32 v122, v122
    v_mfma_f32_16x16x32_bf16 v[136:139], a[204:207], v[52:55], v[136:139]
    v_exp_f32 v123, v123
    v_mfma_f32_16x16x32_bf16 v[136:139], a[200:203], v[48:51], v[136:139]
    v_cvt_pk_bf16_f32 v180, v120, v121
    v_cvt_pk_bf16_f32 v181, v122, v123
    v_mfma_f32_16x16x32_bf16 v[140:143], a[200:203], v[64:67], v[200:203]
    v_exp_f32 v124, v124
    v_mfma_f32_16x16x32_bf16 v[140:143], a[204:207], v[68:71], v[140:143]
    v_exp_f32 v125, v125
    v_mfma_f32_16x16x32_bf16 v[140:143], a[208:211], v[72:75], v[140:143]
    ds_read_b64_tr_b16 v[228:229], v19
    ds_read_b64_tr_b16 v[230:231], v19 offset:4096
    v_mfma_f32_16x16x32_bf16 v[140:143], a[212:215], v[76:79], v[140:143]
    buffer_load_dwordx4 v15, s[12:15], s100 offen offset:2048 nt lds
    v_cvt_pk_bf16_f32 v184, v124, v125
    v_mfma_f32_16x16x32_bf16 v[144:147], a[212:215], v[92:95], v[204:207]
    v_exp_f32 v126, v126
    v_mfma_f32_16x16x32_bf16 v[144:147], a[208:211], v[88:91], v[144:147]
    v_exp_f32 v127, v127
    v_mfma_f32_16x16x32_bf16 v[144:147], a[204:207], v[84:87], v[144:147]
    v_cvt_pk_bf16_f32 v185, v126, v127
    v_mfma_f32_16x16x32_bf16 v[144:147], a[200:203], v[80:83], v[144:147]
    ds_read_b64_tr_b16 v[232:233], v20
    ds_read_b64_tr_b16 v[234:235], v20 offset:4096
    v_mfma_f32_16x16x32_bf16 v[148:151], a[200:203], v[96:99], v[208:211]
    v_exp_f32 v128, v128
    v_mfma_f32_16x16x32_bf16 v[148:151], a[204:207], v[100:103], v[148:151]
    v_exp_f32 v129, v129
    v_mfma_f32_16x16x32_bf16 v[148:151], a[208:211], v[104:107], v[148:151]
    v_exp_f32 v130, v130
    v_mfma_f32_16x16x32_bf16 v[148:151], a[212:215], v[108:111], v[148:151]
    v_exp_f32 v131, v131
    v_mfma_f32_16x16x32_bf16 a[160:163], a[180:183], v[152:155], a[160:163]
    ds_read_b64_tr_b16 v[236:237], v19 offset:256
    ds_read_b64_tr_b16 v[238:239], v19 offset:4352
    v_mfma_f32_16x16x32_bf16 a[164:167], a[180:183], v[156:159], a[164:167]
    v_cvt_pk_bf16_f32 v188, v128, v129
    v_cvt_pk_bf16_f32 v189, v130, v131
    v_mfma_f32_16x16x32_bf16 a[168:171], a[180:183], v[160:163], a[168:171]
    buffer_load_dwordx4 v16, s[12:15], s100 offen offset:3072 nt lds
    v_mfma_f32_16x16x32_bf16 a[172:175], a[180:183], v[164:167], a[172:175]
    v_exp_f32 v132, v132
    v_mfma_f32_16x16x32_bf16 a[176:179], a[180:183], v[168:171], a[176:179]
    s_waitcnt lgkmcnt(4)
    v_exp_f32 v133, v133
    v_mfma_f32_16x16x32_bf16 a[0:3], v[228:231], v[152:155], a[0:3]
    ds_read_b64_tr_b16 v[240:241], v20 offset:256
    ds_read_b64_tr_b16 v[242:243], v20 offset:4352
    v_mfma_f32_16x16x32_bf16 a[4:7], v[228:231], v[156:159], a[4:7]
    v_exp_f32 v134, v134
    v_mfma_f32_16x16x32_bf16 a[8:11], v[228:231], v[160:163], a[8:11]
    v_exp_f32 v135, v135
    v_mfma_f32_16x16x32_bf16 a[12:15], v[228:231], v[164:167], a[12:15]
    v_cvt_pk_bf16_f32 v174, v132, v133
    v_cvt_pk_bf16_f32 v175, v134, v135
    v_mfma_f32_16x16x32_bf16 a[16:19], v[228:231], v[168:171], a[16:19]
    s_waitcnt lgkmcnt(4)
    v_exp_f32 v136, v136
    v_mfma_f32_16x16x32_bf16 a[36:39], v[232:235], v[168:171], a[36:39]
    ds_read_b64_tr_b16 v[228:229], v19 offset:512
    ds_read_b64_tr_b16 v[230:231], v19 offset:4608
    v_mfma_f32_16x16x32_bf16 a[32:35], v[232:235], v[164:167], a[32:35]
    s_add_u32 m0, s32, 49152
    v_exp_f32 v137, v137
    v_mfma_f32_16x16x32_bf16 a[28:31], v[232:235], v[160:163], a[28:31]
    s_mov_b32 s100, 73728
    v_exp_f32 v138, v138
    v_mfma_f32_16x16x32_bf16 a[24:27], v[232:235], v[156:159], a[24:27]
    buffer_load_dwordx4 v13, s[16:19], s100 offen nt lds
    v_cvt_pk_bf16_f32 v178, v136, v137
    v_mfma_f32_16x16x32_bf16 a[20:23], v[232:235], v[152:155], a[20:23]
    s_waitcnt lgkmcnt(4)
    v_exp_f32 v139, v139
    v_mfma_f32_16x16x32_bf16 a[40:43], v[236:239], v[152:155], a[40:43]
    ds_read_b64_tr_b16 v[232:233], v20 offset:512
    ds_read_b64_tr_b16 v[234:235], v20 offset:4608
    v_mfma_f32_16x16x32_bf16 a[44:47], v[236:239], v[156:159], a[44:47]
    v_cvt_pk_bf16_f32 v179, v138, v139
    v_mfma_f32_16x16x32_bf16 a[48:51], v[236:239], v[160:163], a[48:51]
    v_exp_f32 v140, v140
    v_mfma_f32_16x16x32_bf16 a[52:55], v[236:239], v[164:167], a[52:55]
    v_exp_f32 v141, v141
    v_mfma_f32_16x16x32_bf16 a[56:59], v[236:239], v[168:171], a[56:59]
    s_waitcnt lgkmcnt(4)
    v_exp_f32 v142, v142
    v_mfma_f32_16x16x32_bf16 a[76:79], v[240:243], v[168:171], a[76:79]
    ds_read_b64_tr_b16 v[236:237], v19 offset:768
    ds_read_b64_tr_b16 v[238:239], v19 offset:4864
    v_mfma_f32_16x16x32_bf16 a[72:75], v[240:243], v[164:167], a[72:75]
    v_exp_f32 v143, v143
    v_mfma_f32_16x16x32_bf16 a[68:71], v[240:243], v[160:163], a[68:71]
    v_cvt_pk_bf16_f32 v182, v140, v141
    v_cvt_pk_bf16_f32 v183, v142, v143
    v_mfma_f32_16x16x32_bf16 a[64:67], v[240:243], v[156:159], a[64:67]
    v_exp_f32 v144, v144
    v_mfma_f32_16x16x32_bf16 a[60:63], v[240:243], v[152:155], a[60:63]
    s_waitcnt lgkmcnt(4)
    v_exp_f32 v145, v145
    v_mfma_f32_16x16x32_bf16 a[80:83], v[228:231], v[152:155], a[80:83]
    ds_read_b64_tr_b16 v[240:241], v20 offset:768
    ds_read_b64_tr_b16 v[242:243], v20 offset:4864
    v_mfma_f32_16x16x32_bf16 a[84:87], v[228:231], v[156:159], a[84:87]
    buffer_load_dwordx4 v15, s[16:19], s100 offen offset:1024 nt lds
    v_cvt_pk_bf16_f32 v186, v144, v145
    v_mfma_f32_16x16x32_bf16 a[88:91], v[228:231], v[160:163], a[88:91]
    v_add_u32 v19, 32768, v19
    v_mfma_f32_16x16x32_bf16 a[92:95], v[228:231], v[164:167], a[92:95]
    v_add_u32 v20, 32768, v20
    v_mfma_f32_16x16x32_bf16 a[96:99], v[228:231], v[168:171], a[96:99]
    s_waitcnt vmcnt(10) lgkmcnt(0)
    s_barrier
    v_mfma_f32_16x16x32_bf16 a[116:119], v[232:235], v[168:171], a[116:119]
    ds_read_b64 a[184:185], v17
    ds_read_b64 a[186:187], v18
    v_mfma_f32_16x16x32_bf16 a[112:115], v[232:235], v[164:167], a[112:115]
    v_exp_f32 v146, v146
    v_mfma_f32_16x16x32_bf16 a[108:111], v[232:235], v[160:163], a[108:111]
    v_exp_f32 v147, v147
    v_mfma_f32_16x16x32_bf16 a[104:107], v[232:235], v[156:159], a[104:107]
    ds_read_b64 a[188:189], v17 offset:256
    ds_read_b64 a[190:191], v18 offset:256
    v_mfma_f32_16x16x32_bf16 a[100:103], v[232:235], v[152:155], a[100:103]
    v_cvt_pk_bf16_f32 v187, v146, v147
    v_mfma_f32_16x16x32_bf16 a[120:123], v[236:239], v[152:155], a[120:123]
    v_exp_f32 v148, v148
    v_mfma_f32_16x16x32_bf16 a[124:127], v[236:239], v[156:159], a[124:127]
    ds_read_b64 a[192:193], v17 offset:512
    ds_read_b64 a[194:195], v18 offset:512
    v_mfma_f32_16x16x32_bf16 a[128:131], v[236:239], v[160:163], a[128:131]
    buffer_load_dwordx4 v13, s[16:19], s100 offen offset:2048 nt lds
    v_mfma_f32_16x16x32_bf16 a[132:135], v[236:239], v[164:167], a[132:135]
    v_exp_f32 v149, v149
    v_mfma_f32_16x16x32_bf16 a[136:139], v[236:239], v[168:171], a[136:139]
    ds_read_b64 a[196:197], v17 offset:768
    ds_read_b64 a[198:199], v18 offset:768
    v_mfma_f32_16x16x32_bf16 a[156:159], v[240:243], v[168:171], a[156:159]
    v_exp_f32 v150, v150
    v_mfma_f32_16x16x32_bf16 a[152:155], v[240:243], v[164:167], a[152:155]
    v_exp_f32 v151, v151
    v_mfma_f32_16x16x32_bf16 a[148:151], v[240:243], v[160:163], a[148:151]
    v_cvt_pk_bf16_f32 v190, v148, v149
    v_cvt_pk_bf16_f32 v191, v150, v151
    v_mfma_f32_16x16x32_bf16 a[144:147], v[240:243], v[156:159], a[144:147]
    v_mfma_f32_16x16x32_bf16 a[140:143], v[240:243], v[152:155], a[140:143]
    s_waitcnt lgkmcnt(6)
    v_mfma_f32_16x16x32_bf16 v[112:115], a[184:187], v[32:35], v[192:195]
    s_waitcnt lgkmcnt(4)
    ds_read_b64 a[200:201], v17 offset:4096
    ds_read_b64 a[202:203], v18 offset:4096
    v_mfma_f32_16x16x32_bf16 v[112:115], a[188:191], v[36:39], v[112:115]
    s_waitcnt lgkmcnt(4)
    v_mfma_f32_16x16x32_bf16 v[112:115], a[192:195], v[40:43], v[112:115]
    s_waitcnt lgkmcnt(2)
    v_mfma_f32_16x16x32_bf16 v[112:115], a[196:199], v[44:47], v[112:115]
    v_mfma_f32_16x16x32_bf16 v[116:119], a[196:199], v[60:63], v[196:199]
    ds_read_b64 a[204:205], v17 offset:4352
    ds_read_b64 a[206:207], v18 offset:4352
    v_mfma_f32_16x16x32_bf16 v[116:119], a[192:195], v[56:59], v[116:119]
    buffer_load_dwordx4 v15, s[16:19], s100 offen offset:3072 nt lds
    v_mfma_f32_16x16x32_bf16 v[116:119], a[188:191], v[52:55], v[116:119]
    v_mfma_f32_16x16x32_bf16 v[116:119], a[184:187], v[48:51], v[116:119]
    s_nop 0
    v_exp_f32 v112, v112
    v_mfma_f32_16x16x32_bf16 v[120:123], a[184:187], v[64:67], v[200:203]
    ds_read_b64 a[208:209], v17 offset:4608
    ds_read_b64 a[210:211], v18 offset:4608
    v_mfma_f32_16x16x32_bf16 v[120:123], a[188:191], v[68:71], v[120:123]
    v_exp_f32 v113, v113
    v_mfma_f32_16x16x32_bf16 v[120:123], a[192:195], v[72:75], v[120:123]
    v_exp_f32 v114, v114
    v_mfma_f32_16x16x32_bf16 v[120:123], a[196:199], v[76:79], v[120:123]
    v_exp_f32 v115, v115
    v_mfma_f32_16x16x32_bf16 v[124:127], a[196:199], v[92:95], v[204:207]
    ds_read_b64 a[212:213], v17 offset:4864
    ds_read_b64 a[214:215], v18 offset:4864
    v_mfma_f32_16x16x32_bf16 v[124:127], a[192:195], v[88:91], v[124:127]
    s_add_u32 m0, s32, 65536
    v_cvt_pk_bf16_f32 v152, v112, v113
    v_cvt_pk_bf16_f32 v153, v114, v115
    v_mfma_f32_16x16x32_bf16 v[124:127], a[188:191], v[84:87], v[124:127]
    s_mov_b32 s100, 81920
    v_exp_f32 v116, v116
    v_mfma_f32_16x16x32_bf16 v[124:127], a[184:187], v[80:83], v[124:127]
    buffer_load_dwordx4 v13, s[12:15], s100 offen nt lds
    v_mfma_f32_16x16x32_bf16 v[128:131], a[184:187], v[96:99], v[208:211]
    v_exp_f32 v117, v117
    v_mfma_f32_16x16x32_bf16 v[128:131], a[188:191], v[100:103], v[128:131]
    v_exp_f32 v118, v118
    v_mfma_f32_16x16x32_bf16 v[128:131], a[192:195], v[104:107], v[128:131]
    v_exp_f32 v119, v119
    v_mfma_f32_16x16x32_bf16 v[128:131], a[196:199], v[108:111], v[128:131]
    s_waitcnt lgkmcnt(6)
    v_cvt_pk_bf16_f32 v156, v116, v117
    v_cvt_pk_bf16_f32 v157, v118, v119
    v_mfma_f32_16x16x32_bf16 v[132:135], a[200:203], v[32:35], v[192:195]
    s_waitcnt lgkmcnt(4)
    v_exp_f32 v120, v120
    v_mfma_f32_16x16x32_bf16 v[132:135], a[204:207], v[36:39], v[132:135]
    s_waitcnt lgkmcnt(2)
    v_exp_f32 v121, v121
    v_mfma_f32_16x16x32_bf16 v[132:135], a[208:211], v[40:43], v[132:135]
    s_waitcnt lgkmcnt(0)
    v_add_u32 v17, 32768, v17
    v_cvt_pk_bf16_f32 v160, v120, v121
    v_mfma_f32_16x16x32_bf16 v[132:135], a[212:215], v[44:47], v[132:135]
    v_add_u32 v18, 32768, v18
    v_mfma_f32_16x16x32_bf16 v[136:139], a[212:215], v[60:63], v[196:199]
    v_exp_f32 v122, v122
    v_mfma_f32_16x16x32_bf16 v[136:139], a[208:211], v[56:59], v[136:139]
    v_exp_f32 v123, v123
    v_mfma_f32_16x16x32_bf16 v[136:139], a[204:207], v[52:55], v[136:139]
    v_cvt_pk_bf16_f32 v161, v122, v123
    v_mfma_f32_16x16x32_bf16 v[136:139], a[200:203], v[48:51], v[136:139]
    buffer_load_dwordx4 v14, s[12:15], s100 offen offset:1024 nt lds
    v_mfma_f32_16x16x32_bf16 v[140:143], a[200:203], v[64:67], v[200:203]
    v_exp_f32 v124, v124
    v_mfma_f32_16x16x32_bf16 v[140:143], a[204:207], v[68:71], v[140:143]
    v_exp_f32 v125, v125
    v_mfma_f32_16x16x32_bf16 v[140:143], a[208:211], v[72:75], v[140:143]
    ds_read_b64_tr_b16 v[228:229], v19
    ds_read_b64_tr_b16 v[230:231], v19 offset:4096
    v_mfma_f32_16x16x32_bf16 v[140:143], a[212:215], v[76:79], v[140:143]
    v_exp_f32 v126, v126
    v_mfma_f32_16x16x32_bf16 v[144:147], a[212:215], v[92:95], v[204:207]
    v_exp_f32 v127, v127
    v_mfma_f32_16x16x32_bf16 v[144:147], a[208:211], v[88:91], v[144:147]
    v_cvt_pk_bf16_f32 v164, v124, v125
    v_cvt_pk_bf16_f32 v165, v126, v127
    v_mfma_f32_16x16x32_bf16 v[144:147], a[204:207], v[84:87], v[144:147]
    v_exp_f32 v128, v128
    v_mfma_f32_16x16x32_bf16 v[144:147], a[200:203], v[80:83], v[144:147]
    ds_read_b64_tr_b16 v[232:233], v20
    ds_read_b64_tr_b16 v[234:235], v20 offset:4096
    v_mfma_f32_16x16x32_bf16 v[148:151], a[200:203], v[96:99], v[208:211]
    v_exp_f32 v129, v129
    v_mfma_f32_16x16x32_bf16 v[148:151], a[204:207], v[100:103], v[148:151]
    v_exp_f32 v130, v130
    v_mfma_f32_16x16x32_bf16 v[148:151], a[208:211], v[104:107], v[148:151]
    v_exp_f32 v131, v131
    v_mfma_f32_16x16x32_bf16 v[148:151], a[212:215], v[108:111], v[148:151]
    buffer_load_dwordx4 v15, s[12:15], s100 offen offset:2048 nt lds
    v_cvt_pk_bf16_f32 v168, v128, v129
    v_mfma_f32_16x16x32_bf16 a[160:163], a[180:183], v[172:175], a[160:163]
    ds_read_b64_tr_b16 v[236:237], v19 offset:256
    ds_read_b64_tr_b16 v[238:239], v19 offset:4352
    v_mfma_f32_16x16x32_bf16 a[164:167], a[180:183], v[176:179], a[164:167]
    v_cvt_pk_bf16_f32 v169, v130, v131
    v_mfma_f32_16x16x32_bf16 a[168:171], a[180:183], v[180:183], a[168:171]
    v_exp_f32 v132, v132
    v_mfma_f32_16x16x32_bf16 a[172:175], a[180:183], v[184:187], a[172:175]
    v_exp_f32 v133, v133
    v_mfma_f32_16x16x32_bf16 a[176:179], a[180:183], v[188:191], a[176:179]
    s_waitcnt lgkmcnt(4)
    v_exp_f32 v134, v134
    v_mfma_f32_16x16x32_bf16 a[0:3], v[228:231], v[172:175], a[0:3]
    ds_read_b64_tr_b16 v[240:241], v20 offset:256
    ds_read_b64_tr_b16 v[242:243], v20 offset:4352
    v_mfma_f32_16x16x32_bf16 a[4:7], v[228:231], v[176:179], a[4:7]
    v_exp_f32 v135, v135
    v_mfma_f32_16x16x32_bf16 a[8:11], v[228:231], v[180:183], a[8:11]
    v_cvt_pk_bf16_f32 v154, v132, v133
    v_cvt_pk_bf16_f32 v155, v134, v135
    v_mfma_f32_16x16x32_bf16 a[12:15], v[228:231], v[184:187], a[12:15]
    v_exp_f32 v136, v136
    v_mfma_f32_16x16x32_bf16 a[16:19], v[228:231], v[188:191], a[16:19]
    s_waitcnt lgkmcnt(4)
    v_exp_f32 v137, v137
    v_mfma_f32_16x16x32_bf16 a[36:39], v[232:235], v[188:191], a[36:39]
    ds_read_b64_tr_b16 v[228:229], v19 offset:512
    ds_read_b64_tr_b16 v[230:231], v19 offset:4608
    v_mfma_f32_16x16x32_bf16 a[32:35], v[232:235], v[184:187], a[32:35]
    buffer_load_dwordx4 v16, s[12:15], s100 offen offset:3072 nt lds
    v_cvt_pk_bf16_f32 v158, v136, v137
    v_mfma_f32_16x16x32_bf16 a[28:31], v[232:235], v[180:183], a[28:31]
    v_exp_f32 v138, v138
    v_mfma_f32_16x16x32_bf16 a[24:27], v[232:235], v[176:179], a[24:27]
    v_exp_f32 v139, v139
    v_mfma_f32_16x16x32_bf16 a[20:23], v[232:235], v[172:175], a[20:23]
    s_waitcnt lgkmcnt(4)
    v_cvt_pk_bf16_f32 v159, v138, v139
    v_mfma_f32_16x16x32_bf16 a[40:43], v[236:239], v[172:175], a[40:43]
    ds_read_b64_tr_b16 v[232:233], v20 offset:512
    ds_read_b64_tr_b16 v[234:235], v20 offset:4608
    v_mfma_f32_16x16x32_bf16 a[44:47], v[236:239], v[176:179], a[44:47]
    v_exp_f32 v140, v140
    v_mfma_f32_16x16x32_bf16 a[48:51], v[236:239], v[180:183], a[48:51]
    v_exp_f32 v141, v141
    v_mfma_f32_16x16x32_bf16 a[52:55], v[236:239], v[184:187], a[52:55]
    v_exp_f32 v142, v142
    v_mfma_f32_16x16x32_bf16 a[56:59], v[236:239], v[188:191], a[56:59]
    s_waitcnt lgkmcnt(4)
    v_exp_f32 v143, v143
    v_mfma_f32_16x16x32_bf16 a[76:79], v[240:243], v[188:191], a[76:79]
    s_add_u32 m0, s32, 81920
    ds_read_b64_tr_b16 v[236:237], v19 offset:768
    ds_read_b64_tr_b16 v[238:239], v19 offset:4864
    v_mfma_f32_16x16x32_bf16 a[72:75], v[240:243], v[184:187], a[72:75]
    s_mov_b32 s100, 81920
    v_cvt_pk_bf16_f32 v162, v140, v141
    v_cvt_pk_bf16_f32 v163, v142, v143
    v_mfma_f32_16x16x32_bf16 a[68:71], v[240:243], v[180:183], a[68:71]
    buffer_load_dwordx4 v13, s[16:19], s100 offen nt lds
    v_mfma_f32_16x16x32_bf16 a[64:67], v[240:243], v[176:179], a[64:67]
    v_exp_f32 v144, v144
    v_mfma_f32_16x16x32_bf16 a[60:63], v[240:243], v[172:175], a[60:63]
    s_waitcnt lgkmcnt(4)
    v_exp_f32 v145, v145
    v_mfma_f32_16x16x32_bf16 a[80:83], v[228:231], v[172:175], a[80:83]
    ds_read_b64_tr_b16 v[240:241], v20 offset:768
    ds_read_b64_tr_b16 v[242:243], v20 offset:4864
    v_mfma_f32_16x16x32_bf16 a[84:87], v[228:231], v[176:179], a[84:87]
    v_exp_f32 v146, v146
    v_mfma_f32_16x16x32_bf16 a[88:91], v[228:231], v[180:183], a[88:91]
    v_subrev_u32 v19, 131072, v19
    v_cvt_pk_bf16_f32 v166, v144, v145
    v_mfma_f32_16x16x32_bf16 a[92:95], v[228:231], v[184:187], a[92:95]
    v_subrev_u32 v20, 131072, v20
    v_mfma_f32_16x16x32_bf16 a[96:99], v[228:231], v[188:191], a[96:99]
    s_waitcnt vmcnt(9) lgkmcnt(0)
    s_barrier
    v_mfma_f32_16x16x32_bf16 a[116:119], v[232:235], v[188:191], a[116:119]
    ds_read_b64 a[184:185], v17
    ds_read_b64 a[186:187], v18
    v_mfma_f32_16x16x32_bf16 a[112:115], v[232:235], v[184:187], a[112:115]
    v_exp_f32 v147, v147
    v_mfma_f32_16x16x32_bf16 a[108:111], v[232:235], v[180:183], a[108:111]
    v_cvt_pk_bf16_f32 v167, v146, v147
    v_mfma_f32_16x16x32_bf16 a[104:107], v[232:235], v[176:179], a[104:107]
    ds_read_b64 a[188:189], v17 offset:256
    ds_read_b64 a[190:191], v18 offset:256
    v_mfma_f32_16x16x32_bf16 a[100:103], v[232:235], v[172:175], a[100:103]
    buffer_load_dwordx4 v15, s[16:19], s100 offen offset:1024 nt lds
    v_mfma_f32_16x16x32_bf16 a[120:123], v[236:239], v[172:175], a[120:123]
    v_exp_f32 v148, v148
    v_mfma_f32_16x16x32_bf16 a[124:127], v[236:239], v[176:179], a[124:127]
    ds_read_b64 a[192:193], v17 offset:512
    ds_read_b64 a[194:195], v18 offset:512
    v_mfma_f32_16x16x32_bf16 a[128:131], v[236:239], v[180:183], a[128:131]
    v_exp_f32 v149, v149
    v_mfma_f32_16x16x32_bf16 a[132:135], v[236:239], v[184:187], a[132:135]
    v_exp_f32 v150, v150
    v_mfma_f32_16x16x32_bf16 a[136:139], v[236:239], v[188:191], a[136:139]
    ds_read_b64 a[196:197], v17 offset:768
    ds_read_b64 a[198:199], v18 offset:768
    v_mfma_f32_16x16x32_bf16 a[156:159], v[240:243], v[188:191], a[156:159]
    v_exp_f32 v151, v151
    v_mfma_f32_16x16x32_bf16 a[152:155], v[240:243], v[184:187], a[152:155]
    v_cvt_pk_bf16_f32 v170, v148, v149
    v_cvt_pk_bf16_f32 v171, v150, v151
    v_mfma_f32_16x16x32_bf16 a[148:151], v[240:243], v[180:183], a[148:151]
    v_mfma_f32_16x16x32_bf16 a[144:147], v[240:243], v[176:179], a[144:147]
    v_mfma_f32_16x16x32_bf16 a[140:143], v[240:243], v[172:175], a[140:143]
    s_waitcnt lgkmcnt(6)
    v_mfma_f32_16x16x32_bf16 v[112:115], a[184:187], v[32:35], v[192:195]
    s_waitcnt lgkmcnt(4)
    ds_read_b64 a[200:201], v17 offset:4096
    ds_read_b64 a[202:203], v18 offset:4096
    v_mfma_f32_16x16x32_bf16 v[112:115], a[188:191], v[36:39], v[112:115]
    s_waitcnt lgkmcnt(4)
    buffer_load_dwordx4 v13, s[16:19], s100 offen offset:2048 nt lds
    v_mfma_f32_16x16x32_bf16 v[112:115], a[192:195], v[40:43], v[112:115]
    s_waitcnt lgkmcnt(2)
    v_mfma_f32_16x16x32_bf16 v[112:115], a[196:199], v[44:47], v[112:115]
    v_mfma_f32_16x16x32_bf16 v[116:119], a[196:199], v[60:63], v[196:199]
    ds_read_b64 a[204:205], v17 offset:4352
    ds_read_b64 a[206:207], v18 offset:4352
    v_mfma_f32_16x16x32_bf16 v[116:119], a[192:195], v[56:59], v[116:119]
    v_mfma_f32_16x16x32_bf16 v[116:119], a[188:191], v[52:55], v[116:119]
    v_mfma_f32_16x16x32_bf16 v[116:119], a[184:187], v[48:51], v[116:119]
    s_nop 1
    v_exp_f32 v112, v112
    v_mfma_f32_16x16x32_bf16 v[120:123], a[184:187], v[64:67], v[200:203]
    ds_read_b64 a[208:209], v17 offset:4608
    ds_read_b64 a[210:211], v18 offset:4608
    v_mfma_f32_16x16x32_bf16 v[120:123], a[188:191], v[68:71], v[120:123]
    v_exp_f32 v113, v113
    v_mfma_f32_16x16x32_bf16 v[120:123], a[192:195], v[72:75], v[120:123]
    v_exp_f32 v114, v114
    v_mfma_f32_16x16x32_bf16 v[120:123], a[196:199], v[76:79], v[120:123]
    v_exp_f32 v115, v115
    v_mfma_f32_16x16x32_bf16 v[124:127], a[196:199], v[92:95], v[204:207]
    ds_read_b64 a[212:213], v17 offset:4864
    ds_read_b64 a[214:215], v18 offset:4864
    v_mfma_f32_16x16x32_bf16 v[124:127], a[192:195], v[88:91], v[124:127]
    buffer_load_dwordx4 v15, s[16:19], s100 offen offset:3072 nt lds
    v_cvt_pk_bf16_f32 v172, v112, v113
    v_mfma_f32_16x16x32_bf16 v[124:127], a[188:191], v[84:87], v[124:127]
    v_cvt_pk_bf16_f32 v173, v114, v115
    v_mfma_f32_16x16x32_bf16 v[124:127], a[184:187], v[80:83], v[124:127]
    v_exp_f32 v116, v116
    v_mfma_f32_16x16x32_bf16 v[128:131], a[184:187], v[96:99], v[208:211]
    v_exp_f32 v117, v117
    v_mfma_f32_16x16x32_bf16 v[128:131], a[188:191], v[100:103], v[128:131]
    v_exp_f32 v118, v118
    v_mfma_f32_16x16x32_bf16 v[128:131], a[192:195], v[104:107], v[128:131]
    v_exp_f32 v119, v119
    v_mfma_f32_16x16x32_bf16 v[128:131], a[196:199], v[108:111], v[128:131]
    s_waitcnt lgkmcnt(6)
    v_cvt_pk_bf16_f32 v176, v116, v117
    v_cvt_pk_bf16_f32 v177, v118, v119
    v_mfma_f32_16x16x32_bf16 v[132:135], a[200:203], v[32:35], v[192:195]
    s_waitcnt lgkmcnt(4)
    v_exp_f32 v120, v120
    v_mfma_f32_16x16x32_bf16 v[132:135], a[204:207], v[36:39], v[132:135]
    s_waitcnt lgkmcnt(2)
    v_exp_f32 v121, v121
    v_mfma_f32_16x16x32_bf16 v[132:135], a[208:211], v[40:43], v[132:135]
    s_waitcnt lgkmcnt(0)
    s_add_u32 m0, s32, 98304
    v_add_u32 v17, 32768, v17
    v_cvt_pk_bf16_f32 v180, v120, v121
    v_mfma_f32_16x16x32_bf16 v[132:135], a[212:215], v[44:47], v[132:135]
    s_mov_b32 s100, 90112
    v_add_u32 v18, 32768, v18
    v_mfma_f32_16x16x32_bf16 v[136:139], a[212:215], v[60:63], v[196:199]
    buffer_load_dwordx4 v13, s[12:15], s100 offen nt lds
    v_mfma_f32_16x16x32_bf16 v[136:139], a[208:211], v[56:59], v[136:139]
    v_exp_f32 v122, v122
    v_mfma_f32_16x16x32_bf16 v[136:139], a[204:207], v[52:55], v[136:139]
    v_exp_f32 v123, v123
    v_mfma_f32_16x16x32_bf16 v[136:139], a[200:203], v[48:51], v[136:139]
    v_cvt_pk_bf16_f32 v181, v122, v123
    v_mfma_f32_16x16x32_bf16 v[140:143], a[200:203], v[64:67], v[200:203]
    v_exp_f32 v124, v124
    v_mfma_f32_16x16x32_bf16 v[140:143], a[204:207], v[68:71], v[140:143]
    v_exp_f32 v125, v125
    v_mfma_f32_16x16x32_bf16 v[140:143], a[208:211], v[72:75], v[140:143]
    ds_read_b64_tr_b16 v[228:229], v19
    ds_read_b64_tr_b16 v[230:231], v19 offset:4096
    v_mfma_f32_16x16x32_bf16 v[140:143], a[212:215], v[76:79], v[140:143]
    v_exp_f32 v126, v126
    v_mfma_f32_16x16x32_bf16 v[144:147], a[212:215], v[92:95], v[204:207]
    v_exp_f32 v127, v127
    v_mfma_f32_16x16x32_bf16 v[144:147], a[208:211], v[88:91], v[144:147]
    v_cvt_pk_bf16_f32 v184, v124, v125
    v_cvt_pk_bf16_f32 v185, v126, v127
    v_mfma_f32_16x16x32_bf16 v[144:147], a[204:207], v[84:87], v[144:147]
    v_exp_f32 v128, v128
    v_mfma_f32_16x16x32_bf16 v[144:147], a[200:203], v[80:83], v[144:147]
    ds_read_b64_tr_b16 v[232:233], v20
    ds_read_b64_tr_b16 v[234:235], v20 offset:4096
    v_mfma_f32_16x16x32_bf16 v[148:151], a[200:203], v[96:99], v[208:211]
    buffer_load_dwordx4 v14, s[12:15], s100 offen offset:1024 nt lds
    v_mfma_f32_16x16x32_bf16 v[148:151], a[204:207], v[100:103], v[148:151]
    v_exp_f32 v129, v129
    v_mfma_f32_16x16x32_bf16 v[148:151], a[208:211], v[104:107], v[148:151]
    v_exp_f32 v130, v130
    v_mfma_f32_16x16x32_bf16 v[148:151], a[212:215], v[108:111], v[148:151]
    v_exp_f32 v131, v131
    v_mfma_f32_16x16x32_bf16 a[160:163], a[180:183], v[152:155], a[160:163]
    ds_read_b64_tr_b16 v[236:237], v19 offset:256
    ds_read_b64_tr_b16 v[238:239], v19 offset:4352
    v_mfma_f32_16x16x32_bf16 a[164:167], a[180:183], v[156:159], a[164:167]
    v_cvt_pk_bf16_f32 v188, v128, v129
    v_cvt_pk_bf16_f32 v189, v130, v131
    v_mfma_f32_16x16x32_bf16 a[168:171], a[180:183], v[160:163], a[168:171]
    v_exp_f32 v132, v132
    v_mfma_f32_16x16x32_bf16 a[172:175], a[180:183], v[164:167], a[172:175]
    v_exp_f32 v133, v133
    v_mfma_f32_16x16x32_bf16 a[176:179], a[180:183], v[168:171], a[176:179]
    s_waitcnt lgkmcnt(4)
    v_exp_f32 v134, v134
    v_mfma_f32_16x16x32_bf16 a[0:3], v[228:231], v[152:155], a[0:3]
    ds_read_b64_tr_b16 v[240:241], v20 offset:256
    ds_read_b64_tr_b16 v[242:243], v20 offset:4352
    v_mfma_f32_16x16x32_bf16 a[4:7], v[228:231], v[156:159], a[4:7]
    v_exp_f32 v135, v135
    v_mfma_f32_16x16x32_bf16 a[8:11], v[228:231], v[160:163], a[8:11]
    buffer_load_dwordx4 v15, s[12:15], s100 offen offset:2048 nt lds
    v_cvt_pk_bf16_f32 v174, v132, v133
    v_mfma_f32_16x16x32_bf16 a[12:15], v[228:231], v[164:167], a[12:15]
    v_cvt_pk_bf16_f32 v175, v134, v135
    v_mfma_f32_16x16x32_bf16 a[16:19], v[228:231], v[168:171], a[16:19]
    s_waitcnt lgkmcnt(4)
    v_exp_f32 v136, v136
    v_mfma_f32_16x16x32_bf16 a[36:39], v[232:235], v[168:171], a[36:39]
    ds_read_b64_tr_b16 v[228:229], v19 offset:512
    ds_read_b64_tr_b16 v[230:231], v19 offset:4608
    v_mfma_f32_16x16x32_bf16 a[32:35], v[232:235], v[164:167], a[32:35]
    v_exp_f32 v137, v137
    v_mfma_f32_16x16x32_bf16 a[28:31], v[232:235], v[160:163], a[28:31]
    v_exp_f32 v138, v138
    v_mfma_f32_16x16x32_bf16 a[24:27], v[232:235], v[156:159], a[24:27]
    v_exp_f32 v139, v139
    v_mfma_f32_16x16x32_bf16 a[20:23], v[232:235], v[152:155], a[20:23]
    s_waitcnt lgkmcnt(4)
    v_cvt_pk_bf16_f32 v178, v136, v137
    v_cvt_pk_bf16_f32 v179, v138, v139
    v_mfma_f32_16x16x32_bf16 a[40:43], v[236:239], v[152:155], a[40:43]
    ds_read_b64_tr_b16 v[232:233], v20 offset:512
    ds_read_b64_tr_b16 v[234:235], v20 offset:4608
    v_mfma_f32_16x16x32_bf16 a[44:47], v[236:239], v[156:159], a[44:47]
    v_exp_f32 v140, v140
    v_mfma_f32_16x16x32_bf16 a[48:51], v[236:239], v[160:163], a[48:51]
    v_exp_f32 v141, v141
    v_mfma_f32_16x16x32_bf16 a[52:55], v[236:239], v[164:167], a[52:55]
    v_exp_f32 v142, v142
    v_mfma_f32_16x16x32_bf16 a[56:59], v[236:239], v[168:171], a[56:59]
    s_waitcnt lgkmcnt(4)
    buffer_load_dwordx4 v16, s[12:15], s100 offen offset:3072 nt lds
    v_cvt_pk_bf16_f32 v182, v140, v141
    v_mfma_f32_16x16x32_bf16 a[76:79], v[240:243], v[168:171], a[76:79]
    ds_read_b64_tr_b16 v[236:237], v19 offset:768
    ds_read_b64_tr_b16 v[238:239], v19 offset:4864
    v_mfma_f32_16x16x32_bf16 a[72:75], v[240:243], v[164:167], a[72:75]
    v_exp_f32 v143, v143
    v_mfma_f32_16x16x32_bf16 a[68:71], v[240:243], v[160:163], a[68:71]
    v_cvt_pk_bf16_f32 v183, v142, v143
    v_mfma_f32_16x16x32_bf16 a[64:67], v[240:243], v[156:159], a[64:67]
    v_exp_f32 v144, v144
    v_mfma_f32_16x16x32_bf16 a[60:63], v[240:243], v[152:155], a[60:63]
    s_waitcnt lgkmcnt(4)
    v_exp_f32 v145, v145
    v_mfma_f32_16x16x32_bf16 a[80:83], v[228:231], v[152:155], a[80:83]
    ds_read_b64_tr_b16 v[240:241], v20 offset:768
    ds_read_b64_tr_b16 v[242:243], v20 offset:4864
    v_mfma_f32_16x16x32_bf16 a[84:87], v[228:231], v[156:159], a[84:87]
    v_exp_f32 v146, v146
    v_mfma_f32_16x16x32_bf16 a[88:91], v[228:231], v[160:163], a[88:91]
    v_add_u32 v19, 32768, v19
    v_cvt_pk_bf16_f32 v186, v144, v145
    v_mfma_f32_16x16x32_bf16 a[92:95], v[228:231], v[164:167], a[92:95]
    s_add_u32 m0, s32, 114688
    v_add_u32 v20, 32768, v20
    v_mfma_f32_16x16x32_bf16 a[96:99], v[228:231], v[168:171], a[96:99]
    s_waitcnt vmcnt(8) lgkmcnt(0)
    s_barrier
    s_mov_b32 s100, 90112
    v_mfma_f32_16x16x32_bf16 a[116:119], v[232:235], v[168:171], a[116:119]
    ds_read_b64 a[184:185], v17
    ds_read_b64 a[186:187], v18
    v_mfma_f32_16x16x32_bf16 a[112:115], v[232:235], v[164:167], a[112:115]
    buffer_load_dwordx4 v13, s[16:19], s100 offen nt lds
    v_mfma_f32_16x16x32_bf16 a[108:111], v[232:235], v[160:163], a[108:111]
    v_exp_f32 v147, v147
    v_mfma_f32_16x16x32_bf16 a[104:107], v[232:235], v[156:159], a[104:107]
    ds_read_b64 a[188:189], v17 offset:256
    ds_read_b64 a[190:191], v18 offset:256
    v_mfma_f32_16x16x32_bf16 a[100:103], v[232:235], v[152:155], a[100:103]
    v_cvt_pk_bf16_f32 v187, v146, v147
    v_mfma_f32_16x16x32_bf16 a[120:123], v[236:239], v[152:155], a[120:123]
    v_exp_f32 v148, v148
    v_mfma_f32_16x16x32_bf16 a[124:127], v[236:239], v[156:159], a[124:127]
    ds_read_b64 a[192:193], v17 offset:512
    ds_read_b64 a[194:195], v18 offset:512
    v_mfma_f32_16x16x32_bf16 a[128:131], v[236:239], v[160:163], a[128:131]
    v_exp_f32 v149, v149
    v_mfma_f32_16x16x32_bf16 a[132:135], v[236:239], v[164:167], a[132:135]
    v_exp_f32 v150, v150
    v_mfma_f32_16x16x32_bf16 a[136:139], v[236:239], v[168:171], a[136:139]
    ds_read_b64 a[196:197], v17 offset:768
    ds_read_b64 a[198:199], v18 offset:768
    v_mfma_f32_16x16x32_bf16 a[156:159], v[240:243], v[168:171], a[156:159]
    v_exp_f32 v151, v151
    v_mfma_f32_16x16x32_bf16 a[152:155], v[240:243], v[164:167], a[152:155]
    v_cvt_pk_bf16_f32 v190, v148, v149
    v_cvt_pk_bf16_f32 v191, v150, v151
    v_mfma_f32_16x16x32_bf16 a[148:151], v[240:243], v[160:163], a[148:151]
    buffer_load_dwordx4 v15, s[16:19], s100 offen offset:1024 nt lds
    v_mfma_f32_16x16x32_bf16 a[144:147], v[240:243], v[156:159], a[144:147]
    v_mfma_f32_16x16x32_bf16 a[140:143], v[240:243], v[152:155], a[140:143]
    s_waitcnt lgkmcnt(6)
    v_mfma_f32_16x16x32_bf16 v[112:115], a[184:187], v[32:35], v[192:195]
    s_waitcnt lgkmcnt(4)
    ds_read_b64 a[200:201], v17 offset:4096
    ds_read_b64 a[202:203], v18 offset:4096
    v_mfma_f32_16x16x32_bf16 v[112:115], a[188:191], v[36:39], v[112:115]
    s_waitcnt lgkmcnt(4)
    v_mov_b32 v23, 0
    v_mfma_f32_16x16x32_bf16 v[112:115], a[192:195], v[40:43], v[112:115]
    s_waitcnt lgkmcnt(2)
    v_and_b32 v27, 31, v0
    v_mfma_f32_16x16x32_bf16 v[112:115], a[196:199], v[44:47], v[112:115]
    v_lshlrev_b32 v27, 2, v27
    v_mfma_f32_16x16x32_bf16 v[116:119], a[196:199], v[60:63], v[196:199]
    ds_read_b64 a[204:205], v17 offset:4352
    ds_read_b64 a[206:207], v18 offset:4352
    v_mfma_f32_16x16x32_bf16 v[116:119], a[192:195], v[56:59], v[116:119]
    buffer_load_dword v26, v23, s[40:43], 0 offen sc1
    v_mfma_f32_16x16x32_bf16 v[116:119], a[188:191], v[52:55], v[116:119]
    v_mfma_f32_16x16x32_bf16 v[116:119], a[184:187], v[48:51], v[116:119]
    v_exp_f32 v112, v112
    v_mfma_f32_16x16x32_bf16 v[120:123], a[184:187], v[64:67], v[200:203]
    ds_read_b64 a[208:209], v17 offset:4608
    ds_read_b64 a[210:211], v18 offset:4608
    v_mfma_f32_16x16x32_bf16 v[120:123], a[188:191], v[68:71], v[120:123]
    buffer_load_dwordx4 v13, s[16:19], s100 offen offset:2048 nt lds
    v_mfma_f32_16x16x32_bf16 v[120:123], a[192:195], v[72:75], v[120:123]
    v_exp_f32 v113, v113
    v_mfma_f32_16x16x32_bf16 v[120:123], a[196:199], v[76:79], v[120:123]
    v_exp_f32 v114, v114
    v_mfma_f32_16x16x32_bf16 v[124:127], a[196:199], v[92:95], v[204:207]
    ds_read_b64 a[212:213], v17 offset:4864
    ds_read_b64 a[214:215], v18 offset:4864
    v_mfma_f32_16x16x32_bf16 v[124:127], a[192:195], v[88:91], v[124:127]
    v_exp_f32 v115, v115
    v_mfma_f32_16x16x32_bf16 v[124:127], a[188:191], v[84:87], v[124:127]
    v_cvt_pk_bf16_f32 v152, v112, v113
    v_cvt_pk_bf16_f32 v153, v114, v115
    v_mfma_f32_16x16x32_bf16 v[124:127], a[184:187], v[80:83], v[124:127]
    v_exp_f32 v116, v116
    v_mfma_f32_16x16x32_bf16 v[128:131], a[184:187], v[96:99], v[208:211]
    v_exp_f32 v117, v117
    v_mfma_f32_16x16x32_bf16 v[128:131], a[188:191], v[100:103], v[128:131]
    v_exp_f32 v118, v118
    v_mfma_f32_16x16x32_bf16 v[128:131], a[192:195], v[104:107], v[128:131]
    v_exp_f32 v119, v119
    v_mfma_f32_16x16x32_bf16 v[128:131], a[196:199], v[108:111], v[128:131]
    s_waitcnt lgkmcnt(6)
    v_cvt_pk_bf16_f32 v156, v116, v117
    v_cvt_pk_bf16_f32 v157, v118, v119
    v_mfma_f32_16x16x32_bf16 v[132:135], a[200:203], v[32:35], v[192:195]
    s_waitcnt lgkmcnt(4)
    v_exp_f32 v120, v120
    v_mfma_f32_16x16x32_bf16 v[132:135], a[204:207], v[36:39], v[132:135]
    s_waitcnt lgkmcnt(2)
    buffer_load_dwordx4 v15, s[16:19], s100 offen offset:3072 nt lds
    v_mfma_f32_16x16x32_bf16 v[132:135], a[208:211], v[40:43], v[132:135]
    s_waitcnt lgkmcnt(0)
    v_add_u32 v17, 32768, v17
    v_mfma_f32_16x16x32_bf16 v[132:135], a[212:215], v[44:47], v[132:135]
    v_add_u32 v18, 32768, v18
    v_mfma_f32_16x16x32_bf16 v[136:139], a[212:215], v[60:63], v[196:199]
    v_exp_f32 v121, v121
    v_mfma_f32_16x16x32_bf16 v[136:139], a[208:211], v[56:59], v[136:139]
    v_exp_f32 v122, v122
    v_mfma_f32_16x16x32_bf16 v[136:139], a[204:207], v[52:55], v[136:139]
    v_exp_f32 v123, v123
    v_mfma_f32_16x16x32_bf16 v[136:139], a[200:203], v[48:51], v[136:139]
    v_cvt_pk_bf16_f32 v160, v120, v121
    v_cvt_pk_bf16_f32 v161, v122, v123
    v_mfma_f32_16x16x32_bf16 v[140:143], a[200:203], v[64:67], v[200:203]
    v_exp_f32 v124, v124
    v_mfma_f32_16x16x32_bf16 v[140:143], a[204:207], v[68:71], v[140:143]
    v_exp_f32 v125, v125
    v_mfma_f32_16x16x32_bf16 v[140:143], a[208:211], v[72:75], v[140:143]
    s_add_u32 m0, s32, 131072
    ds_read_b64_tr_b16 v[228:229], v19
    ds_read_b64_tr_b16 v[230:231], v19 offset:4096
    v_mfma_f32_16x16x32_bf16 v[140:143], a[212:215], v[76:79], v[140:143]
    s_mov_b32 s100, 98304
    v_exp_f32 v126, v126
    v_mfma_f32_16x16x32_bf16 v[144:147], a[212:215], v[92:95], v[204:207]
    buffer_load_dwordx4 v13, s[12:15], s100 offen nt lds
    v_cvt_pk_bf16_f32 v164, v124, v125
    v_mfma_f32_16x16x32_bf16 v[144:147], a[208:211], v[88:91], v[144:147]
    v_exp_f32 v127, v127
    v_mfma_f32_16x16x32_bf16 v[144:147], a[204:207], v[84:87], v[144:147]
    v_cvt_pk_bf16_f32 v165, v126, v127
    v_mfma_f32_16x16x32_bf16 v[144:147], a[200:203], v[80:83], v[144:147]
    ds_read_b64_tr_b16 v[232:233], v20
    ds_read_b64_tr_b16 v[234:235], v20 offset:4096
    v_mfma_f32_16x16x32_bf16 v[148:151], a[200:203], v[96:99], v[208:211]
    v_exp_f32 v128, v128
    v_mfma_f32_16x16x32_bf16 v[148:151], a[204:207], v[100:103], v[148:151]
    v_exp_f32 v129, v129
    v_mfma_f32_16x16x32_bf16 v[148:151], a[208:211], v[104:107], v[148:151]
    v_exp_f32 v130, v130
    v_mfma_f32_16x16x32_bf16 v[148:151], a[212:215], v[108:111], v[148:151]
    v_exp_f32 v131, v131
    v_mfma_f32_16x16x32_bf16 a[160:163], a[180:183], v[172:175], a[160:163]
    ds_read_b64_tr_b16 v[236:237], v19 offset:256
    ds_read_b64_tr_b16 v[238:239], v19 offset:4352
    v_mfma_f32_16x16x32_bf16 a[164:167], a[180:183], v[176:179], a[164:167]
    v_cvt_pk_bf16_f32 v168, v128, v129
    v_cvt_pk_bf16_f32 v169, v130, v131
    v_mfma_f32_16x16x32_bf16 a[168:171], a[180:183], v[180:183], a[168:171]
    v_exp_f32 v132, v132
    v_mfma_f32_16x16x32_bf16 a[172:175], a[180:183], v[184:187], a[172:175]
    v_exp_f32 v133, v133
    v_mfma_f32_16x16x32_bf16 a[176:179], a[180:183], v[188:191], a[176:179]
    s_waitcnt lgkmcnt(4)
    buffer_load_dwordx4 v14, s[12:15], s100 offen offset:1024 nt lds
    v_cvt_pk_bf16_f32 v154, v132, v133
    v_mfma_f32_16x16x32_bf16 a[0:3], v[228:231], v[172:175], a[0:3]
    ds_read_b64_tr_b16 v[240:241], v20 offset:256
    ds_read_b64_tr_b16 v[242:243], v20 offset:4352
    v_mfma_f32_16x16x32_bf16 a[4:7], v[228:231], v[176:179], a[4:7]
    v_exp_f32 v134, v134
    v_mfma_f32_16x16x32_bf16 a[8:11], v[228:231], v[180:183], a[8:11]
    v_exp_f32 v135, v135
    v_mfma_f32_16x16x32_bf16 a[12:15], v[228:231], v[184:187], a[12:15]
    v_cvt_pk_bf16_f32 v155, v134, v135
    v_mfma_f32_16x16x32_bf16 a[16:19], v[228:231], v[188:191], a[16:19]
    s_waitcnt lgkmcnt(4)
    v_exp_f32 v136, v136
    v_mfma_f32_16x16x32_bf16 a[36:39], v[232:235], v[188:191], a[36:39]
    ds_read_b64_tr_b16 v[228:229], v19 offset:512
    ds_read_b64_tr_b16 v[230:231], v19 offset:4608
    v_mfma_f32_16x16x32_bf16 a[32:35], v[232:235], v[184:187], a[32:35]
    v_exp_f32 v137, v137
    v_mfma_f32_16x16x32_bf16 a[28:31], v[232:235], v[180:183], a[28:31]
    v_exp_f32 v138, v138
    v_mfma_f32_16x16x32_bf16 a[24:27], v[232:235], v[176:179], a[24:27]
    v_exp_f32 v139, v139
    v_mfma_f32_16x16x32_bf16 a[20:23], v[232:235], v[172:175], a[20:23]
    s_waitcnt lgkmcnt(4)
    v_cvt_pk_bf16_f32 v158, v136, v137
    v_cvt_pk_bf16_f32 v159, v138, v139
    v_mfma_f32_16x16x32_bf16 a[40:43], v[236:239], v[172:175], a[40:43]
    ds_read_b64_tr_b16 v[232:233], v20 offset:512
    ds_read_b64_tr_b16 v[234:235], v20 offset:4608
    v_mfma_f32_16x16x32_bf16 a[44:47], v[236:239], v[176:179], a[44:47]
    buffer_load_dwordx4 v15, s[12:15], s100 offen offset:2048 nt lds
    v_mfma_f32_16x16x32_bf16 a[48:51], v[236:239], v[180:183], a[48:51]
    v_exp_f32 v140, v140
    v_mfma_f32_16x16x32_bf16 a[52:55], v[236:239], v[184:187], a[52:55]
    v_exp_f32 v141, v141
    v_mfma_f32_16x16x32_bf16 a[56:59], v[236:239], v[188:191], a[56:59]
    s_waitcnt lgkmcnt(4)
    v_exp_f32 v142, v142
    v_mfma_f32_16x16x32_bf16 a[76:79], v[240:243], v[188:191], a[76:79]
    ds_read_b64_tr_b16 v[236:237], v19 offset:768
    ds_read_b64_tr_b16 v[238:239], v19 offset:4864
    v_mfma_f32_16x16x32_bf16 a[72:75], v[240:243], v[184:187], a[72:75]
    v_exp_f32 v143, v143
    v_mfma_f32_16x16x32_bf16 a[68:71], v[240:243], v[180:183], a[68:71]
    v_cvt_pk_bf16_f32 v162, v140, v141
    v_cvt_pk_bf16_f32 v163, v142, v143
    v_mfma_f32_16x16x32_bf16 a[64:67], v[240:243], v[176:179], a[64:67]
    v_exp_f32 v144, v144
    v_mfma_f32_16x16x32_bf16 a[60:63], v[240:243], v[172:175], a[60:63]
    s_waitcnt lgkmcnt(4)
    v_exp_f32 v145, v145
    v_mfma_f32_16x16x32_bf16 a[80:83], v[228:231], v[172:175], a[80:83]
    ds_read_b64_tr_b16 v[240:241], v20 offset:768
    ds_read_b64_tr_b16 v[242:243], v20 offset:4864
    v_mfma_f32_16x16x32_bf16 a[84:87], v[228:231], v[176:179], a[84:87]
    v_exp_f32 v146, v146
    v_mfma_f32_16x16x32_bf16 a[88:91], v[228:231], v[180:183], a[88:91]
    v_add_u32 v19, 32768, v19
    buffer_load_dwordx4 v16, s[12:15], s100 offen offset:3072 nt lds
    v_mfma_f32_16x16x32_bf16 a[92:95], v[228:231], v[184:187], a[92:95]
    v_add_u32 v20, 32768, v20
    v_cvt_pk_bf16_f32 v166, v144, v145
    v_mfma_f32_16x16x32_bf16 a[96:99], v[228:231], v[188:191], a[96:99]
    s_waitcnt vmcnt(9) lgkmcnt(0)
    s_barrier
    v_mfma_f32_16x16x32_bf16 a[116:119], v[232:235], v[188:191], a[116:119]
    ds_read_b64 a[184:185], v17
    ds_read_b64 a[186:187], v18
    v_mfma_f32_16x16x32_bf16 a[112:115], v[232:235], v[184:187], a[112:115]
    s_mov_b32 s28, (L_out - L_code0) & 0xffffff80
    s_mov_b32 s46, L_end - L_code0
    buffer_load_dword v30, v29, s[44:47], s28 offen
    v_mfma_f32_16x16x32_bf16 a[108:111], v[232:235], v[180:183], a[108:111]
    v_exp_f32 v147, v147
    v_mfma_f32_16x16x32_bf16 a[104:107], v[232:235], v[176:179], a[104:107]
    ds_read_b64 a[188:189], v17 offset:256
    ds_read_b64 a[190:191], v18 offset:256
    v_mfma_f32_16x16x32_bf16 a[100:103], v[232:235], v[172:175], a[100:103]
    v_cvt_pk_bf16_f32 v167, v146, v147
    v_mfma_f32_16x16x32_bf16 a[120:123], v[236:239], v[172:175], a[120:123]
    v_exp_f32 v148, v148
    v_mfma_f32_16x16x32_bf16 a[124:127], v[236:239], v[176:179], a[124:127]
    ds_read_b64 a[192:193], v17 offset:512
    ds_read_b64 a[194:195], v18 offset:512
    v_mfma_f32_16x16x32_bf16 a[128:131], v[236:239], v[180:183], a[128:131]
    s_add_u32 m0, s32, 147456
    v_exp_f32 v149, v149
    v_mfma_f32_16x16x32_bf16 a[132:135], v[236:239], v[184:187], a[132:135]
    s_mov_b32 s100, 98304
    v_exp_f32 v150, v150
    v_mfma_f32_16x16x32_bf16 a[136:139], v[236:239], v[188:191], a[136:139]
    ds_read_b64 a[196:197], v17 offset:768
    ds_read_b64 a[198:199], v18 offset:768
    v_mfma_f32_16x16x32_bf16 a[156:159], v[240:243], v[188:191], a[156:159]
    buffer_load_dwordx4 v13, s[16:19], s100 offen nt lds
    v_cvt_pk_bf16_f32 v170, v148, v149
    v_mfma_f32_16x16x32_bf16 a[152:155], v[240:243], v[184:187], a[152:155]
    v_exp_f32 v151, v151
    v_mfma_f32_16x16x32_bf16 a[148:151], v[240:243], v[180:183], a[148:151]
    v_cvt_pk_bf16_f32 v171, v150, v151
    v_mfma_f32_16x16x32_bf16 a[144:147], v[240:243], v[176:179], a[144:147]
    v_mfma_f32_16x16x32_bf16 a[140:143], v[240:243], v[172:175], a[140:143]
    s_waitcnt lgkmcnt(6)
    v_mfma_f32_16x16x32_bf16 v[112:115], a[184:187], v[32:35], v[192:195]
    s_waitcnt lgkmcnt(4)
    ds_read_b64 a[200:201], v17 offset:4096
    ds_read_b64 a[202:203], v18 offset:4096
    v_mfma_f32_16x16x32_bf16 v[112:115], a[188:191], v[36:39], v[112:115]
    s_waitcnt lgkmcnt(4)
    v_mfma_f32_16x16x32_bf16 v[112:115], a[192:195], v[40:43], v[112:115]
    s_waitcnt lgkmcnt(2)
    v_mfma_f32_16x16x32_bf16 v[112:115], a[196:199], v[44:47], v[112:115]
    v_mfma_f32_16x16x32_bf16 v[116:119], a[196:199], v[60:63], v[196:199]
    ds_read_b64 a[204:205], v17 offset:4352
    ds_read_b64 a[206:207], v18 offset:4352
    v_mfma_f32_16x16x32_bf16 v[116:119], a[192:195], v[56:59], v[116:119]
    v_mfma_f32_16x16x32_bf16 v[116:119], a[188:191], v[52:55], v[116:119]
    buffer_load_dwordx4 v15, s[16:19], s100 offen offset:1024 nt lds
    v_mfma_f32_16x16x32_bf16 v[116:119], a[184:187], v[48:51], v[116:119]
    s_nop 0
    v_exp_f32 v112, v112
    v_mfma_f32_16x16x32_bf16 v[120:123], a[184:187], v[64:67], v[200:203]
    ds_read_b64 a[208:209], v17 offset:4608
    ds_read_b64 a[210:211], v18 offset:4608
    v_mfma_f32_16x16x32_bf16 v[120:123], a[188:191], v[68:71], v[120:123]
    v_exp_f32 v113, v113
    v_mfma_f32_16x16x32_bf16 v[120:123], a[192:195], v[72:75], v[120:123]
    v_exp_f32 v114, v114
    v_mfma_f32_16x16x32_bf16 v[120:123], a[196:199], v[76:79], v[120:123]
    v_exp_f32 v115, v115
    v_mfma_f32_16x16x32_bf16 v[124:127], a[196:199], v[92:95], v[204:207]
    ds_read_b64 a[212:213], v17 offset:4864
    ds_read_b64 a[214:215], v18 offset:4864
    v_mfma_f32_16x16x32_bf16 v[124:127], a[192:195], v[88:91], v[124:127]
    v_cvt_pk_bf16_f32 v172, v112, v113
    v_cvt_pk_bf16_f32 v173, v114, v115
    v_mfma_f32_16x16x32_bf16 v[124:127], a[188:191], v[84:87], v[124:127]
    v_exp_f32 v116, v116
    v_mfma_f32_16x16x32_bf16 v[124:127], a[184:187], v[80:83], v[124:127]
    v_exp_f32 v117, v117
    v_mfma_f32_16x16x32_bf16 v[128:131], a[184:187], v[96:99], v[208:211]
    v_exp_f32 v118, v118
    v_mfma_f32_16x16x32_bf16 v[128:131], a[188:191], v[100:103], v[128:131]
    buffer_load_dwordx4 v13, s[16:19], s100 offen offset:2048 nt lds
    v_cvt_pk_bf16_f32 v176, v116, v117
    v_mfma_f32_16x16x32_bf16 v[128:131], a[192:195], v[104:107], v[128:131]
    v_exp_f32 v119, v119
    v_mfma_f32_16x16x32_bf16 v[128:131], a[196:199], v[108:111], v[128:131]
    s_waitcnt lgkmcnt(6)
    v_cvt_pk_bf16_f32 v177, v118, v119
    v_mfma_f32_16x16x32_bf16 v[132:135], a[200:203], v[32:35], v[192:195]
    s_waitcnt lgkmcnt(4)
    v_exp_f32 v120, v120
    v_mfma_f32_16x16x32_bf16 v[132:135], a[204:207], v[36:39], v[132:135]
    s_waitcnt lgkmcnt(2)
    v_exp_f32 v121, v121
    v_mfma_f32_16x16x32_bf16 v[132:135], a[208:211], v[40:43], v[132:135]
    s_waitcnt lgkmcnt(0)
    v_add_u32 v17, 32768, v17
    v_cvt_pk_bf16_f32 v180, v120, v121
    v_mfma_f32_16x16x32_bf16 v[132:135], a[212:215], v[44:47], v[132:135]
    v_add_u32 v18, 32768, v18
    v_mfma_f32_16x16x32_bf16 v[136:139], a[212:215], v[60:63], v[196:199]
    v_exp_f32 v122, v122
    v_mfma_f32_16x16x32_bf16 v[136:139], a[208:211], v[56:59], v[136:139]
    v_exp_f32 v123, v123
    v_mfma_f32_16x16x32_bf16 v[136:139], a[204:207], v[52:55], v[136:139]
    v_cvt_pk_bf16_f32 v181, v122, v123
    v_mfma_f32_16x16x32_bf16 v[136:139], a[200:203], v[48:51], v[136:139]
    v_exp_f32 v124, v124
    v_mfma_f32_16x16x32_bf16 v[140:143], a[200:203], v[64:67], v[200:203]
    v_exp_f32 v125, v125
    v_mfma_f32_16x16x32_bf16 v[140:143], a[204:207], v[68:71], v[140:143]
    buffer_load_dwordx4 v15, s[16:19], s100 offen offset:3072 nt lds
    v_cvt_pk_bf16_f32 v184, v124, v125
    v_mfma_f32_16x16x32_bf16 v[140:143], a[208:211], v[72:75], v[140:143]
    ds_read_b64_tr_b16 v[228:229], v19
    ds_read_b64_tr_b16 v[230:231], v19 offset:4096
    v_mfma_f32_16x16x32_bf16 v[140:143], a[212:215], v[76:79], v[140:143]
    v_exp_f32 v126, v126
    v_mfma_f32_16x16x32_bf16 v[144:147], a[212:215], v[92:95], v[204:207]
    v_exp_f32 v127, v127
    v_mfma_f32_16x16x32_bf16 v[144:147], a[208:211], v[88:91], v[144:147]
    v_cvt_pk_bf16_f32 v185, v126, v127
    v_mfma_f32_16x16x32_bf16 v[144:147], a[204:207], v[84:87], v[144:147]
    v_exp_f32 v128, v128
    v_mfma_f32_16x16x32_bf16 v[144:147], a[200:203], v[80:83], v[144:147]
    ds_read_b64_tr_b16 v[232:233], v20
    ds_read_b64_tr_b16 v[234:235], v20 offset:4096
    v_mfma_f32_16x16x32_bf16 v[148:151], a[200:203], v[96:99], v[208:211]
    v_exp_f32 v129, v129
    v_mfma_f32_16x16x32_bf16 v[148:151], a[204:207], v[100:103], v[148:151]
    v_exp_f32 v130, v130
    v_mfma_f32_16x16x32_bf16 v[148:151], a[208:211], v[104:107], v[148:151]
    v_exp_f32 v131, v131
    v_mfma_f32_16x16x32_bf16 v[148:151], a[212:215], v[108:111], v[148:151]
    s_add_u32 m0, s32, 0
    v_cvt_pk_bf16_f32 v188, v128, v129
    v_cvt_pk_bf16_f32 v189, v130, v131
    v_mfma_f32_16x16x32_bf16 a[160:163], a[180:183], v[152:155], a[160:163]
    s_mov_b32 s100, 106496
    ds_read_b64_tr_b16 v[236:237], v19 offset:256
    ds_read_b64_tr_b16 v[238:239], v19 offset:4352
    v_mfma_f32_16x16x32_bf16 a[164:167], a[180:183], v[156:159], a[164:167]
    buffer_load_dwordx4 v13, s[12:15], s100 offen nt lds
    v_mfma_f32_16x16x32_bf16 a[168:171], a[180:183], v[160:163], a[168:171]
    v_exp_f32 v132, v132
    v_mfma_f32_16x16x32_bf16 a[172:175], a[180:183], v[164:167], a[172:175]
    v_exp_f32 v133, v133
    v_mfma_f32_16x16x32_bf16 a[176:179], a[180:183], v[168:171], a[176:179]
    s_waitcnt lgkmcnt(4)
    v_exp_f32 v134, v134
    v_mfma_f32_16x16x32_bf16 a[0:3], v[228:231], v[152:155], a[0:3]
    ds_read_b64_tr_b16 v[240:241], v20 offset:256
    ds_read_b64_tr_b16 v[242:243], v20 offset:4352
    v_mfma_f32_16x16x32_bf16 a[4:7], v[228:231], v[156:159], a[4:7]
    v_exp_f32 v135, v135
    v_mfma_f32_16x16x32_bf16 a[8:11], v[228:231], v[160:163], a[8:11]
    v_cvt_pk_bf16_f32 v174, v132, v133
    v_cvt_pk_bf16_f32 v175, v134, v135
    v_mfma_f32_16x16x32_bf16 a[12:15], v[228:231], v[164:167], a[12:15]
    v_exp_f32 v136, v136
    v_mfma_f32_16x16x32_bf16 a[16:19], v[228:231], v[168:171], a[16:19]
    s_waitcnt lgkmcnt(4)
    v_exp_f32 v137, v137
    v_mfma_f32_16x16x32_bf16 a[36:39], v[232:235], v[168:171], a[36:39]
    ds_read_b64_tr_b16 v[228:229], v19 offset:512
    ds_read_b64_tr_b16 v[230:231], v19 offset:4608
    v_mfma_f32_16x16x32_bf16 a[32:35], v[232:235], v[164:167], a[32:35]
    v_exp_f32 v138, v138
    v_mfma_f32_16x16x32_bf16 a[28:31], v[232:235], v[160:163], a[28:31]
    buffer_load_dwordx4 v14, s[12:15], s100 offen offset:1024 nt lds
    v_cvt_pk_bf16_f32 v178, v136, v137
    v_mfma_f32_16x16x32_bf16 a[24:27], v[232:235], v[156:159], a[24:27]
    v_exp_f32 v139, v139
    v_mfma_f32_16x16x32_bf16 a[20:23], v[232:235], v[152:155], a[20:23]
    s_waitcnt lgkmcnt(4)
    v_cvt_pk_bf16_f32 v179, v138, v139
    v_mfma_f32_16x16x32_bf16 a[40:43], v[236:239], v[152:155], a[40:43]
    ds_read_b64_tr_b16 v[232:233], v20 offset:512
    ds_read_b64_tr_b16 v[234:235], v20 offset:4608
    v_mfma_f32_16x16x32_bf16 a[44:47], v[236:239], v[156:159], a[44:47]
    v_exp_f32 v140, v140
    v_mfma_f32_16x16x32_bf16 a[48:51], v[236:239], v[160:163], a[48:51]
    v_exp_f32 v141, v141
    v_mfma_f32_16x16x32_bf16 a[52:55], v[236:239], v[164:167], a[52:55]
    v_exp_f32 v142, v142
    v_mfma_f32_16x16x32_bf16 a[56:59], v[236:239], v[168:171], a[56:59]
    s_waitcnt lgkmcnt(4)
    v_exp_f32 v143, v143
    v_mfma_f32_16x16x32_bf16 a[76:79], v[240:243], v[168:171], a[76:79]
    ds_read_b64_tr_b16 v[236:237], v19 offset:768
    ds_read_b64_tr_b16 v[238:239], v19 offset:4864
    v_mfma_f32_16x16x32_bf16 a[72:75], v[240:243], v[164:167], a[72:75]
    v_cvt_pk_bf16_f32 v182, v140, v141
    v_cvt_pk_bf16_f32 v183, v142, v143
    v_mfma_f32_16x16x32_bf16 a[68:71], v[240:243], v[160:163], a[68:71]
    v_exp_f32 v144, v144
    v_mfma_f32_16x16x32_bf16 a[64:67], v[240:243], v[156:159], a[64:67]
    v_exp_f32 v145, v145
    v_mfma_f32_16x16x32_bf16 a[60:63], v[240:243], v[152:155], a[60:63]
    s_waitcnt lgkmcnt(4)
    buffer_load_dwordx4 v15, s[12:15], s100 offen offset:2048 nt lds
    v_cvt_pk_bf16_f32 v186, v144, v145
    v_mfma_f32_16x16x32_bf16 a[80:83], v[228:231], v[152:155], a[80:83]
    ds_read_b64_tr_b16 v[240:241], v20 offset:768
    ds_read_b64_tr_b16 v[242:243], v20 offset:4864
    v_mfma_f32_16x16x32_bf16 a[84:87], v[228:231], v[156:159], a[84:87]
    v_exp_f32 v146, v146
    v_mfma_f32_16x16x32_bf16 a[88:91], v[228:231], v[160:163], a[88:91]
    v_add_u32 v19, 32768, v19
    v_mfma_f32_16x16x32_bf16 a[92:95], v[228:231], v[164:167], a[92:95]
    v_add_u32 v20, 32768, v20
    v_mfma_f32_16x16x32_bf16 a[96:99], v[228:231], v[168:171], a[96:99]
    s_waitcnt vmcnt(8) lgkmcnt(0)
    s_barrier
    v_mfma_f32_16x16x32_bf16 a[116:119], v[232:235], v[168:171], a[116:119]
    ds_read_b64 a[184:185], v17
    ds_read_b64 a[186:187], v18
    v_mfma_f32_16x16x32_bf16 a[112:115], v[232:235], v[164:167], a[112:115]
    v_exp_f32 v147, v147
    v_mfma_f32_16x16x32_bf16 a[108:111], v[232:235], v[160:163], a[108:111]
    v_cvt_pk_bf16_f32 v187, v146, v147
    v_mfma_f32_16x16x32_bf16 a[104:107], v[232:235], v[156:159], a[104:107]
    ds_read_b64 a[188:189], v17 offset:256
    ds_read_b64 a[190:191], v18 offset:256
    v_mfma_f32_16x16x32_bf16 a[100:103], v[232:235], v[152:155], a[100:103]
    v_exp_f32 v148, v148
    v_mfma_f32_16x16x32_bf16 a[120:123], v[236:239], v[152:155], a[120:123]
    v_exp_f32 v149, v149
    v_mfma_f32_16x16x32_bf16 a[124:127], v[236:239], v[156:159], a[124:127]
    ds_read_b64 a[192:193], v17 offset:512
    ds_read_b64 a[194:195], v18 offset:512
    v_mfma_f32_16x16x32_bf16 a[128:131], v[236:239], v[160:163], a[128:131]
    buffer_load_dwordx4 v16, s[12:15], s100 offen offset:3072 nt lds
    v_cvt_pk_bf16_f32 v190, v148, v149
    v_mfma_f32_16x16x32_bf16 a[132:135], v[236:239], v[164:167], a[132:135]
    v_exp_f32 v150, v150
    v_mfma_f32_16x16x32_bf16 a[136:139], v[236:239], v[168:171], a[136:139]
    ds_read_b64 a[196:197], v17 offset:768
    ds_read_b64 a[198:199], v18 offset:768
    v_mfma_f32_16x16x32_bf16 a[156:159], v[240:243], v[168:171], a[156:159]
    v_exp_f32 v151, v151
    v_mfma_f32_16x16x32_bf16 a[152:155], v[240:243], v[164:167], a[152:155]
    v_cvt_pk_bf16_f32 v191, v150, v151
    v_mfma_f32_16x16x32_bf16 a[148:151], v[240:243], v[160:163], a[148:151]
    v_mfma_f32_16x16x32_bf16 a[144:147], v[240:243], v[156:159], a[144:147]
    v_mfma_f32_16x16x32_bf16 a[140:143], v[240:243], v[152:155], a[140:143]
    s_waitcnt lgkmcnt(6)
    v_mfma_f32_16x16x32_bf16 v[112:115], a[184:187], v[32:35], v[192:195]
    s_waitcnt lgkmcnt(4)
    s_add_u32 m0, s32, 16384
    ds_read_b64 a[200:201], v17 offset:4096
    ds_read_b64 a[202:203], v18 offset:4096
    v_mfma_f32_16x16x32_bf16 v[112:115], a[188:191], v[36:39], v[112:115]
    s_waitcnt lgkmcnt(4)
    s_mov_b32 s100, 106496
    v_mfma_f32_16x16x32_bf16 v[112:115], a[192:195], v[40:43], v[112:115]
    s_waitcnt lgkmcnt(2)
    buffer_load_dwordx4 v13, s[16:19], s100 offen nt lds
    v_readfirstlane_b32 s101, v26
    s_nop 0
    s_cmp_ge_u32 s101, 256
    s_cbranch_scc0 L_cnt_slow
L_cnt_ok:
    buffer_load_dword v24, v27, s[36:39], s48 offen sc1
    v_mfma_f32_16x16x32_bf16 v[112:115], a[196:199], v[44:47], v[112:115]
    v_mfma_f32_16x16x32_bf16 v[116:119], a[196:199], v[60:63], v[196:199]
    ds_read_b64 a[204:205], v17 offset:4352
    ds_read_b64 a[206:207], v18 offset:4352
    v_mfma_f32_16x16x32_bf16 v[116:119], a[192:195], v[56:59], v[116:119]
    v_mfma_f32_16x16x32_bf16 v[116:119], a[188:191], v[52:55], v[116:119]
    v_mfma_f32_16x16x32_bf16 v[116:119], a[184:187], v[48:51], v[116:119]
    s_nop 1
    v_exp_f32 v112, v112
    v_mfma_f32_16x16x32_bf16 v[120:123], a[184:187], v[64:67], v[200:203]
    ds_read_b64 a[208:209], v17 offset:4608
    ds_read_b64 a[210:211], v18 offset:4608
    v_mfma_f32_16x16x32_bf16 v[120:123], a[188:191], v[68:71], v[120:123]
    v_exp_f32 v113, v113
    v_mfma_f32_16x16x32_bf16 v[120:123], a[192:195], v[72:75], v[120:123]
    v_exp_f32 v114, v114
    v_mfma_f32_16x16x32_bf16 v[120:123], a[196:199], v[76:79], v[120:123]
    v_exp_f32 v115, v115
    v_mfma_f32_16x16x32_bf16 v[124:127], a[196:199], v[92:95], v[204:207]
    ds_read_b64 a[212:213], v17 offset:4864
    ds_read_b64 a[214:215], v18 offset:4864
    v_mfma_f32_16x16x32_bf16 v[124:127], a[192:195], v[88:91], v[124:127]
    v_cvt_pk_bf16_f32 v152, v112, v113
    v_cvt_pk_bf16_f32 v153, v114, v115
    v_mfma_f32_16x16x32_bf16 v[124:127], a[188:191], v[84:87], v[124:127]
    buffer_load_dwordx4 v15, s[16:19], s100 offen offset:1024 nt lds
    v_mfma_f32_16x16x32_bf16 v[124:127], a[184:187], v[80:83], v[124:127]
    v_exp_f32 v116, v116
    v_mfma_f32_16x16x32_bf16 v[128:131], a[184:187], v[96:99], v[208:211]
    v_exp_f32 v117, v117
    v_mfma_f32_16x16x32_bf16 v[128:131], a[188:191], v[100:103], v[128:131]
    v_exp_f32 v118, v118
    v_mfma_f32_16x16x32_bf16 v[128:131], a[192:195], v[104:107], v[128:131]
    v_exp_f32 v119, v119
    v_mfma_f32_16x16x32_bf16 v[128:131], a[196:199], v[108:111], v[128:131]
    s_waitcnt lgkmcnt(6)
    v_cvt_pk_bf16_f32 v156, v116, v117
    v_cvt_pk_bf16_f32 v157, v118, v119
    v_mfma_f32_16x16x32_bf16 v[132:135], a[200:203], v[32:35], v[192:195]
    s_waitcnt lgkmcnt(4)
    v_exp_f32 v120, v120
    v_mfma_f32_16x16x32_bf16 v[132:135], a[204:207], v[36:39], v[132:135]
    s_waitcnt lgkmcnt(2)
    v_exp_f32 v121, v121
    v_mfma_f32_16x16x32_bf16 v[132:135], a[208:211], v[40:43], v[132:135]
    s_waitcnt lgkmcnt(0)
    v_subrev_u32 v17, 131072, v17
    v_cvt_pk_bf16_f32 v160, v120, v121
    v_mfma_f32_16x16x32_bf16 v[132:135], a[212:215], v[44:47], v[132:135]
    v_subrev_u32 v18, 131072, v18
    v_mfma_f32_16x16x32_bf16 v[136:139], a[212:215], v[60:63], v[196:199]
    v_exp_f32 v122, v122
    v_mfma_f32_16x16x32_bf16 v[136:139], a[208:211], v[56:59], v[136:139]
    v_exp_f32 v123, v123
    v_mfma_f32_16x16x32_bf16 v[136:139], a[204:207], v[52:55], v[136:139]
    buffer_load_dwordx4 v13, s[16:19], s100 offen offset:2048 nt lds
    v_cvt_pk_bf16_f32 v161, v122, v123
    v_mfma_f32_16x16x32_bf16 v[136:139], a[200:203], v[48:51], v[136:139]
    v_exp_f32 v124, v124
    v_mfma_f32_16x16x32_bf16 v[140:143], a[200:203], v[64:67], v[200:203]
    v_exp_f32 v125, v125
    v_mfma_f32_16x16x32_bf16 v[140:143], a[204:207], v[68:71], v[140:143]
    v_exp_f32 v126, v126
    v_mfma_f32_16x16x32_bf16 v[140:143], a[208:211], v[72:75], v[140:143]
    ds_read_b64_tr_b16 v[228:229], v19
    ds_read_b64_tr_b16 v[230:231], v19 offset:4096
    v_mfma_f32_16x16x32_bf16 v[140:143], a[212:215], v[76:79], v[140:143]
    v_exp_f32 v127, v127
    v_mfma_f32_16x16x32_bf16 v[144:147], a[212:215], v[92:95], v[204:207]
    v_cvt_pk_bf16_f32 v164, v124, v125
    v_cvt_pk_bf16_f32 v165, v126, v127
    v_mfma_f32_16x16x32_bf16 v[144:147], a[208:211], v[88:91], v[144:147]
    v_exp_f32 v128, v128
    v_mfma_f32_16x16x32_bf16 v[144:147], a[204:207], v[84:87], v[144:147]
    v_exp_f32 v129, v129
    v_mfma_f32_16x16x32_bf16 v[144:147], a[200:203], v[80:83], v[144:147]
    ds_read_b64_tr_b16 v[232:233], v20
    ds_read_b64_tr_b16 v[234:235], v20 offset:4096
    v_mfma_f32_16x16x32_bf16 v[148:151], a[200:203], v[96:99], v[208:211]
    v_exp_f32 v130, v130
    v_mfma_f32_16x16x32_bf16 v[148:151], a[204:207], v[100:103], v[148:151]
    v_exp_f32 v131, v131
    v_mfma_f32_16x16x32_bf16 v[148:151], a[208:211], v[104:107], v[148:151]
    buffer_load_dwordx4 v15, s[16:19], s100 offen offset:3072 nt lds
    v_cvt_pk_bf16_f32 v168, v128, v129
    v_mfma_f32_16x16x32_bf16 v[148:151], a[212:215], v[108:111], v[148:151]
    v_cvt_pk_bf16_f32 v169, v130, v131
    v_mfma_f32_16x16x32_bf16 a[160:163], a[180:183], v[172:175], a[160:163]
    ds_read_b64_tr_b16 v[236:237], v19 offset:256
    ds_read_b64_tr_b16 v[238:239], v19 offset:4352
    v_mfma_f32_16x16x32_bf16 a[164:167], a[180:183], v[176:179], a[164:167]
    v_exp_f32 v132, v132
    v_mfma_f32_16x16x32_bf16 a[168:171], a[180:183], v[180:183], a[168:171]
    v_exp_f32 v133, v133
    v_mfma_f32_16x16x32_bf16 a[172:175], a[180:183], v[184:187], a[172:175]
    v_exp_f32 v134, v134
    v_mfma_f32_16x16x32_bf16 a[176:179], a[180:183], v[188:191], a[176:179]
    s_waitcnt lgkmcnt(4)
    v_exp_f32 v135, v135
    v_mfma_f32_16x16x32_bf16 a[0:3], v[228:231], v[172:175], a[0:3]
    ds_read_b64_tr_b16 v[240:241], v20 offset:256
    ds_read_b64_tr_b16 v[242:243], v20 offset:4352
    v_mfma_f32_16x16x32_bf16 a[4:7], v[228:231], v[176:179], a[4:7]
    v_cvt_pk_bf16_f32 v154, v132, v133
    v_cvt_pk_bf16_f32 v155, v134, v135
    v_mfma_f32_16x16x32_bf16 a[8:11], v[228:231], v[180:183], a[8:11]
    s_add_u32 m0, s32, 32768
    v_exp_f32 v136, v136
    v_mfma_f32_16x16x32_bf16 a[12:15], v[228:231], v[184:187], a[12:15]
    s_mov_b32 s100, 114688
    v_exp_f32 v137, v137
    v_mfma_f32_16x16x32_bf16 a[16:19], v[228:231], v[188:191], a[16:19]
    s_waitcnt lgkmcnt(4)
    buffer_load_dwordx4 v13, s[12:15], s100 offen nt lds
    v_cvt_pk_bf16_f32 v158, v136, v137
    v_mfma_f32_16x16x32_bf16 a[36:39], v[232:235], v[188:191], a[36:39]
    ds_read_b64_tr_b16 v[228:229], v19 offset:512
    ds_read_b64_tr_b16 v[230:231], v19 offset:4608
    v_mfma_f32_16x16x32_bf16 a[32:35], v[232:235], v[184:187], a[32:35]
    v_exp_f32 v138, v138
    v_mfma_f32_16x16x32_bf16 a[28:31], v[232:235], v[180:183], a[28:31]
    v_exp_f32 v139, v139
    v_mfma_f32_16x16x32_bf16 a[24:27], v[232:235], v[176:179], a[24:27]
    v_cvt_pk_bf16_f32 v159, v138, v139
    v_mfma_f32_16x16x32_bf16 a[20:23], v[232:235], v[172:175], a[20:23]
    s_waitcnt lgkmcnt(4)
    v_exp_f32 v140, v140
    v_mfma_f32_16x16x32_bf16 a[40:43], v[236:239], v[172:175], a[40:43]
    ds_read_b64_tr_b16 v[232:233], v20 offset:512
    ds_read_b64_tr_b16 v[234:235], v20 offset:4608
    v_mfma_f32_16x16x32_bf16 a[44:47], v[236:239], v[176:179], a[44:47]
    v_exp_f32 v141, v141
    v_mfma_f32_16x16x32_bf16 a[48:51], v[236:239], v[180:183], a[48:51]
    v_exp_f32 v142, v142
    v_mfma_f32_16x16x32_bf16 a[52:55], v[236:239], v[184:187], a[52:55]
    v_exp_f32 v143, v143
    v_mfma_f32_16x16x32_bf16 a[56:59], v[236:239], v[188:191], a[56:59]
    s_waitcnt lgkmcnt(4)
    v_cvt_pk_bf16_f32 v162, v140, v141
    v_cvt_pk_bf16_f32 v163, v142, v143
    v_mfma_f32_16x16x32_bf16 a[76:79], v[240:243], v[188:191], a[76:79]
    ds_read_b64_tr_b16 v[236:237], v19 offset:768
    ds_read_b64_tr_b16 v[238:239], v19 offset:4864
    v_mfma_f32_16x16x32_bf16 a[72:75], v[240:243], v[184:187], a[72:75]
    buffer_load_dwordx4 v14, s[12:15], s100 offen offset:1024 nt lds
    v_mfma_f32_16x16x32_bf16 a[68:71], v[240:243], v[180:183], a[68:71]
    v_exp_f32 v144, v144
    v_mfma_f32_16x16x32_bf16 a[64:67], v[240:243], v[176:179], a[64:67]
    v_exp_f32 v145, v145
    v_mfma_f32_16x16x32_bf16 a[60:63], v[240:243], v[172:175], a[60:63]
    s_waitcnt lgkmcnt(4)
    v_exp_f32 v146, v146
    v_mfma_f32_16x16x32_bf16 a[80:83], v[228:231], v[172:175], a[80:83]
    ds_read_b64_tr_b16 v[240:241], v20 offset:768
    ds_read_b64_tr_b16 v[242:243], v20 offset:4864
    v_mfma_f32_16x16x32_bf16 a[84:87], v[228:231], v[176:179], a[84:87]
    v_exp_f32 v147, v147
    v_mfma_f32_16x16x32_bf16 a[88:91], v[228:231], v[180:183], a[88:91]
    v_add_u32 v19, 32768, v19
    v_cvt_pk_bf16_f32 v166, v144, v145
    v_mfma_f32_16x16x32_bf16 a[92:95], v[228:231], v[184:187], a[92:95]
    v_add_u32 v20, 32768, v20
    v_cvt_pk_bf16_f32 v167, v146, v147
    v_mfma_f32_16x16x32_bf16 a[96:99], v[228:231], v[188:191], a[96:99]
    s_waitcnt vmcnt(7) lgkmcnt(0)
    s_barrier
    v_mfma_f32_16x16x32_bf16 a[116:119], v[232:235], v[188:191], a[116:119]
    ds_read_b64 a[184:185], v17
    ds_read_b64 a[186:187], v18
    v_mfma_f32_16x16x32_bf16 a[112:115], v[232:235], v[184:187], a[112:115]
    v_exp_f32 v148, v148
    v_mfma_f32_16x16x32_bf16 a[108:111], v[232:235], v[180:183], a[108:111]
    v_exp_f32 v149, v149
    v_mfma_f32_16x16x32_bf16 a[104:107], v[232:235], v[176:179], a[104:107]
    ds_read_b64 a[188:189], v17 offset:256
    ds_read_b64 a[190:191], v18 offset:256
    v_mfma_f32_16x16x32_bf16 a[100:103], v[232:235], v[172:175], a[100:103]
    buffer_load_dwordx4 v15, s[12:15], s100 offen offset:2048 nt lds
    v_cvt_pk_bf16_f32 v170, v148, v149
    v_mfma_f32_16x16x32_bf16 a[120:123], v[236:239], v[172:175], a[120:123]
    v_exp_f32 v150, v150
    v_mfma_f32_16x16x32_bf16 a[124:127], v[236:239], v[176:179], a[124:127]
    ds_read_b64 a[192:193], v17 offset:512
    ds_read_b64 a[194:195], v18 offset:512
    v_mfma_f32_16x16x32_bf16 a[128:131], v[236:239], v[180:183], a[128:131]
    v_exp_f32 v151, v151
    v_mfma_f32_16x16x32_bf16 a[132:135], v[236:239], v[184:187], a[132:135]
    v_cvt_pk_bf16_f32 v171, v150, v151
    v_mfma_f32_16x16x32_bf16 a[136:139], v[236:239], v[188:191], a[136:139]
    ds_read_b64 a[196:197], v17 offset:768
    ds_read_b64 a[198:199], v18 offset:768
    v_mfma_f32_16x16x32_bf16 a[156:159], v[240:243], v[188:191], a[156:159]
    v_mfma_f32_16x16x32_bf16 a[152:155], v[240:243], v[184:187], a[152:155]
    v_mfma_f32_16x16x32_bf16 a[148:151], v[240:243], v[180:183], a[148:151]
    v_mfma_f32_16x16x32_bf16 a[144:147], v[240:243], v[176:179], a[144:147]
    v_mfma_f32_16x16x32_bf16 a[140:143], v[240:243], v[172:175], a[140:143]
    s_waitcnt lgkmcnt(6)
    buffer_load_dwordx4 v16, s[12:15], s100 offen offset:3072 nt lds
    v_mfma_f32_16x16x32_bf16 v[112:115], a[184:187], v[32:35], v[192:195]
    s_waitcnt lgkmcnt(4)
    ds_read_b64 a[200:201], v17 offset:4096
    ds_read_b64 a[202:203], v18 offset:4096
    v_mfma_f32_16x16x32_bf16 v[112:115], a[188:191], v[36:39], v[112:115]
    s_waitcnt lgkmcnt(4)
    v_mfma_f32_16x16x32_bf16 v[112:115], a[192:195], v[40:43], v[112:115]
    s_waitcnt lgkmcnt(2)
    v_mfma_f32_16x16x32_bf16 v[112:115], a[196:199], v[44:47], v[112:115]
    v_mfma_f32_16x16x32_bf16 v[116:119], a[196:199], v[60:63], v[196:199]
    ds_read_b64 a[204:205], v17 offset:4352
    ds_read_b64 a[206:207], v18 offset:4352
    v_mfma_f32_16x16x32_bf16 v[116:119], a[192:195], v[56:59], v[116:119]
    v_mfma_f32_16x16x32_bf16 v[116:119], a[188:191], v[52:55], v[116:119]
    v_mfma_f32_16x16x32_bf16 v[116:119], a[184:187], v[48:51], v[116:119]
    s_nop 1
    v_exp_f32 v112, v112
    v_mfma_f32_16x16x32_bf16 v[120:123], a[184:187], v[64:67], v[200:203]
    ds_read_b64 a[208:209], v17 offset:4608
    ds_read_b64 a[210:211], v18 offset:4608
    v_mfma_f32_16x16x32_bf16 v[120:123], a[188:191], v[68:71], v[120:123]
    s_add_u32 m0, s32, 49152
    v_exp_f32 v113, v113
    v_mfma_f32_16x16x32_bf16 v[120:123], a[192:195], v[72:75], v[120:123]
    s_mov_b32 s100, 114688
    v_exp_f32 v114, v114
    v_mfma_f32_16x16x32_bf16 v[120:123], a[196:199], v[76:79], v[120:123]
    buffer_load_dwordx4 v13, s[16:19], s100 offen nt lds
    v_cvt_pk_bf16_f32 v172, v112, v113
    v_mfma_f32_16x16x32_bf16 v[124:127], a[196:199], v[92:95], v[204:207]
    ds_read_b64 a[212:213], v17 offset:4864
    ds_read_b64 a[214:215], v18 offset:4864
    v_mfma_f32_16x16x32_bf16 v[124:127], a[192:195], v[88:91], v[124:127]
    v_exp_f32 v115, v115
    v_mfma_f32_16x16x32_bf16 v[124:127], a[188:191], v[84:87], v[124:127]
    v_cvt_pk_bf16_f32 v173, v114, v115
    v_mfma_f32_16x16x32_bf16 v[124:127], a[184:187], v[80:83], v[124:127]
    v_exp_f32 v116, v116
    v_mfma_f32_16x16x32_bf16 v[128:131], a[184:187], v[96:99], v[208:211]
    v_exp_f32 v117, v117
    v_mfma_f32_16x16x32_bf16 v[128:131], a[188:191], v[100:103], v[128:131]
    v_exp_f32 v118, v118
    v_mfma_f32_16x16x32_bf16 v[128:131], a[192:195], v[104:107], v[128:131]
    v_exp_f32 v119, v119
    v_mfma_f32_16x16x32_bf16 v[128:131], a[196:199], v[108:111], v[128:131]
    s_waitcnt lgkmcnt(6)
    v_cvt_pk_bf16_f32 v176, v116, v117
    v_cvt_pk_bf16_f32 v177, v118, v119
    v_mfma_f32_16x16x32_bf16 v[132:135], a[200:203], v[32:35], v[192:195]
    s_waitcnt lgkmcnt(4)
    v_exp_f32 v120, v120
    v_mfma_f32_16x16x32_bf16 v[132:135], a[204:207], v[36:39], v[132:135]
    s_waitcnt lgkmcnt(2)
    v_exp_f32 v121, v121
    v_mfma_f32_16x16x32_bf16 v[132:135], a[208:211], v[40:43], v[132:135]
    s_waitcnt lgkmcnt(0)
    v_add_u32 v17, 32768, v17
    v_cvt_pk_bf16_f32 v180, v120, v121
    v_mfma_f32_16x16x32_bf16 v[132:135], a[212:215], v[44:47], v[132:135]
    v_add_u32 v18, 32768, v18
    buffer_load_dwordx4 v15, s[16:19], s100 offen offset:1024 nt lds
    v_mfma_f32_16x16x32_bf16 v[136:139], a[212:215], v[60:63], v[196:199]
    v_exp_f32 v122, v122
    v_mfma_f32_16x16x32_bf16 v[136:139], a[208:211], v[56:59], v[136:139]
    v_exp_f32 v123, v123
    v_mfma_f32_16x16x32_bf16 v[136:139], a[204:207], v[52:55], v[136:139]
    v_cvt_pk_bf16_f32 v181, v122, v123
    v_mfma_f32_16x16x32_bf16 v[136:139], a[200:203], v[48:51], v[136:139]
    v_exp_f32 v124, v124
    v_mfma_f32_16x16x32_bf16 v[140:143], a[200:203], v[64:67], v[200:203]
    v_exp_f32 v125, v125
    v_mfma_f32_16x16x32_bf16 v[140:143], a[204:207], v[68:71], v[140:143]
    v_exp_f32 v126, v126
    v_mfma_f32_16x16x32_bf16 v[140:143], a[208:211], v[72:75], v[140:143]
    ds_read_b64_tr_b16 v[228:229], v19
    ds_read_b64_tr_b16 v[230:231], v19 offset:4096
    v_mfma_f32_16x16x32_bf16 v[140:143], a[212:215], v[76:79], v[140:143]
    v_exp_f32 v127, v127
    v_mfma_f32_16x16x32_bf16 v[144:147], a[212:215], v[92:95], v[204:207]
    v_cvt_pk_bf16_f32 v184, v124, v125
    v_cvt_pk_bf16_f32 v185, v126, v127
    v_mfma_f32_16x16x32_bf16 v[144:147], a[208:211], v[88:91], v[144:147]
    v_exp_f32 v128, v128
    v_mfma_f32_16x16x32_bf16 v[144:147], a[204:207], v[84:87], v[144:147]
    buffer_load_dwordx4 v13, s[16:19], s100 offen offset:2048 nt lds
    v_mfma_f32_16x16x32_bf16 v[144:147], a[200:203], v[80:83], v[144:147]
    ds_read_b64_tr_b16 v[232:233], v20
    ds_read_b64_tr_b16 v[234:235], v20 offset:4096
    v_mfma_f32_16x16x32_bf16 v[148:151], a[200:203], v[96:99], v[208:211]
    v_exp_f32 v129, v129
    v_mfma_f32_16x16x32_bf16 v[148:151], a[204:207], v[100:103], v[148:151]
    v_exp_f32 v130, v130
    v_mfma_f32_16x16x32_bf16 v[148:151], a[208:211], v[104:107], v[148:151]
    v_exp_f32 v131, v131
    v_mfma_f32_16x16x32_bf16 v[148:151], a[212:215], v[108:111], v[148:151]
    v_cvt_pk_bf16_f32 v188, v128, v129
    v_cvt_pk_bf16_f32 v189, v130, v131
    v_mfma_f32_16x16x32_bf16 a[160:163], a[180:183], v[152:155], a[160:163]
    ds_read_b64_tr_b16 v[236:237], v19 offset:256
    ds_read_b64_tr_b16 v[238:239], v19 offset:4352
    v_mfma_f32_16x16x32_bf16 a[164:167], a[180:183], v[156:159], a[164:167]
    v_exp_f32 v132, v132
    v_mfma_f32_16x16x32_bf16 a[168:171], a[180:183], v[160:163], a[168:171]
    v_exp_f32 v133, v133
    v_mfma_f32_16x16x32_bf16 a[172:175], a[180:183], v[164:167], a[172:175]
    v_exp_f32 v134, v134
    v_mfma_f32_16x16x32_bf16 a[176:179], a[180:183], v[168:171], a[176:179]
    s_waitcnt lgkmcnt(4)
    v_exp_f32 v135, v135
    v_mfma_f32_16x16x32_bf16 a[0:3], v[228:231], v[152:155], a[0:3]
    ds_read_b64_tr_b16 v[240:241], v20 offset:256
    ds_read_b64_tr_b16 v[242:243], v20 offset:4352
    v_mfma_f32_16x16x32_bf16 a[4:7], v[228:231], v[156:159], a[4:7]
    buffer_load_dwordx4 v15, s[16:19], s100 offen offset:3072 nt lds
    v_cvt_pk_bf16_f32 v174, v132, v133
    v_mfma_f32_16x16x32_bf16 a[8:11], v[228:231], v[160:163], a[8:11]
    v_cvt_pk_bf16_f32 v175, v134, v135
    v_mfma_f32_16x16x32_bf16 a[12:15], v[228:231], v[164:167], a[12:15]
    v_exp_f32 v136, v136
    v_mfma_f32_16x16x32_bf16 a[16:19], v[228:231], v[168:171], a[16:19]
    s_waitcnt lgkmcnt(4)
    v_exp_f32 v137, v137
    v_mfma_f32_16x16x32_bf16 a[36:39], v[232:235], v[168:171], a[36:39]
    ds_read_b64_tr_b16 v[228:229], v19 offset:512
    ds_read_b64_tr_b16 v[230:231], v19 offset:4608
    v_mfma_f32_16x16x32_bf16 a[32:35], v[232:235], v[164:167], a[32:35]
    v_exp_f32 v138, v138
    v_mfma_f32_16x16x32_bf16 a[28:31], v[232:235], v[160:163], a[28:31]
    v_exp_f32 v139, v139
    v_mfma_f32_16x16x32_bf16 a[24:27], v[232:235], v[156:159], a[24:27]
    v_cvt_pk_bf16_f32 v178, v136, v137
    v_cvt_pk_bf16_f32 v179, v138, v139
    v_mfma_f32_16x16x32_bf16 a[20:23], v[232:235], v[152:155], a[20:23]
    s_waitcnt lgkmcnt(4)
    v_exp_f32 v140, v140
    v_mfma_f32_16x16x32_bf16 a[40:43], v[236:239], v[152:155], a[40:43]
    ds_read_b64_tr_b16 v[232:233], v20 offset:512
    ds_read_b64_tr_b16 v[234:235], v20 offset:4608
    v_mfma_f32_16x16x32_bf16 a[44:47], v[236:239], v[156:159], a[44:47]
    s_add_u32 m0, s32, 65536
    v_exp_f32 v141, v141
    v_mfma_f32_16x16x32_bf16 a[48:51], v[236:239], v[160:163], a[48:51]
    s_mov_b32 s100, 122880
    v_exp_f32 v142, v142
    v_mfma_f32_16x16x32_bf16 a[52:55], v[236:239], v[164:167], a[52:55]
    buffer_load_dwordx4 v13, s[12:15], s100 offen nt lds
    v_cvt_pk_bf16_f32 v182, v140, v141
    v_mfma_f32_16x16x32_bf16 a[56:59], v[236:239], v[168:171], a[56:59]
    s_waitcnt lgkmcnt(4)
    v_exp_f32 v143, v143
    v_mfma_f32_16x16x32_bf16 a[76:79], v[240:243], v[168:171], a[76:79]
    ds_read_b64_tr_b16 v[236:237], v19 offset:768
    ds_read_b64_tr_b16 v[238:239], v19 offset:4864
    v_mfma_f32_16x16x32_bf16 a[72:75], v[240:243], v[164:167], a[72:75]
    v_cvt_pk_bf16_f32 v183, v142, v143
    v_mfma_f32_16x16x32_bf16 a[68:71], v[240:243], v[160:163], a[68:71]
    v_exp_f32 v144, v144
    v_mfma_f32_16x16x32_bf16 a[64:67], v[240:243], v[156:159], a[64:67]
    v_exp_f32 v145, v145
    v_mfma_f32_16x16x32_bf16 a[60:63], v[240:243], v[152:155], a[60:63]
    s_waitcnt lgkmcnt(4)
    v_exp_f32 v146, v146
    v_mfma_f32_16x16x32_bf16 a[80:83], v[228:231], v[152:155], a[80:83]
    ds_read_b64_tr_b16 v[240:241], v20 offset:768
    ds_read_b64_tr_b16 v[242:243], v20 offset:4864
    v_mfma_f32_16x16x32_bf16 a[84:87], v[228:231], v[156:159], a[84:87]
    v_exp_f32 v147, v147
    v_mfma_f32_16x16x32_bf16 a[88:91], v[228:231], v[160:163], a[88:91]
    v_subrev_u32 v19, 131072, v19
    v_cvt_pk_bf16_f32 v186, v144, v145
    v_mfma_f32_16x16x32_bf16 a[92:95], v[228:231], v[164:167], a[92:95]
    v_subrev_u32 v20, 131072, v20
    v_cvt_pk_bf16_f32 v187, v146, v147
    v_mfma_f32_16x16x32_bf16 a[96:99], v[228:231], v[168:171], a[96:99]
    s_waitcnt vmcnt(5) lgkmcnt(0)
    s_barrier
    buffer_load_dwordx4 v14, s[12:15], s100 offen offset:1024 nt lds
    v_mfma_f32_16x16x32_bf16 a[116:119], v[232:235], v[168:171], a[116:119]
    ds_read_b64 a[184:185], v17
    ds_read_b64 a[186:187], v18
    v_mfma_f32_16x16x32_bf16 a[112:115], v[232:235], v[164:167], a[112:115]
    v_exp_f32 v148, v148
    v_mfma_f32_16x16x32_bf16 a[108:111], v[232:235], v[160:163], a[108:111]
    v_exp_f32 v149, v149
    v_mfma_f32_16x16x32_bf16 a[104:107], v[232:235], v[156:159], a[104:107]
    ds_read_b64 a[188:189], v17 offset:256
    ds_read_b64 a[190:191], v18 offset:256
    v_mfma_f32_16x16x32_bf16 a[100:103], v[232:235], v[152:155], a[100:103]
    v_exp_f32 v150, v150
    v_mfma_f32_16x16x32_bf16 a[120:123], v[236:239], v[152:155], a[120:123]
    v_exp_f32 v151, v151
    v_mfma_f32_16x16x32_bf16 a[124:127], v[236:239], v[156:159], a[124:127]
    ds_read_b64 a[192:193], v17 offset:512
    ds_read_b64 a[194:195], v18 offset:512
    v_mfma_f32_16x16x32_bf16 a[128:131], v[236:239], v[160:163], a[128:131]
    v_cvt_pk_bf16_f32 v190, v148, v149
    v_cvt_pk_bf16_f32 v191, v150, v151
    v_mfma_f32_16x16x32_bf16 a[132:135], v[236:239], v[164:167], a[132:135]
    v_mfma_f32_16x16x32_bf16 a[136:139], v[236:239], v[168:171], a[136:139]
    ds_read_b64 a[196:197], v17 offset:768
    ds_read_b64 a[198:199], v18 offset:768
    v_mfma_f32_16x16x32_bf16 a[156:159], v[240:243], v[168:171], a[156:159]
    v_mfma_f32_16x16x32_bf16 a[152:155], v[240:243], v[164:167], a[152:155]
    buffer_load_dwordx4 v15, s[12:15], s100 offen offset:2048 nt lds
    v_mfma_f32_16x16x32_bf16 a[148:151], v[240:243], v[160:163], a[148:151]
    v_mfma_f32_16x16x32_bf16 a[144:147], v[240:243], v[156:159], a[144:147]
    v_mfma_f32_16x16x32_bf16 a[140:143], v[240:243], v[152:155], a[140:143]
    s_waitcnt lgkmcnt(6)
    v_mfma_f32_16x16x32_bf16 v[112:115], a[184:187], v[32:35], v[192:195]
    s_waitcnt lgkmcnt(4)
    ds_read_b64 a[200:201], v17 offset:4096
    ds_read_b64 a[202:203], v18 offset:4096
    v_mfma_f32_16x16x32_bf16 v[112:115], a[188:191], v[36:39], v[112:115]
    s_waitcnt lgkmcnt(4)
    v_mfma_f32_16x16x32_bf16 v[112:115], a[192:195], v[40:43], v[112:115]
    s_waitcnt lgkmcnt(2)
    v_and_b32 v24, 15, v24
    v_mfma_f32_16x16x32_bf16 v[112:115], a[196:199], v[44:47], v[112:115]
    v_cmp_eq_u32 s[54:55], s66, v24
    v_mfma_f32_16x16x32_bf16 v[116:119], a[196:199], v[60:63], v[196:199]
    ds_read_b64 a[204:205], v17 offset:4352
    ds_read_b64 a[206:207], v18 offset:4352
    v_mfma_f32_16x16x32_bf16 v[116:119], a[192:195], v[56:59], v[116:119]
    v_mfma_f32_16x16x32_bf16 v[116:119], a[188:191], v[52:55], v[116:119]
    v_mfma_f32_16x16x32_bf16 v[116:119], a[184:187], v[48:51], v[116:119]
    s_nop 0
    v_exp_f32 v112, v112
    v_mfma_f32_16x16x32_bf16 v[120:123], a[184:187], v[64:67], v[200:203]
    ds_read_b64 a[208:209], v17 offset:4608
    ds_read_b64 a[210:211], v18 offset:4608
    v_mfma_f32_16x16x32_bf16 v[120:123], a[188:191], v[68:71], v[120:123]
    buffer_load_dwordx4 v16, s[12:15], s100 offen offset:3072 nt lds
    v_mfma_f32_16x16x32_bf16 v[120:123], a[192:195], v[72:75], v[120:123]
    v_exp_f32 v113, v113
    v_mfma_f32_16x16x32_bf16 v[120:123], a[196:199], v[76:79], v[120:123]
    v_exp_f32 v114, v114
    v_mfma_f32_16x16x32_bf16 v[124:127], a[196:199], v[92:95], v[204:207]
    ds_read_b64 a[212:213], v17 offset:4864
    ds_read_b64 a[214:215], v18 offset:4864
    v_mfma_f32_16x16x32_bf16 v[124:127], a[192:195], v[88:91], v[124:127]
    v_exp_f32 v115, v115
    v_mfma_f32_16x16x32_bf16 v[124:127], a[188:191], v[84:87], v[124:127]
    v_cvt_pk_bf16_f32 v152, v112, v113
    v_cvt_pk_bf16_f32 v153, v114, v115
    v_mfma_f32_16x16x32_bf16 v[124:127], a[184:187], v[80:83], v[124:127]
    v_exp_f32 v116, v116
    v_mfma_f32_16x16x32_bf16 v[128:131], a[184:187], v[96:99], v[208:211]
    v_exp_f32 v117, v117
    v_mfma_f32_16x16x32_bf16 v[128:131], a[188:191], v[100:103], v[128:131]
    s_add_u32 m0, s32, 81920
    v_exp_f32 v118, v118
    v_mfma_f32_16x16x32_bf16 v[128:131], a[192:195], v[104:107], v[128:131]
    s_mov_b32 s100, 122880
    v_exp_f32 v119, v119
    v_mfma_f32_16x16x32_bf16 v[128:131], a[196:199], v[108:111], v[128:131]
    s_waitcnt lgkmcnt(6)
    buffer_load_dwordx4 v13, s[16:19], s100 offen nt lds
    v_cvt_pk_bf16_f32 v156, v116, v117
    v_mfma_f32_16x16x32_bf16 v[132:135], a[200:203], v[32:35], v[192:195]
    s_waitcnt lgkmcnt(4)
    v_cvt_pk_bf16_f32 v157, v118, v119
    v_mfma_f32_16x16x32_bf16 v[132:135], a[204:207], v[36:39], v[132:135]
    s_waitcnt lgkmcnt(2)
    v_exp_f32 v120, v120
    v_mfma_f32_16x16x32_bf16 v[132:135], a[208:211], v[40:43], v[132:135]
    s_waitcnt lgkmcnt(0)
    v_add_u32 v17, 32768, v17
    v_mfma_f32_16x16x32_bf16 v[132:135], a[212:215], v[44:47], v[132:135]
    v_add_u32 v18, 32768, v18
    v_mfma_f32_16x16x32_bf16 v[136:139], a[212:215], v[60:63], v[196:199]
    v_exp_f32 v121, v121
    v_mfma_f32_16x16x32_bf16 v[136:139], a[208:211], v[56:59], v[136:139]
    v_exp_f32 v122, v122
    v_mfma_f32_16x16x32_bf16 v[136:139], a[204:207], v[52:55], v[136:139]
    v_exp_f32 v123, v123
    v_mfma_f32_16x16x32_bf16 v[136:139], a[200:203], v[48:51], v[136:139]
    v_cvt_pk_bf16_f32 v160, v120, v121
    v_cvt_pk_bf16_f32 v161, v122, v123
    v_mfma_f32_16x16x32_bf16 v[140:143], a[200:203], v[64:67], v[200:203]
    v_exp_f32 v124, v124
    v_mfma_f32_16x16x32_bf16 v[140:143], a[204:207], v[68:71], v[140:143]
    v_exp_f32 v125, v125
    v_mfma_f32_16x16x32_bf16 v[140:143], a[208:211], v[72:75], v[140:143]
    ds_read_b64_tr_b16 v[228:229], v19
    ds_read_b64_tr_b16 v[230:231], v19 offset:4096
    v_mfma_f32_16x16x32_bf16 v[140:143], a[212:215], v[76:79], v[140:143]
    buffer_load_dwordx4 v15, s[16:19], s100 offen offset:1024 nt lds
    v_cvt_pk_bf16_f32 v164, v124, v125
    v_mfma_f32_16x16x32_bf16 v[144:147], a[212:215], v[92:95], v[204:207]
    v_exp_f32 v126, v126
    v_mfma_f32_16x16x32_bf16 v[144:147], a[208:211], v[88:91], v[144:147]
    v_exp_f32 v127, v127
    v_mfma_f32_16x16x32_bf16 v[144:147], a[204:207], v[84:87], v[144:147]
    v_cvt_pk_bf16_f32 v165, v126, v127
    v_mfma_f32_16x16x32_bf16 v[144:147], a[200:203], v[80:83], v[144:147]
    ds_read_b64_tr_b16 v[232:233], v20
    ds_read_b64_tr_b16 v[234:235], v20 offset:4096
    v_mfma_f32_16x16x32_bf16 v[148:151], a[200:203], v[96:99], v[208:211]
    v_exp_f32 v128, v128
    v_mfma_f32_16x16x32_bf16 v[148:151], a[204:207], v[100:103], v[148:151]
    v_exp_f32 v129, v129
    v_mfma_f32_16x16x32_bf16 v[148:151], a[208:211], v[104:107], v[148:151]
    v_exp_f32 v130, v130
    v_mfma_f32_16x16x32_bf16 v[148:151], a[212:215], v[108:111], v[148:151]
    v_exp_f32 v131, v131
    v_mfma_f32_16x16x32_bf16 a[160:163], a[180:183], v[172:175], a[160:163]
    ds_read_b64_tr_b16 v[236:237], v19 offset:256
    ds_read_b64_tr_b16 v[238:239], v19 offset:4352
    v_mfma_f32_16x16x32_bf16 a[164:167], a[180:183], v[176:179], a[164:167]
    v_cvt_pk_bf16_f32 v168, v128, v129
    v_cvt_pk_bf16_f32 v169, v130, v131
    v_mfma_f32_16x16x32_bf16 a[168:171], a[180:183], v[180:183], a[168:171]
    v_exp_f32 v132, v132
    v_mfma_f32_16x16x32_bf16 a[172:175], a[180:183], v[184:187], a[172:175]
    buffer_load_dwordx4 v13, s[16:19], s100 offen offset:2048 nt lds
    v_mfma_f32_16x16x32_bf16 a[176:179], a[180:183], v[188:191], a[176:179]
    s_waitcnt lgkmcnt(4)
    v_exp_f32 v133, v133
    v_mfma_f32_16x16x32_bf16 a[0:3], v[228:231], v[172:175], a[0:3]
    ds_read_b64_tr_b16 v[240:241], v20 offset:256
    ds_read_b64_tr_b16 v[242:243], v20 offset:4352
    v_mfma_f32_16x16x32_bf16 a[4:7], v[228:231], v[176:179], a[4:7]
    v_exp_f32 v134, v134
    v_mfma_f32_16x16x32_bf16 a[8:11], v[228:231], v[180:183], a[8:11]
    v_exp_f32 v135, v135
    v_mfma_f32_16x16x32_bf16 a[12:15], v[228:231], v[184:187], a[12:15]
    v_cvt_pk_bf16_f32 v154, v132, v133
    v_cvt_pk_bf16_f32 v155, v134, v135
    v_mfma_f32_16x16x32_bf16 a[16:19], v[228:231], v[188:191], a[16:19]
    s_waitcnt lgkmcnt(4)
    v_exp_f32 v136, v136
    v_mfma_f32_16x16x32_bf16 a[36:39], v[232:235], v[188:191], a[36:39]
    ds_read_b64_tr_b16 v[228:229], v19 offset:512
    ds_read_b64_tr_b16 v[230:231], v19 offset:4608
    v_mfma_f32_16x16x32_bf16 a[32:35], v[232:235], v[184:187], a[32:35]
    v_exp_f32 v137, v137
    v_mfma_f32_16x16x32_bf16 a[28:31], v[232:235], v[180:183], a[28:31]
    v_exp_f32 v138, v138
    v_mfma_f32_16x16x32_bf16 a[24:27], v[232:235], v[176:179], a[24:27]
    v_exp_f32 v139, v139
    v_mfma_f32_16x16x32_bf16 a[20:23], v[232:235], v[172:175], a[20:23]
    s_waitcnt lgkmcnt(4)
    v_cvt_pk_bf16_f32 v158, v136, v137
    v_cvt_pk_bf16_f32 v159, v138, v139
    v_mfma_f32_16x16x32_bf16 a[40:43], v[236:239], v[172:175], a[40:43]
    ds_read_b64_tr_b16 v[232:233], v20 offset:512
    ds_read_b64_tr_b16 v[234:235], v20 offset:4608
    v_mfma_f32_16x16x32_bf16 a[44:47], v[236:239], v[176:179], a[44:47]
    buffer_load_dwordx4 v15, s[16:19], s100 offen offset:3072 nt lds
    v_mfma_f32_16x16x32_bf16 a[48:51], v[236:239], v[180:183], a[48:51]
    v_exp_f32 v140, v140
    v_mfma_f32_16x16x32_bf16 a[52:55], v[236:239], v[184:187], a[52:55]
    v_exp_f32 v141, v141
    v_mfma_f32_16x16x32_bf16 a[56:59], v[236:239], v[188:191], a[56:59]
    s_waitcnt lgkmcnt(4)
    s_add_u32 s28, s25, 0
    s_and_b32 s28, s28, 7
    v_exp_f32 v142, v142
    v_mfma_f32_16x16x32_bf16 a[76:79], v[240:243], v[188:191], a[76:79]
    s_lshl_b32 s28, s28, 1
    s_add_u32 s28, s28, s31
    ds_read_b64_tr_b16 v[236:237], v19 offset:768
    ds_read_b64_tr_b16 v[238:239], v19 offset:4864
    v_mfma_f32_16x16x32_bf16 a[72:75], v[240:243], v[184:187], a[72:75]
    s_lshl_b32 s27, s28, 16
    s_add_u32 m0, s32, 98304
    v_exp_f32 v143, v143
    v_mfma_f32_16x16x32_bf16 a[68:71], v[240:243], v[180:183], a[68:71]
    buffer_load_dwordx4 v1, s[8:11], s27 offen lds
    v_cvt_pk_bf16_f32 v162, v140, v141
    v_mfma_f32_16x16x32_bf16 a[64:67], v[240:243], v[176:179], a[64:67]
    v_cvt_pk_bf16_f32 v163, v142, v143
    v_mfma_f32_16x16x32_bf16 a[60:63], v[240:243], v[172:175], a[60:63]
    s_waitcnt lgkmcnt(4)
    v_exp_f32 v144, v144
    v_mfma_f32_16x16x32_bf16 a[80:83], v[228:231], v[172:175], a[80:83]
    ds_read_b64_tr_b16 v[240:241], v20 offset:768
    ds_read_b64_tr_b16 v[242:243], v20 offset:4864
    v_mfma_f32_16x16x32_bf16 a[84:87], v[228:231], v[176:179], a[84:87]
    v_exp_f32 v145, v145
    v_mfma_f32_16x16x32_bf16 a[88:91], v[228:231], v[180:183], a[88:91]
    v_add_u32 v19, 32768, v19
    v_cvt_pk_bf16_f32 v166, v144, v145
    v_mfma_f32_16x16x32_bf16 a[92:95], v[228:231], v[184:187], a[92:95]
    v_add_u32 v20, 32768, v20
    v_mfma_f32_16x16x32_bf16 a[96:99], v[228:231], v[188:191], a[96:99]
    s_waitcnt vmcnt(5) lgkmcnt(0)
    s_barrier
    v_mfma_f32_16x16x32_bf16 a[116:119], v[232:235], v[188:191], a[116:119]
    ds_read_b64 a[184:185], v17
    ds_read_b64 a[186:187], v18
    v_mfma_f32_16x16x32_bf16 a[112:115], v[232:235], v[184:187], a[112:115]
    buffer_load_dwordx4 v2, s[8:11], s27 offen offset:1024 lds
    v_mfma_f32_16x16x32_bf16 a[108:111], v[232:235], v[180:183], a[108:111]
    v_exp_f32 v146, v146
    v_mfma_f32_16x16x32_bf16 a[104:107], v[232:235], v[176:179], a[104:107]
    ds_read_b64 a[188:189], v17 offset:256
    ds_read_b64 a[190:191], v18 offset:256
    v_mfma_f32_16x16x32_bf16 a[100:103], v[232:235], v[172:175], a[100:103]
    v_exp_f32 v147, v147
    v_mfma_f32_16x16x32_bf16 a[120:123], v[236:239], v[172:175], a[120:123]
    v_cvt_pk_bf16_f32 v167, v146, v147
    v_mfma_f32_16x16x32_bf16 a[124:127], v[236:239], v[176:179], a[124:127]
    ds_read_b64 a[192:193], v17 offset:512
    ds_read_b64 a[194:195], v18 offset:512
    v_mfma_f32_16x16x32_bf16 a[128:131], v[236:239], v[180:183], a[128:131]
    v_exp_f32 v148, v148
    v_mfma_f32_16x16x32_bf16 a[132:135], v[236:239], v[184:187], a[132:135]
    v_exp_f32 v149, v149
    v_mfma_f32_16x16x32_bf16 a[136:139], v[236:239], v[188:191], a[136:139]
    ds_read_b64 a[196:197], v17 offset:768
    ds_read_b64 a[198:199], v18 offset:768
    v_mfma_f32_16x16x32_bf16 a[156:159], v[240:243], v[188:191], a[156:159]
    buffer_load_dwordx4 v3, s[8:11], s27 offen offset:2048 lds
    v_cvt_pk_bf16_f32 v170, v148, v149
    v_mfma_f32_16x16x32_bf16 a[152:155], v[240:243], v[184:187], a[152:155]
    v_exp_f32 v150, v150
    v_mfma_f32_16x16x32_bf16 a[148:151], v[240:243], v[180:183], a[148:151]
    v_exp_f32 v151, v151
    v_mfma_f32_16x16x32_bf16 a[144:147], v[240:243], v[176:179], a[144:147]
    v_cvt_pk_bf16_f32 v171, v150, v151
    v_mfma_f32_16x16x32_bf16 a[140:143], v[240:243], v[172:175], a[140:143]
    s_waitcnt lgkmcnt(6)
    v_mfma_f32_16x16x32_bf16 v[112:115], a[184:187], v[32:35], v[192:195]
    s_waitcnt lgkmcnt(4)
    ds_read_b64 a[200:201], v17 offset:4096
    ds_read_b64 a[202:203], v18 offset:4096
    v_mfma_f32_16x16x32_bf16 v[112:115], a[188:191], v[36:39], v[112:115]
    s_waitcnt lgkmcnt(4)
    v_mfma_f32_16x16x32_bf16 v[112:115], a[192:195], v[40:43], v[112:115]
    s_waitcnt lgkmcnt(2)
    v_mfma_f32_16x16x32_bf16 v[112:115], a[196:199], v[44:47], v[112:115]
    buffer_load_dwordx4 v4, s[8:11], s27 offen offset:3072 lds
    v_mfma_f32_16x16x32_bf16 v[116:119], a[196:199], v[60:63], v[196:199]
    ds_read_b64 a[204:205], v17 offset:4352
    ds_read_b64 a[206:207], v18 offset:4352
    v_mfma_f32_16x16x32_bf16 v[116:119], a[192:195], v[56:59], v[116:119]
    v_mfma_f32_16x16x32_bf16 v[116:119], a[188:191], v[52:55], v[116:119]
    v_mfma_f32_16x16x32_bf16 v[116:119], a[184:187], v[48:51], v[116:119]
    s_nop 0
    v_exp_f32 v112, v112
    v_mfma_f32_16x16x32_bf16 v[120:123], a[184:187], v[64:67], v[200:203]
    s_add_u32 s28, s25, 1
    s_and_b32 s28, s28, 7
    ds_read_b64 a[208:209], v17 offset:4608
    ds_read_b64 a[210:211], v18 offset:4608
    v_mfma_f32_16x16x32_bf16 v[120:123], a[188:191], v[68:71], v[120:123]
    s_lshl_b32 s28, s28, 1
    s_add_u32 s28, s28, s31
    v_exp_f32 v113, v113
    v_mfma_f32_16x16x32_bf16 v[120:123], a[192:195], v[72:75], v[120:123]
    s_lshl_b32 s27, s28, 16
    s_add_u32 m0, s32, 114688
    v_exp_f32 v114, v114
    v_mfma_f32_16x16x32_bf16 v[120:123], a[196:199], v[76:79], v[120:123]
    buffer_load_dwordx4 v1, s[8:11], s27 offen lds
    v_cvt_pk_bf16_f32 v172, v112, v113
    v_mfma_f32_16x16x32_bf16 v[124:127], a[196:199], v[92:95], v[204:207]
    ds_read_b64 a[212:213], v17 offset:4864
    ds_read_b64 a[214:215], v18 offset:4864
    v_mfma_f32_16x16x32_bf16 v[124:127], a[192:195], v[88:91], v[124:127]
    v_exp_f32 v116, v116
    v_mfma_f32_16x16x32_bf16 v[124:127], a[188:191], v[84:87], v[124:127]
    v_exp_f32 v117, v117
    v_mfma_f32_16x16x32_bf16 v[124:127], a[184:187], v[80:83], v[124:127]
    v_exp_f32 v120, v120
    v_mfma_f32_16x16x32_bf16 v[128:131], a[184:187], v[96:99], v[208:211]
    v_exp_f32 v115, v115
    v_mfma_f32_16x16x32_bf16 v[128:131], a[188:191], v[100:103], v[128:131]
    v_exp_f32 v118, v118
    v_mfma_f32_16x16x32_bf16 v[128:131], a[192:195], v[104:107], v[128:131]
    v_exp_f32 v121, v121
    v_mfma_f32_16x16x32_bf16 v[128:131], a[196:199], v[108:111], v[128:131]
    s_waitcnt lgkmcnt(6)
    buffer_load_dwordx4 v2, s[8:11], s27 offen offset:1024 lds
    v_cvt_pk_bf16_f32 v173, v114, v115
    v_mfma_f32_16x16x32_bf16 v[132:135], a[200:203], v[32:35], v[192:195]
    s_waitcnt lgkmcnt(4)
    v_exp_f32 v124, v124
    v_mfma_f32_16x16x32_bf16 v[132:135], a[204:207], v[36:39], v[132:135]
    s_waitcnt lgkmcnt(2)
    v_exp_f32 v119, v119
    v_mfma_f32_16x16x32_bf16 v[132:135], a[208:211], v[40:43], v[132:135]
    s_waitcnt lgkmcnt(0)
    v_exp_f32 v122, v122
    v_mfma_f32_16x16x32_bf16 v[132:135], a[212:215], v[44:47], v[132:135]
    v_exp_f32 v125, v125
    v_mfma_f32_16x16x32_bf16 v[136:139], a[212:215], v[60:63], v[196:199]
    v_exp_f32 v128, v128
    v_mfma_f32_16x16x32_bf16 v[136:139], a[208:211], v[56:59], v[136:139]
    v_cvt_pk_bf16_f32 v176, v116, v117
    v_cvt_pk_bf16_f32 v177, v118, v119
    v_mfma_f32_16x16x32_bf16 v[136:139], a[204:207], v[52:55], v[136:139]
    v_exp_f32 v123, v123
    v_mfma_f32_16x16x32_bf16 v[136:139], a[200:203], v[48:51], v[136:139]
    buffer_load_dwordx4 v3, s[8:11], s27 offen offset:2048 lds
    v_cvt_pk_bf16_f32 v180, v120, v121
    v_mfma_f32_16x16x32_bf16 v[140:143], a[200:203], v[64:67], v[200:203]
    v_exp_f32 v132, v132
    v_mfma_f32_16x16x32_bf16 v[140:143], a[204:207], v[68:71], v[140:143]
    v_exp_f32 v133, v133
    v_mfma_f32_16x16x32_bf16 v[140:143], a[208:211], v[72:75], v[140:143]
    ds_read_b64_tr_b16 v[228:229], v19
    ds_read_b64_tr_b16 v[230:231], v19 offset:4096
    v_mfma_f32_16x16x32_bf16 v[140:143], a[212:215], v[76:79], v[140:143]
    v_exp_f32 v136, v136
    v_mfma_f32_16x16x32_bf16 v[144:147], a[212:215], v[92:95], v[204:207]
    v_exp_f32 v134, v134
    v_mfma_f32_16x16x32_bf16 v[144:147], a[208:211], v[88:91], v[144:147]
    v_exp_f32 v137, v137
    v_mfma_f32_16x16x32_bf16 v[144:147], a[204:207], v[84:87], v[144:147]
    v_exp_f32 v135, v135
    v_mfma_f32_16x16x32_bf16 v[144:147], a[200:203], v[80:83], v[144:147]
    ds_read_b64_tr_b16 v[232:233], v20
    ds_read_b64_tr_b16 v[234:235], v20 offset:4096
    v_mfma_f32_16x16x32_bf16 v[148:151], a[200:203], v[96:99], v[208:211]
    buffer_load_dwordx4 v4, s[8:11], s27 offen offset:3072 lds
    v_cvt_pk_bf16_f32 v174, v132, v133
    v_mfma_f32_16x16x32_bf16 v[148:151], a[204:207], v[100:103], v[148:151]
    v_exp_f32 v140, v140
    v_mfma_f32_16x16x32_bf16 v[148:151], a[208:211], v[104:107], v[148:151]
    v_exp_f32 v138, v138
    v_mfma_f32_16x16x32_bf16 v[148:151], a[212:215], v[108:111], v[148:151]
    v_exp_f32 v141, v141
    v_mfma_f32_16x16x32_bf16 a[160:163], a[180:183], v[152:155], a[160:163]
    ds_read_b64_tr_b16 v[236:237], v19 offset:256
    ds_read_b64_tr_b16 v[238:239], v19 offset:4352
    v_mfma_f32_16x16x32_bf16 a[164:167], a[180:183], v[156:159], a[164:167]
    s_add_u32 s28, s25, 2
    s_and_b32 s28, s28, 7
    v_exp_f32 v144, v144
    v_mfma_f32_16x16x32_bf16 a[168:171], a[180:183], v[160:163], a[168:171]
    s_lshl_b32 s28, s28, 1
    s_add_u32 s28, s28, s31
    v_cvt_pk_bf16_f32 v175, v134, v135
    v_cvt_pk_bf16_f32 v178, v136, v137
    v_mfma_f32_16x16x32_bf16 a[172:175], a[180:183], v[164:167], a[172:175]
    s_lshl_b32 s27, s28, 16
    s_add_u32 m0, s32, 131072
    v_exp_f32 v139, v139
    v_mfma_f32_16x16x32_bf16 a[176:179], a[180:183], v[168:171], a[176:179]
    s_waitcnt lgkmcnt(4)
    buffer_load_dwordx4 v1, s[8:11], s27 offen lds
    v_cvt_pk_bf16_f32 v179, v138, v139
    v_mfma_f32_16x16x32_bf16 a[0:3], v[228:231], v[152:155], a[0:3]
    ds_read_b64_tr_b16 v[240:241], v20 offset:256
    ds_read_b64_tr_b16 v[242:243], v20 offset:4352
    v_mfma_f32_16x16x32_bf16 a[4:7], v[228:231], v[156:159], a[4:7]
    v_exp_f32 v142, v142
    v_mfma_f32_16x16x32_bf16 a[8:11], v[228:231], v[160:163], a[8:11]
    v_exp_f32 v145, v145
    v_mfma_f32_16x16x32_bf16 a[12:15], v[228:231], v[164:167], a[12:15]
    v_exp_f32 v148, v148
    v_mfma_f32_16x16x32_bf16 a[16:19], v[228:231], v[168:171], a[16:19]
    s_waitcnt lgkmcnt(4)
    v_exp_f32 v126, v126
    v_mfma_f32_16x16x32_bf16 a[36:39], v[232:235], v[168:171], a[36:39]
    ds_read_b64_tr_b16 v[228:229], v19 offset:512
    ds_read_b64_tr_b16 v[230:231], v19 offset:4608
    v_mfma_f32_16x16x32_bf16 a[32:35], v[232:235], v[164:167], a[32:35]
    v_exp_f32 v129, v129
    v_mfma_f32_16x16x32_bf16 a[28:31], v[232:235], v[160:163], a[28:31]
    buffer_load_dwordx4 v2, s[8:11], s27 offen offset:1024 lds
    v_cvt_pk_bf16_f32 v181, v122, v123
    v_mfma_f32_16x16x32_bf16 a[24:27], v[232:235], v[156:159], a[24:27]
    v_exp_f32 v143, v143
    v_mfma_f32_16x16x32_bf16 a[20:23], v[232:235], v[152:155], a[20:23]
    s_waitcnt lgkmcnt(4)
    v_exp_f32 v146, v146
    v_mfma_f32_16x16x32_bf16 a[40:43], v[236:239], v[152:155], a[40:43]
    ds_read_b64_tr_b16 v[232:233], v20 offset:512
    ds_read_b64_tr_b16 v[234:235], v20 offset:4608
    v_mfma_f32_16x16x32_bf16 a[44:47], v[236:239], v[156:159], a[44:47]
    v_exp_f32 v149, v149
    v_mfma_f32_16x16x32_bf16 a[48:51], v[236:239], v[160:163], a[48:51]
    v_exp_f32 v127, v127
    v_mfma_f32_16x16x32_bf16 a[52:55], v[236:239], v[164:167], a[52:55]
    v_exp_f32 v130, v130
    v_mfma_f32_16x16x32_bf16 a[56:59], v[236:239], v[168:171], a[56:59]
    s_waitcnt lgkmcnt(4)
    v_cvt_pk_bf16_f32 v182, v140, v141
    v_cvt_pk_bf16_f32 v183, v142, v143
    v_mfma_f32_16x16x32_bf16 a[76:79], v[240:243], v[168:171], a[76:79]
    ds_read_b64_tr_b16 v[236:237], v19 offset:768
    ds_read_b64_tr_b16 v[238:239], v19 offset:4864
    v_mfma_f32_16x16x32_bf16 a[72:75], v[240:243], v[164:167], a[72:75]
    buffer_load_dwordx4 v3, s[8:11], s27 offen offset:2048 lds
    v_cvt_pk_bf16_f32 v184, v124, v125
    v_mfma_f32_16x16x32_bf16 a[68:71], v[240:243], v[160:163], a[68:71]
    v_exp_f32 v147, v147
    v_mfma_f32_16x16x32_bf16 a[64:67], v[240:243], v[156:159], a[64:67]
    v_exp_f32 v150, v150
    v_mfma_f32_16x16x32_bf16 a[60:63], v[240:243], v[152:155], a[60:63]
    s_waitcnt lgkmcnt(4)
    v_cvt_pk_bf16_f32 v185, v126, v127
    v_cvt_pk_bf16_f32 v186, v144, v145
    v_mfma_f32_16x16x32_bf16 a[80:83], v[228:231], v[152:155], a[80:83]
    ds_read_b64_tr_b16 v[240:241], v20 offset:768
    ds_read_b64_tr_b16 v[242:243], v20 offset:4864
    v_mfma_f32_16x16x32_bf16 a[84:87], v[228:231], v[156:159], a[84:87]
    v_exp_f32 v131, v131
    v_mfma_f32_16x16x32_bf16 a[88:91], v[228:231], v[160:163], a[88:91]
    v_add_u32 v19, 32768, v19
    v_cvt_pk_bf16_f32 v187, v146, v147
    v_mfma_f32_16x16x32_bf16 a[92:95], v[228:231], v[164:167], a[92:95]
    v_add_u32 v20, 32768, v20
    v_cvt_pk_bf16_f32 v188, v128, v129
    v_mfma_f32_16x16x32_bf16 a[96:99], v[228:231], v[168:171], a[96:99]
    s_waitcnt vmcnt(11) lgkmcnt(0)
    s_barrier
    buffer_load_dwordx4 v4, s[8:11], s27 offen offset:3072 lds
    v_mfma_f32_16x16x32_bf16 a[116:119], v[232:235], v[168:171], a[116:119]
    v_exp_f32 v151, v151
    v_mfma_f32_16x16x32_bf16 a[112:115], v[232:235], v[164:167], a[112:115]
    v_cvt_pk_bf16_f32 v189, v130, v131
    v_cvt_pk_bf16_f32 v190, v148, v149
    v_mfma_f32_16x16x32_bf16 a[108:111], v[232:235], v[160:163], a[108:111]
    v_cvt_pk_bf16_f32 v191, v150, v151
    v_mfma_f32_16x16x32_bf16 a[104:107], v[232:235], v[156:159], a[104:107]
    v_mfma_f32_16x16x32_bf16 a[100:103], v[232:235], v[152:155], a[100:103]
    s_add_u32 s28, s25, 3
    s_and_b32 s28, s28, 7
    v_mfma_f32_16x16x32_bf16 a[120:123], v[236:239], v[152:155], a[120:123]
    s_lshl_b32 s28, s28, 1
    s_add_u32 s28, s28, s31
    ds_read_b64_tr_b16 v[228:229], v19
    ds_read_b64_tr_b16 v[230:231], v19 offset:4096
    v_mfma_f32_16x16x32_bf16 a[124:127], v[236:239], v[156:159], a[124:127]
    s_lshl_b32 s27, s28, 16
    s_add_u32 m0, s32, 147456
    v_mfma_f32_16x16x32_bf16 a[128:131], v[236:239], v[160:163], a[128:131]
    buffer_load_dwordx4 v1, s[8:11], s27 offen lds
    v_mfma_f32_16x16x32_bf16 a[132:135], v[236:239], v[164:167], a[132:135]
    v_mfma_f32_16x16x32_bf16 a[136:139], v[236:239], v[168:171], a[136:139]
    v_mfma_f32_16x16x32_bf16 a[156:159], v[240:243], v[168:171], a[156:159]
    ds_read_b64_tr_b16 v[232:233], v20
    ds_read_b64_tr_b16 v[234:235], v20 offset:4096
    v_mfma_f32_16x16x32_bf16 a[152:155], v[240:243], v[164:167], a[152:155]
    v_mfma_f32_16x16x32_bf16 a[148:151], v[240:243], v[160:163], a[148:151]
    v_mfma_f32_16x16x32_bf16 a[144:147], v[240:243], v[156:159], a[144:147]
    v_mfma_f32_16x16x32_bf16 a[140:143], v[240:243], v[152:155], a[140:143]
    v_mfma_f32_16x16x32_bf16 a[160:163], a[180:183], v[172:175], a[160:163]
    ds_read_b64_tr_b16 v[236:237], v19 offset:256
    ds_read_b64_tr_b16 v[238:239], v19 offset:4352
    v_mfma_f32_16x16x32_bf16 a[164:167], a[180:183], v[176:179], a[164:167]
    buffer_load_dwordx4 v2, s[8:11], s27 offen offset:1024 lds
    v_mfma_f32_16x16x32_bf16 a[168:171], a[180:183], v[180:183], a[168:171]
    v_mfma_f32_16x16x32_bf16 a[172:175], a[180:183], v[184:187], a[172:175]
    v_mfma_f32_16x16x32_bf16 a[176:179], a[180:183], v[188:191], a[176:179]
    s_waitcnt lgkmcnt(4)
    v_mfma_f32_16x16x32_bf16 a[0:3], v[228:231], v[172:175], a[0:3]
    ds_read_b64_tr_b16 v[240:241], v20 offset:256
    ds_read_b64_tr_b16 v[242:243], v20 offset:4352
    v_mfma_f32_16x16x32_bf16 a[4:7], v[228:231], v[176:179], a[4:7]
    v_mfma_f32_16x16x32_bf16 a[8:11], v[228:231], v[180:183], a[8:11]
    v_mfma_f32_16x16x32_bf16 a[12:15], v[228:231], v[184:187], a[12:15]
    v_mfma_f32_16x16x32_bf16 a[16:19], v[228:231], v[188:191], a[16:19]
    s_waitcnt lgkmcnt(4)
    buffer_load_dwordx4 v3, s[8:11], s27 offen offset:2048 lds
    v_mfma_f32_16x16x32_bf16 a[36:39], v[232:235], v[188:191], a[36:39]
    ds_read_b64_tr_b16 v[228:229], v19 offset:512
    ds_read_b64_tr_b16 v[230:231], v19 offset:4608
    v_mfma_f32_16x16x32_bf16 a[32:35], v[232:235], v[184:187], a[32:35]
    v_mfma_f32_16x16x32_bf16 a[28:31], v[232:235], v[180:183], a[28:31]
    v_mfma_f32_16x16x32_bf16 a[24:27], v[232:235], v[176:179], a[24:27]
    v_mfma_f32_16x16x32_bf16 a[20:23], v[232:235], v[172:175], a[20:23]
    s_waitcnt lgkmcnt(4)
    v_mfma_f32_16x16x32_bf16 a[40:43], v[236:239], v[172:175], a[40:43]
    ds_read_b64_tr_b16 v[232:233], v20 offset:512
    ds_read_b64_tr_b16 v[234:235], v20 offset:4608
    v_mfma_f32_16x16x32_bf16 a[44:47], v[236:239], v[176:179], a[44:47]
    v_mfma_f32_16x16x32_bf16 a[48:51], v[236:239], v[180:183], a[48:51]
    buffer_load_dwordx4 v4, s[8:11], s27 offen offset:3072 lds
    v_mfma_f32_16x16x32_bf16 a[52:55], v[236:239], v[184:187], a[52:55]
    v_mfma_f32_16x16x32_bf16 a[56:59], v[236:239], v[188:191], a[56:59]
    s_waitcnt lgkmcnt(4)
    v_mfma_f32_16x16x32_bf16 a[76:79], v[240:243], v[188:191], a[76:79]
    ds_read_b64_tr_b16 v[236:237], v19 offset:768
    ds_read_b64_tr_b16 v[238:239], v19 offset:4864
    v_mfma_f32_16x16x32_bf16 a[72:75], v[240:243], v[184:187], a[72:75]
    v_mfma_f32_16x16x32_bf16 a[68:71], v[240:243], v[180:183], a[68:71]
    v_mfma_f32_16x16x32_bf16 a[64:67], v[240:243], v[176:179], a[64:67]
    v_mfma_f32_16x16x32_bf16 a[60:63], v[240:243], v[172:175], a[60:63]
    s_waitcnt lgkmcnt(4)
    v_mfma_f32_16x16x32_bf16 a[80:83], v[228:231], v[172:175], a[80:83]
    ds_read_b64_tr_b16 v[240:241], v20 offset:768
    ds_read_b64_tr_b16 v[242:243], v20 offset:4864
    v_mfma_f32_16x16x32_bf16 a[84:87], v[228:231], v[176:179], a[84:87]
    v_mfma_f32_16x16x32_bf16 a[88:91], v[228:231], v[180:183], a[88:91]
    v_mfma_f32_16x16x32_bf16 a[92:95], v[228:231], v[184:187], a[92:95]
    v_mfma_f32_16x16x32_bf16 a[96:99], v[228:231], v[188:191], a[96:99]
    s_waitcnt lgkmcnt(4)
    v_mfma_f32_16x16x32_bf16 a[116:119], v[232:235], v[188:191], a[116:119]
    v_mfma_f32_16x16x32_bf16 a[112:115], v[232:235], v[184:187], a[112:115]
    v_mfma_f32_16x16x32_bf16 a[108:111], v[232:235], v[180:183], a[108:111]
    v_mfma_f32_16x16x32_bf16 a[104:107], v[232:235], v[176:179], a[104:107]
    v_mfma_f32_16x16x32_bf16 a[100:103], v[232:235], v[172:175], a[100:103]
    s_waitcnt lgkmcnt(2)
    v_mfma_f32_16x16x32_bf16 a[120:123], v[236:239], v[172:175], a[120:123]
    v_mfma_f32_16x16x32_bf16 a[124:127], v[236:239], v[176:179], a[124:127]
    v_mfma_f32_16x16x32_bf16 a[128:131], v[236:239], v[180:183], a[128:131]
    v_mfma_f32_16x16x32_bf16 a[132:135], v[236:239], v[184:187], a[132:135]
    v_mfma_f32_16x16x32_bf16 a[136:139], v[236:239], v[188:191], a[136:139]
    s_waitcnt lgkmcnt(0)
    v_mfma_f32_16x16x32_bf16 a[156:159], v[240:243], v[188:191], a[156:159]
    v_mfma_f32_16x16x32_bf16 a[152:155], v[240:243], v[184:187], a[152:155]
    v_mfma_f32_16x16x32_bf16 a[148:151], v[240:243], v[180:183], a[148:151]
    v_mfma_f32_16x16x32_bf16 a[144:147], v[240:243], v[176:179], a[144:147]
    v_mfma_f32_16x16x32_bf16 a[140:143], v[240:243], v[172:175], a[140:143]
L_out:
    s_barrier
    s_load_dword s59, s[94:95], 0
    v_accvgpr_read_b32 v244, a160
    v_accvgpr_read_b32 v246, a164
    v_accvgpr_read_b32 v248, a168
    v_accvgpr_read_b32 v250, a172
    v_accvgpr_read_b32 v252, a176
    v_add_f32 v245, v244, v246
    v_add_f32 v247, v248, v250
    v_add_f32 v245, v245, v252
    v_add_f32 v245, v245, v247
    v_cmp_nge_f32 vcc, 0x4b800000, v245
    s_nop 4
    s_cbranch_vccnz L_exact
L_checked:
    s_cmp_eq_u64 s[54:55], -1
    s_cbranch_scc0 L_remote
    v_rcp_f32 v244, v244
    v_rcp_f32 v246, v246
    v_rcp_f32 v248, v248
    v_rcp_f32 v250, v250
    v_rcp_f32 v252, v252
    s_add_u32 s29, s33, 0
    v_accvgpr_read_b32 v112, a0
    v_accvgpr_read_b32 v113, a1
    v_accvgpr_read_b32 v114, a2
    v_accvgpr_read_b32 v115, a3
    v_accvgpr_read_b32 v116, a20
    v_accvgpr_read_b32 v117, a21
    v_accvgpr_read_b32 v118, a22
    v_accvgpr_read_b32 v119, a23
    v_pk_mul_f32 v[112:113], v[112:113], v[244:245] op_sel_hi:[1,0]
    v_pk_mul_f32 v[114:115], v[114:115], v[244:245] op_sel_hi:[1,0]
    v_pk_mul_f32 v[116:117], v[116:117], v[244:245] op_sel_hi:[1,0]
    v_pk_mul_f32 v[118:119], v[118:119], v[244:245] op_sel_hi:[1,0]
    v_cvt_pk_bf16_f32 v120, v112, v113
    v_cvt_pk_bf16_f32 v121, v114, v115
    v_cvt_pk_bf16_f32 v122, v116, v117
    v_cvt_pk_bf16_f32 v123, v118, v119
    buffer_store_dwordx4 v[120:123], v21, s[20:23], s29 offen
    v_accvgpr_read_b32 v124, a4
    v_accvgpr_read_b32 v125, a5
    v_accvgpr_read_b32 v126, a6
    v_accvgpr_read_b32 v127, a7
    v_accvgpr_read_b32 v128, a24
    v_accvgpr_read_b32 v129, a25
    v_accvgpr_read_b32 v130, a26
    v_accvgpr_read_b32 v131, a27
    v_pk_mul_f32 v[124:125], v[124:125], v[246:247] op_sel_hi:[1,0]
    v_pk_mul_f32 v[126:127], v[126:127], v[246:247] op_sel_hi:[1,0]
    v_pk_mul_f32 v[128:129], v[128:129], v[246:247] op_sel_hi:[1,0]
    v_pk_mul_f32 v[130:131], v[130:131], v[246:247] op_sel_hi:[1,0]
    v_cvt_pk_bf16_f32 v132, v124, v125
    v_cvt_pk_bf16_f32 v133, v126, v127
    v_cvt_pk_bf16_f32 v134, v128, v129
    v_cvt_pk_bf16_f32 v135, v130, v131
    buffer_store_dwordx4 v[132:135], v21, s[20:23], s29 offen offset:1024
    v_accvgpr_read_b32 v136, a8
    v_accvgpr_read_b32 v137, a9
    v_accvgpr_read_b32 v138, a10
    v_accvgpr_read_b32 v139, a11
    v_accvgpr_read_b32 v140, a28
    v_accvgpr_read_b32 v141, a29
    v_accvgpr_read_b32 v142, a30
    v_accvgpr_read_b32 v143, a31
    v_pk_mul_f32 v[136:137], v[136:137], v[248:249] op_sel_hi:[1,0]
    v_pk_mul_f32 v[138:139], v[138:139], v[248:249] op_sel_hi:[1,0]
    v_pk_mul_f32 v[140:141], v[140:141], v[248:249] op_sel_hi:[1,0]
    v_pk_mul_f32 v[142:143], v[142:143], v[248:249] op_sel_hi:[1,0]
    v_cvt_pk_bf16_f32 v144, v136, v137
    v_cvt_pk_bf16_f32 v145, v138, v139
    v_cvt_pk_bf16_f32 v146, v140, v141
    v_cvt_pk_bf16_f32 v147, v142, v143
    buffer_store_dwordx4 v[144:147], v21, s[20:23], s29 offen offset:2048
    v_accvgpr_read_b32 v148, a12
    v_accvgpr_read_b32 v149, a13
    v_accvgpr_read_b32 v150, a14
    v_accvgpr_read_b32 v151, a15
    v_accvgpr_read_b32 v152, a32
    v_accvgpr_read_b32 v153, a33
    v_accvgpr_read_b32 v154, a34
    v_accvgpr_read_b32 v155, a35
    v_pk_mul_f32 v[148:149], v[148:149], v[250:251] op_sel_hi:[1,0]
    v_pk_mul_f32 v[150:151], v[150:151], v[250:251] op_sel_hi:[1,0]
    v_pk_mul_f32 v[152:153], v[152:153], v[250:251] op_sel_hi:[1,0]
    v_pk_mul_f32 v[154:155], v[154:155], v[250:251] op_sel_hi:[1,0]
    v_cvt_pk_bf16_f32 v156, v148, v149
    v_cvt_pk_bf16_f32 v157, v150, v151
    v_cvt_pk_bf16_f32 v158, v152, v153
    v_cvt_pk_bf16_f32 v159, v154, v155
    buffer_store_dwordx4 v[156:159], v21, s[20:23], s29 offen offset:3072
    v_accvgpr_read_b32 v160, a16
    v_accvgpr_read_b32 v161, a17
    v_accvgpr_read_b32 v162, a18
    v_accvgpr_read_b32 v163, a19
    v_accvgpr_read_b32 v164, a36
    v_accvgpr_read_b32 v165, a37
    v_accvgpr_read_b32 v166, a38
    v_accvgpr_read_b32 v167, a39
    v_pk_mul_f32 v[160:161], v[160:161], v[252:253] op_sel_hi:[1,0]
    v_pk_mul_f32 v[162:163], v[162:163], v[252:253] op_sel_hi:[1,0]
    v_pk_mul_f32 v[164:165], v[164:165], v[252:253] op_sel_hi:[1,0]
    v_pk_mul_f32 v[166:167], v[166:167], v[252:253] op_sel_hi:[1,0]
    v_cvt_pk_bf16_f32 v168, v160, v161
    v_cvt_pk_bf16_f32 v169, v162, v163
    v_cvt_pk_bf16_f32 v170, v164, v165
    v_cvt_pk_bf16_f32 v171, v166, v167
    s_add_u32 s100, s29, 4096
    buffer_store_dwordx4 v[168:171], v21, s[20:23], s100 offen
    s_add_u32 s29, s33, 10240
    v_accvgpr_read_b32 v172, a40
    v_accvgpr_read_b32 v173, a41
    v_accvgpr_read_b32 v174, a42
    v_accvgpr_read_b32 v175, a43
    v_accvgpr_read_b32 v176, a60
    v_accvgpr_read_b32 v177, a61
    v_accvgpr_read_b32 v178, a62
    v_accvgpr_read_b32 v179, a63
    v_pk_mul_f32 v[172:173], v[172:173], v[244:245] op_sel_hi:[1,0]
    v_pk_mul_f32 v[174:175], v[174:175], v[244:245] op_sel_hi:[1,0]
    v_pk_mul_f32 v[176:177], v[176:177], v[244:245] op_sel_hi:[1,0]
    v_pk_mul_f32 v[178:179], v[178:179], v[244:245] op_sel_hi:[1,0]
    v_cvt_pk_bf16_f32 v180, v172, v173
    v_cvt_pk_bf16_f32 v181, v174, v175
    v_cvt_pk_bf16_f32 v182, v176, v177
    v_cvt_pk_bf16_f32 v183, v178, v179
    buffer_store_dwordx4 v[180:183], v21, s[20:23], s29 offen
    v_accvgpr_read_b32 v184, a44
    v_accvgpr_read_b32 v185, a45
    v_accvgpr_read_b32 v186, a46
    v_accvgpr_read_b32 v187, a47
    v_accvgpr_read_b32 v188, a64
    v_accvgpr_read_b32 v189, a65
    v_accvgpr_read_b32 v190, a66
    v_accvgpr_read_b32 v191, a67
    v_pk_mul_f32 v[184:185], v[184:185], v[246:247] op_sel_hi:[1,0]
    v_pk_mul_f32 v[186:187], v[186:187], v[246:247] op_sel_hi:[1,0]
    v_pk_mul_f32 v[188:189], v[188:189], v[246:247] op_sel_hi:[1,0]
    v_pk_mul_f32 v[190:191], v[190:191], v[246:247] op_sel_hi:[1,0]
    v_cvt_pk_bf16_f32 v192, v184, v185
    v_cvt_pk_bf16_f32 v193, v186, v187
    v_cvt_pk_bf16_f32 v194, v188, v189
    v_cvt_pk_bf16_f32 v195, v190, v191
    buffer_store_dwordx4 v[192:195], v21, s[20:23], s29 offen offset:1024
    v_accvgpr_read_b32 v196, a48
    v_accvgpr_read_b32 v197, a49
    v_accvgpr_read_b32 v198, a50
    v_accvgpr_read_b32 v199, a51
    v_accvgpr_read_b32 v200, a68
    v_accvgpr_read_b32 v201, a69
    v_accvgpr_read_b32 v202, a70
    v_accvgpr_read_b32 v203, a71
    v_pk_mul_f32 v[196:197], v[196:197], v[248:249] op_sel_hi:[1,0]
    v_pk_mul_f32 v[198:199], v[198:199], v[248:249] op_sel_hi:[1,0]
    v_pk_mul_f32 v[200:201], v[200:201], v[248:249] op_sel_hi:[1,0]
    v_pk_mul_f32 v[202:203], v[202:203], v[248:249] op_sel_hi:[1,0]
    v_cvt_pk_bf16_f32 v204, v196, v197
    v_cvt_pk_bf16_f32 v205, v198, v199
    v_cvt_pk_bf16_f32 v206, v200, v201
    v_cvt_pk_bf16_f32 v207, v202, v203
    buffer_store_dwordx4 v[204:207], v21, s[20:23], s29 offen offset:2048
    v_accvgpr_read_b32 v112, a52
    v_accvgpr_read_b32 v113, a53
    v_accvgpr_read_b32 v114, a54
    v_accvgpr_read_b32 v115, a55
    v_accvgpr_read_b32 v116, a72
    v_accvgpr_read_b32 v117, a73
    v_accvgpr_read_b32 v118, a74
    v_accvgpr_read_b32 v119, a75
    v_pk_mul_f32 v[112:113], v[112:113], v[250:251] op_sel_hi:[1,0]
    v_pk_mul_f32 v[114:115], v[114:115], v[250:251] op_sel_hi:[1,0]
    v_pk_mul_f32 v[116:117], v[116:117], v[250:251] op_sel_hi:[1,0]
    v_pk_mul_f32 v[118:119], v[118:119], v[250:251] op_sel_hi:[1,0]
    v_cvt_pk_bf16_f32 v120, v112, v113
    v_cvt_pk_bf16_f32 v121, v114, v115
    v_cvt_pk_bf16_f32 v122, v116, v117
    v_cvt_pk_bf16_f32 v123, v118, v119
    buffer_store_dwordx4 v[120:123], v21, s[20:23], s29 offen offset:3072
    v_accvgpr_read_b32 v124, a56
    v_accvgpr_read_b32 v125, a57
    v_accvgpr_read_b32 v126, a58
    v_accvgpr_read_b32 v127, a59
    v_accvgpr_read_b32 v128, a76
    v_accvgpr_read_b32 v129, a77
    v_accvgpr_read_b32 v130, a78
    v_accvgpr_read_b32 v131, a79
    v_pk_mul_f32 v[124:125], v[124:125], v[252:253] op_sel_hi:[1,0]
    v_pk_mul_f32 v[126:127], v[126:127], v[252:253] op_sel_hi:[1,0]
    v_pk_mul_f32 v[128:129], v[128:129], v[252:253] op_sel_hi:[1,0]
    v_pk_mul_f32 v[130:131], v[130:131], v[252:253] op_sel_hi:[1,0]
    v_cvt_pk_bf16_f32 v132, v124, v125
    v_cvt_pk_bf16_f32 v133, v126, v127
    v_cvt_pk_bf16_f32 v134, v128, v129
    v_cvt_pk_bf16_f32 v135, v130, v131
    s_add_u32 s100, s29, 4096
    buffer_store_dwordx4 v[132:135], v21, s[20:23], s100 offen
    s_add_u32 s29, s33, 20480
    v_accvgpr_read_b32 v136, a80
    v_accvgpr_read_b32 v137, a81
    v_accvgpr_read_b32 v138, a82
    v_accvgpr_read_b32 v139, a83
    v_accvgpr_read_b32 v140, a100
    v_accvgpr_read_b32 v141, a101
    v_accvgpr_read_b32 v142, a102
    v_accvgpr_read_b32 v143, a103
    v_pk_mul_f32 v[136:137], v[136:137], v[244:245] op_sel_hi:[1,0]
    v_pk_mul_f32 v[138:139], v[138:139], v[244:245] op_sel_hi:[1,0]
    v_pk_mul_f32 v[140:141], v[140:141], v[244:245] op_sel_hi:[1,0]
    v_pk_mul_f32 v[142:143], v[142:143], v[244:245] op_sel_hi:[1,0]
    v_cvt_pk_bf16_f32 v144, v136, v137
    v_cvt_pk_bf16_f32 v145, v138, v139
    v_cvt_pk_bf16_f32 v146, v140, v141
    v_cvt_pk_bf16_f32 v147, v142, v143
    buffer_store_dwordx4 v[144:147], v21, s[20:23], s29 offen
    v_accvgpr_read_b32 v148, a84
    v_accvgpr_read_b32 v149, a85
    v_accvgpr_read_b32 v150, a86
    v_accvgpr_read_b32 v151, a87
    v_accvgpr_read_b32 v152, a104
    v_accvgpr_read_b32 v153, a105
    v_accvgpr_read_b32 v154, a106
    v_accvgpr_read_b32 v155, a107
    v_pk_mul_f32 v[148:149], v[148:149], v[246:247] op_sel_hi:[1,0]
    v_pk_mul_f32 v[150:151], v[150:151], v[246:247] op_sel_hi:[1,0]
    v_pk_mul_f32 v[152:153], v[152:153], v[246:247] op_sel_hi:[1,0]
    v_pk_mul_f32 v[154:155], v[154:155], v[246:247] op_sel_hi:[1,0]
    v_cvt_pk_bf16_f32 v156, v148, v149
    v_cvt_pk_bf16_f32 v157, v150, v151
    v_cvt_pk_bf16_f32 v158, v152, v153
    v_cvt_pk_bf16_f32 v159, v154, v155
    buffer_store_dwordx4 v[156:159], v21, s[20:23], s29 offen offset:1024
    v_accvgpr_read_b32 v160, a88
    v_accvgpr_read_b32 v161, a89
    v_accvgpr_read_b32 v162, a90
    v_accvgpr_read_b32 v163, a91
    v_accvgpr_read_b32 v164, a108
    v_accvgpr_read_b32 v165, a109
    v_accvgpr_read_b32 v166, a110
    v_accvgpr_read_b32 v167, a111
    v_pk_mul_f32 v[160:161], v[160:161], v[248:249] op_sel_hi:[1,0]
    v_pk_mul_f32 v[162:163], v[162:163], v[248:249] op_sel_hi:[1,0]
    v_pk_mul_f32 v[164:165], v[164:165], v[248:249] op_sel_hi:[1,0]
    v_pk_mul_f32 v[166:167], v[166:167], v[248:249] op_sel_hi:[1,0]
    v_cvt_pk_bf16_f32 v168, v160, v161
    v_cvt_pk_bf16_f32 v169, v162, v163
    v_cvt_pk_bf16_f32 v170, v164, v165
    v_cvt_pk_bf16_f32 v171, v166, v167
    buffer_store_dwordx4 v[168:171], v21, s[20:23], s29 offen offset:2048
    v_accvgpr_read_b32 v172, a92
    v_accvgpr_read_b32 v173, a93
    v_accvgpr_read_b32 v174, a94
    v_accvgpr_read_b32 v175, a95
    v_accvgpr_read_b32 v176, a112
    v_accvgpr_read_b32 v177, a113
    v_accvgpr_read_b32 v178, a114
    v_accvgpr_read_b32 v179, a115
    v_pk_mul_f32 v[172:173], v[172:173], v[250:251] op_sel_hi:[1,0]
    v_pk_mul_f32 v[174:175], v[174:175], v[250:251] op_sel_hi:[1,0]
    v_pk_mul_f32 v[176:177], v[176:177], v[250:251] op_sel_hi:[1,0]
    v_pk_mul_f32 v[178:179], v[178:179], v[250:251] op_sel_hi:[1,0]
    v_cvt_pk_bf16_f32 v180, v172, v173
    v_cvt_pk_bf16_f32 v181, v174, v175
    v_cvt_pk_bf16_f32 v182, v176, v177
    v_cvt_pk_bf16_f32 v183, v178, v179
    buffer_store_dwordx4 v[180:183], v21, s[20:23], s29 offen offset:3072
    v_accvgpr_read_b32 v184, a96
    v_accvgpr_read_b32 v185, a97
    v_accvgpr_read_b32 v186, a98
    v_accvgpr_read_b32 v187, a99
    v_accvgpr_read_b32 v188, a116
    v_accvgpr_read_b32 v189, a117
    v_accvgpr_read_b32 v190, a118
    v_accvgpr_read_b32 v191, a119
    v_pk_mul_f32 v[184:185], v[184:185], v[252:253] op_sel_hi:[1,0]
    v_pk_mul_f32 v[186:187], v[186:187], v[252:253] op_sel_hi:[1,0]
    v_pk_mul_f32 v[188:189], v[188:189], v[252:253] op_sel_hi:[1,0]
    v_pk_mul_f32 v[190:191], v[190:191], v[252:253] op_sel_hi:[1,0]
    v_cvt_pk_bf16_f32 v192, v184, v185
    v_cvt_pk_bf16_f32 v193, v186, v187
    v_cvt_pk_bf16_f32 v194, v188, v189
    v_cvt_pk_bf16_f32 v195, v190, v191
    s_add_u32 s100, s29, 4096
    buffer_store_dwordx4 v[192:195], v21, s[20:23], s100 offen
    s_add_u32 s29, s33, 30720
    v_accvgpr_read_b32 v196, a120
    v_accvgpr_read_b32 v197, a121
    v_accvgpr_read_b32 v198, a122
    v_accvgpr_read_b32 v199, a123
    v_accvgpr_read_b32 v200, a140
    v_accvgpr_read_b32 v201, a141
    v_accvgpr_read_b32 v202, a142
    v_accvgpr_read_b32 v203, a143
    v_pk_mul_f32 v[196:197], v[196:197], v[244:245] op_sel_hi:[1,0]
    v_pk_mul_f32 v[198:199], v[198:199], v[244:245] op_sel_hi:[1,0]
    v_pk_mul_f32 v[200:201], v[200:201], v[244:245] op_sel_hi:[1,0]
    v_pk_mul_f32 v[202:203], v[202:203], v[244:245] op_sel_hi:[1,0]
    v_cvt_pk_bf16_f32 v204, v196, v197
    v_cvt_pk_bf16_f32 v205, v198, v199
    v_cvt_pk_bf16_f32 v206, v200, v201
    v_cvt_pk_bf16_f32 v207, v202, v203
    buffer_store_dwordx4 v[204:207], v21, s[20:23], s29 offen
    v_accvgpr_read_b32 v112, a124
    v_accvgpr_read_b32 v113, a125
    v_accvgpr_read_b32 v114, a126
    v_accvgpr_read_b32 v115, a127
    v_accvgpr_read_b32 v116, a144
    v_accvgpr_read_b32 v117, a145
    v_accvgpr_read_b32 v118, a146
    v_accvgpr_read_b32 v119, a147
    v_pk_mul_f32 v[112:113], v[112:113], v[246:247] op_sel_hi:[1,0]
    v_pk_mul_f32 v[114:115], v[114:115], v[246:247] op_sel_hi:[1,0]
    v_pk_mul_f32 v[116:117], v[116:117], v[246:247] op_sel_hi:[1,0]
    v_pk_mul_f32 v[118:119], v[118:119], v[246:247] op_sel_hi:[1,0]
    v_cvt_pk_bf16_f32 v120, v112, v113
    v_cvt_pk_bf16_f32 v121, v114, v115
    v_cvt_pk_bf16_f32 v122, v116, v117
    v_cvt_pk_bf16_f32 v123, v118, v119
    buffer_store_dwordx4 v[120:123], v21, s[20:23], s29 offen offset:1024
    v_accvgpr_read_b32 v124, a128
    v_accvgpr_read_b32 v125, a129
    v_accvgpr_read_b32 v126, a130
    v_accvgpr_read_b32 v127, a131
    v_accvgpr_read_b32 v128, a148
    v_accvgpr_read_b32 v129, a149
    v_accvgpr_read_b32 v130, a150
    v_accvgpr_read_b32 v131, a151
    v_pk_mul_f32 v[124:125], v[124:125], v[248:249] op_sel_hi:[1,0]
    v_pk_mul_f32 v[126:127], v[126:127], v[248:249] op_sel_hi:[1,0]
    v_pk_mul_f32 v[128:129], v[128:129], v[248:249] op_sel_hi:[1,0]
    v_pk_mul_f32 v[130:131], v[130:131], v[248:249] op_sel_hi:[1,0]
    v_cvt_pk_bf16_f32 v132, v124, v125
    v_cvt_pk_bf16_f32 v133, v126, v127
    v_cvt_pk_bf16_f32 v134, v128, v129
    v_cvt_pk_bf16_f32 v135, v130, v131
    buffer_store_dwordx4 v[132:135], v21, s[20:23], s29 offen offset:2048
    v_accvgpr_read_b32 v136, a132
    v_accvgpr_read_b32 v137, a133
    v_accvgpr_read_b32 v138, a134
    v_accvgpr_read_b32 v139, a135
    v_accvgpr_read_b32 v140, a152
    v_accvgpr_read_b32 v141, a153
    v_accvgpr_read_b32 v142, a154
    v_accvgpr_read_b32 v143, a155
    v_pk_mul_f32 v[136:137], v[136:137], v[250:251] op_sel_hi:[1,0]
    v_pk_mul_f32 v[138:139], v[138:139], v[250:251] op_sel_hi:[1,0]
    v_pk_mul_f32 v[140:141], v[140:141], v[250:251] op_sel_hi:[1,0]
    v_pk_mul_f32 v[142:143], v[142:143], v[250:251] op_sel_hi:[1,0]
    v_cvt_pk_bf16_f32 v144, v136, v137
    v_cvt_pk_bf16_f32 v145, v138, v139
    v_cvt_pk_bf16_f32 v146, v140, v141
    v_cvt_pk_bf16_f32 v147, v142, v143
    buffer_store_dwordx4 v[144:147], v21, s[20:23], s29 offen offset:3072
    v_accvgpr_read_b32 v148, a136
    v_accvgpr_read_b32 v149, a137
    v_accvgpr_read_b32 v150, a138
    v_accvgpr_read_b32 v151, a139
    v_accvgpr_read_b32 v152, a156
    v_accvgpr_read_b32 v153, a157
    v_accvgpr_read_b32 v154, a158
    v_accvgpr_read_b32 v155, a159
    v_pk_mul_f32 v[148:149], v[148:149], v[252:253] op_sel_hi:[1,0]
    v_pk_mul_f32 v[150:151], v[150:151], v[252:253] op_sel_hi:[1,0]
    v_pk_mul_f32 v[152:153], v[152:153], v[252:253] op_sel_hi:[1,0]
    v_pk_mul_f32 v[154:155], v[154:155], v[252:253] op_sel_hi:[1,0]
    v_cvt_pk_bf16_f32 v156, v148, v149
    v_cvt_pk_bf16_f32 v157, v150, v151
    v_cvt_pk_bf16_f32 v158, v152, v153
    v_cvt_pk_bf16_f32 v159, v154, v155
    s_add_u32 s100, s29, 4096
    buffer_store_dwordx4 v[156:159], v21, s[20:23], s100 offen
    s_or_b32 s29, s66, 0x100
    v_mov_b32 v29, s29
    s_movk_i32 s29, 0xff
    s_mov_b32 s12, s50
    s_and_b32 s13, s51, 0xffff
    s_mov_b32 s14, 40960
    s_mov_b32 s15, 0x20000
    s_waitcnt vmcnt(0)
    buffer_store_dword v29, v31, s[36:39], s63 offen
L_published:
    buffer_load_dword v24, v27, s[36:39], s48 offen sc1
    s_waitcnt vmcnt(0)
    v_cmp_lt_u32 s[52:53], s29, v24
    s_nop 0
    s_cmp_eq_u64 s[52:53], -1
    s_cbranch_scc0 L_flag_slow
L_flag_ok:
    s_add_u32 s28, s25, 0
    s_and_b32 s28, s28, 7
    s_lshl_b32 s28, s28, 1
    s_add_u32 s28, s28, s31
    s_mul_i32 s26, s28, 10240
    s_add_u32 m0, s30, 0
    s_nop 0
    buffer_load_dwordx4 v5, s[20:23], s26 offen sc1 lds
    buffer_load_dwordx4 v5, s[20:23], s26 offen offset:1024 sc1 lds
    buffer_load_dwordx4 v5, s[20:23], s26 offen offset:2048 sc1 lds
    buffer_load_dwordx4 v5, s[20:23], s26 offen offset:3072 sc1 lds
    s_add_u32 m0, s30, 4096
    s_nop 0
    buffer_load_dwordx4 v6, s[20:23], s26 offen sc1 lds
    s_add_u32 s28, s25, 1
    s_and_b32 s28, s28, 7
    s_lshl_b32 s28, s28, 1
    s_add_u32 s28, s28, s31
    s_mul_i32 s26, s28, 10240
    s_add_u32 m0, s30, 20480
    s_nop 0
    buffer_load_dwordx4 v5, s[20:23], s26 offen sc1 lds
    buffer_load_dwordx4 v5, s[20:23], s26 offen offset:1024 sc1 lds
    buffer_load_dwordx4 v5, s[20:23], s26 offen offset:2048 sc1 lds
    buffer_load_dwordx4 v5, s[20:23], s26 offen offset:3072 sc1 lds
    s_add_u32 m0, s30, 24576
    s_nop 0
    buffer_load_dwordx4 v6, s[20:23], s26 offen sc1 lds
    v_add_u32 v216, 49152, v7
    v_add_u32 v217, 49152, v8
    s_waitcnt vmcnt(5)
    s_barrier
    ds_read_b128 a[0:3], v9
    ds_read_b64_tr_b16 a[80:81], v7 offset:16384
    ds_read_b64_tr_b16 a[82:83], v7 offset:20480
    ds_read_b128 a[20:23], v9 offset:10240
    ds_read_b64_tr_b16 a[84:85], v7 offset:24576
    ds_read_b64_tr_b16 a[86:87], v7 offset:28672
    ds_read_b128 a[24:27], v9 offset:11264
    ds_read_b128 a[4:7], v9 offset:1024
    ds_read_b128 a[8:11], v9 offset:2048
    ds_read_b128 a[28:31], v9 offset:12288
    ds_read_b128 a[32:35], v9 offset:13312
    ds_read_b128 a[12:15], v9 offset:3072
    s_waitcnt lgkmcnt(6)
    ds_read_b128 a[16:19], v9 offset:4096
    ds_read_b128 a[36:39], v9 offset:14336
    ds_read_b64_tr_b16 a[92:93], v8 offset:24576
    ds_read_b64_tr_b16 a[94:95], v8 offset:28672
    ds_read_b64_tr_b16 a[88:89], v8 offset:16384
    ds_read_b64_tr_b16 a[90:91], v8 offset:20480
    s_waitcnt lgkmcnt(0)
    v_mfma_f32_16x16x32_bf16 v[96:99], a[80:83], a[0:3], 0
    ds_read_b64_tr_b16 a[96:97], v7 offset:16640
    ds_read_b64_tr_b16 a[98:99], v7 offset:20736
    v_mfma_f32_16x16x32_bf16 v[96:99], a[84:87], a[20:23], v[96:99]
    ds_read_b64_tr_b16 a[100:101], v7 offset:24832
    ds_read_b64_tr_b16 a[102:103], v7 offset:28928
    v_mfma_f32_16x16x32_bf16 v[100:103], a[84:87], a[24:27], 0
    s_add_u32 s28, s25, 2
    s_and_b32 s28, s28, 7
    s_lshl_b32 s28, s28, 1
    v_mfma_f32_16x16x32_bf16 v[100:103], a[80:83], a[4:7], v[100:103]
    s_add_u32 s28, s28, s31
    s_mul_i32 s26, s28, 10240
    s_add_u32 m0, s30, 40960
    v_mfma_f32_16x16x32_bf16 v[104:107], a[80:83], a[8:11], 0
    buffer_load_dwordx4 v5, s[20:23], s26 offen sc1 lds
    v_mfma_f32_16x16x32_bf16 v[104:107], a[84:87], a[28:31], v[104:107]
    v_mfma_f32_16x16x32_bf16 v[108:111], a[84:87], a[32:35], 0
    buffer_load_dwordx4 v5, s[20:23], s26 offen offset:1024 sc1 lds
    v_mfma_f32_16x16x32_bf16 v[108:111], a[80:83], a[12:15], v[108:111]
    v_mfma_f32_16x16x32_bf16 v[112:115], a[80:83], a[16:19], 0
    v_mfma_f32_16x16x32_bf16 v[112:115], a[84:87], a[36:39], v[112:115]
    buffer_load_dwordx4 v5, s[20:23], s26 offen offset:2048 sc1 lds
    v_mfma_f32_16x16x32_bf16 v[132:135], a[92:95], a[36:39], 0
    ds_read_b64_tr_b16 a[84:85], v8 offset:24832
    ds_read_b64_tr_b16 a[86:87], v8 offset:28928
    v_mfma_f32_16x16x32_bf16 v[132:135], a[88:91], a[16:19], v[132:135]
    ds_read_b64_tr_b16 a[80:81], v8 offset:16640
    ds_read_b64_tr_b16 a[82:83], v8 offset:20736
    v_mfma_f32_16x16x32_bf16 v[128:131], a[88:91], a[12:15], 0
    buffer_load_dwordx4 v5, s[20:23], s26 offen offset:3072 sc1 lds
    v_mfma_f32_16x16x32_bf16 v[128:131], a[92:95], a[32:35], v[128:131]
    v_mfma_f32_16x16x32_bf16 v[124:127], a[92:95], a[28:31], 0
    s_add_u32 m0, s30, 45056
    v_mfma_f32_16x16x32_bf16 v[124:127], a[88:91], a[8:11], v[124:127]
    buffer_load_dwordx4 v6, s[20:23], s26 offen sc1 lds
    v_mfma_f32_16x16x32_bf16 v[120:123], a[88:91], a[4:7], 0
    s_add_u32 s28, s25, 3
    s_and_b32 s28, s28, 7
    s_lshl_b32 s28, s28, 1
    v_mfma_f32_16x16x32_bf16 v[120:123], a[92:95], a[24:27], v[120:123]
    s_add_u32 s28, s28, s31
    s_mul_i32 s26, s28, 10240
    s_add_u32 m0, s30, 61440
    v_mfma_f32_16x16x32_bf16 v[116:119], a[92:95], a[20:23], 0
    s_waitcnt vmcnt(5) lgkmcnt(0)
    s_barrier
    v_mfma_f32_16x16x32_bf16 v[116:119], a[88:91], a[0:3], v[116:119]
    ds_read_b128 a[40:43], v9 offset:20480
    ds_read_b128 a[60:63], v9 offset:30720
    v_mfma_f32_16x16x32_bf16 v[136:139], a[96:99], a[0:3], 0
    ds_read_b64_tr_b16 a[88:89], v7 offset:32768
    ds_read_b64_tr_b16 a[90:91], v7 offset:36864
    v_mfma_f32_16x16x32_bf16 v[136:139], a[100:103], a[20:23], v[136:139]
    ds_read_b64_tr_b16 a[92:93], v7 offset:40960
    ds_read_b64_tr_b16 a[94:95], v7 offset:45056
    v_mfma_f32_16x16x32_bf16 v[140:143], a[100:103], a[24:27], 0
    ds_read_b128 a[64:67], v9 offset:31744
    ds_read_b128 a[44:47], v9 offset:21504
    v_mfma_f32_16x16x32_bf16 v[140:143], a[96:99], a[4:7], v[140:143]
    ds_read_b128 a[48:51], v9 offset:22528
    ds_read_b128 a[68:71], v9 offset:32768
    v_mfma_f32_16x16x32_bf16 v[144:147], a[96:99], a[8:11], 0
    ds_read_b128 a[72:75], v9 offset:33792
    ds_read_b128 a[52:55], v9 offset:23552
    v_mfma_f32_16x16x32_bf16 v[144:147], a[100:103], a[28:31], v[144:147]
    ds_read_b128 a[56:59], v9 offset:24576
    ds_read_b128 a[76:79], v9 offset:34816
    v_mfma_f32_16x16x32_bf16 v[148:151], a[100:103], a[32:35], 0
    buffer_load_dwordx4 v5, s[20:23], s26 offen sc1 lds
    v_mfma_f32_16x16x32_bf16 v[148:151], a[96:99], a[12:15], v[148:151]
    buffer_load_dwordx4 v5, s[20:23], s26 offen offset:1024 sc1 lds
    v_mfma_f32_16x16x32_bf16 v[152:155], a[96:99], a[16:19], 0
    buffer_load_dwordx4 v5, s[20:23], s26 offen offset:2048 sc1 lds
    v_mfma_f32_16x16x32_bf16 v[152:155], a[100:103], a[36:39], v[152:155]
    buffer_load_dwordx4 v5, s[20:23], s26 offen offset:3072 sc1 lds
    v_mfma_f32_16x16x32_bf16 v[172:175], a[84:87], a[36:39], 0
    ds_read_b64_tr_b16 a[100:101], v8 offset:40960
    ds_read_b64_tr_b16 a[102:103], v8 offset:45056
    v_mfma_f32_16x16x32_bf16 v[172:175], a[80:83], a[16:19], v[172:175]
    s_add_u32 m0, s30, 65536
    ds_read_b64_tr_b16 a[96:97], v8 offset:32768
    ds_read_b64_tr_b16 a[98:99], v8 offset:36864
    v_mfma_f32_16x16x32_bf16 v[168:171], a[80:83], a[12:15], 0
    buffer_load_dwordx4 v6, s[20:23], s26 offen sc1 lds
    v_mfma_f32_16x16x32_bf16 v[168:171], a[84:87], a[32:35], v[168:171]
    s_add_u32 s28, s25, 4
    s_and_b32 s28, s28, 7
    s_lshl_b32 s28, s28, 1
    s_add_u32 s28, s28, s31
    s_lshl_b32 s27, s28, 16
    s_add_u32 m0, s32, 98304
    v_mfma_f32_16x16x32_bf16 v[164:167], a[84:87], a[28:31], 0
    buffer_load_dwordx4 v1, s[8:11], s27 offen lds
    v_mfma_f32_16x16x32_bf16 v[164:167], a[80:83], a[8:11], v[164:167]
    v_mfma_f32_16x16x32_bf16 v[160:163], a[80:83], a[4:7], 0
    v_mfma_f32_16x16x32_bf16 v[160:163], a[84:87], a[24:27], v[160:163]
    buffer_load_dwordx4 v2, s[8:11], s27 offen offset:1024 lds
    v_mfma_f32_16x16x32_bf16 v[156:159], a[84:87], a[20:23], 0
    v_mfma_f32_16x16x32_bf16 v[156:159], a[80:83], a[0:3], v[156:159]
    s_waitcnt lgkmcnt(14)
    buffer_load_dwordx4 v3, s[8:11], s27 offen offset:2048 lds
    v_mfma_f32_16x16x32_bf16 v[96:99], a[88:91], a[40:43], v[96:99]
    s_waitcnt lgkmcnt(12)
    ds_read_b64_tr_b16 a[80:81], v7 offset:33024
    ds_read_b64_tr_b16 a[82:83], v7 offset:37120
    v_mfma_f32_16x16x32_bf16 v[96:99], a[92:95], a[60:63], v[96:99]
    s_waitcnt lgkmcnt(13)
    ds_read_b64_tr_b16 a[84:85], v7 offset:41216
    ds_read_b64_tr_b16 a[86:87], v7 offset:45312
    v_mfma_f32_16x16x32_bf16 v[100:103], a[92:95], a[64:67], v[100:103]
    s_waitcnt lgkmcnt(14)
    buffer_load_dwordx4 v4, s[8:11], s27 offen offset:3072 lds
    v_mfma_f32_16x16x32_bf16 v[100:103], a[88:91], a[44:47], v[100:103]
    s_waitcnt lgkmcnt(13)
    s_add_u32 s28, s25, 4
    s_and_b32 s28, s28, 7
    s_lshl_b32 s28, s28, 1
    s_add_u32 s28, s28, s31
    s_mul_i32 s26, s28, 10240
    s_add_u32 m0, s30, 0
    v_mfma_f32_16x16x32_bf16 v[104:107], a[88:91], a[48:51], v[104:107]
    s_waitcnt lgkmcnt(12)
    buffer_load_dwordx4 v5, s[20:23], s26 offen sc1 lds
    v_mfma_f32_16x16x32_bf16 v[104:107], a[92:95], a[68:71], v[104:107]
    s_waitcnt lgkmcnt(11)
    v_mfma_f32_16x16x32_bf16 v[108:111], a[92:95], a[72:75], v[108:111]
    s_waitcnt lgkmcnt(10)
    v_mfma_f32_16x16x32_bf16 v[108:111], a[88:91], a[52:55], v[108:111]
    s_waitcnt lgkmcnt(9)
    buffer_load_dwordx4 v5, s[20:23], s26 offen offset:1024 sc1 lds
    v_mfma_f32_16x16x32_bf16 v[112:115], a[88:91], a[56:59], v[112:115]
    s_waitcnt lgkmcnt(8)
    v_mfma_f32_16x16x32_bf16 v[112:115], a[92:95], a[76:79], v[112:115]
    s_waitcnt lgkmcnt(6)
    buffer_load_dwordx4 v5, s[20:23], s26 offen offset:2048 sc1 lds
    v_mfma_f32_16x16x32_bf16 v[132:135], a[100:103], a[76:79], v[132:135]
    s_waitcnt lgkmcnt(4)
    ds_read_b64_tr_b16 a[92:93], v8 offset:41216
    ds_read_b64_tr_b16 a[94:95], v8 offset:45312
    v_mfma_f32_16x16x32_bf16 v[132:135], a[96:99], a[56:59], v[132:135]
    ds_read_b64_tr_b16 a[88:89], v8 offset:33024
    ds_read_b64_tr_b16 a[90:91], v8 offset:37120
    v_mfma_f32_16x16x32_bf16 v[128:131], a[96:99], a[52:55], v[128:131]
    buffer_load_dwordx4 v5, s[20:23], s26 offen offset:3072 sc1 lds
    v_mfma_f32_16x16x32_bf16 v[128:131], a[100:103], a[72:75], v[128:131]
    v_mfma_f32_16x16x32_bf16 v[124:127], a[100:103], a[68:71], v[124:127]
    s_add_u32 m0, s30, 4096
    v_mfma_f32_16x16x32_bf16 v[124:127], a[96:99], a[48:51], v[124:127]
    buffer_load_dwordx4 v6, s[20:23], s26 offen sc1 lds
    v_mfma_f32_16x16x32_bf16 v[120:123], a[96:99], a[44:47], v[120:123]
    s_add_u32 s28, s25, 5
    s_and_b32 s28, s28, 7
    s_lshl_b32 s28, s28, 1
    v_mfma_f32_16x16x32_bf16 v[120:123], a[100:103], a[64:67], v[120:123]
    s_add_u32 s28, s28, s31
    s_lshl_b32 s27, s28, 16
    s_add_u32 m0, s32, 114688
    v_mfma_f32_16x16x32_bf16 v[116:119], a[100:103], a[60:63], v[116:119]
    s_waitcnt vmcnt(14) lgkmcnt(0)
    s_barrier
    v_mfma_f32_16x16x32_bf16 v[116:119], a[96:99], a[40:43], v[116:119]
    ds_read_b128 a[0:3], v10
    ds_read_b128 a[20:23], v10 offset:10240
    v_mfma_f32_16x16x32_bf16 v[136:139], a[80:83], a[40:43], v[136:139]
    ds_read_b64_tr_b16 a[96:97], v216
    ds_read_b64_tr_b16 a[98:99], v216 offset:4096
    v_mfma_f32_16x16x32_bf16 v[136:139], a[84:87], a[60:63], v[136:139]
    ds_read_b64_tr_b16 a[100:101], v216 offset:8192
    ds_read_b64_tr_b16 a[102:103], v216 offset:12288
    v_mfma_f32_16x16x32_bf16 v[140:143], a[84:87], a[64:67], v[140:143]
    ds_read_b128 a[24:27], v10 offset:11264
    ds_read_b128 a[4:7], v10 offset:1024
    v_mfma_f32_16x16x32_bf16 v[140:143], a[80:83], a[44:47], v[140:143]
    ds_read_b128 a[8:11], v10 offset:2048
    ds_read_b128 a[28:31], v10 offset:12288
    v_mfma_f32_16x16x32_bf16 v[144:147], a[80:83], a[48:51], v[144:147]
    ds_read_b128 a[32:35], v10 offset:13312
    ds_read_b128 a[12:15], v10 offset:3072
    v_mfma_f32_16x16x32_bf16 v[144:147], a[84:87], a[68:71], v[144:147]
    ds_read_b128 a[16:19], v10 offset:4096
    ds_read_b128 a[36:39], v10 offset:14336
    v_mfma_f32_16x16x32_bf16 v[148:151], a[84:87], a[72:75], v[148:151]
    buffer_load_dwordx4 v1, s[8:11], s27 offen lds
    v_mfma_f32_16x16x32_bf16 v[148:151], a[80:83], a[52:55], v[148:151]
    buffer_load_dwordx4 v2, s[8:11], s27 offen offset:1024 lds
    v_mfma_f32_16x16x32_bf16 v[152:155], a[80:83], a[56:59], v[152:155]
    v_mfma_f32_16x16x32_bf16 v[152:155], a[84:87], a[76:79], v[152:155]
    v_mfma_f32_16x16x32_bf16 v[172:175], a[92:95], a[76:79], v[172:175]
    ds_read_b64_tr_b16 a[84:85], v217 offset:8192
    ds_read_b64_tr_b16 a[86:87], v217 offset:12288
    v_mfma_f32_16x16x32_bf16 v[172:175], a[88:91], a[56:59], v[172:175]
    ds_read_b64_tr_b16 a[80:81], v217
    ds_read_b64_tr_b16 a[82:83], v217 offset:4096
    v_mfma_f32_16x16x32_bf16 v[168:171], a[88:91], a[52:55], v[168:171]
    buffer_load_dwordx4 v3, s[8:11], s27 offen offset:2048 lds
    v_mfma_f32_16x16x32_bf16 v[168:171], a[92:95], a[72:75], v[168:171]
    v_mfma_f32_16x16x32_bf16 v[164:167], a[92:95], a[68:71], v[164:167]
    buffer_load_dwordx4 v4, s[8:11], s27 offen offset:3072 lds
    v_mfma_f32_16x16x32_bf16 v[164:167], a[88:91], a[48:51], v[164:167]
    s_add_u32 s28, s25, 5
    s_and_b32 s28, s28, 7
    v_mfma_f32_16x16x32_bf16 v[160:163], a[88:91], a[44:47], v[160:163]
    s_lshl_b32 s28, s28, 1
    s_add_u32 s28, s28, s31
    v_mfma_f32_16x16x32_bf16 v[160:163], a[92:95], a[64:67], v[160:163]
    s_mul_i32 s26, s28, 10240
    s_add_u32 m0, s30, 20480
    v_mfma_f32_16x16x32_bf16 v[156:159], a[92:95], a[60:63], v[156:159]
    buffer_load_dwordx4 v5, s[20:23], s26 offen sc1 lds
    v_mfma_f32_16x16x32_bf16 v[156:159], a[88:91], a[40:43], v[156:159]
    s_waitcnt lgkmcnt(14)
    v_mfma_f32_16x16x32_bf16 v[96:99], a[96:99], a[0:3], v[96:99]
    s_waitcnt lgkmcnt(12)
    ds_read_b64_tr_b16 a[88:89], v216 offset:256
    ds_read_b64_tr_b16 a[90:91], v216 offset:4352
    v_mfma_f32_16x16x32_bf16 v[96:99], a[100:103], a[20:23], v[96:99]
    s_waitcnt lgkmcnt(13)
    ds_read_b64_tr_b16 a[92:93], v216 offset:8448
    ds_read_b64_tr_b16 a[94:95], v216 offset:12544
    v_mfma_f32_16x16x32_bf16 v[100:103], a[100:103], a[24:27], v[100:103]
    s_waitcnt lgkmcnt(14)
    buffer_load_dwordx4 v5, s[20:23], s26 offen offset:1024 sc1 lds
    v_mfma_f32_16x16x32_bf16 v[100:103], a[96:99], a[4:7], v[100:103]
    s_waitcnt lgkmcnt(13)
    v_mfma_f32_16x16x32_bf16 v[104:107], a[96:99], a[8:11], v[104:107]
    s_waitcnt lgkmcnt(12)
    v_mfma_f32_16x16x32_bf16 v[104:107], a[100:103], a[28:31], v[104:107]
    s_waitcnt lgkmcnt(11)
    v_mfma_f32_16x16x32_bf16 v[108:111], a[100:103], a[32:35], v[108:111]
    s_waitcnt lgkmcnt(10)
    buffer_load_dwordx4 v5, s[20:23], s26 offen offset:2048 sc1 lds
    v_mfma_f32_16x16x32_bf16 v[108:111], a[96:99], a[12:15], v[108:111]
    s_waitcnt lgkmcnt(9)
    v_mfma_f32_16x16x32_bf16 v[112:115], a[96:99], a[16:19], v[112:115]
    s_waitcnt lgkmcnt(8)
    v_mfma_f32_16x16x32_bf16 v[112:115], a[100:103], a[36:39], v[112:115]
    s_waitcnt lgkmcnt(6)
    v_mfma_f32_16x16x32_bf16 v[132:135], a[84:87], a[36:39], v[132:135]
    s_waitcnt lgkmcnt(4)
    ds_read_b64_tr_b16 a[100:101], v217 offset:8448
    ds_read_b64_tr_b16 a[102:103], v217 offset:12544
    v_mfma_f32_16x16x32_bf16 v[132:135], a[80:83], a[16:19], v[132:135]
    ds_read_b64_tr_b16 a[96:97], v217 offset:256
    ds_read_b64_tr_b16 a[98:99], v217 offset:4352
    v_mfma_f32_16x16x32_bf16 v[128:131], a[80:83], a[12:15], v[128:131]
    buffer_load_dwordx4 v5, s[20:23], s26 offen offset:3072 sc1 lds
    v_mfma_f32_16x16x32_bf16 v[128:131], a[84:87], a[32:35], v[128:131]
    v_mfma_f32_16x16x32_bf16 v[124:127], a[84:87], a[28:31], v[124:127]
    s_add_u32 m0, s30, 24576
    v_mfma_f32_16x16x32_bf16 v[124:127], a[80:83], a[8:11], v[124:127]
    buffer_load_dwordx4 v6, s[20:23], s26 offen sc1 lds
    v_mfma_f32_16x16x32_bf16 v[120:123], a[80:83], a[4:7], v[120:123]
    s_add_u32 s28, s25, 6
    s_and_b32 s28, s28, 7
    s_lshl_b32 s28, s28, 1
    v_mfma_f32_16x16x32_bf16 v[120:123], a[84:87], a[24:27], v[120:123]
    s_add_u32 s28, s28, s31
    s_lshl_b32 s27, s28, 16
    s_add_u32 m0, s32, 131072
    v_mfma_f32_16x16x32_bf16 v[116:119], a[84:87], a[20:23], v[116:119]
    s_waitcnt vmcnt(18) lgkmcnt(0)
    s_barrier
    v_mfma_f32_16x16x32_bf16 v[116:119], a[80:83], a[0:3], v[116:119]
    ds_read_b128 a[40:43], v10 offset:20480
    ds_read_b128 a[60:63], v10 offset:30720
    v_mfma_f32_16x16x32_bf16 v[136:139], a[88:91], a[0:3], v[136:139]
    ds_read_b64_tr_b16 a[80:81], v216 offset:16384
    ds_read_b64_tr_b16 a[82:83], v216 offset:20480
    v_mfma_f32_16x16x32_bf16 v[136:139], a[92:95], a[20:23], v[136:139]
    ds_read_b64_tr_b16 a[84:85], v216 offset:24576
    ds_read_b64_tr_b16 a[86:87], v216 offset:28672
    v_mfma_f32_16x16x32_bf16 v[140:143], a[92:95], a[24:27], v[140:143]
    ds_read_b128 a[64:67], v10 offset:31744
    ds_read_b128 a[44:47], v10 offset:21504
    v_mfma_f32_16x16x32_bf16 v[140:143], a[88:91], a[4:7], v[140:143]
    ds_read_b128 a[48:51], v10 offset:22528
    ds_read_b128 a[68:71], v10 offset:32768
    v_mfma_f32_16x16x32_bf16 v[144:147], a[88:91], a[8:11], v[144:147]
    ds_read_b128 a[72:75], v10 offset:33792
    ds_read_b128 a[52:55], v10 offset:23552
    v_mfma_f32_16x16x32_bf16 v[144:147], a[92:95], a[28:31], v[144:147]
    ds_read_b128 a[56:59], v10 offset:24576
    ds_read_b128 a[76:79], v10 offset:34816
    v_mfma_f32_16x16x32_bf16 v[148:151], a[92:95], a[32:35], v[148:151]
    buffer_load_dwordx4 v1, s[8:11], s27 offen lds
    v_mfma_f32_16x16x32_bf16 v[148:151], a[88:91], a[12:15], v[148:151]
    buffer_load_dwordx4 v2, s[8:11], s27 offen offset:1024 lds
    v_mfma_f32_16x16x32_bf16 v[152:155], a[88:91], a[16:19], v[152:155]
    v_mfma_f32_16x16x32_bf16 v[152:155], a[92:95], a[36:39], v[152:155]
    v_mfma_f32_16x16x32_bf16 v[172:175], a[100:103], a[36:39], v[172:175]
    ds_read_b64_tr_b16 a[92:93], v217 offset:24576
    ds_read_b64_tr_b16 a[94:95], v217 offset:28672
    v_mfma_f32_16x16x32_bf16 v[172:175], a[96:99], a[16:19], v[172:175]
    ds_read_b64_tr_b16 a[88:89], v217 offset:16384
    ds_read_b64_tr_b16 a[90:91], v217 offset:20480
    v_mfma_f32_16x16x32_bf16 v[168:171], a[96:99], a[12:15], v[168:171]
    buffer_load_dwordx4 v3, s[8:11], s27 offen offset:2048 lds
    v_mfma_f32_16x16x32_bf16 v[168:171], a[100:103], a[32:35], v[168:171]
    v_mfma_f32_16x16x32_bf16 v[164:167], a[100:103], a[28:31], v[164:167]
    buffer_load_dwordx4 v4, s[8:11], s27 offen offset:3072 lds
    v_mfma_f32_16x16x32_bf16 v[164:167], a[96:99], a[8:11], v[164:167]
    s_add_u32 s28, s25, 6
    s_and_b32 s28, s28, 7
    v_mfma_f32_16x16x32_bf16 v[160:163], a[96:99], a[4:7], v[160:163]
    s_lshl_b32 s28, s28, 1
    s_add_u32 s28, s28, s31
    v_mfma_f32_16x16x32_bf16 v[160:163], a[100:103], a[24:27], v[160:163]
    s_mul_i32 s26, s28, 10240
    s_add_u32 m0, s30, 40960
    v_mfma_f32_16x16x32_bf16 v[156:159], a[100:103], a[20:23], v[156:159]
    buffer_load_dwordx4 v5, s[20:23], s26 offen sc1 lds
    v_mfma_f32_16x16x32_bf16 v[156:159], a[96:99], a[0:3], v[156:159]
    s_waitcnt lgkmcnt(14)
    v_mfma_f32_16x16x32_bf16 v[96:99], a[80:83], a[40:43], v[96:99]
    s_waitcnt lgkmcnt(12)
    ds_read_b64_tr_b16 a[96:97], v216 offset:16640
    ds_read_b64_tr_b16 a[98:99], v216 offset:20736
    v_mfma_f32_16x16x32_bf16 v[96:99], a[84:87], a[60:63], v[96:99]
    s_waitcnt lgkmcnt(13)
    ds_read_b64_tr_b16 a[100:101], v216 offset:24832
    ds_read_b64_tr_b16 a[102:103], v216 offset:28928
    v_mfma_f32_16x16x32_bf16 v[100:103], a[84:87], a[64:67], v[100:103]
    s_waitcnt lgkmcnt(14)
    buffer_load_dwordx4 v5, s[20:23], s26 offen offset:1024 sc1 lds
    v_mfma_f32_16x16x32_bf16 v[100:103], a[80:83], a[44:47], v[100:103]
    s_waitcnt lgkmcnt(13)
    v_mfma_f32_16x16x32_bf16 v[104:107], a[80:83], a[48:51], v[104:107]
    s_waitcnt lgkmcnt(12)
    v_mfma_f32_16x16x32_bf16 v[104:107], a[84:87], a[68:71], v[104:107]
    s_waitcnt lgkmcnt(11)
    v_mfma_f32_16x16x32_bf16 v[108:111], a[84:87], a[72:75], v[108:111]
    s_waitcnt lgkmcnt(10)
    buffer_load_dwordx4 v5, s[20:23], s26 offen offset:2048 sc1 lds
    v_mfma_f32_16x16x32_bf16 v[108:111], a[80:83], a[52:55], v[108:111]
    s_waitcnt lgkmcnt(9)
    v_mfma_f32_16x16x32_bf16 v[112:115], a[80:83], a[56:59], v[112:115]
    s_waitcnt lgkmcnt(8)
    v_mfma_f32_16x16x32_bf16 v[112:115], a[84:87], a[76:79], v[112:115]
    s_waitcnt lgkmcnt(6)
    v_mfma_f32_16x16x32_bf16 v[132:135], a[92:95], a[76:79], v[132:135]
    s_waitcnt lgkmcnt(4)
    ds_read_b64_tr_b16 a[84:85], v217 offset:24832
    ds_read_b64_tr_b16 a[86:87], v217 offset:28928
    v_mfma_f32_16x16x32_bf16 v[132:135], a[88:91], a[56:59], v[132:135]
    ds_read_b64_tr_b16 a[80:81], v217 offset:16640
    ds_read_b64_tr_b16 a[82:83], v217 offset:20736
    v_mfma_f32_16x16x32_bf16 v[128:131], a[88:91], a[52:55], v[128:131]
    buffer_load_dwordx4 v5, s[20:23], s26 offen offset:3072 sc1 lds
    v_mfma_f32_16x16x32_bf16 v[128:131], a[92:95], a[72:75], v[128:131]
    v_mfma_f32_16x16x32_bf16 v[124:127], a[92:95], a[68:71], v[124:127]
    s_add_u32 m0, s30, 45056
    v_mfma_f32_16x16x32_bf16 v[124:127], a[88:91], a[48:51], v[124:127]
    buffer_load_dwordx4 v6, s[20:23], s26 offen sc1 lds
    v_mfma_f32_16x16x32_bf16 v[120:123], a[88:91], a[44:47], v[120:123]
    s_add_u32 s28, s25, 7
    s_and_b32 s28, s28, 7
    s_lshl_b32 s28, s28, 1
    v_mfma_f32_16x16x32_bf16 v[120:123], a[92:95], a[64:67], v[120:123]
    s_add_u32 s28, s28, s31
    s_lshl_b32 s27, s28, 16
    s_add_u32 m0, s32, 147456
    v_mfma_f32_16x16x32_bf16 v[116:119], a[92:95], a[60:63], v[116:119]
    s_waitcnt vmcnt(18) lgkmcnt(0)
    s_barrier
    v_mfma_f32_16x16x32_bf16 v[116:119], a[88:91], a[40:43], v[116:119]
    ds_read_b128 a[0:3], v9
    ds_read_b128 a[20:23], v9 offset:10240
    v_mfma_f32_16x16x32_bf16 v[136:139], a[96:99], a[40:43], v[136:139]
    ds_read_b64_tr_b16 a[88:89], v7 offset:16384
    ds_read_b64_tr_b16 a[90:91], v7 offset:20480
    v_mfma_f32_16x16x32_bf16 v[136:139], a[100:103], a[60:63], v[136:139]
    ds_read_b64_tr_b16 a[92:93], v7 offset:24576
    ds_read_b64_tr_b16 a[94:95], v7 offset:28672
    v_mfma_f32_16x16x32_bf16 v[140:143], a[100:103], a[64:67], v[140:143]
    ds_read_b128 a[24:27], v9 offset:11264
    ds_read_b128 a[4:7], v9 offset:1024
    v_mfma_f32_16x16x32_bf16 v[140:143], a[96:99], a[44:47], v[140:143]
    ds_read_b128 a[8:11], v9 offset:2048
    ds_read_b128 a[28:31], v9 offset:12288
    v_mfma_f32_16x16x32_bf16 v[144:147], a[96:99], a[48:51], v[144:147]
    ds_read_b128 a[32:35], v9 offset:13312
    ds_read_b128 a[12:15], v9 offset:3072
    v_mfma_f32_16x16x32_bf16 v[144:147], a[100:103], a[68:71], v[144:147]
    ds_read_b128 a[16:19], v9 offset:4096
    ds_read_b128 a[36:39], v9 offset:14336
    v_mfma_f32_16x16x32_bf16 v[148:151], a[100:103], a[72:75], v[148:151]
    buffer_load_dwordx4 v1, s[8:11], s27 offen lds
    v_mfma_f32_16x16x32_bf16 v[148:151], a[96:99], a[52:55], v[148:151]
    buffer_load_dwordx4 v2, s[8:11], s27 offen offset:1024 lds
    v_mfma_f32_16x16x32_bf16 v[152:155], a[96:99], a[56:59], v[152:155]
    v_mfma_f32_16x16x32_bf16 v[152:155], a[100:103], a[76:79], v[152:155]
    v_mfma_f32_16x16x32_bf16 v[172:175], a[84:87], a[76:79], v[172:175]
    ds_read_b64_tr_b16 a[100:101], v8 offset:24576
    ds_read_b64_tr_b16 a[102:103], v8 offset:28672
    v_mfma_f32_16x16x32_bf16 v[172:175], a[80:83], a[56:59], v[172:175]
    ds_read_b64_tr_b16 a[96:97], v8 offset:16384
    ds_read_b64_tr_b16 a[98:99], v8 offset:20480
    v_mfma_f32_16x16x32_bf16 v[168:171], a[80:83], a[52:55], v[168:171]
    buffer_load_dwordx4 v3, s[8:11], s27 offen offset:2048 lds
    v_mfma_f32_16x16x32_bf16 v[168:171], a[84:87], a[72:75], v[168:171]
    v_mfma_f32_16x16x32_bf16 v[164:167], a[84:87], a[68:71], v[164:167]
    buffer_load_dwordx4 v4, s[8:11], s27 offen offset:3072 lds
    v_mfma_f32_16x16x32_bf16 v[164:167], a[80:83], a[48:51], v[164:167]
    s_add_u32 s28, s25, 7
    s_and_b32 s28, s28, 7
    v_mfma_f32_16x16x32_bf16 v[160:163], a[80:83], a[44:47], v[160:163]
    s_lshl_b32 s28, s28, 1
    s_add_u32 s28, s28, s31
    v_mfma_f32_16x16x32_bf16 v[160:163], a[84:87], a[64:67], v[160:163]
    s_mul_i32 s26, s28, 10240
    s_add_u32 m0, s30, 61440
    v_mfma_f32_16x16x32_bf16 v[156:159], a[84:87], a[60:63], v[156:159]
    buffer_load_dwordx4 v5, s[20:23], s26 offen sc1 lds
    v_mfma_f32_16x16x32_bf16 v[156:159], a[80:83], a[40:43], v[156:159]
    s_waitcnt lgkmcnt(14)
    v_mfma_f32_16x16x32_bf16 v[96:99], a[88:91], a[0:3], v[96:99]
    s_waitcnt lgkmcnt(12)
    ds_read_b64_tr_b16 a[80:81], v7 offset:16640
    ds_read_b64_tr_b16 a[82:83], v7 offset:20736
    v_mfma_f32_16x16x32_bf16 v[96:99], a[92:95], a[20:23], v[96:99]
    s_waitcnt lgkmcnt(13)
    ds_read_b64_tr_b16 a[84:85], v7 offset:24832
    ds_read_b64_tr_b16 a[86:87], v7 offset:28928
    v_mfma_f32_16x16x32_bf16 v[100:103], a[92:95], a[24:27], v[100:103]
    s_waitcnt lgkmcnt(14)
    buffer_load_dwordx4 v5, s[20:23], s26 offen offset:1024 sc1 lds
    v_mfma_f32_16x16x32_bf16 v[100:103], a[88:91], a[4:7], v[100:103]
    s_waitcnt lgkmcnt(13)
    v_mfma_f32_16x16x32_bf16 v[104:107], a[88:91], a[8:11], v[104:107]
    s_waitcnt lgkmcnt(12)
    v_mfma_f32_16x16x32_bf16 v[104:107], a[92:95], a[28:31], v[104:107]
    s_waitcnt lgkmcnt(11)
    v_mfma_f32_16x16x32_bf16 v[108:111], a[92:95], a[32:35], v[108:111]
    s_waitcnt lgkmcnt(10)
    buffer_load_dwordx4 v5, s[20:23], s26 offen offset:2048 sc1 lds
    v_mfma_f32_16x16x32_bf16 v[108:111], a[88:91], a[12:15], v[108:111]
    s_waitcnt lgkmcnt(9)
    v_mfma_f32_16x16x32_bf16 v[112:115], a[88:91], a[16:19], v[112:115]
    s_waitcnt lgkmcnt(8)
    v_mfma_f32_16x16x32_bf16 v[112:115], a[92:95], a[36:39], v[112:115]
    s_waitcnt lgkmcnt(6)
    v_mfma_f32_16x16x32_bf16 v[132:135], a[100:103], a[36:39], v[132:135]
    s_waitcnt lgkmcnt(4)
    ds_read_b64_tr_b16 a[92:93], v8 offset:24832
    ds_read_b64_tr_b16 a[94:95], v8 offset:28928
    v_mfma_f32_16x16x32_bf16 v[132:135], a[96:99], a[16:19], v[132:135]
    ds_read_b64_tr_b16 a[88:89], v8 offset:16640
    ds_read_b64_tr_b16 a[90:91], v8 offset:20736
    v_mfma_f32_16x16x32_bf16 v[128:131], a[96:99], a[12:15], v[128:131]
    buffer_load_dwordx4 v5, s[20:23], s26 offen offset:3072 sc1 lds
    v_mfma_f32_16x16x32_bf16 v[128:131], a[100:103], a[32:35], v[128:131]
    v_mfma_f32_16x16x32_bf16 v[124:127], a[100:103], a[28:31], v[124:127]
    s_add_u32 m0, s30, 65536
    v_mfma_f32_16x16x32_bf16 v[124:127], a[96:99], a[8:11], v[124:127]
    buffer_load_dwordx4 v6, s[20:23], s26 offen sc1 lds
    v_mfma_f32_16x16x32_bf16 v[120:123], a[96:99], a[4:7], v[120:123]
    s_add_u32 s28, s25, 0
    s_and_b32 s28, s28, 7
    s_or_b32 s28, s28, 8
    s_lshl_b32 s28, s28, 1
    v_mfma_f32_16x16x32_bf16 v[120:123], a[100:103], a[24:27], v[120:123]
    s_add_u32 s28, s28, s31
    s_lshl_b32 s27, s28, 16
    s_add_u32 m0, s32, 98304
    v_mfma_f32_16x16x32_bf16 v[116:119], a[100:103], a[20:23], v[116:119]
    s_waitcnt vmcnt(18) lgkmcnt(0)
    s_barrier
    v_mfma_f32_16x16x32_bf16 v[116:119], a[96:99], a[0:3], v[116:119]
    ds_read_b128 a[40:43], v9 offset:20480
    ds_read_b128 a[60:63], v9 offset:30720
    v_mfma_f32_16x16x32_bf16 v[136:139], a[80:83], a[0:3], v[136:139]
    ds_read_b64_tr_b16 a[96:97], v7 offset:32768
    ds_read_b64_tr_b16 a[98:99], v7 offset:36864
    v_mfma_f32_16x16x32_bf16 v[136:139], a[84:87], a[20:23], v[136:139]
    ds_read_b64_tr_b16 a[100:101], v7 offset:40960
    ds_read_b64_tr_b16 a[102:103], v7 offset:45056
    v_mfma_f32_16x16x32_bf16 v[140:143], a[84:87], a[24:27], v[140:143]
    ds_read_b128 a[64:67], v9 offset:31744
    ds_read_b128 a[44:47], v9 offset:21504
    v_mfma_f32_16x16x32_bf16 v[140:143], a[80:83], a[4:7], v[140:143]
    ds_read_b128 a[48:51], v9 offset:22528
    ds_read_b128 a[68:71], v9 offset:32768
    v_mfma_f32_16x16x32_bf16 v[144:147], a[80:83], a[8:11], v[144:147]
    ds_read_b128 a[72:75], v9 offset:33792
    ds_read_b128 a[52:55], v9 offset:23552
    v_mfma_f32_16x16x32_bf16 v[144:147], a[84:87], a[28:31], v[144:147]
    ds_read_b128 a[56:59], v9 offset:24576
    ds_read_b128 a[76:79], v9 offset:34816
    v_mfma_f32_16x16x32_bf16 v[148:151], a[84:87], a[32:35], v[148:151]
    buffer_load_dwordx4 v1, s[8:11], s27 offen lds
    v_mfma_f32_16x16x32_bf16 v[148:151], a[80:83], a[12:15], v[148:151]
    buffer_load_dwordx4 v2, s[8:11], s27 offen offset:1024 lds
    v_mfma_f32_16x16x32_bf16 v[152:155], a[80:83], a[16:19], v[152:155]
    v_mfma_f32_16x16x32_bf16 v[152:155], a[84:87], a[36:39], v[152:155]
    v_mfma_f32_16x16x32_bf16 v[172:175], a[92:95], a[36:39], v[172:175]
    ds_read_b64_tr_b16 a[84:85], v8 offset:40960
    ds_read_b64_tr_b16 a[86:87], v8 offset:45056
    v_mfma_f32_16x16x32_bf16 v[172:175], a[88:91], a[16:19], v[172:175]
    ds_read_b64_tr_b16 a[80:81], v8 offset:32768
    ds_read_b64_tr_b16 a[82:83], v8 offset:36864
    v_mfma_f32_16x16x32_bf16 v[168:171], a[88:91], a[12:15], v[168:171]
    buffer_load_dwordx4 v3, s[8:11], s27 offen offset:2048 lds
    v_mfma_f32_16x16x32_bf16 v[168:171], a[92:95], a[32:35], v[168:171]
    v_mfma_f32_16x16x32_bf16 v[164:167], a[92:95], a[28:31], v[164:167]
    buffer_load_dwordx4 v4, s[8:11], s27 offen offset:3072 lds
    v_mfma_f32_16x16x32_bf16 v[164:167], a[88:91], a[8:11], v[164:167]
    s_add_u32 s28, s25, 0
    s_and_b32 s28, s28, 7
    s_or_b32 s28, s28, 8
    v_mfma_f32_16x16x32_bf16 v[160:163], a[88:91], a[4:7], v[160:163]
    s_lshl_b32 s28, s28, 1
    s_add_u32 s28, s28, s31
    v_mfma_f32_16x16x32_bf16 v[160:163], a[92:95], a[24:27], v[160:163]
    s_mul_i32 s26, s28, 10240
    s_add_u32 m0, s30, 0
    v_mfma_f32_16x16x32_bf16 v[156:159], a[92:95], a[20:23], v[156:159]
    buffer_load_dwordx4 v5, s[20:23], s26 offen sc1 lds
    v_mfma_f32_16x16x32_bf16 v[156:159], a[88:91], a[0:3], v[156:159]
    s_waitcnt lgkmcnt(14)
    v_mfma_f32_16x16x32_bf16 v[96:99], a[96:99], a[40:43], v[96:99]
    s_waitcnt lgkmcnt(12)
    ds_read_b64_tr_b16 a[88:89], v7 offset:33024
    ds_read_b64_tr_b16 a[90:91], v7 offset:37120
    v_mfma_f32_16x16x32_bf16 v[96:99], a[100:103], a[60:63], v[96:99]
    s_waitcnt lgkmcnt(13)
    ds_read_b64_tr_b16 a[92:93], v7 offset:41216
    ds_read_b64_tr_b16 a[94:95], v7 offset:45312
    v_mfma_f32_16x16x32_bf16 v[100:103], a[100:103], a[64:67], v[100:103]
    s_waitcnt lgkmcnt(14)
    buffer_load_dwordx4 v5, s[20:23], s26 offen offset:1024 sc1 lds
    v_mfma_f32_16x16x32_bf16 v[100:103], a[96:99], a[44:47], v[100:103]
    s_waitcnt lgkmcnt(13)
    v_mfma_f32_16x16x32_bf16 v[104:107], a[96:99], a[48:51], v[104:107]
    s_waitcnt lgkmcnt(12)
    v_mfma_f32_16x16x32_bf16 v[104:107], a[100:103], a[68:71], v[104:107]
    s_waitcnt lgkmcnt(11)
    v_mfma_f32_16x16x32_bf16 v[108:111], a[100:103], a[72:75], v[108:111]
    s_waitcnt lgkmcnt(10)
    buffer_load_dwordx4 v5, s[20:23], s26 offen offset:2048 sc1 lds
    v_mfma_f32_16x16x32_bf16 v[108:111], a[96:99], a[52:55], v[108:111]
    s_waitcnt lgkmcnt(9)
    v_mfma_f32_16x16x32_bf16 v[112:115], a[96:99], a[56:59], v[112:115]
    s_waitcnt lgkmcnt(8)
    v_mfma_f32_16x16x32_bf16 v[112:115], a[100:103], a[76:79], v[112:115]
    s_waitcnt lgkmcnt(6)
    v_mfma_f32_16x16x32_bf16 v[132:135], a[84:87], a[76:79], v[132:135]
    s_waitcnt lgkmcnt(4)
    ds_read_b64_tr_b16 a[100:101], v8 offset:41216
    ds_read_b64_tr_b16 a[102:103], v8 offset:45312
    v_mfma_f32_16x16x32_bf16 v[132:135], a[80:83], a[56:59], v[132:135]
    ds_read_b64_tr_b16 a[96:97], v8 offset:33024
    ds_read_b64_tr_b16 a[98:99], v8 offset:37120
    v_mfma_f32_16x16x32_bf16 v[128:131], a[80:83], a[52:55], v[128:131]
    buffer_load_dwordx4 v5, s[20:23], s26 offen offset:3072 sc1 lds
    v_mfma_f32_16x16x32_bf16 v[128:131], a[84:87], a[72:75], v[128:131]
    v_mfma_f32_16x16x32_bf16 v[124:127], a[84:87], a[68:71], v[124:127]
    s_add_u32 m0, s30, 4096
    v_mfma_f32_16x16x32_bf16 v[124:127], a[80:83], a[48:51], v[124:127]
    buffer_load_dwordx4 v6, s[20:23], s26 offen sc1 lds
    v_mfma_f32_16x16x32_bf16 v[120:123], a[80:83], a[44:47], v[120:123]
    s_add_u32 s28, s25, 1
    s_and_b32 s28, s28, 7
    s_or_b32 s28, s28, 8
    s_lshl_b32 s28, s28, 1
    v_mfma_f32_16x16x32_bf16 v[120:123], a[84:87], a[64:67], v[120:123]
    s_add_u32 s28, s28, s31
    s_lshl_b32 s27, s28, 16
    s_add_u32 m0, s32, 114688
    v_mfma_f32_16x16x32_bf16 v[116:119], a[84:87], a[60:63], v[116:119]
    s_waitcnt vmcnt(18) lgkmcnt(0)
    s_barrier
    v_mfma_f32_16x16x32_bf16 v[116:119], a[80:83], a[40:43], v[116:119]
    ds_read_b128 a[0:3], v10
    ds_read_b128 a[20:23], v10 offset:10240
    v_mfma_f32_16x16x32_bf16 v[136:139], a[88:91], a[40:43], v[136:139]
    ds_read_b64_tr_b16 a[80:81], v216
    ds_read_b64_tr_b16 a[82:83], v216 offset:4096
    v_mfma_f32_16x16x32_bf16 v[136:139], a[92:95], a[60:63], v[136:139]
    ds_read_b64_tr_b16 a[84:85], v216 offset:8192
    ds_read_b64_tr_b16 a[86:87], v216 offset:12288
    v_mfma_f32_16x16x32_bf16 v[140:143], a[92:95], a[64:67], v[140:143]
    ds_read_b128 a[24:27], v10 offset:11264
    ds_read_b128 a[4:7], v10 offset:1024
    v_mfma_f32_16x16x32_bf16 v[140:143], a[88:91], a[44:47], v[140:143]
    ds_read_b128 a[8:11], v10 offset:2048
    ds_read_b128 a[28:31], v10 offset:12288
    v_mfma_f32_16x16x32_bf16 v[144:147], a[88:91], a[48:51], v[144:147]
    ds_read_b128 a[32:35], v10 offset:13312
    ds_read_b128 a[12:15], v10 offset:3072
    v_mfma_f32_16x16x32_bf16 v[144:147], a[92:95], a[68:71], v[144:147]
    ds_read_b128 a[16:19], v10 offset:4096
    ds_read_b128 a[36:39], v10 offset:14336
    v_mfma_f32_16x16x32_bf16 v[148:151], a[92:95], a[72:75], v[148:151]
    buffer_load_dwordx4 v1, s[8:11], s27 offen lds
    v_mfma_f32_16x16x32_bf16 v[148:151], a[88:91], a[52:55], v[148:151]
    buffer_load_dwordx4 v2, s[8:11], s27 offen offset:1024 lds
    v_mfma_f32_16x16x32_bf16 v[152:155], a[88:91], a[56:59], v[152:155]
    v_mfma_f32_16x16x32_bf16 v[152:155], a[92:95], a[76:79], v[152:155]
    v_mfma_f32_16x16x32_bf16 v[172:175], a[100:103], a[76:79], v[172:175]
    ds_read_b64_tr_b16 a[92:93], v217 offset:8192
    ds_read_b64_tr_b16 a[94:95], v217 offset:12288
    v_mfma_f32_16x16x32_bf16 v[172:175], a[96:99], a[56:59], v[172:175]
    ds_read_b64_tr_b16 a[88:89], v217
    ds_read_b64_tr_b16 a[90:91], v217 offset:4096
    v_mfma_f32_16x16x32_bf16 v[168:171], a[96:99], a[52:55], v[168:171]
    buffer_load_dwordx4 v3, s[8:11], s27 offen offset:2048 lds
    v_mfma_f32_16x16x32_bf16 v[168:171], a[100:103], a[72:75], v[168:171]
    v_mfma_f32_16x16x32_bf16 v[164:167], a[100:103], a[68:71], v[164:167]
    buffer_load_dwordx4 v4, s[8:11], s27 offen offset:3072 lds
    v_mfma_f32_16x16x32_bf16 v[164:167], a[96:99], a[48:51], v[164:167]
    s_add_u32 s28, s25, 1
    s_and_b32 s28, s28, 7
    s_or_b32 s28, s28, 8
    v_mfma_f32_16x16x32_bf16 v[160:163], a[96:99], a[44:47], v[160:163]
    s_lshl_b32 s28, s28, 1
    s_add_u32 s28, s28, s31
    v_mfma_f32_16x16x32_bf16 v[160:163], a[100:103], a[64:67], v[160:163]
    s_mul_i32 s26, s28, 10240
    s_add_u32 m0, s30, 20480
    v_mfma_f32_16x16x32_bf16 v[156:159], a[100:103], a[60:63], v[156:159]
    buffer_load_dwordx4 v5, s[20:23], s26 offen sc1 lds
    v_mfma_f32_16x16x32_bf16 v[156:159], a[96:99], a[40:43], v[156:159]
    s_waitcnt lgkmcnt(14)
    v_mfma_f32_16x16x32_bf16 v[96:99], a[80:83], a[0:3], v[96:99]
    s_waitcnt lgkmcnt(12)
    ds_read_b64_tr_b16 a[96:97], v216 offset:256
    ds_read_b64_tr_b16 a[98:99], v216 offset:4352
    v_mfma_f32_16x16x32_bf16 v[96:99], a[84:87], a[20:23], v[96:99]
    s_waitcnt lgkmcnt(13)
    ds_read_b64_tr_b16 a[100:101], v216 offset:8448
    ds_read_b64_tr_b16 a[102:103], v216 offset:12544
    v_mfma_f32_16x16x32_bf16 v[100:103], a[84:87], a[24:27], v[100:103]
    s_waitcnt lgkmcnt(14)
    buffer_load_dwordx4 v5, s[20:23], s26 offen offset:1024 sc1 lds
    v_mfma_f32_16x16x32_bf16 v[100:103], a[80:83], a[4:7], v[100:103]
    s_waitcnt lgkmcnt(13)
    v_mfma_f32_16x16x32_bf16 v[104:107], a[80:83], a[8:11], v[104:107]
    s_waitcnt lgkmcnt(12)
    v_mfma_f32_16x16x32_bf16 v[104:107], a[84:87], a[28:31], v[104:107]
    s_waitcnt lgkmcnt(11)
    v_mfma_f32_16x16x32_bf16 v[108:111], a[84:87], a[32:35], v[108:111]
    s_waitcnt lgkmcnt(10)
    buffer_load_dwordx4 v5, s[20:23], s26 offen offset:2048 sc1 lds
    v_mfma_f32_16x16x32_bf16 v[108:111], a[80:83], a[12:15], v[108:111]
    s_waitcnt lgkmcnt(9)
    v_mfma_f32_16x16x32_bf16 v[112:115], a[80:83], a[16:19], v[112:115]
    s_waitcnt lgkmcnt(8)
    v_mfma_f32_16x16x32_bf16 v[112:115], a[84:87], a[36:39], v[112:115]
    s_waitcnt lgkmcnt(6)
    v_mfma_f32_16x16x32_bf16 v[132:135], a[92:95], a[36:39], v[132:135]
    s_waitcnt lgkmcnt(4)
    ds_read_b64_tr_b16 a[84:85], v217 offset:8448
    ds_read_b64_tr_b16 a[86:87], v217 offset:12544
    v_mfma_f32_16x16x32_bf16 v[132:135], a[88:91], a[16:19], v[132:135]
    ds_read_b64_tr_b16 a[80:81], v217 offset:256
    ds_read_b64_tr_b16 a[82:83], v217 offset:4352
    v_mfma_f32_16x16x32_bf16 v[128:131], a[88:91], a[12:15], v[128:131]
    buffer_load_dwordx4 v5, s[20:23], s26 offen offset:3072 sc1 lds
    v_mfma_f32_16x16x32_bf16 v[128:131], a[92:95], a[32:35], v[128:131]
    v_mfma_f32_16x16x32_bf16 v[124:127], a[92:95], a[28:31], v[124:127]
    s_add_u32 m0, s30, 24576
    v_mfma_f32_16x16x32_bf16 v[124:127], a[88:91], a[8:11], v[124:127]
    buffer_load_dwordx4 v6, s[20:23], s26 offen sc1 lds
    v_mfma_f32_16x16x32_bf16 v[120:123], a[88:91], a[4:7], v[120:123]
    s_add_u32 s28, s25, 2
    s_and_b32 s28, s28, 7
    s_or_b32 s28, s28, 8
    s_lshl_b32 s28, s28, 1
    v_mfma_f32_16x16x32_bf16 v[120:123], a[92:95], a[24:27], v[120:123]
    s_add_u32 s28, s28, s31
    s_lshl_b32 s27, s28, 16
    s_add_u32 m0, s32, 131072
    v_mfma_f32_16x16x32_bf16 v[116:119], a[92:95], a[20:23], v[116:119]
    s_waitcnt vmcnt(18) lgkmcnt(0)
    s_barrier
    v_mfma_f32_16x16x32_bf16 v[116:119], a[88:91], a[0:3], v[116:119]
    ds_read_b128 a[40:43], v10 offset:20480
    ds_read_b128 a[60:63], v10 offset:30720
    v_mfma_f32_16x16x32_bf16 v[136:139], a[96:99], a[0:3], v[136:139]
    ds_read_b64_tr_b16 a[88:89], v216 offset:16384
    ds_read_b64_tr_b16 a[90:91], v216 offset:20480
    v_mfma_f32_16x16x32_bf16 v[136:139], a[100:103], a[20:23], v[136:139]
    ds_read_b64_tr_b16 a[92:93], v216 offset:24576
    ds_read_b64_tr_b16 a[94:95], v216 offset:28672
    v_mfma_f32_16x16x32_bf16 v[140:143], a[100:103], a[24:27], v[140:143]
    ds_read_b128 a[64:67], v10 offset:31744
    ds_read_b128 a[44:47], v10 offset:21504
    v_mfma_f32_16x16x32_bf16 v[140:143], a[96:99], a[4:7], v[140:143]
    ds_read_b128 a[48:51], v10 offset:22528
    ds_read_b128 a[68:71], v10 offset:32768
    v_mfma_f32_16x16x32_bf16 v[144:147], a[96:99], a[8:11], v[144:147]
    ds_read_b128 a[72:75], v10 offset:33792
    ds_read_b128 a[52:55], v10 offset:23552
    v_mfma_f32_16x16x32_bf16 v[144:147], a[100:103], a[28:31], v[144:147]
    ds_read_b128 a[56:59], v10 offset:24576
    ds_read_b128 a[76:79], v10 offset:34816
    v_mfma_f32_16x16x32_bf16 v[148:151], a[100:103], a[32:35], v[148:151]
    buffer_load_dwordx4 v1, s[8:11], s27 offen lds
    v_mfma_f32_16x16x32_bf16 v[148:151], a[96:99], a[12:15], v[148:151]
    buffer_load_dwordx4 v2, s[8:11], s27 offen offset:1024 lds
    v_mfma_f32_16x16x32_bf16 v[152:155], a[96:99], a[16:19], v[152:155]
    v_mfma_f32_16x16x32_bf16 v[152:155], a[100:103], a[36:39], v[152:155]
    v_mfma_f32_16x16x32_bf16 v[172:175], a[84:87], a[36:39], v[172:175]
    ds_read_b64_tr_b16 a[100:101], v217 offset:24576
    ds_read_b64_tr_b16 a[102:103], v217 offset:28672
    v_mfma_f32_16x16x32_bf16 v[172:175], a[80:83], a[16:19], v[172:175]
    ds_read_b64_tr_b16 a[96:97], v217 offset:16384
    ds_read_b64_tr_b16 a[98:99], v217 offset:20480
    v_mfma_f32_16x16x32_bf16 v[168:171], a[80:83], a[12:15], v[168:171]
    buffer_load_dwordx4 v3, s[8:11], s27 offen offset:2048 lds
    v_mfma_f32_16x16x32_bf16 v[168:171], a[84:87], a[32:35], v[168:171]
    v_mfma_f32_16x16x32_bf16 v[164:167], a[84:87], a[28:31], v[164:167]
    buffer_load_dwordx4 v4, s[8:11], s27 offen offset:3072 lds
    v_mfma_f32_16x16x32_bf16 v[164:167], a[80:83], a[8:11], v[164:167]
    s_add_u32 s28, s25, 2
    s_and_b32 s28, s28, 7
    s_or_b32 s28, s28, 8
    v_mfma_f32_16x16x32_bf16 v[160:163], a[80:83], a[4:7], v[160:163]
    s_lshl_b32 s28, s28, 1
    s_add_u32 s28, s28, s31
    v_mfma_f32_16x16x32_bf16 v[160:163], a[84:87], a[24:27], v[160:163]
    s_mul_i32 s26, s28, 10240
    s_add_u32 m0, s30, 40960
    v_mfma_f32_16x16x32_bf16 v[156:159], a[84:87], a[20:23], v[156:159]
    buffer_load_dwordx4 v5, s[20:23], s26 offen sc1 lds
    v_mfma_f32_16x16x32_bf16 v[156:159], a[80:83], a[0:3], v[156:159]
    s_waitcnt lgkmcnt(14)
    v_mfma_f32_16x16x32_bf16 v[96:99], a[88:91], a[40:43], v[96:99]
    s_waitcnt lgkmcnt(12)
    ds_read_b64_tr_b16 a[80:81], v216 offset:16640
    ds_read_b64_tr_b16 a[82:83], v216 offset:20736
    v_mfma_f32_16x16x32_bf16 v[96:99], a[92:95], a[60:63], v[96:99]
    s_waitcnt lgkmcnt(13)
    ds_read_b64_tr_b16 a[84:85], v216 offset:24832
    ds_read_b64_tr_b16 a[86:87], v216 offset:28928
    v_mfma_f32_16x16x32_bf16 v[100:103], a[92:95], a[64:67], v[100:103]
    s_waitcnt lgkmcnt(14)
    buffer_load_dwordx4 v5, s[20:23], s26 offen offset:1024 sc1 lds
    v_mfma_f32_16x16x32_bf16 v[100:103], a[88:91], a[44:47], v[100:103]
    s_waitcnt lgkmcnt(13)
    v_mfma_f32_16x16x32_bf16 v[104:107], a[88:91], a[48:51], v[104:107]
    s_waitcnt lgkmcnt(12)
    v_mfma_f32_16x16x32_bf16 v[104:107], a[92:95], a[68:71], v[104:107]
    s_waitcnt lgkmcnt(11)
    v_mfma_f32_16x16x32_bf16 v[108:111], a[92:95], a[72:75], v[108:111]
    s_waitcnt lgkmcnt(10)
    buffer_load_dwordx4 v5, s[20:23], s26 offen offset:2048 sc1 lds
    v_mfma_f32_16x16x32_bf16 v[108:111], a[88:91], a[52:55], v[108:111]
    s_waitcnt lgkmcnt(9)
    v_mfma_f32_16x16x32_bf16 v[112:115], a[88:91], a[56:59], v[112:115]
    s_waitcnt lgkmcnt(8)
    v_mfma_f32_16x16x32_bf16 v[112:115], a[92:95], a[76:79], v[112:115]
    s_waitcnt lgkmcnt(6)
    v_mfma_f32_16x16x32_bf16 v[132:135], a[100:103], a[76:79], v[132:135]
    s_waitcnt lgkmcnt(4)
    ds_read_b64_tr_b16 a[92:93], v217 offset:24832
    ds_read_b64_tr_b16 a[94:95], v217 offset:28928
    v_mfma_f32_16x16x32_bf16 v[132:135], a[96:99], a[56:59], v[132:135]
    ds_read_b64_tr_b16 a[88:89], v217 offset:16640
    ds_read_b64_tr_b16 a[90:91], v217 offset:20736
    v_mfma_f32_16x16x32_bf16 v[128:131], a[96:99], a[52:55], v[128:131]
    buffer_load_dwordx4 v5, s[20:23], s26 offen offset:3072 sc1 lds
    v_mfma_f32_16x16x32_bf16 v[128:131], a[100:103], a[72:75], v[128:131]
    v_mfma_f32_16x16x32_bf16 v[124:127], a[100:103], a[68:71], v[124:127]
    s_add_u32 m0, s30, 45056
    v_mfma_f32_16x16x32_bf16 v[124:127], a[96:99], a[48:51], v[124:127]
    buffer_load_dwordx4 v6, s[20:23], s26 offen sc1 lds
    v_mfma_f32_16x16x32_bf16 v[120:123], a[96:99], a[44:47], v[120:123]
    s_add_u32 s28, s25, 3
    s_and_b32 s28, s28, 7
    s_or_b32 s28, s28, 8
    s_lshl_b32 s28, s28, 1
    v_mfma_f32_16x16x32_bf16 v[120:123], a[100:103], a[64:67], v[120:123]
    s_add_u32 s28, s28, s31
    s_lshl_b32 s27, s28, 16
    s_add_u32 m0, s32, 147456
    v_mfma_f32_16x16x32_bf16 v[116:119], a[100:103], a[60:63], v[116:119]
    s_waitcnt vmcnt(18) lgkmcnt(0)
    s_barrier
    v_mfma_f32_16x16x32_bf16 v[116:119], a[96:99], a[40:43], v[116:119]
    ds_read_b128 a[0:3], v9
    ds_read_b128 a[20:23], v9 offset:10240
    v_mfma_f32_16x16x32_bf16 v[136:139], a[80:83], a[40:43], v[136:139]
    ds_read_b64_tr_b16 a[96:97], v7 offset:16384
    ds_read_b64_tr_b16 a[98:99], v7 offset:20480
    v_mfma_f32_16x16x32_bf16 v[136:139], a[84:87], a[60:63], v[136:139]
    ds_read_b64_tr_b16 a[100:101], v7 offset:24576
    ds_read_b64_tr_b16 a[102:103], v7 offset:28672
    v_mfma_f32_16x16x32_bf16 v[140:143], a[84:87], a[64:67], v[140:143]
    ds_read_b128 a[24:27], v9 offset:11264
    ds_read_b128 a[4:7], v9 offset:1024
    v_mfma_f32_16x16x32_bf16 v[140:143], a[80:83], a[44:47], v[140:143]
    ds_read_b128 a[8:11], v9 offset:2048
    ds_read_b128 a[28:31], v9 offset:12288
    v_mfma_f32_16x16x32_bf16 v[144:147], a[80:83], a[48:51], v[144:147]
    ds_read_b128 a[32:35], v9 offset:13312
    ds_read_b128 a[12:15], v9 offset:3072
    v_mfma_f32_16x16x32_bf16 v[144:147], a[84:87], a[68:71], v[144:147]
    ds_read_b128 a[16:19], v9 offset:4096
    ds_read_b128 a[36:39], v9 offset:14336
    v_mfma_f32_16x16x32_bf16 v[148:151], a[84:87], a[72:75], v[148:151]
    buffer_load_dwordx4 v1, s[8:11], s27 offen lds
    v_mfma_f32_16x16x32_bf16 v[148:151], a[80:83], a[52:55], v[148:151]
    buffer_load_dwordx4 v2, s[8:11], s27 offen offset:1024 lds
    v_mfma_f32_16x16x32_bf16 v[152:155], a[80:83], a[56:59], v[152:155]
    v_mfma_f32_16x16x32_bf16 v[152:155], a[84:87], a[76:79], v[152:155]
    v_mfma_f32_16x16x32_bf16 v[172:175], a[92:95], a[76:79], v[172:175]
    ds_read_b64_tr_b16 a[84:85], v8 offset:24576
    ds_read_b64_tr_b16 a[86:87], v8 offset:28672
    v_mfma_f32_16x16x32_bf16 v[172:175], a[88:91], a[56:59], v[172:175]
    ds_read_b64_tr_b16 a[80:81], v8 offset:16384
    ds_read_b64_tr_b16 a[82:83], v8 offset:20480
    v_mfma_f32_16x16x32_bf16 v[168:171], a[88:91], a[52:55], v[168:171]
    buffer_load_dwordx4 v3, s[8:11], s27 offen offset:2048 lds
    v_mfma_f32_16x16x32_bf16 v[168:171], a[92:95], a[72:75], v[168:171]
    v_mfma_f32_16x16x32_bf16 v[164:167], a[92:95], a[68:71], v[164:167]
    buffer_load_dwordx4 v4, s[8:11], s27 offen offset:3072 lds
    v_mfma_f32_16x16x32_bf16 v[164:167], a[88:91], a[48:51], v[164:167]
    s_add_u32 s28, s25, 3
    s_and_b32 s28, s28, 7
    s_or_b32 s28, s28, 8
    v_mfma_f32_16x16x32_bf16 v[160:163], a[88:91], a[44:47], v[160:163]
    s_lshl_b32 s28, s28, 1
    s_add_u32 s28, s28, s31
    v_mfma_f32_16x16x32_bf16 v[160:163], a[92:95], a[64:67], v[160:163]
    s_mul_i32 s26, s28, 10240
    s_add_u32 m0, s30, 61440
    v_mfma_f32_16x16x32_bf16 v[156:159], a[92:95], a[60:63], v[156:159]
    buffer_load_dwordx4 v5, s[20:23], s26 offen sc1 lds
    v_mfma_f32_16x16x32_bf16 v[156:159], a[88:91], a[40:43], v[156:159]
    s_waitcnt lgkmcnt(14)
    v_mfma_f32_16x16x32_bf16 v[96:99], a[96:99], a[0:3], v[96:99]
    s_waitcnt lgkmcnt(12)
    ds_read_b64_tr_b16 a[88:89], v7 offset:16640
    ds_read_b64_tr_b16 a[90:91], v7 offset:20736
    v_mfma_f32_16x16x32_bf16 v[96:99], a[100:103], a[20:23], v[96:99]
    s_waitcnt lgkmcnt(13)
    ds_read_b64_tr_b16 a[92:93], v7 offset:24832
    ds_read_b64_tr_b16 a[94:95], v7 offset:28928
    v_mfma_f32_16x16x32_bf16 v[100:103], a[100:103], a[24:27], v[100:103]
    s_waitcnt lgkmcnt(14)
    buffer_load_dwordx4 v5, s[20:23], s26 offen offset:1024 sc1 lds
    v_mfma_f32_16x16x32_bf16 v[100:103], a[96:99], a[4:7], v[100:103]
    s_waitcnt lgkmcnt(13)
    v_mfma_f32_16x16x32_bf16 v[104:107], a[96:99], a[8:11], v[104:107]
    s_waitcnt lgkmcnt(12)
    v_mfma_f32_16x16x32_bf16 v[104:107], a[100:103], a[28:31], v[104:107]
    s_waitcnt lgkmcnt(11)
    v_mfma_f32_16x16x32_bf16 v[108:111], a[100:103], a[32:35], v[108:111]
    s_waitcnt lgkmcnt(10)
    buffer_load_dwordx4 v5, s[20:23], s26 offen offset:2048 sc1 lds
    v_mfma_f32_16x16x32_bf16 v[108:111], a[96:99], a[12:15], v[108:111]
    s_waitcnt lgkmcnt(9)
    v_mfma_f32_16x16x32_bf16 v[112:115], a[96:99], a[16:19], v[112:115]
    s_waitcnt lgkmcnt(8)
    v_mfma_f32_16x16x32_bf16 v[112:115], a[100:103], a[36:39], v[112:115]
    s_waitcnt lgkmcnt(6)
    v_mfma_f32_16x16x32_bf16 v[132:135], a[84:87], a[36:39], v[132:135]
    s_waitcnt lgkmcnt(4)
    ds_read_b64_tr_b16 a[100:101], v8 offset:24832
    ds_read_b64_tr_b16 a[102:103], v8 offset:28928
    v_mfma_f32_16x16x32_bf16 v[132:135], a[80:83], a[16:19], v[132:135]
    ds_read_b64_tr_b16 a[96:97], v8 offset:16640
    ds_read_b64_tr_b16 a[98:99], v8 offset:20736
    v_mfma_f32_16x16x32_bf16 v[128:131], a[80:83], a[12:15], v[128:131]
    buffer_load_dwordx4 v5, s[20:23], s26 offen offset:3072 sc1 lds
    v_mfma_f32_16x16x32_bf16 v[128:131], a[84:87], a[32:35], v[128:131]
    v_mfma_f32_16x16x32_bf16 v[124:127], a[84:87], a[28:31], v[124:127]
    s_add_u32 m0, s30, 65536
    v_mfma_f32_16x16x32_bf16 v[124:127], a[80:83], a[8:11], v[124:127]
    buffer_load_dwordx4 v6, s[20:23], s26 offen sc1 lds
    v_mfma_f32_16x16x32_bf16 v[120:123], a[80:83], a[4:7], v[120:123]
    s_add_u32 s28, s25, 4
    s_and_b32 s28, s28, 7
    s_or_b32 s28, s28, 8
    s_lshl_b32 s28, s28, 1
    v_mfma_f32_16x16x32_bf16 v[120:123], a[84:87], a[24:27], v[120:123]
    s_add_u32 s28, s28, s31
    s_lshl_b32 s27, s28, 16
    s_add_u32 m0, s32, 98304
    v_mfma_f32_16x16x32_bf16 v[116:119], a[84:87], a[20:23], v[116:119]
    s_waitcnt vmcnt(18) lgkmcnt(0)
    s_barrier
    v_mfma_f32_16x16x32_bf16 v[116:119], a[80:83], a[0:3], v[116:119]
    ds_read_b128 a[40:43], v9 offset:20480
    ds_read_b128 a[60:63], v9 offset:30720
    v_mfma_f32_16x16x32_bf16 v[136:139], a[88:91], a[0:3], v[136:139]
    ds_read_b64_tr_b16 a[80:81], v7 offset:32768
    ds_read_b64_tr_b16 a[82:83], v7 offset:36864
    v_mfma_f32_16x16x32_bf16 v[136:139], a[92:95], a[20:23], v[136:139]
    ds_read_b64_tr_b16 a[84:85], v7 offset:40960
    ds_read_b64_tr_b16 a[86:87], v7 offset:45056
    v_mfma_f32_16x16x32_bf16 v[140:143], a[92:95], a[24:27], v[140:143]
    ds_read_b128 a[64:67], v9 offset:31744
    ds_read_b128 a[44:47], v9 offset:21504
    v_mfma_f32_16x16x32_bf16 v[140:143], a[88:91], a[4:7], v[140:143]
    ds_read_b128 a[48:51], v9 offset:22528
    ds_read_b128 a[68:71], v9 offset:32768
    v_mfma_f32_16x16x32_bf16 v[144:147], a[88:91], a[8:11], v[144:147]
    ds_read_b128 a[72:75], v9 offset:33792
    ds_read_b128 a[52:55], v9 offset:23552
    v_mfma_f32_16x16x32_bf16 v[144:147], a[92:95], a[28:31], v[144:147]
    ds_read_b128 a[56:59], v9 offset:24576
    ds_read_b128 a[76:79], v9 offset:34816
    v_mfma_f32_16x16x32_bf16 v[148:151], a[92:95], a[32:35], v[148:151]
    buffer_load_dwordx4 v1, s[8:11], s27 offen lds
    v_mfma_f32_16x16x32_bf16 v[148:151], a[88:91], a[12:15], v[148:151]
    buffer_load_dwordx4 v2, s[8:11], s27 offen offset:1024 lds
    v_mfma_f32_16x16x32_bf16 v[152:155], a[88:91], a[16:19], v[152:155]
    v_mfma_f32_16x16x32_bf16 v[152:155], a[92:95], a[36:39], v[152:155]
    v_mfma_f32_16x16x32_bf16 v[172:175], a[100:103], a[36:39], v[172:175]
    ds_read_b64_tr_b16 a[92:93], v8 offset:40960
    ds_read_b64_tr_b16 a[94:95], v8 offset:45056
    v_mfma_f32_16x16x32_bf16 v[172:175], a[96:99], a[16:19], v[172:175]
    ds_read_b64_tr_b16 a[88:89], v8 offset:32768
    ds_read_b64_tr_b16 a[90:91], v8 offset:36864
    v_mfma_f32_16x16x32_bf16 v[168:171], a[96:99], a[12:15], v[168:171]
    buffer_load_dwordx4 v3, s[8:11], s27 offen offset:2048 lds
    v_mfma_f32_16x16x32_bf16 v[168:171], a[100:103], a[32:35], v[168:171]
    v_mfma_f32_16x16x32_bf16 v[164:167], a[100:103], a[28:31], v[164:167]
    buffer_load_dwordx4 v4, s[8:11], s27 offen offset:3072 lds
    v_mfma_f32_16x16x32_bf16 v[164:167], a[96:99], a[8:11], v[164:167]
    s_add_u32 s28, s25, 4
    s_and_b32 s28, s28, 7
    s_or_b32 s28, s28, 8
    v_mfma_f32_16x16x32_bf16 v[160:163], a[96:99], a[4:7], v[160:163]
    s_lshl_b32 s28, s28, 1
    s_add_u32 s28, s28, s31
    v_mfma_f32_16x16x32_bf16 v[160:163], a[100:103], a[24:27], v[160:163]
    s_mul_i32 s26, s28, 10240
    s_add_u32 m0, s30, 0
    v_mfma_f32_16x16x32_bf16 v[156:159], a[100:103], a[20:23], v[156:159]
    buffer_load_dwordx4 v5, s[20:23], s26 offen sc1 lds
    v_mfma_f32_16x16x32_bf16 v[156:159], a[96:99], a[0:3], v[156:159]
    s_waitcnt lgkmcnt(14)
    v_mfma_f32_16x16x32_bf16 v[96:99], a[80:83], a[40:43], v[96:99]
    s_waitcnt lgkmcnt(12)
    ds_read_b64_tr_b16 a[96:97], v7 offset:33024
    ds_read_b64_tr_b16 a[98:99], v7 offset:37120
    v_mfma_f32_16x16x32_bf16 v[96:99], a[84:87], a[60:63], v[96:99]
    s_waitcnt lgkmcnt(13)
    ds_read_b64_tr_b16 a[100:101], v7 offset:41216
    ds_read_b64_tr_b16 a[102:103], v7 offset:45312
    v_mfma_f32_16x16x32_bf16 v[100:103], a[84:87], a[64:67], v[100:103]
    s_waitcnt lgkmcnt(14)
    buffer_load_dwordx4 v5, s[20:23], s26 offen offset:1024 sc1 lds
    v_mfma_f32_16x16x32_bf16 v[100:103], a[80:83], a[44:47], v[100:103]
    s_waitcnt lgkmcnt(13)
    v_mfma_f32_16x16x32_bf16 v[104:107], a[80:83], a[48:51], v[104:107]
    s_waitcnt lgkmcnt(12)
    v_mfma_f32_16x16x32_bf16 v[104:107], a[84:87], a[68:71], v[104:107]
    s_waitcnt lgkmcnt(11)
    v_mfma_f32_16x16x32_bf16 v[108:111], a[84:87], a[72:75], v[108:111]
    s_waitcnt lgkmcnt(10)
    buffer_load_dwordx4 v5, s[20:23], s26 offen offset:2048 sc1 lds
    v_mfma_f32_16x16x32_bf16 v[108:111], a[80:83], a[52:55], v[108:111]
    s_waitcnt lgkmcnt(9)
    v_mfma_f32_16x16x32_bf16 v[112:115], a[80:83], a[56:59], v[112:115]
    s_waitcnt lgkmcnt(8)
    v_mfma_f32_16x16x32_bf16 v[112:115], a[84:87], a[76:79], v[112:115]
    s_waitcnt lgkmcnt(6)
    v_mfma_f32_16x16x32_bf16 v[132:135], a[92:95], a[76:79], v[132:135]
    s_waitcnt lgkmcnt(4)
    ds_read_b64_tr_b16 a[84:85], v8 offset:41216
    ds_read_b64_tr_b16 a[86:87], v8 offset:45312
    v_mfma_f32_16x16x32_bf16 v[132:135], a[88:91], a[56:59], v[132:135]
    ds_read_b64_tr_b16 a[80:81], v8 offset:33024
    ds_read_b64_tr_b16 a[82:83], v8 offset:37120
    v_mfma_f32_16x16x32_bf16 v[128:131], a[88:91], a[52:55], v[128:131]
    buffer_load_dwordx4 v5, s[20:23], s26 offen offset:3072 sc1 lds
    v_mfma_f32_16x16x32_bf16 v[128:131], a[92:95], a[72:75], v[128:131]
    v_mfma_f32_16x16x32_bf16 v[124:127], a[92:95], a[68:71], v[124:127]
    s_add_u32 m0, s30, 4096
    v_mfma_f32_16x16x32_bf16 v[124:127], a[88:91], a[48:51], v[124:127]
    buffer_load_dwordx4 v6, s[20:23], s26 offen sc1 lds
    v_mfma_f32_16x16x32_bf16 v[120:123], a[88:91], a[44:47], v[120:123]
    s_add_u32 s28, s25, 5
    s_and_b32 s28, s28, 7
    s_or_b32 s28, s28, 8
    s_lshl_b32 s28, s28, 1
    v_mfma_f32_16x16x32_bf16 v[120:123], a[92:95], a[64:67], v[120:123]
    s_add_u32 s28, s28, s31
    s_lshl_b32 s27, s28, 16
    s_add_u32 m0, s32, 114688
    v_mfma_f32_16x16x32_bf16 v[116:119], a[92:95], a[60:63], v[116:119]
    s_waitcnt vmcnt(18) lgkmcnt(0)
    s_barrier
    v_mfma_f32_16x16x32_bf16 v[116:119], a[88:91], a[40:43], v[116:119]
    ds_read_b128 a[0:3], v10
    ds_read_b128 a[20:23], v10 offset:10240
    v_mfma_f32_16x16x32_bf16 v[136:139], a[96:99], a[40:43], v[136:139]
    ds_read_b64_tr_b16 a[88:89], v216
    ds_read_b64_tr_b16 a[90:91], v216 offset:4096
    v_mfma_f32_16x16x32_bf16 v[136:139], a[100:103], a[60:63], v[136:139]
    ds_read_b64_tr_b16 a[92:93], v216 offset:8192
    ds_read_b64_tr_b16 a[94:95], v216 offset:12288
    v_mfma_f32_16x16x32_bf16 v[140:143], a[100:103], a[64:67], v[140:143]
    ds_read_b128 a[24:27], v10 offset:11264
    ds_read_b128 a[4:7], v10 offset:1024
    v_mfma_f32_16x16x32_bf16 v[140:143], a[96:99], a[44:47], v[140:143]
    ds_read_b128 a[8:11], v10 offset:2048
    ds_read_b128 a[28:31], v10 offset:12288
    v_mfma_f32_16x16x32_bf16 v[144:147], a[96:99], a[48:51], v[144:147]
    ds_read_b128 a[32:35], v10 offset:13312
    ds_read_b128 a[12:15], v10 offset:3072
    v_mfma_f32_16x16x32_bf16 v[144:147], a[100:103], a[68:71], v[144:147]
    ds_read_b128 a[16:19], v10 offset:4096
    ds_read_b128 a[36:39], v10 offset:14336
    v_mfma_f32_16x16x32_bf16 v[148:151], a[100:103], a[72:75], v[148:151]
    buffer_load_dwordx4 v1, s[8:11], s27 offen lds
    v_mfma_f32_16x16x32_bf16 v[148:151], a[96:99], a[52:55], v[148:151]
    buffer_load_dwordx4 v2, s[8:11], s27 offen offset:1024 lds
    v_mfma_f32_16x16x32_bf16 v[152:155], a[96:99], a[56:59], v[152:155]
    v_mfma_f32_16x16x32_bf16 v[152:155], a[100:103], a[76:79], v[152:155]
    v_mfma_f32_16x16x32_bf16 v[172:175], a[84:87], a[76:79], v[172:175]
    ds_read_b64_tr_b16 a[100:101], v217 offset:8192
    ds_read_b64_tr_b16 a[102:103], v217 offset:12288
    v_mfma_f32_16x16x32_bf16 v[172:175], a[80:83], a[56:59], v[172:175]
    ds_read_b64_tr_b16 a[96:97], v217
    ds_read_b64_tr_b16 a[98:99], v217 offset:4096
    v_mfma_f32_16x16x32_bf16 v[168:171], a[80:83], a[52:55], v[168:171]
    buffer_load_dwordx4 v3, s[8:11], s27 offen offset:2048 lds
    v_mfma_f32_16x16x32_bf16 v[168:171], a[84:87], a[72:75], v[168:171]
    v_mfma_f32_16x16x32_bf16 v[164:167], a[84:87], a[68:71], v[164:167]
    buffer_load_dwordx4 v4, s[8:11], s27 offen offset:3072 lds
    v_mfma_f32_16x16x32_bf16 v[164:167], a[80:83], a[48:51], v[164:167]
    s_add_u32 s28, s25, 5
    s_and_b32 s28, s28, 7
    s_or_b32 s28, s28, 8
    v_mfma_f32_16x16x32_bf16 v[160:163], a[80:83], a[44:47], v[160:163]
    s_lshl_b32 s28, s28, 1
    s_add_u32 s28, s28, s31
    v_mfma_f32_16x16x32_bf16 v[160:163], a[84:87], a[64:67], v[160:163]
    s_mul_i32 s26, s28, 10240
    s_add_u32 m0, s30, 20480
    v_mfma_f32_16x16x32_bf16 v[156:159], a[84:87], a[60:63], v[156:159]
    buffer_load_dwordx4 v5, s[20:23], s26 offen sc1 lds
    v_mfma_f32_16x16x32_bf16 v[156:159], a[80:83], a[40:43], v[156:159]
    s_waitcnt lgkmcnt(14)
    v_mfma_f32_16x16x32_bf16 v[96:99], a[88:91], a[0:3], v[96:99]
    s_waitcnt lgkmcnt(12)
    ds_read_b64_tr_b16 a[80:81], v216 offset:256
    ds_read_b64_tr_b16 a[82:83], v216 offset:4352
    v_mfma_f32_16x16x32_bf16 v[96:99], a[92:95], a[20:23], v[96:99]
    s_waitcnt lgkmcnt(13)
    ds_read_b64_tr_b16 a[84:85], v216 offset:8448
    ds_read_b64_tr_b16 a[86:87], v216 offset:12544
    v_mfma_f32_16x16x32_bf16 v[100:103], a[92:95], a[24:27], v[100:103]
    s_waitcnt lgkmcnt(14)
    buffer_load_dwordx4 v5, s[20:23], s26 offen offset:1024 sc1 lds
    v_mfma_f32_16x16x32_bf16 v[100:103], a[88:91], a[4:7], v[100:103]
    s_waitcnt lgkmcnt(13)
    v_mfma_f32_16x16x32_bf16 v[104:107], a[88:91], a[8:11], v[104:107]
    s_waitcnt lgkmcnt(12)
    v_mfma_f32_16x16x32_bf16 v[104:107], a[92:95], a[28:31], v[104:107]
    s_waitcnt lgkmcnt(11)
    v_mfma_f32_16x16x32_bf16 v[108:111], a[92:95], a[32:35], v[108:111]
    s_waitcnt lgkmcnt(10)
    buffer_load_dwordx4 v5, s[20:23], s26 offen offset:2048 sc1 lds
    v_mfma_f32_16x16x32_bf16 v[108:111], a[88:91], a[12:15], v[108:111]
    s_waitcnt lgkmcnt(9)
    v_mfma_f32_16x16x32_bf16 v[112:115], a[88:91], a[16:19], v[112:115]
    s_waitcnt lgkmcnt(8)
    v_mfma_f32_16x16x32_bf16 v[112:115], a[92:95], a[36:39], v[112:115]
    s_waitcnt lgkmcnt(6)
    v_mfma_f32_16x16x32_bf16 v[132:135], a[100:103], a[36:39], v[132:135]
    s_waitcnt lgkmcnt(4)
    ds_read_b64_tr_b16 a[92:93], v217 offset:8448
    ds_read_b64_tr_b16 a[94:95], v217 offset:12544
    v_mfma_f32_16x16x32_bf16 v[132:135], a[96:99], a[16:19], v[132:135]
    ds_read_b64_tr_b16 a[88:89], v217 offset:256
    ds_read_b64_tr_b16 a[90:91], v217 offset:4352
    v_mfma_f32_16x16x32_bf16 v[128:131], a[96:99], a[12:15], v[128:131]
    buffer_load_dwordx4 v5, s[20:23], s26 offen offset:3072 sc1 lds
    v_mfma_f32_16x16x32_bf16 v[128:131], a[100:103], a[32:35], v[128:131]
    v_mfma_f32_16x16x32_bf16 v[124:127], a[100:103], a[28:31], v[124:127]
    s_add_u32 m0, s30, 24576
    v_mfma_f32_16x16x32_bf16 v[124:127], a[96:99], a[8:11], v[124:127]
    buffer_load_dwordx4 v6, s[20:23], s26 offen sc1 lds
    v_mfma_f32_16x16x32_bf16 v[120:123], a[96:99], a[4:7], v[120:123]
    s_add_u32 s28, s25, 6
    s_and_b32 s28, s28, 7
    s_or_b32 s28, s28, 8
    s_lshl_b32 s28, s28, 1
    v_mfma_f32_16x16x32_bf16 v[120:123], a[100:103], a[24:27], v[120:123]
    s_add_u32 s28, s28, s31
    s_lshl_b32 s27, s28, 16
    s_add_u32 m0, s32, 131072
    v_mfma_f32_16x16x32_bf16 v[116:119], a[100:103], a[20:23], v[116:119]
    s_waitcnt vmcnt(18) lgkmcnt(0)
    s_barrier
    v_mfma_f32_16x16x32_bf16 v[116:119], a[96:99], a[0:3], v[116:119]
    ds_read_b128 a[40:43], v10 offset:20480
    ds_read_b128 a[60:63], v10 offset:30720
    v_mfma_f32_16x16x32_bf16 v[136:139], a[80:83], a[0:3], v[136:139]
    ds_read_b64_tr_b16 a[96:97], v216 offset:16384
    ds_read_b64_tr_b16 a[98:99], v216 offset:20480
    v_mfma_f32_16x16x32_bf16 v[136:139], a[84:87], a[20:23], v[136:139]
    ds_read_b64_tr_b16 a[100:101], v216 offset:24576
    ds_read_b64_tr_b16 a[102:103], v216 offset:28672
    v_mfma_f32_16x16x32_bf16 v[140:143], a[84:87], a[24:27], v[140:143]
    ds_read_b128 a[64:67], v10 offset:31744
    ds_read_b128 a[44:47], v10 offset:21504
    v_mfma_f32_16x16x32_bf16 v[140:143], a[80:83], a[4:7], v[140:143]
    ds_read_b128 a[48:51], v10 offset:22528
    ds_read_b128 a[68:71], v10 offset:32768
    v_mfma_f32_16x16x32_bf16 v[144:147], a[80:83], a[8:11], v[144:147]
    ds_read_b128 a[72:75], v10 offset:33792
    ds_read_b128 a[52:55], v10 offset:23552
    v_mfma_f32_16x16x32_bf16 v[144:147], a[84:87], a[28:31], v[144:147]
    ds_read_b128 a[56:59], v10 offset:24576
    ds_read_b128 a[76:79], v10 offset:34816
    v_mfma_f32_16x16x32_bf16 v[148:151], a[84:87], a[32:35], v[148:151]
    buffer_load_dwordx4 v1, s[8:11], s27 offen lds
    v_mfma_f32_16x16x32_bf16 v[148:151], a[80:83], a[12:15], v[148:151]
    buffer_load_dwordx4 v2, s[8:11], s27 offen offset:1024 lds
    v_mfma_f32_16x16x32_bf16 v[152:155], a[80:83], a[16:19], v[152:155]
    v_mfma_f32_16x16x32_bf16 v[152:155], a[84:87], a[36:39], v[152:155]
    v_mfma_f32_16x16x32_bf16 v[172:175], a[92:95], a[36:39], v[172:175]
    ds_read_b64_tr_b16 a[84:85], v217 offset:24576
    ds_read_b64_tr_b16 a[86:87], v217 offset:28672
    v_mfma_f32_16x16x32_bf16 v[172:175], a[88:91], a[16:19], v[172:175]
    ds_read_b64_tr_b16 a[80:81], v217 offset:16384
    ds_read_b64_tr_b16 a[82:83], v217 offset:20480
    v_mfma_f32_16x16x32_bf16 v[168:171], a[88:91], a[12:15], v[168:171]
    buffer_load_dwordx4 v3, s[8:11], s27 offen offset:2048 lds
    v_mfma_f32_16x16x32_bf16 v[168:171], a[92:95], a[32:35], v[168:171]
    v_mfma_f32_16x16x32_bf16 v[164:167], a[92:95], a[28:31], v[164:167]
    buffer_load_dwordx4 v4, s[8:11], s27 offen offset:3072 lds
    v_mfma_f32_16x16x32_bf16 v[164:167], a[88:91], a[8:11], v[164:167]
    s_add_u32 s28, s25, 6
    s_and_b32 s28, s28, 7
    s_or_b32 s28, s28, 8
    v_mfma_f32_16x16x32_bf16 v[160:163], a[88:91], a[4:7], v[160:163]
    s_lshl_b32 s28, s28, 1
    s_add_u32 s28, s28, s31
    v_mfma_f32_16x16x32_bf16 v[160:163], a[92:95], a[24:27], v[160:163]
    s_mul_i32 s26, s28, 10240
    s_add_u32 m0, s30, 40960
    v_mfma_f32_16x16x32_bf16 v[156:159], a[92:95], a[20:23], v[156:159]
    buffer_load_dwordx4 v5, s[20:23], s26 offen sc1 lds
    v_mfma_f32_16x16x32_bf16 v[156:159], a[88:91], a[0:3], v[156:159]
    s_waitcnt lgkmcnt(14)
    v_mfma_f32_16x16x32_bf16 v[96:99], a[96:99], a[40:43], v[96:99]
    s_waitcnt lgkmcnt(12)
    ds_read_b64_tr_b16 a[88:89], v216 offset:16640
    ds_read_b64_tr_b16 a[90:91], v216 offset:20736
    v_mfma_f32_16x16x32_bf16 v[96:99], a[100:103], a[60:63], v[96:99]
    s_waitcnt lgkmcnt(13)
    ds_read_b64_tr_b16 a[92:93], v216 offset:24832
    ds_read_b64_tr_b16 a[94:95], v216 offset:28928
    v_mfma_f32_16x16x32_bf16 v[100:103], a[100:103], a[64:67], v[100:103]
    s_waitcnt lgkmcnt(14)
    buffer_load_dwordx4 v5, s[20:23], s26 offen offset:1024 sc1 lds
    v_mfma_f32_16x16x32_bf16 v[100:103], a[96:99], a[44:47], v[100:103]
    s_waitcnt lgkmcnt(13)
    v_mfma_f32_16x16x32_bf16 v[104:107], a[96:99], a[48:51], v[104:107]
    s_waitcnt lgkmcnt(12)
    v_mfma_f32_16x16x32_bf16 v[104:107], a[100:103], a[68:71], v[104:107]
    s_waitcnt lgkmcnt(11)
    v_mfma_f32_16x16x32_bf16 v[108:111], a[100:103], a[72:75], v[108:111]
    s_waitcnt lgkmcnt(10)
    buffer_load_dwordx4 v5, s[20:23], s26 offen offset:2048 sc1 lds
    v_mfma_f32_16x16x32_bf16 v[108:111], a[96:99], a[52:55], v[108:111]
    s_waitcnt lgkmcnt(9)
    v_mfma_f32_16x16x32_bf16 v[112:115], a[96:99], a[56:59], v[112:115]
    s_waitcnt lgkmcnt(8)
    v_mfma_f32_16x16x32_bf16 v[112:115], a[100:103], a[76:79], v[112:115]
    s_waitcnt lgkmcnt(6)
    v_mfma_f32_16x16x32_bf16 v[132:135], a[84:87], a[76:79], v[132:135]
    s_waitcnt lgkmcnt(4)
    ds_read_b64_tr_b16 a[100:101], v217 offset:24832
    ds_read_b64_tr_b16 a[102:103], v217 offset:28928
    v_mfma_f32_16x16x32_bf16 v[132:135], a[80:83], a[56:59], v[132:135]
    ds_read_b64_tr_b16 a[96:97], v217 offset:16640
    ds_read_b64_tr_b16 a[98:99], v217 offset:20736
    v_mfma_f32_16x16x32_bf16 v[128:131], a[80:83], a[52:55], v[128:131]
    buffer_load_dwordx4 v5, s[20:23], s26 offen offset:3072 sc1 lds
    v_mfma_f32_16x16x32_bf16 v[128:131], a[84:87], a[72:75], v[128:131]
    v_mfma_f32_16x16x32_bf16 v[124:127], a[84:87], a[68:71], v[124:127]
    s_add_u32 m0, s30, 45056
    v_mfma_f32_16x16x32_bf16 v[124:127], a[80:83], a[48:51], v[124:127]
    buffer_load_dwordx4 v6, s[20:23], s26 offen sc1 lds
    v_mfma_f32_16x16x32_bf16 v[120:123], a[80:83], a[44:47], v[120:123]
    s_add_u32 s28, s25, 7
    s_and_b32 s28, s28, 7
    s_or_b32 s28, s28, 8
    s_lshl_b32 s28, s28, 1
    v_mfma_f32_16x16x32_bf16 v[120:123], a[84:87], a[64:67], v[120:123]
    s_add_u32 s28, s28, s31
    s_lshl_b32 s27, s28, 16
    s_add_u32 m0, s32, 147456
    v_mfma_f32_16x16x32_bf16 v[116:119], a[84:87], a[60:63], v[116:119]
    s_waitcnt vmcnt(18) lgkmcnt(0)
    s_barrier
    v_mfma_f32_16x16x32_bf16 v[116:119], a[80:83], a[40:43], v[116:119]
    ds_read_b128 a[0:3], v9
    ds_read_b128 a[20:23], v9 offset:10240
    v_mfma_f32_16x16x32_bf16 v[136:139], a[88:91], a[40:43], v[136:139]
    ds_read_b64_tr_b16 a[80:81], v7 offset:16384
    ds_read_b64_tr_b16 a[82:83], v7 offset:20480
    v_mfma_f32_16x16x32_bf16 v[136:139], a[92:95], a[60:63], v[136:139]
    ds_read_b64_tr_b16 a[84:85], v7 offset:24576
    ds_read_b64_tr_b16 a[86:87], v7 offset:28672
    v_mfma_f32_16x16x32_bf16 v[140:143], a[92:95], a[64:67], v[140:143]
    ds_read_b128 a[24:27], v9 offset:11264
    ds_read_b128 a[4:7], v9 offset:1024
    v_mfma_f32_16x16x32_bf16 v[140:143], a[88:91], a[44:47], v[140:143]
    ds_read_b128 a[8:11], v9 offset:2048
    ds_read_b128 a[28:31], v9 offset:12288
    v_mfma_f32_16x16x32_bf16 v[144:147], a[88:91], a[48:51], v[144:147]
    ds_read_b128 a[32:35], v9 offset:13312
    ds_read_b128 a[12:15], v9 offset:3072
    v_mfma_f32_16x16x32_bf16 v[144:147], a[92:95], a[68:71], v[144:147]
    ds_read_b128 a[16:19], v9 offset:4096
    ds_read_b128 a[36:39], v9 offset:14336
    v_mfma_f32_16x16x32_bf16 v[148:151], a[92:95], a[72:75], v[148:151]
    buffer_load_dwordx4 v1, s[8:11], s27 offen lds
    v_mfma_f32_16x16x32_bf16 v[148:151], a[88:91], a[52:55], v[148:151]
    buffer_load_dwordx4 v2, s[8:11], s27 offen offset:1024 lds
    v_mfma_f32_16x16x32_bf16 v[152:155], a[88:91], a[56:59], v[152:155]
    v_mfma_f32_16x16x32_bf16 v[152:155], a[92:95], a[76:79], v[152:155]
    v_mfma_f32_16x16x32_bf16 v[172:175], a[100:103], a[76:79], v[172:175]
    ds_read_b64_tr_b16 a[92:93], v8 offset:24576
    ds_read_b64_tr_b16 a[94:95], v8 offset:28672
    v_mfma_f32_16x16x32_bf16 v[172:175], a[96:99], a[56:59], v[172:175]
    ds_read_b64_tr_b16 a[88:89], v8 offset:16384
    ds_read_b64_tr_b16 a[90:91], v8 offset:20480
    v_mfma_f32_16x16x32_bf16 v[168:171], a[96:99], a[52:55], v[168:171]
    buffer_load_dwordx4 v3, s[8:11], s27 offen offset:2048 lds
    v_mfma_f32_16x16x32_bf16 v[168:171], a[100:103], a[72:75], v[168:171]
    v_mfma_f32_16x16x32_bf16 v[164:167], a[100:103], a[68:71], v[164:167]
    buffer_load_dwordx4 v4, s[8:11], s27 offen offset:3072 lds
    v_mfma_f32_16x16x32_bf16 v[164:167], a[96:99], a[48:51], v[164:167]
    s_add_u32 s28, s25, 7
    s_and_b32 s28, s28, 7
    s_or_b32 s28, s28, 8
    v_mfma_f32_16x16x32_bf16 v[160:163], a[96:99], a[44:47], v[160:163]
    s_lshl_b32 s28, s28, 1
    s_add_u32 s28, s28, s31
    v_mfma_f32_16x16x32_bf16 v[160:163], a[100:103], a[64:67], v[160:163]
    s_mul_i32 s26, s28, 10240
    s_add_u32 m0, s30, 61440
    v_mfma_f32_16x16x32_bf16 v[156:159], a[100:103], a[60:63], v[156:159]
    buffer_load_dwordx4 v5, s[20:23], s26 offen sc1 lds
    v_mfma_f32_16x16x32_bf16 v[156:159], a[96:99], a[40:43], v[156:159]
    s_waitcnt lgkmcnt(14)
    v_mfma_f32_16x16x32_bf16 v[96:99], a[80:83], a[0:3], v[96:99]
    s_waitcnt lgkmcnt(12)
    ds_read_b64_tr_b16 a[96:97], v7 offset:16640
    ds_read_b64_tr_b16 a[98:99], v7 offset:20736
    v_mfma_f32_16x16x32_bf16 v[96:99], a[84:87], a[20:23], v[96:99]
    s_waitcnt lgkmcnt(13)
    ds_read_b64_tr_b16 a[100:101], v7 offset:24832
    ds_read_b64_tr_b16 a[102:103], v7 offset:28928
    v_mfma_f32_16x16x32_bf16 v[100:103], a[84:87], a[24:27], v[100:103]
    s_waitcnt lgkmcnt(14)
    buffer_load_dwordx4 v5, s[20:23], s26 offen offset:1024 sc1 lds
    v_mfma_f32_16x16x32_bf16 v[100:103], a[80:83], a[4:7], v[100:103]
    s_waitcnt lgkmcnt(13)
    v_mfma_f32_16x16x32_bf16 v[104:107], a[80:83], a[8:11], v[104:107]
    s_waitcnt lgkmcnt(12)
    v_mfma_f32_16x16x32_bf16 v[104:107], a[84:87], a[28:31], v[104:107]
    s_waitcnt lgkmcnt(11)
    v_mfma_f32_16x16x32_bf16 v[108:111], a[84:87], a[32:35], v[108:111]
    s_waitcnt lgkmcnt(10)
    buffer_load_dwordx4 v5, s[20:23], s26 offen offset:2048 sc1 lds
    v_mfma_f32_16x16x32_bf16 v[108:111], a[80:83], a[12:15], v[108:111]
    s_waitcnt lgkmcnt(9)
    v_mfma_f32_16x16x32_bf16 v[112:115], a[80:83], a[16:19], v[112:115]
    s_waitcnt lgkmcnt(8)
    v_mfma_f32_16x16x32_bf16 v[112:115], a[84:87], a[36:39], v[112:115]
    s_waitcnt lgkmcnt(6)
    v_mfma_f32_16x16x32_bf16 v[132:135], a[92:95], a[36:39], v[132:135]
    s_waitcnt lgkmcnt(4)
    ds_read_b64_tr_b16 a[84:85], v8 offset:24832
    ds_read_b64_tr_b16 a[86:87], v8 offset:28928
    v_mfma_f32_16x16x32_bf16 v[132:135], a[88:91], a[16:19], v[132:135]
    ds_read_b64_tr_b16 a[80:81], v8 offset:16640
    ds_read_b64_tr_b16 a[82:83], v8 offset:20736
    v_mfma_f32_16x16x32_bf16 v[128:131], a[88:91], a[12:15], v[128:131]
    buffer_load_dwordx4 v5, s[20:23], s26 offen offset:3072 sc1 lds
    v_mfma_f32_16x16x32_bf16 v[128:131], a[92:95], a[32:35], v[128:131]
    v_mfma_f32_16x16x32_bf16 v[124:127], a[92:95], a[28:31], v[124:127]
    s_add_u32 m0, s30, 65536
    v_mfma_f32_16x16x32_bf16 v[124:127], a[88:91], a[8:11], v[124:127]
    buffer_load_dwordx4 v6, s[20:23], s26 offen sc1 lds
    v_mfma_f32_16x16x32_bf16 v[120:123], a[88:91], a[4:7], v[120:123]
    s_add_u32 s28, s25, 0
    s_and_b32 s28, s28, 7
    s_or_b32 s28, s28, 16
    s_lshl_b32 s28, s28, 1
    v_mfma_f32_16x16x32_bf16 v[120:123], a[92:95], a[24:27], v[120:123]
    s_add_u32 s28, s28, s31
    s_lshl_b32 s27, s28, 16
    s_add_u32 m0, s32, 98304
    v_mfma_f32_16x16x32_bf16 v[116:119], a[92:95], a[20:23], v[116:119]
    s_waitcnt vmcnt(18) lgkmcnt(0)
    s_barrier
    v_mfma_f32_16x16x32_bf16 v[116:119], a[88:91], a[0:3], v[116:119]
    ds_read_b128 a[40:43], v9 offset:20480
    ds_read_b128 a[60:63], v9 offset:30720
    v_mfma_f32_16x16x32_bf16 v[136:139], a[96:99], a[0:3], v[136:139]
    ds_read_b64_tr_b16 a[88:89], v7 offset:32768
    ds_read_b64_tr_b16 a[90:91], v7 offset:36864
    v_mfma_f32_16x16x32_bf16 v[136:139], a[100:103], a[20:23], v[136:139]
    ds_read_b64_tr_b16 a[92:93], v7 offset:40960
    ds_read_b64_tr_b16 a[94:95], v7 offset:45056
    v_mfma_f32_16x16x32_bf16 v[140:143], a[100:103], a[24:27], v[140:143]
    ds_read_b128 a[64:67], v9 offset:31744
    ds_read_b128 a[44:47], v9 offset:21504
    v_mfma_f32_16x16x32_bf16 v[140:143], a[96:99], a[4:7], v[140:143]
    ds_read_b128 a[48:51], v9 offset:22528
    ds_read_b128 a[68:71], v9 offset:32768
    v_mfma_f32_16x16x32_bf16 v[144:147], a[96:99], a[8:11], v[144:147]
    ds_read_b128 a[72:75], v9 offset:33792
    ds_read_b128 a[52:55], v9 offset:23552
    v_mfma_f32_16x16x32_bf16 v[144:147], a[100:103], a[28:31], v[144:147]
    ds_read_b128 a[56:59], v9 offset:24576
    ds_read_b128 a[76:79], v9 offset:34816
    v_mfma_f32_16x16x32_bf16 v[148:151], a[100:103], a[32:35], v[148:151]
    buffer_load_dwordx4 v1, s[8:11], s27 offen lds
    v_mfma_f32_16x16x32_bf16 v[148:151], a[96:99], a[12:15], v[148:151]
    buffer_load_dwordx4 v2, s[8:11], s27 offen offset:1024 lds
    v_mfma_f32_16x16x32_bf16 v[152:155], a[96:99], a[16:19], v[152:155]
    v_mfma_f32_16x16x32_bf16 v[152:155], a[100:103], a[36:39], v[152:155]
    v_mfma_f32_16x16x32_bf16 v[172:175], a[84:87], a[36:39], v[172:175]
    ds_read_b64_tr_b16 a[100:101], v8 offset:40960
    ds_read_b64_tr_b16 a[102:103], v8 offset:45056
    v_mfma_f32_16x16x32_bf16 v[172:175], a[80:83], a[16:19], v[172:175]
    ds_read_b64_tr_b16 a[96:97], v8 offset:32768
    ds_read_b64_tr_b16 a[98:99], v8 offset:36864
    v_mfma_f32_16x16x32_bf16 v[168:171], a[80:83], a[12:15], v[168:171]
    buffer_load_dwordx4 v3, s[8:11], s27 offen offset:2048 lds
    v_mfma_f32_16x16x32_bf16 v[168:171], a[84:87], a[32:35], v[168:171]
    v_mfma_f32_16x16x32_bf16 v[164:167], a[84:87], a[28:31], v[164:167]
    buffer_load_dwordx4 v4, s[8:11], s27 offen offset:3072 lds
    v_mfma_f32_16x16x32_bf16 v[164:167], a[80:83], a[8:11], v[164:167]
    s_add_u32 s28, s25, 0
    s_and_b32 s28, s28, 7
    s_or_b32 s28, s28, 16
    v_mfma_f32_16x16x32_bf16 v[160:163], a[80:83], a[4:7], v[160:163]
    s_lshl_b32 s28, s28, 1
    s_add_u32 s28, s28, s31
    v_mfma_f32_16x16x32_bf16 v[160:163], a[84:87], a[24:27], v[160:163]
    s_mul_i32 s26, s28, 10240
    s_add_u32 m0, s30, 0
    v_mfma_f32_16x16x32_bf16 v[156:159], a[84:87], a[20:23], v[156:159]
    buffer_load_dwordx4 v5, s[20:23], s26 offen sc1 lds
    v_mfma_f32_16x16x32_bf16 v[156:159], a[80:83], a[0:3], v[156:159]
    s_waitcnt lgkmcnt(14)
    v_mfma_f32_16x16x32_bf16 v[96:99], a[88:91], a[40:43], v[96:99]
    s_waitcnt lgkmcnt(12)
    ds_read_b64_tr_b16 a[80:81], v7 offset:33024
    ds_read_b64_tr_b16 a[82:83], v7 offset:37120
    v_mfma_f32_16x16x32_bf16 v[96:99], a[92:95], a[60:63], v[96:99]
    s_waitcnt lgkmcnt(13)
    ds_read_b64_tr_b16 a[84:85], v7 offset:41216
    ds_read_b64_tr_b16 a[86:87], v7 offset:45312
    v_mfma_f32_16x16x32_bf16 v[100:103], a[92:95], a[64:67], v[100:103]
    s_waitcnt lgkmcnt(14)
    buffer_load_dwordx4 v5, s[20:23], s26 offen offset:1024 sc1 lds
    v_mfma_f32_16x16x32_bf16 v[100:103], a[88:91], a[44:47], v[100:103]
    s_waitcnt lgkmcnt(13)
    v_mfma_f32_16x16x32_bf16 v[104:107], a[88:91], a[48:51], v[104:107]
    s_waitcnt lgkmcnt(12)
    v_mfma_f32_16x16x32_bf16 v[104:107], a[92:95], a[68:71], v[104:107]
    s_waitcnt lgkmcnt(11)
    v_mfma_f32_16x16x32_bf16 v[108:111], a[92:95], a[72:75], v[108:111]
    s_waitcnt lgkmcnt(10)
    buffer_load_dwordx4 v5, s[20:23], s26 offen offset:2048 sc1 lds
    v_mfma_f32_16x16x32_bf16 v[108:111], a[88:91], a[52:55], v[108:111]
    s_waitcnt lgkmcnt(9)
    v_mfma_f32_16x16x32_bf16 v[112:115], a[88:91], a[56:59], v[112:115]
    s_waitcnt lgkmcnt(8)
    v_mfma_f32_16x16x32_bf16 v[112:115], a[92:95], a[76:79], v[112:115]
    s_waitcnt lgkmcnt(6)
    v_mfma_f32_16x16x32_bf16 v[132:135], a[100:103], a[76:79], v[132:135]
    s_waitcnt lgkmcnt(4)
    ds_read_b64_tr_b16 a[92:93], v8 offset:41216
    ds_read_b64_tr_b16 a[94:95], v8 offset:45312
    v_mfma_f32_16x16x32_bf16 v[132:135], a[96:99], a[56:59], v[132:135]
    ds_read_b64_tr_b16 a[88:89], v8 offset:33024
    ds_read_b64_tr_b16 a[90:91], v8 offset:37120
    v_mfma_f32_16x16x32_bf16 v[128:131], a[96:99], a[52:55], v[128:131]
    buffer_load_dwordx4 v5, s[20:23], s26 offen offset:3072 sc1 lds
    v_mfma_f32_16x16x32_bf16 v[128:131], a[100:103], a[72:75], v[128:131]
    v_mfma_f32_16x16x32_bf16 v[124:127], a[100:103], a[68:71], v[124:127]
    s_add_u32 m0, s30, 4096
    v_mfma_f32_16x16x32_bf16 v[124:127], a[96:99], a[48:51], v[124:127]
    buffer_load_dwordx4 v6, s[20:23], s26 offen sc1 lds
    v_mfma_f32_16x16x32_bf16 v[120:123], a[96:99], a[44:47], v[120:123]
    s_add_u32 s28, s25, 1
    s_and_b32 s28, s28, 7
    s_or_b32 s28, s28, 16
    s_lshl_b32 s28, s28, 1
    v_mfma_f32_16x16x32_bf16 v[120:123], a[100:103], a[64:67], v[120:123]
    s_add_u32 s28, s28, s31
    s_lshl_b32 s27, s28, 16
    s_add_u32 m0, s32, 114688
    v_mfma_f32_16x16x32_bf16 v[116:119], a[100:103], a[60:63], v[116:119]
    s_waitcnt vmcnt(18) lgkmcnt(0)
    s_barrier
    v_mfma_f32_16x16x32_bf16 v[116:119], a[96:99], a[40:43], v[116:119]
    ds_read_b128 a[0:3], v10
    ds_read_b128 a[20:23], v10 offset:10240
    v_mfma_f32_16x16x32_bf16 v[136:139], a[80:83], a[40:43], v[136:139]
    ds_read_b64_tr_b16 a[96:97], v216
    ds_read_b64_tr_b16 a[98:99], v216 offset:4096
    v_mfma_f32_16x16x32_bf16 v[136:139], a[84:87], a[60:63], v[136:139]
    ds_read_b64_tr_b16 a[100:101], v216 offset:8192
    ds_read_b64_tr_b16 a[102:103], v216 offset:12288
    v_mfma_f32_16x16x32_bf16 v[140:143], a[84:87], a[64:67], v[140:143]
    ds_read_b128 a[24:27], v10 offset:11264
    ds_read_b128 a[4:7], v10 offset:1024
    v_mfma_f32_16x16x32_bf16 v[140:143], a[80:83], a[44:47], v[140:143]
    ds_read_b128 a[8:11], v10 offset:2048
    ds_read_b128 a[28:31], v10 offset:12288
    v_mfma_f32_16x16x32_bf16 v[144:147], a[80:83], a[48:51], v[144:147]
    ds_read_b128 a[32:35], v10 offset:13312
    ds_read_b128 a[12:15], v10 offset:3072
    v_mfma_f32_16x16x32_bf16 v[144:147], a[84:87], a[68:71], v[144:147]
    ds_read_b128 a[16:19], v10 offset:4096
    ds_read_b128 a[36:39], v10 offset:14336
    v_mfma_f32_16x16x32_bf16 v[148:151], a[84:87], a[72:75], v[148:151]
    buffer_load_dwordx4 v1, s[8:11], s27 offen lds
    v_mfma_f32_16x16x32_bf16 v[148:151], a[80:83], a[52:55], v[148:151]
    buffer_load_dwordx4 v2, s[8:11], s27 offen offset:1024 lds
    v_mfma_f32_16x16x32_bf16 v[152:155], a[80:83], a[56:59], v[152:155]
    v_mfma_f32_16x16x32_bf16 v[152:155], a[84:87], a[76:79], v[152:155]
    v_mfma_f32_16x16x32_bf16 v[172:175], a[92:95], a[76:79], v[172:175]
    ds_read_b64_tr_b16 a[84:85], v217 offset:8192
    ds_read_b64_tr_b16 a[86:87], v217 offset:12288
    v_mfma_f32_16x16x32_bf16 v[172:175], a[88:91], a[56:59], v[172:175]
    ds_read_b64_tr_b16 a[80:81], v217
    ds_read_b64_tr_b16 a[82:83], v217 offset:4096
    v_mfma_f32_16x16x32_bf16 v[168:171], a[88:91], a[52:55], v[168:171]
    buffer_load_dwordx4 v3, s[8:11], s27 offen offset:2048 lds
    v_mfma_f32_16x16x32_bf16 v[168:171], a[92:95], a[72:75], v[168:171]
    v_mfma_f32_16x16x32_bf16 v[164:167], a[92:95], a[68:71], v[164:167]
    buffer_load_dwordx4 v4, s[8:11], s27 offen offset:3072 lds
    v_mfma_f32_16x16x32_bf16 v[164:167], a[88:91], a[48:51], v[164:167]
    s_add_u32 s28, s25, 1
    s_and_b32 s28, s28, 7
    s_or_b32 s28, s28, 16
    v_mfma_f32_16x16x32_bf16 v[160:163], a[88:91], a[44:47], v[160:163]
    s_lshl_b32 s28, s28, 1
    s_add_u32 s28, s28, s31
    v_mfma_f32_16x16x32_bf16 v[160:163], a[92:95], a[64:67], v[160:163]
    s_mul_i32 s26, s28, 10240
    s_add_u32 m0, s30, 20480
    v_mfma_f32_16x16x32_bf16 v[156:159], a[92:95], a[60:63], v[156:159]
    buffer_load_dwordx4 v5, s[20:23], s26 offen sc1 lds
    v_mfma_f32_16x16x32_bf16 v[156:159], a[88:91], a[40:43], v[156:159]
    s_waitcnt lgkmcnt(14)
    v_mfma_f32_16x16x32_bf16 v[96:99], a[96:99], a[0:3], v[96:99]
    s_waitcnt lgkmcnt(12)
    ds_read_b64_tr_b16 a[88:89], v216 offset:256
    ds_read_b64_tr_b16 a[90:91], v216 offset:4352
    v_mfma_f32_16x16x32_bf16 v[96:99], a[100:103], a[20:23], v[96:99]
    s_waitcnt lgkmcnt(13)
    ds_read_b64_tr_b16 a[92:93], v216 offset:8448
    ds_read_b64_tr_b16 a[94:95], v216 offset:12544
    v_mfma_f32_16x16x32_bf16 v[100:103], a[100:103], a[24:27], v[100:103]
    s_waitcnt lgkmcnt(14)
    buffer_load_dwordx4 v5, s[20:23], s26 offen offset:1024 sc1 lds
    v_mfma_f32_16x16x32_bf16 v[100:103], a[96:99], a[4:7], v[100:103]
    s_waitcnt lgkmcnt(13)
    v_mfma_f32_16x16x32_bf16 v[104:107], a[96:99], a[8:11], v[104:107]
    s_waitcnt lgkmcnt(12)
    v_mfma_f32_16x16x32_bf16 v[104:107], a[100:103], a[28:31], v[104:107]
    s_waitcnt lgkmcnt(11)
    v_mfma_f32_16x16x32_bf16 v[108:111], a[100:103], a[32:35], v[108:111]
    s_waitcnt lgkmcnt(10)
    buffer_load_dwordx4 v5, s[20:23], s26 offen offset:2048 sc1 lds
    v_mfma_f32_16x16x32_bf16 v[108:111], a[96:99], a[12:15], v[108:111]
    s_waitcnt lgkmcnt(9)
    v_mfma_f32_16x16x32_bf16 v[112:115], a[96:99], a[16:19], v[112:115]
    s_waitcnt lgkmcnt(8)
    v_mfma_f32_16x16x32_bf16 v[112:115], a[100:103], a[36:39], v[112:115]
    s_waitcnt lgkmcnt(6)
    v_mfma_f32_16x16x32_bf16 v[132:135], a[84:87], a[36:39], v[132:135]
    s_waitcnt lgkmcnt(4)
    ds_read_b64_tr_b16 a[100:101], v217 offset:8448
    ds_read_b64_tr_b16 a[102:103], v217 offset:12544
    v_mfma_f32_16x16x32_bf16 v[132:135], a[80:83], a[16:19], v[132:135]
    ds_read_b64_tr_b16 a[96:97], v217 offset:256
    ds_read_b64_tr_b16 a[98:99], v217 offset:4352
    v_mfma_f32_16x16x32_bf16 v[128:131], a[80:83], a[12:15], v[128:131]
    buffer_load_dwordx4 v5, s[20:23], s26 offen offset:3072 sc1 lds
    v_mfma_f32_16x16x32_bf16 v[128:131], a[84:87], a[32:35], v[128:131]
    v_mfma_f32_16x16x32_bf16 v[124:127], a[84:87], a[28:31], v[124:127]
    s_add_u32 m0, s30, 24576
    v_mfma_f32_16x16x32_bf16 v[124:127], a[80:83], a[8:11], v[124:127]
    buffer_load_dwordx4 v6, s[20:23], s26 offen sc1 lds
    v_mfma_f32_16x16x32_bf16 v[120:123], a[80:83], a[4:7], v[120:123]
    s_add_u32 s28, s25, 2
    s_and_b32 s28, s28, 7
    s_or_b32 s28, s28, 16
    s_lshl_b32 s28, s28, 1
    v_mfma_f32_16x16x32_bf16 v[120:123], a[84:87], a[24:27], v[120:123]
    s_add_u32 s28, s28, s31
    s_lshl_b32 s27, s28, 16
    s_add_u32 m0, s32, 131072
    v_mfma_f32_16x16x32_bf16 v[116:119], a[84:87], a[20:23], v[116:119]
    s_waitcnt vmcnt(18) lgkmcnt(0)
    s_barrier
    v_mfma_f32_16x16x32_bf16 v[116:119], a[80:83], a[0:3], v[116:119]
    ds_read_b128 a[40:43], v10 offset:20480
    ds_read_b128 a[60:63], v10 offset:30720
    v_mfma_f32_16x16x32_bf16 v[136:139], a[88:91], a[0:3], v[136:139]
    ds_read_b64_tr_b16 a[80:81], v216 offset:16384
    ds_read_b64_tr_b16 a[82:83], v216 offset:20480
    v_mfma_f32_16x16x32_bf16 v[136:139], a[92:95], a[20:23], v[136:139]
    ds_read_b64_tr_b16 a[84:85], v216 offset:24576
    ds_read_b64_tr_b16 a[86:87], v216 offset:28672
    v_mfma_f32_16x16x32_bf16 v[140:143], a[92:95], a[24:27], v[140:143]
    ds_read_b128 a[64:67], v10 offset:31744
    ds_read_b128 a[44:47], v10 offset:21504
    v_mfma_f32_16x16x32_bf16 v[140:143], a[88:91], a[4:7], v[140:143]
    ds_read_b128 a[48:51], v10 offset:22528
    ds_read_b128 a[68:71], v10 offset:32768
    v_mfma_f32_16x16x32_bf16 v[144:147], a[88:91], a[8:11], v[144:147]
    ds_read_b128 a[72:75], v10 offset:33792
    ds_read_b128 a[52:55], v10 offset:23552
    v_mfma_f32_16x16x32_bf16 v[144:147], a[92:95], a[28:31], v[144:147]
    ds_read_b128 a[56:59], v10 offset:24576
    ds_read_b128 a[76:79], v10 offset:34816
    v_mfma_f32_16x16x32_bf16 v[148:151], a[92:95], a[32:35], v[148:151]
    buffer_load_dwordx4 v1, s[8:11], s27 offen lds
    v_mfma_f32_16x16x32_bf16 v[148:151], a[88:91], a[12:15], v[148:151]
    buffer_load_dwordx4 v2, s[8:11], s27 offen offset:1024 lds
    v_mfma_f32_16x16x32_bf16 v[152:155], a[88:91], a[16:19], v[152:155]
    v_mfma_f32_16x16x32_bf16 v[152:155], a[92:95], a[36:39], v[152:155]
    v_mfma_f32_16x16x32_bf16 v[172:175], a[100:103], a[36:39], v[172:175]
    ds_read_b64_tr_b16 a[92:93], v217 offset:24576
    ds_read_b64_tr_b16 a[94:95], v217 offset:28672
    v_mfma_f32_16x16x32_bf16 v[172:175], a[96:99], a[16:19], v[172:175]
    ds_read_b64_tr_b16 a[88:89], v217 offset:16384
    ds_read_b64_tr_b16 a[90:91], v217 offset:20480
    v_mfma_f32_16x16x32_bf16 v[168:171], a[96:99], a[12:15], v[168:171]
    buffer_load_dwordx4 v3, s[8:11], s27 offen offset:2048 lds
    v_mfma_f32_16x16x32_bf16 v[168:171], a[100:103], a[32:35], v[168:171]
    v_mfma_f32_16x16x32_bf16 v[164:167], a[100:103], a[28:31], v[164:167]
    buffer_load_dwordx4 v4, s[8:11], s27 offen offset:3072 lds
    v_mfma_f32_16x16x32_bf16 v[164:167], a[96:99], a[8:11], v[164:167]
    s_add_u32 s28, s25, 2
    s_and_b32 s28, s28, 7
    s_or_b32 s28, s28, 16
    v_mfma_f32_16x16x32_bf16 v[160:163], a[96:99], a[4:7], v[160:163]
    s_lshl_b32 s28, s28, 1
    s_add_u32 s28, s28, s31
    v_mfma_f32_16x16x32_bf16 v[160:163], a[100:103], a[24:27], v[160:163]
    s_mul_i32 s26, s28, 10240
    s_add_u32 m0, s30, 40960
    v_mfma_f32_16x16x32_bf16 v[156:159], a[100:103], a[20:23], v[156:159]
    buffer_load_dwordx4 v5, s[20:23], s26 offen sc1 lds
    v_mfma_f32_16x16x32_bf16 v[156:159], a[96:99], a[0:3], v[156:159]
    s_waitcnt lgkmcnt(14)
    v_mfma_f32_16x16x32_bf16 v[96:99], a[80:83], a[40:43], v[96:99]
    s_waitcnt lgkmcnt(12)
    ds_read_b64_tr_b16 a[96:97], v216 offset:16640
    ds_read_b64_tr_b16 a[98:99], v216 offset:20736
    v_mfma_f32_16x16x32_bf16 v[96:99], a[84:87], a[60:63], v[96:99]
    s_waitcnt lgkmcnt(13)
    ds_read_b64_tr_b16 a[100:101], v216 offset:24832
    ds_read_b64_tr_b16 a[102:103], v216 offset:28928
    v_mfma_f32_16x16x32_bf16 v[100:103], a[84:87], a[64:67], v[100:103]
    s_waitcnt lgkmcnt(14)
    buffer_load_dwordx4 v5, s[20:23], s26 offen offset:1024 sc1 lds
    v_mfma_f32_16x16x32_bf16 v[100:103], a[80:83], a[44:47], v[100:103]
    s_waitcnt lgkmcnt(13)
    v_mfma_f32_16x16x32_bf16 v[104:107], a[80:83], a[48:51], v[104:107]
    s_waitcnt lgkmcnt(12)
    v_mfma_f32_16x16x32_bf16 v[104:107], a[84:87], a[68:71], v[104:107]
    s_waitcnt lgkmcnt(11)
    v_mfma_f32_16x16x32_bf16 v[108:111], a[84:87], a[72:75], v[108:111]
    s_waitcnt lgkmcnt(10)
    buffer_load_dwordx4 v5, s[20:23], s26 offen offset:2048 sc1 lds
    v_mfma_f32_16x16x32_bf16 v[108:111], a[80:83], a[52:55], v[108:111]
    s_waitcnt lgkmcnt(9)
    v_mfma_f32_16x16x32_bf16 v[112:115], a[80:83], a[56:59], v[112:115]
    s_waitcnt lgkmcnt(8)
    v_mfma_f32_16x16x32_bf16 v[112:115], a[84:87], a[76:79], v[112:115]
    s_waitcnt lgkmcnt(6)
    v_mfma_f32_16x16x32_bf16 v[132:135], a[92:95], a[76:79], v[132:135]
    s_waitcnt lgkmcnt(4)
    ds_read_b64_tr_b16 a[84:85], v217 offset:24832
    ds_read_b64_tr_b16 a[86:87], v217 offset:28928
    v_mfma_f32_16x16x32_bf16 v[132:135], a[88:91], a[56:59], v[132:135]
    ds_read_b64_tr_b16 a[80:81], v217 offset:16640
    ds_read_b64_tr_b16 a[82:83], v217 offset:20736
    v_mfma_f32_16x16x32_bf16 v[128:131], a[88:91], a[52:55], v[128:131]
    buffer_load_dwordx4 v5, s[20:23], s26 offen offset:3072 sc1 lds
    v_mfma_f32_16x16x32_bf16 v[128:131], a[92:95], a[72:75], v[128:131]
    v_mfma_f32_16x16x32_bf16 v[124:127], a[92:95], a[68:71], v[124:127]
    s_add_u32 m0, s30, 45056
    v_mfma_f32_16x16x32_bf16 v[124:127], a[88:91], a[48:51], v[124:127]
    buffer_load_dwordx4 v6, s[20:23], s26 offen sc1 lds
    v_mfma_f32_16x16x32_bf16 v[120:123], a[88:91], a[44:47], v[120:123]
    s_add_u32 s28, s25, 3
    s_and_b32 s28, s28, 7
    s_or_b32 s28, s28, 16
    s_lshl_b32 s28, s28, 1
    v_mfma_f32_16x16x32_bf16 v[120:123], a[92:95], a[64:67], v[120:123]
    s_add_u32 s28, s28, s31
    s_lshl_b32 s27, s28, 16
    s_add_u32 m0, s32, 147456
    v_mfma_f32_16x16x32_bf16 v[116:119], a[92:95], a[60:63], v[116:119]
    s_waitcnt vmcnt(18) lgkmcnt(0)
    s_barrier
    v_mfma_f32_16x16x32_bf16 v[116:119], a[88:91], a[40:43], v[116:119]
    ds_read_b128 a[0:3], v9
    ds_read_b128 a[20:23], v9 offset:10240
    v_mfma_f32_16x16x32_bf16 v[136:139], a[96:99], a[40:43], v[136:139]
    ds_read_b64_tr_b16 a[88:89], v7 offset:16384
    ds_read_b64_tr_b16 a[90:91], v7 offset:20480
    v_mfma_f32_16x16x32_bf16 v[136:139], a[100:103], a[60:63], v[136:139]
    ds_read_b64_tr_b16 a[92:93], v7 offset:24576
    ds_read_b64_tr_b16 a[94:95], v7 offset:28672
    v_mfma_f32_16x16x32_bf16 v[140:143], a[100:103], a[64:67], v[140:143]
    ds_read_b128 a[24:27], v9 offset:11264
    ds_read_b128 a[4:7], v9 offset:1024
    v_mfma_f32_16x16x32_bf16 v[140:143], a[96:99], a[44:47], v[140:143]
    ds_read_b128 a[8:11], v9 offset:2048
    ds_read_b128 a[28:31], v9 offset:12288
    v_mfma_f32_16x16x32_bf16 v[144:147], a[96:99], a[48:51], v[144:147]
    ds_read_b128 a[32:35], v9 offset:13312
    ds_read_b128 a[12:15], v9 offset:3072
    v_mfma_f32_16x16x32_bf16 v[144:147], a[100:103], a[68:71], v[144:147]
    ds_read_b128 a[16:19], v9 offset:4096
    ds_read_b128 a[36:39], v9 offset:14336
    v_mfma_f32_16x16x32_bf16 v[148:151], a[100:103], a[72:75], v[148:151]
    buffer_load_dwordx4 v1, s[8:11], s27 offen lds
    v_mfma_f32_16x16x32_bf16 v[148:151], a[96:99], a[52:55], v[148:151]
    buffer_load_dwordx4 v2, s[8:11], s27 offen offset:1024 lds
    v_mfma_f32_16x16x32_bf16 v[152:155], a[96:99], a[56:59], v[152:155]
    v_mfma_f32_16x16x32_bf16 v[152:155], a[100:103], a[76:79], v[152:155]
    v_mfma_f32_16x16x32_bf16 v[172:175], a[84:87], a[76:79], v[172:175]
    ds_read_b64_tr_b16 a[100:101], v8 offset:24576
    ds_read_b64_tr_b16 a[102:103], v8 offset:28672
    v_mfma_f32_16x16x32_bf16 v[172:175], a[80:83], a[56:59], v[172:175]
    ds_read_b64_tr_b16 a[96:97], v8 offset:16384
    ds_read_b64_tr_b16 a[98:99], v8 offset:20480
    v_mfma_f32_16x16x32_bf16 v[168:171], a[80:83], a[52:55], v[168:171]
    buffer_load_dwordx4 v3, s[8:11], s27 offen offset:2048 lds
    v_mfma_f32_16x16x32_bf16 v[168:171], a[84:87], a[72:75], v[168:171]
    v_mfma_f32_16x16x32_bf16 v[164:167], a[84:87], a[68:71], v[164:167]
    buffer_load_dwordx4 v4, s[8:11], s27 offen offset:3072 lds
    v_mfma_f32_16x16x32_bf16 v[164:167], a[80:83], a[48:51], v[164:167]
    s_add_u32 s28, s25, 3
    s_and_b32 s28, s28, 7
    s_or_b32 s28, s28, 16
    v_mfma_f32_16x16x32_bf16 v[160:163], a[80:83], a[44:47], v[160:163]
    s_lshl_b32 s28, s28, 1
    s_add_u32 s28, s28, s31
    v_mfma_f32_16x16x32_bf16 v[160:163], a[84:87], a[64:67], v[160:163]
    s_mul_i32 s26, s28, 10240
    s_add_u32 m0, s30, 61440
    v_mfma_f32_16x16x32_bf16 v[156:159], a[84:87], a[60:63], v[156:159]
    buffer_load_dwordx4 v5, s[20:23], s26 offen sc1 lds
    v_mfma_f32_16x16x32_bf16 v[156:159], a[80:83], a[40:43], v[156:159]
    s_waitcnt lgkmcnt(14)
    v_mfma_f32_16x16x32_bf16 v[96:99], a[88:91], a[0:3], v[96:99]
    s_waitcnt lgkmcnt(12)
    ds_read_b64_tr_b16 a[80:81], v7 offset:16640
    ds_read_b64_tr_b16 a[82:83], v7 offset:20736
    v_mfma_f32_16x16x32_bf16 v[96:99], a[92:95], a[20:23], v[96:99]
    s_waitcnt lgkmcnt(13)
    ds_read_b64_tr_b16 a[84:85], v7 offset:24832
    ds_read_b64_tr_b16 a[86:87], v7 offset:28928
    v_mfma_f32_16x16x32_bf16 v[100:103], a[92:95], a[24:27], v[100:103]
    s_waitcnt lgkmcnt(14)
    buffer_load_dwordx4 v5, s[20:23], s26 offen offset:1024 sc1 lds
    v_mfma_f32_16x16x32_bf16 v[100:103], a[88:91], a[4:7], v[100:103]
    s_waitcnt lgkmcnt(13)
    v_mfma_f32_16x16x32_bf16 v[104:107], a[88:91], a[8:11], v[104:107]
    s_waitcnt lgkmcnt(12)
    v_mfma_f32_16x16x32_bf16 v[104:107], a[92:95], a[28:31], v[104:107]
    s_waitcnt lgkmcnt(11)
    v_mfma_f32_16x16x32_bf16 v[108:111], a[92:95], a[32:35], v[108:111]
    s_waitcnt lgkmcnt(10)
    buffer_load_dwordx4 v5, s[20:23], s26 offen offset:2048 sc1 lds
    v_mfma_f32_16x16x32_bf16 v[108:111], a[88:91], a[12:15], v[108:111]
    s_waitcnt lgkmcnt(9)
    v_mfma_f32_16x16x32_bf16 v[112:115], a[88:91], a[16:19], v[112:115]
    s_waitcnt lgkmcnt(8)
    v_mfma_f32_16x16x32_bf16 v[112:115], a[92:95], a[36:39], v[112:115]
    s_waitcnt lgkmcnt(6)
    v_mfma_f32_16x16x32_bf16 v[132:135], a[100:103], a[36:39], v[132:135]
    s_waitcnt lgkmcnt(4)
    ds_read_b64_tr_b16 a[92:93], v8 offset:24832
    ds_read_b64_tr_b16 a[94:95], v8 offset:28928
    v_mfma_f32_16x16x32_bf16 v[132:135], a[96:99], a[16:19], v[132:135]
    ds_read_b64_tr_b16 a[88:89], v8 offset:16640
    ds_read_b64_tr_b16 a[90:91], v8 offset:20736
    v_mfma_f32_16x16x32_bf16 v[128:131], a[96:99], a[12:15], v[128:131]
    buffer_load_dwordx4 v5, s[20:23], s26 offen offset:3072 sc1 lds
    v_mfma_f32_16x16x32_bf16 v[128:131], a[100:103], a[32:35], v[128:131]
    v_mfma_f32_16x16x32_bf16 v[124:127], a[100:103], a[28:31], v[124:127]
    s_add_u32 m0, s30, 65536
    v_mfma_f32_16x16x32_bf16 v[124:127], a[96:99], a[8:11], v[124:127]
    buffer_load_dwordx4 v6, s[20:23], s26 offen sc1 lds
    v_mfma_f32_16x16x32_bf16 v[120:123], a[96:99], a[4:7], v[120:123]
    s_add_u32 s28, s25, 4
    s_and_b32 s28, s28, 7
    s_or_b32 s28, s28, 16
    s_lshl_b32 s28, s28, 1
    v_mfma_f32_16x16x32_bf16 v[120:123], a[100:103], a[24:27], v[120:123]
    s_add_u32 s28, s28, s31
    s_lshl_b32 s27, s28, 16
    s_add_u32 m0, s32, 98304
    v_mfma_f32_16x16x32_bf16 v[116:119], a[100:103], a[20:23], v[116:119]
    s_waitcnt vmcnt(18) lgkmcnt(0)
    s_barrier
    v_mfma_f32_16x16x32_bf16 v[116:119], a[96:99], a[0:3], v[116:119]
    ds_read_b128 a[40:43], v9 offset:20480
    ds_read_b128 a[60:63], v9 offset:30720
    v_mfma_f32_16x16x32_bf16 v[136:139], a[80:83], a[0:3], v[136:139]
    ds_read_b64_tr_b16 a[96:97], v7 offset:32768
    ds_read_b64_tr_b16 a[98:99], v7 offset:36864
    v_mfma_f32_16x16x32_bf16 v[136:139], a[84:87], a[20:23], v[136:139]
    ds_read_b64_tr_b16 a[100:101], v7 offset:40960
    ds_read_b64_tr_b16 a[102:103], v7 offset:45056
    v_mfma_f32_16x16x32_bf16 v[140:143], a[84:87], a[24:27], v[140:143]
    ds_read_b128 a[64:67], v9 offset:31744
    ds_read_b128 a[44:47], v9 offset:21504
    v_mfma_f32_16x16x32_bf16 v[140:143], a[80:83], a[4:7], v[140:143]
    ds_read_b128 a[48:51], v9 offset:22528
    ds_read_b128 a[68:71], v9 offset:32768
    v_mfma_f32_16x16x32_bf16 v[144:147], a[80:83], a[8:11], v[144:147]
    ds_read_b128 a[72:75], v9 offset:33792
    ds_read_b128 a[52:55], v9 offset:23552
    v_mfma_f32_16x16x32_bf16 v[144:147], a[84:87], a[28:31], v[144:147]
    ds_read_b128 a[56:59], v9 offset:24576
    ds_read_b128 a[76:79], v9 offset:34816
    v_mfma_f32_16x16x32_bf16 v[148:151], a[84:87], a[32:35], v[148:151]
    buffer_load_dwordx4 v1, s[8:11], s27 offen lds
    v_mfma_f32_16x16x32_bf16 v[148:151], a[80:83], a[12:15], v[148:151]
    buffer_load_dwordx4 v2, s[8:11], s27 offen offset:1024 lds
    v_mfma_f32_16x16x32_bf16 v[152:155], a[80:83], a[16:19], v[152:155]
    v_mfma_f32_16x16x32_bf16 v[152:155], a[84:87], a[36:39], v[152:155]
    v_mfma_f32_16x16x32_bf16 v[172:175], a[92:95], a[36:39], v[172:175]
    ds_read_b64_tr_b16 a[84:85], v8 offset:40960
    ds_read_b64_tr_b16 a[86:87], v8 offset:45056
    v_mfma_f32_16x16x32_bf16 v[172:175], a[88:91], a[16:19], v[172:175]
    ds_read_b64_tr_b16 a[80:81], v8 offset:32768
    ds_read_b64_tr_b16 a[82:83], v8 offset:36864
    v_mfma_f32_16x16x32_bf16 v[168:171], a[88:91], a[12:15], v[168:171]
    buffer_load_dwordx4 v3, s[8:11], s27 offen offset:2048 lds
    v_mfma_f32_16x16x32_bf16 v[168:171], a[92:95], a[32:35], v[168:171]
    v_mfma_f32_16x16x32_bf16 v[164:167], a[92:95], a[28:31], v[164:167]
    buffer_load_dwordx4 v4, s[8:11], s27 offen offset:3072 lds
    v_mfma_f32_16x16x32_bf16 v[164:167], a[88:91], a[8:11], v[164:167]
    s_add_u32 s28, s25, 4
    s_and_b32 s28, s28, 7
    s_or_b32 s28, s28, 16
    v_mfma_f32_16x16x32_bf16 v[160:163], a[88:91], a[4:7], v[160:163]
    s_lshl_b32 s28, s28, 1
    s_add_u32 s28, s28, s31
    v_mfma_f32_16x16x32_bf16 v[160:163], a[92:95], a[24:27], v[160:163]
    s_mul_i32 s26, s28, 10240
    s_add_u32 m0, s30, 0
    v_mfma_f32_16x16x32_bf16 v[156:159], a[92:95], a[20:23], v[156:159]
    buffer_load_dwordx4 v5, s[20:23], s26 offen sc1 lds
    v_mfma_f32_16x16x32_bf16 v[156:159], a[88:91], a[0:3], v[156:159]
    s_waitcnt lgkmcnt(14)
    v_mfma_f32_16x16x32_bf16 v[96:99], a[96:99], a[40:43], v[96:99]
    s_waitcnt lgkmcnt(12)
    ds_read_b64_tr_b16 a[88:89], v7 offset:33024
    ds_read_b64_tr_b16 a[90:91], v7 offset:37120
    v_mfma_f32_16x16x32_bf16 v[96:99], a[100:103], a[60:63], v[96:99]
    s_waitcnt lgkmcnt(13)
    ds_read_b64_tr_b16 a[92:93], v7 offset:41216
    ds_read_b64_tr_b16 a[94:95], v7 offset:45312
    v_mfma_f32_16x16x32_bf16 v[100:103], a[100:103], a[64:67], v[100:103]
    s_waitcnt lgkmcnt(14)
    buffer_load_dwordx4 v5, s[20:23], s26 offen offset:1024 sc1 lds
    v_mfma_f32_16x16x32_bf16 v[100:103], a[96:99], a[44:47], v[100:103]
    s_waitcnt lgkmcnt(13)
    v_mfma_f32_16x16x32_bf16 v[104:107], a[96:99], a[48:51], v[104:107]
    s_waitcnt lgkmcnt(12)
    v_mfma_f32_16x16x32_bf16 v[104:107], a[100:103], a[68:71], v[104:107]
    s_waitcnt lgkmcnt(11)
    v_mfma_f32_16x16x32_bf16 v[108:111], a[100:103], a[72:75], v[108:111]
    s_waitcnt lgkmcnt(10)
    buffer_load_dwordx4 v5, s[20:23], s26 offen offset:2048 sc1 lds
    v_mfma_f32_16x16x32_bf16 v[108:111], a[96:99], a[52:55], v[108:111]
    s_waitcnt lgkmcnt(9)
    v_mfma_f32_16x16x32_bf16 v[112:115], a[96:99], a[56:59], v[112:115]
    s_waitcnt lgkmcnt(8)
    v_mfma_f32_16x16x32_bf16 v[112:115], a[100:103], a[76:79], v[112:115]
    s_waitcnt lgkmcnt(6)
    v_mfma_f32_16x16x32_bf16 v[132:135], a[84:87], a[76:79], v[132:135]
    s_waitcnt lgkmcnt(4)
    ds_read_b64_tr_b16 a[100:101], v8 offset:41216
    ds_read_b64_tr_b16 a[102:103], v8 offset:45312
    v_mfma_f32_16x16x32_bf16 v[132:135], a[80:83], a[56:59], v[132:135]
    ds_read_b64_tr_b16 a[96:97], v8 offset:33024
    ds_read_b64_tr_b16 a[98:99], v8 offset:37120
    v_mfma_f32_16x16x32_bf16 v[128:131], a[80:83], a[52:55], v[128:131]
    buffer_load_dwordx4 v5, s[20:23], s26 offen offset:3072 sc1 lds
    v_mfma_f32_16x16x32_bf16 v[128:131], a[84:87], a[72:75], v[128:131]
    v_mfma_f32_16x16x32_bf16 v[124:127], a[84:87], a[68:71], v[124:127]
    s_add_u32 m0, s30, 4096
    v_mfma_f32_16x16x32_bf16 v[124:127], a[80:83], a[48:51], v[124:127]
    buffer_load_dwordx4 v6, s[20:23], s26 offen sc1 lds
    v_mfma_f32_16x16x32_bf16 v[120:123], a[80:83], a[44:47], v[120:123]
    s_add_u32 s28, s25, 5
    s_and_b32 s28, s28, 7
    s_or_b32 s28, s28, 16
    s_lshl_b32 s28, s28, 1
    v_mfma_f32_16x16x32_bf16 v[120:123], a[84:87], a[64:67], v[120:123]
    s_add_u32 s28, s28, s31
    s_lshl_b32 s27, s28, 16
    s_add_u32 m0, s32, 114688
    v_mfma_f32_16x16x32_bf16 v[116:119], a[84:87], a[60:63], v[116:119]
    s_waitcnt vmcnt(18) lgkmcnt(0)
    s_barrier
    v_mfma_f32_16x16x32_bf16 v[116:119], a[80:83], a[40:43], v[116:119]
    ds_read_b128 a[0:3], v10
    ds_read_b128 a[20:23], v10 offset:10240
    v_mfma_f32_16x16x32_bf16 v[136:139], a[88:91], a[40:43], v[136:139]
    ds_read_b64_tr_b16 a[80:81], v216
    ds_read_b64_tr_b16 a[82:83], v216 offset:4096
    v_mfma_f32_16x16x32_bf16 v[136:139], a[92:95], a[60:63], v[136:139]
    ds_read_b64_tr_b16 a[84:85], v216 offset:8192
    ds_read_b64_tr_b16 a[86:87], v216 offset:12288
    v_mfma_f32_16x16x32_bf16 v[140:143], a[92:95], a[64:67], v[140:143]
    ds_read_b128 a[24:27], v10 offset:11264
    ds_read_b128 a[4:7], v10 offset:1024
    v_mfma_f32_16x16x32_bf16 v[140:143], a[88:91], a[44:47], v[140:143]
    ds_read_b128 a[8:11], v10 offset:2048
    ds_read_b128 a[28:31], v10 offset:12288
    v_mfma_f32_16x16x32_bf16 v[144:147], a[88:91], a[48:51], v[144:147]
    ds_read_b128 a[32:35], v10 offset:13312
    ds_read_b128 a[12:15], v10 offset:3072
    v_mfma_f32_16x16x32_bf16 v[144:147], a[92:95], a[68:71], v[144:147]
    ds_read_b128 a[16:19], v10 offset:4096
    ds_read_b128 a[36:39], v10 offset:14336
    v_mfma_f32_16x16x32_bf16 v[148:151], a[92:95], a[72:75], v[148:151]
    buffer_load_dwordx4 v1, s[8:11], s27 offen lds
    v_mfma_f32_16x16x32_bf16 v[148:151], a[88:91], a[52:55], v[148:151]
    buffer_load_dwordx4 v2, s[8:11], s27 offen offset:1024 lds
    v_mfma_f32_16x16x32_bf16 v[152:155], a[88:91], a[56:59], v[152:155]
    v_mfma_f32_16x16x32_bf16 v[152:155], a[92:95], a[76:79], v[152:155]
    v_mfma_f32_16x16x32_bf16 v[172:175], a[100:103], a[76:79], v[172:175]
    ds_read_b64_tr_b16 a[92:93], v217 offset:8192
    ds_read_b64_tr_b16 a[94:95], v217 offset:12288
    v_mfma_f32_16x16x32_bf16 v[172:175], a[96:99], a[56:59], v[172:175]
    ds_read_b64_tr_b16 a[88:89], v217
    ds_read_b64_tr_b16 a[90:91], v217 offset:4096
    v_mfma_f32_16x16x32_bf16 v[168:171], a[96:99], a[52:55], v[168:171]
    buffer_load_dwordx4 v3, s[8:11], s27 offen offset:2048 lds
    v_mfma_f32_16x16x32_bf16 v[168:171], a[100:103], a[72:75], v[168:171]
    v_mfma_f32_16x16x32_bf16 v[164:167], a[100:103], a[68:71], v[164:167]
    buffer_load_dwordx4 v4, s[8:11], s27 offen offset:3072 lds
    v_mfma_f32_16x16x32_bf16 v[164:167], a[96:99], a[48:51], v[164:167]
    s_add_u32 s28, s25, 5
    s_and_b32 s28, s28, 7
    s_or_b32 s28, s28, 16
    v_mfma_f32_16x16x32_bf16 v[160:163], a[96:99], a[44:47], v[160:163]
    s_lshl_b32 s28, s28, 1
    s_add_u32 s28, s28, s31
    v_mfma_f32_16x16x32_bf16 v[160:163], a[100:103], a[64:67], v[160:163]
    s_mul_i32 s26, s28, 10240
    s_add_u32 m0, s30, 20480
    v_mfma_f32_16x16x32_bf16 v[156:159], a[100:103], a[60:63], v[156:159]
    buffer_load_dwordx4 v5, s[20:23], s26 offen sc1 lds
    v_mfma_f32_16x16x32_bf16 v[156:159], a[96:99], a[40:43], v[156:159]
    s_waitcnt lgkmcnt(14)
    v_mfma_f32_16x16x32_bf16 v[96:99], a[80:83], a[0:3], v[96:99]
    s_waitcnt lgkmcnt(12)
    ds_read_b64_tr_b16 a[96:97], v216 offset:256
    ds_read_b64_tr_b16 a[98:99], v216 offset:4352
    v_mfma_f32_16x16x32_bf16 v[96:99], a[84:87], a[20:23], v[96:99]
    s_waitcnt lgkmcnt(13)
    ds_read_b64_tr_b16 a[100:101], v216 offset:8448
    ds_read_b64_tr_b16 a[102:103], v216 offset:12544
    v_mfma_f32_16x16x32_bf16 v[100:103], a[84:87], a[24:27], v[100:103]
    s_waitcnt lgkmcnt(14)
    buffer_load_dwordx4 v5, s[20:23], s26 offen offset:1024 sc1 lds
    v_mfma_f32_16x16x32_bf16 v[100:103], a[80:83], a[4:7], v[100:103]
    s_waitcnt lgkmcnt(13)
    v_mfma_f32_16x16x32_bf16 v[104:107], a[80:83], a[8:11], v[104:107]
    s_waitcnt lgkmcnt(12)
    v_mfma_f32_16x16x32_bf16 v[104:107], a[84:87], a[28:31], v[104:107]
    s_waitcnt lgkmcnt(11)
    v_mfma_f32_16x16x32_bf16 v[108:111], a[84:87], a[32:35], v[108:111]
    s_waitcnt lgkmcnt(10)
    buffer_load_dwordx4 v5, s[20:23], s26 offen offset:2048 sc1 lds
    v_mfma_f32_16x16x32_bf16 v[108:111], a[80:83], a[12:15], v[108:111]
    s_waitcnt lgkmcnt(9)
    v_mfma_f32_16x16x32_bf16 v[112:115], a[80:83], a[16:19], v[112:115]
    s_waitcnt lgkmcnt(8)
    v_mfma_f32_16x16x32_bf16 v[112:115], a[84:87], a[36:39], v[112:115]
    s_waitcnt lgkmcnt(6)
    v_mfma_f32_16x16x32_bf16 v[132:135], a[92:95], a[36:39], v[132:135]
    s_waitcnt lgkmcnt(4)
    ds_read_b64_tr_b16 a[84:85], v217 offset:8448
    ds_read_b64_tr_b16 a[86:87], v217 offset:12544
    v_mfma_f32_16x16x32_bf16 v[132:135], a[88:91], a[16:19], v[132:135]
    ds_read_b64_tr_b16 a[80:81], v217 offset:256
    ds_read_b64_tr_b16 a[82:83], v217 offset:4352
    v_mfma_f32_16x16x32_bf16 v[128:131], a[88:91], a[12:15], v[128:131]
    buffer_load_dwordx4 v5, s[20:23], s26 offen offset:3072 sc1 lds
    v_mfma_f32_16x16x32_bf16 v[128:131], a[92:95], a[32:35], v[128:131]
    v_mfma_f32_16x16x32_bf16 v[124:127], a[92:95], a[28:31], v[124:127]
    s_add_u32 m0, s30, 24576
    v_mfma_f32_16x16x32_bf16 v[124:127], a[88:91], a[8:11], v[124:127]
    buffer_load_dwordx4 v6, s[20:23], s26 offen sc1 lds
    v_mfma_f32_16x16x32_bf16 v[120:123], a[88:91], a[4:7], v[120:123]
    s_add_u32 s28, s25, 6
    s_and_b32 s28, s28, 7
    s_or_b32 s28, s28, 16
    s_lshl_b32 s28, s28, 1
    v_mfma_f32_16x16x32_bf16 v[120:123], a[92:95], a[24:27], v[120:123]
    s_add_u32 s28, s28, s31
    s_lshl_b32 s27, s28, 16
    s_add_u32 m0, s32, 131072
    v_mfma_f32_16x16x32_bf16 v[116:119], a[92:95], a[20:23], v[116:119]
    s_waitcnt vmcnt(18) lgkmcnt(0)
    s_barrier
    v_mfma_f32_16x16x32_bf16 v[116:119], a[88:91], a[0:3], v[116:119]
    ds_read_b128 a[40:43], v10 offset:20480
    ds_read_b128 a[60:63], v10 offset:30720
    v_mfma_f32_16x16x32_bf16 v[136:139], a[96:99], a[0:3], v[136:139]
    ds_read_b64_tr_b16 a[88:89], v216 offset:16384
    ds_read_b64_tr_b16 a[90:91], v216 offset:20480
    v_mfma_f32_16x16x32_bf16 v[136:139], a[100:103], a[20:23], v[136:139]
    ds_read_b64_tr_b16 a[92:93], v216 offset:24576
    ds_read_b64_tr_b16 a[94:95], v216 offset:28672
    v_mfma_f32_16x16x32_bf16 v[140:143], a[100:103], a[24:27], v[140:143]
    ds_read_b128 a[64:67], v10 offset:31744
    ds_read_b128 a[44:47], v10 offset:21504
    v_mfma_f32_16x16x32_bf16 v[140:143], a[96:99], a[4:7], v[140:143]
    ds_read_b128 a[48:51], v10 offset:22528
    ds_read_b128 a[68:71], v10 offset:32768
    v_mfma_f32_16x16x32_bf16 v[144:147], a[96:99], a[8:11], v[144:147]
    ds_read_b128 a[72:75], v10 offset:33792
    ds_read_b128 a[52:55], v10 offset:23552
    v_mfma_f32_16x16x32_bf16 v[144:147], a[100:103], a[28:31], v[144:147]
    ds_read_b128 a[56:59], v10 offset:24576
    ds_read_b128 a[76:79], v10 offset:34816
    v_mfma_f32_16x16x32_bf16 v[148:151], a[100:103], a[32:35], v[148:151]
    buffer_load_dwordx4 v1, s[8:11], s27 offen lds
    v_mfma_f32_16x16x32_bf16 v[148:151], a[96:99], a[12:15], v[148:151]
    buffer_load_dwordx4 v2, s[8:11], s27 offen offset:1024 lds
    v_mfma_f32_16x16x32_bf16 v[152:155], a[96:99], a[16:19], v[152:155]
    v_mfma_f32_16x16x32_bf16 v[152:155], a[100:103], a[36:39], v[152:155]
    v_mfma_f32_16x16x32_bf16 v[172:175], a[84:87], a[36:39], v[172:175]
    ds_read_b64_tr_b16 a[100:101], v217 offset:24576
    ds_read_b64_tr_b16 a[102:103], v217 offset:28672
    v_mfma_f32_16x16x32_bf16 v[172:175], a[80:83], a[16:19], v[172:175]
    ds_read_b64_tr_b16 a[96:97], v217 offset:16384
    ds_read_b64_tr_b16 a[98:99], v217 offset:20480
    v_mfma_f32_16x16x32_bf16 v[168:171], a[80:83], a[12:15], v[168:171]
    buffer_load_dwordx4 v3, s[8:11], s27 offen offset:2048 lds
    v_mfma_f32_16x16x32_bf16 v[168:171], a[84:87], a[32:35], v[168:171]
    v_mfma_f32_16x16x32_bf16 v[164:167], a[84:87], a[28:31], v[164:167]
    buffer_load_dwordx4 v4, s[8:11], s27 offen offset:3072 lds
    v_mfma_f32_16x16x32_bf16 v[164:167], a[80:83], a[8:11], v[164:167]
    s_add_u32 s28, s25, 6
    s_and_b32 s28, s28, 7
    s_or_b32 s28, s28, 16
    v_mfma_f32_16x16x32_bf16 v[160:163], a[80:83], a[4:7], v[160:163]
    s_lshl_b32 s28, s28, 1
    s_add_u32 s28, s28, s31
    v_mfma_f32_16x16x32_bf16 v[160:163], a[84:87], a[24:27], v[160:163]
    s_mul_i32 s26, s28, 10240
    s_add_u32 m0, s30, 40960
    v_mfma_f32_16x16x32_bf16 v[156:159], a[84:87], a[20:23], v[156:159]
    buffer_load_dwordx4 v5, s[20:23], s26 offen sc1 lds
    v_mfma_f32_16x16x32_bf16 v[156:159], a[80:83], a[0:3], v[156:159]
    s_waitcnt lgkmcnt(14)
    v_mfma_f32_16x16x32_bf16 v[96:99], a[88:91], a[40:43], v[96:99]
    s_waitcnt lgkmcnt(12)
    ds_read_b64_tr_b16 a[80:81], v216 offset:16640
    ds_read_b64_tr_b16 a[82:83], v216 offset:20736
    v_mfma_f32_16x16x32_bf16 v[96:99], a[92:95], a[60:63], v[96:99]
    s_waitcnt lgkmcnt(13)
    ds_read_b64_tr_b16 a[84:85], v216 offset:24832
    ds_read_b64_tr_b16 a[86:87], v216 offset:28928
    v_mfma_f32_16x16x32_bf16 v[100:103], a[92:95], a[64:67], v[100:103]
    s_waitcnt lgkmcnt(14)
    buffer_load_dwordx4 v5, s[20:23], s26 offen offset:1024 sc1 lds
    v_mfma_f32_16x16x32_bf16 v[100:103], a[88:91], a[44:47], v[100:103]
    s_waitcnt lgkmcnt(13)
    v_mfma_f32_16x16x32_bf16 v[104:107], a[88:91], a[48:51], v[104:107]
    s_waitcnt lgkmcnt(12)
    v_mfma_f32_16x16x32_bf16 v[104:107], a[92:95], a[68:71], v[104:107]
    s_waitcnt lgkmcnt(11)
    v_mfma_f32_16x16x32_bf16 v[108:111], a[92:95], a[72:75], v[108:111]
    s_waitcnt lgkmcnt(10)
    buffer_load_dwordx4 v5, s[20:23], s26 offen offset:2048 sc1 lds
    v_mfma_f32_16x16x32_bf16 v[108:111], a[88:91], a[52:55], v[108:111]
    s_waitcnt lgkmcnt(9)
    v_mfma_f32_16x16x32_bf16 v[112:115], a[88:91], a[56:59], v[112:115]
    s_waitcnt lgkmcnt(8)
    v_mfma_f32_16x16x32_bf16 v[112:115], a[92:95], a[76:79], v[112:115]
    s_waitcnt lgkmcnt(6)
    v_mfma_f32_16x16x32_bf16 v[132:135], a[100:103], a[76:79], v[132:135]
    s_waitcnt lgkmcnt(4)
    ds_read_b64_tr_b16 a[92:93], v217 offset:24832
    ds_read_b64_tr_b16 a[94:95], v217 offset:28928
    v_mfma_f32_16x16x32_bf16 v[132:135], a[96:99], a[56:59], v[132:135]
    ds_read_b64_tr_b16 a[88:89], v217 offset:16640
    ds_read_b64_tr_b16 a[90:91], v217 offset:20736
    v_mfma_f32_16x16x32_bf16 v[128:131], a[96:99], a[52:55], v[128:131]
    buffer_load_dwordx4 v5, s[20:23], s26 offen offset:3072 sc1 lds
    v_mfma_f32_16x16x32_bf16 v[128:131], a[100:103], a[72:75], v[128:131]
    v_mfma_f32_16x16x32_bf16 v[124:127], a[100:103], a[68:71], v[124:127]
    s_add_u32 m0, s30, 45056
    v_mfma_f32_16x16x32_bf16 v[124:127], a[96:99], a[48:51], v[124:127]
    buffer_load_dwordx4 v6, s[20:23], s26 offen sc1 lds
    v_mfma_f32_16x16x32_bf16 v[120:123], a[96:99], a[44:47], v[120:123]
    s_add_u32 s28, s25, 7
    s_and_b32 s28, s28, 7
    s_or_b32 s28, s28, 16
    s_lshl_b32 s28, s28, 1
    v_mfma_f32_16x16x32_bf16 v[120:123], a[100:103], a[64:67], v[120:123]
    s_add_u32 s28, s28, s31
    s_lshl_b32 s27, s28, 16
    s_add_u32 m0, s32, 147456
    v_mfma_f32_16x16x32_bf16 v[116:119], a[100:103], a[60:63], v[116:119]
    s_waitcnt vmcnt(18) lgkmcnt(0)
    s_barrier
    v_mfma_f32_16x16x32_bf16 v[116:119], a[96:99], a[40:43], v[116:119]
    ds_read_b128 a[0:3], v9
    ds_read_b128 a[20:23], v9 offset:10240
    v_mfma_f32_16x16x32_bf16 v[136:139], a[80:83], a[40:43], v[136:139]
    ds_read_b64_tr_b16 a[96:97], v7 offset:16384
    ds_read_b64_tr_b16 a[98:99], v7 offset:20480
    v_mfma_f32_16x16x32_bf16 v[136:139], a[84:87], a[60:63], v[136:139]
    ds_read_b64_tr_b16 a[100:101], v7 offset:24576
    ds_read_b64_tr_b16 a[102:103], v7 offset:28672
    v_mfma_f32_16x16x32_bf16 v[140:143], a[84:87], a[64:67], v[140:143]
    ds_read_b128 a[24:27], v9 offset:11264
    ds_read_b128 a[4:7], v9 offset:1024
    v_mfma_f32_16x16x32_bf16 v[140:143], a[80:83], a[44:47], v[140:143]
    ds_read_b128 a[8:11], v9 offset:2048
    ds_read_b128 a[28:31], v9 offset:12288
    v_mfma_f32_16x16x32_bf16 v[144:147], a[80:83], a[48:51], v[144:147]
    ds_read_b128 a[32:35], v9 offset:13312
    ds_read_b128 a[12:15], v9 offset:3072
    v_mfma_f32_16x16x32_bf16 v[144:147], a[84:87], a[68:71], v[144:147]
    ds_read_b128 a[16:19], v9 offset:4096
    ds_read_b128 a[36:39], v9 offset:14336
    v_mfma_f32_16x16x32_bf16 v[148:151], a[84:87], a[72:75], v[148:151]
    buffer_load_dwordx4 v1, s[8:11], s27 offen lds
    v_mfma_f32_16x16x32_bf16 v[148:151], a[80:83], a[52:55], v[148:151]
    buffer_load_dwordx4 v2, s[8:11], s27 offen offset:1024 lds
    v_mfma_f32_16x16x32_bf16 v[152:155], a[80:83], a[56:59], v[152:155]
    v_mfma_f32_16x16x32_bf16 v[152:155], a[84:87], a[76:79], v[152:155]
    v_mfma_f32_16x16x32_bf16 v[172:175], a[92:95], a[76:79], v[172:175]
    ds_read_b64_tr_b16 a[84:85], v8 offset:24576
    ds_read_b64_tr_b16 a[86:87], v8 offset:28672
    v_mfma_f32_16x16x32_bf16 v[172:175], a[88:91], a[56:59], v[172:175]
    ds_read_b64_tr_b16 a[80:81], v8 offset:16384
    ds_read_b64_tr_b16 a[82:83], v8 offset:20480
    v_mfma_f32_16x16x32_bf16 v[168:171], a[88:91], a[52:55], v[168:171]
    buffer_load_dwordx4 v3, s[8:11], s27 offen offset:2048 lds
    v_mfma_f32_16x16x32_bf16 v[168:171], a[92:95], a[72:75], v[168:171]
    v_mfma_f32_16x16x32_bf16 v[164:167], a[92:95], a[68:71], v[164:167]
    buffer_load_dwordx4 v4, s[8:11], s27 offen offset:3072 lds
    v_mfma_f32_16x16x32_bf16 v[164:167], a[88:91], a[48:51], v[164:167]
    s_add_u32 s28, s25, 7
    s_and_b32 s28, s28, 7
    s_or_b32 s28, s28, 16
    v_mfma_f32_16x16x32_bf16 v[160:163], a[88:91], a[44:47], v[160:163]
    s_lshl_b32 s28, s28, 1
    s_add_u32 s28, s28, s31
    v_mfma_f32_16x16x32_bf16 v[160:163], a[92:95], a[64:67], v[160:163]
    s_mul_i32 s26, s28, 10240
    s_add_u32 m0, s30, 61440
    v_mfma_f32_16x16x32_bf16 v[156:159], a[92:95], a[60:63], v[156:159]
    buffer_load_dwordx4 v5, s[20:23], s26 offen sc1 lds
    v_mfma_f32_16x16x32_bf16 v[156:159], a[88:91], a[40:43], v[156:159]
    s_waitcnt lgkmcnt(14)
    v_mfma_f32_16x16x32_bf16 v[96:99], a[96:99], a[0:3], v[96:99]
    s_waitcnt lgkmcnt(12)
    ds_read_b64_tr_b16 a[88:89], v7 offset:16640
    ds_read_b64_tr_b16 a[90:91], v7 offset:20736
    v_mfma_f32_16x16x32_bf16 v[96:99], a[100:103], a[20:23], v[96:99]
    s_waitcnt lgkmcnt(13)
    ds_read_b64_tr_b16 a[92:93], v7 offset:24832
    ds_read_b64_tr_b16 a[94:95], v7 offset:28928
    v_mfma_f32_16x16x32_bf16 v[100:103], a[100:103], a[24:27], v[100:103]
    s_waitcnt lgkmcnt(14)
    buffer_load_dwordx4 v5, s[20:23], s26 offen offset:1024 sc1 lds
    v_mfma_f32_16x16x32_bf16 v[100:103], a[96:99], a[4:7], v[100:103]
    s_waitcnt lgkmcnt(13)
    v_mfma_f32_16x16x32_bf16 v[104:107], a[96:99], a[8:11], v[104:107]
    s_waitcnt lgkmcnt(12)
    v_mfma_f32_16x16x32_bf16 v[104:107], a[100:103], a[28:31], v[104:107]
    s_waitcnt lgkmcnt(11)
    v_mfma_f32_16x16x32_bf16 v[108:111], a[100:103], a[32:35], v[108:111]
    s_waitcnt lgkmcnt(10)
    buffer_load_dwordx4 v5, s[20:23], s26 offen offset:2048 sc1 lds
    v_mfma_f32_16x16x32_bf16 v[108:111], a[96:99], a[12:15], v[108:111]
    s_waitcnt lgkmcnt(9)
    v_mfma_f32_16x16x32_bf16 v[112:115], a[96:99], a[16:19], v[112:115]
    s_waitcnt lgkmcnt(8)
    v_mfma_f32_16x16x32_bf16 v[112:115], a[100:103], a[36:39], v[112:115]
    s_waitcnt lgkmcnt(6)
    v_mfma_f32_16x16x32_bf16 v[132:135], a[84:87], a[36:39], v[132:135]
    s_waitcnt lgkmcnt(4)
    ds_read_b64_tr_b16 a[100:101], v8 offset:24832
    ds_read_b64_tr_b16 a[102:103], v8 offset:28928
    v_mfma_f32_16x16x32_bf16 v[132:135], a[80:83], a[16:19], v[132:135]
    ds_read_b64_tr_b16 a[96:97], v8 offset:16640
    ds_read_b64_tr_b16 a[98:99], v8 offset:20736
    v_mfma_f32_16x16x32_bf16 v[128:131], a[80:83], a[12:15], v[128:131]
    buffer_load_dwordx4 v5, s[20:23], s26 offen offset:3072 sc1 lds
    v_mfma_f32_16x16x32_bf16 v[128:131], a[84:87], a[32:35], v[128:131]
    v_mfma_f32_16x16x32_bf16 v[124:127], a[84:87], a[28:31], v[124:127]
    s_add_u32 m0, s30, 65536
    v_mfma_f32_16x16x32_bf16 v[124:127], a[80:83], a[8:11], v[124:127]
    buffer_load_dwordx4 v6, s[20:23], s26 offen sc1 lds
    v_mfma_f32_16x16x32_bf16 v[120:123], a[80:83], a[4:7], v[120:123]
    s_add_u32 s28, s25, 0
    s_and_b32 s28, s28, 7
    s_or_b32 s28, s28, 24
    s_lshl_b32 s28, s28, 1
    v_mfma_f32_16x16x32_bf16 v[120:123], a[84:87], a[24:27], v[120:123]
    s_add_u32 s28, s28, s31
    s_lshl_b32 s27, s28, 16
    s_add_u32 m0, s32, 98304
    v_mfma_f32_16x16x32_bf16 v[116:119], a[84:87], a[20:23], v[116:119]
    s_waitcnt vmcnt(18) lgkmcnt(0)
    s_barrier
    v_mfma_f32_16x16x32_bf16 v[116:119], a[80:83], a[0:3], v[116:119]
    ds_read_b128 a[40:43], v9 offset:20480
    ds_read_b128 a[60:63], v9 offset:30720
    v_mfma_f32_16x16x32_bf16 v[136:139], a[88:91], a[0:3], v[136:139]
    ds_read_b64_tr_b16 a[80:81], v7 offset:32768
    ds_read_b64_tr_b16 a[82:83], v7 offset:36864
    v_mfma_f32_16x16x32_bf16 v[136:139], a[92:95], a[20:23], v[136:139]
    ds_read_b64_tr_b16 a[84:85], v7 offset:40960
    ds_read_b64_tr_b16 a[86:87], v7 offset:45056
    v_mfma_f32_16x16x32_bf16 v[140:143], a[92:95], a[24:27], v[140:143]
    ds_read_b128 a[64:67], v9 offset:31744
    ds_read_b128 a[44:47], v9 offset:21504
    v_mfma_f32_16x16x32_bf16 v[140:143], a[88:91], a[4:7], v[140:143]
    ds_read_b128 a[48:51], v9 offset:22528
    ds_read_b128 a[68:71], v9 offset:32768
    v_mfma_f32_16x16x32_bf16 v[144:147], a[88:91], a[8:11], v[144:147]
    ds_read_b128 a[72:75], v9 offset:33792
    ds_read_b128 a[52:55], v9 offset:23552
    v_mfma_f32_16x16x32_bf16 v[144:147], a[92:95], a[28:31], v[144:147]
    ds_read_b128 a[56:59], v9 offset:24576
    ds_read_b128 a[76:79], v9 offset:34816
    v_mfma_f32_16x16x32_bf16 v[148:151], a[92:95], a[32:35], v[148:151]
    buffer_load_dwordx4 v1, s[8:11], s27 offen lds
    v_mfma_f32_16x16x32_bf16 v[148:151], a[88:91], a[12:15], v[148:151]
    buffer_load_dwordx4 v2, s[8:11], s27 offen offset:1024 lds
    v_mfma_f32_16x16x32_bf16 v[152:155], a[88:91], a[16:19], v[152:155]
    v_mfma_f32_16x16x32_bf16 v[152:155], a[92:95], a[36:39], v[152:155]
    v_mfma_f32_16x16x32_bf16 v[172:175], a[100:103], a[36:39], v[172:175]
    ds_read_b64_tr_b16 a[92:93], v8 offset:40960
    ds_read_b64_tr_b16 a[94:95], v8 offset:45056
    v_mfma_f32_16x16x32_bf16 v[172:175], a[96:99], a[16:19], v[172:175]
    ds_read_b64_tr_b16 a[88:89], v8 offset:32768
    ds_read_b64_tr_b16 a[90:91], v8 offset:36864
    v_mfma_f32_16x16x32_bf16 v[168:171], a[96:99], a[12:15], v[168:171]
    buffer_load_dwordx4 v3, s[8:11], s27 offen offset:2048 lds
    v_mfma_f32_16x16x32_bf16 v[168:171], a[100:103], a[32:35], v[168:171]
    v_mfma_f32_16x16x32_bf16 v[164:167], a[100:103], a[28:31], v[164:167]
    buffer_load_dwordx4 v4, s[8:11], s27 offen offset:3072 lds
    v_mfma_f32_16x16x32_bf16 v[164:167], a[96:99], a[8:11], v[164:167]
    s_add_u32 s28, s25, 0
    s_and_b32 s28, s28, 7
    s_or_b32 s28, s28, 24
    v_mfma_f32_16x16x32_bf16 v[160:163], a[96:99], a[4:7], v[160:163]
    s_lshl_b32 s28, s28, 1
    s_add_u32 s28, s28, s31
    v_mfma_f32_16x16x32_bf16 v[160:163], a[100:103], a[24:27], v[160:163]
    s_mul_i32 s26, s28, 10240
    s_add_u32 m0, s30, 0
    v_mfma_f32_16x16x32_bf16 v[156:159], a[100:103], a[20:23], v[156:159]
    buffer_load_dwordx4 v5, s[20:23], s26 offen sc1 lds
    v_mfma_f32_16x16x32_bf16 v[156:159], a[96:99], a[0:3], v[156:159]
    s_waitcnt lgkmcnt(14)
    v_mfma_f32_16x16x32_bf16 v[96:99], a[80:83], a[40:43], v[96:99]
    s_waitcnt lgkmcnt(12)
    ds_read_b64_tr_b16 a[96:97], v7 offset:33024
    ds_read_b64_tr_b16 a[98:99], v7 offset:37120
    v_mfma_f32_16x16x32_bf16 v[96:99], a[84:87], a[60:63], v[96:99]
    s_waitcnt lgkmcnt(13)
    ds_read_b64_tr_b16 a[100:101], v7 offset:41216
    ds_read_b64_tr_b16 a[102:103], v7 offset:45312
    v_mfma_f32_16x16x32_bf16 v[100:103], a[84:87], a[64:67], v[100:103]
    s_waitcnt lgkmcnt(14)
    buffer_load_dwordx4 v5, s[20:23], s26 offen offset:1024 sc1 lds
    v_mfma_f32_16x16x32_bf16 v[100:103], a[80:83], a[44:47], v[100:103]
    s_waitcnt lgkmcnt(13)
    v_mfma_f32_16x16x32_bf16 v[104:107], a[80:83], a[48:51], v[104:107]
    s_waitcnt lgkmcnt(12)
    v_mfma_f32_16x16x32_bf16 v[104:107], a[84:87], a[68:71], v[104:107]
    s_waitcnt lgkmcnt(11)
    v_mfma_f32_16x16x32_bf16 v[108:111], a[84:87], a[72:75], v[108:111]
    s_waitcnt lgkmcnt(10)
    buffer_load_dwordx4 v5, s[20:23], s26 offen offset:2048 sc1 lds
    v_mfma_f32_16x16x32_bf16 v[108:111], a[80:83], a[52:55], v[108:111]
    s_waitcnt lgkmcnt(9)
    v_mfma_f32_16x16x32_bf16 v[112:115], a[80:83], a[56:59], v[112:115]
    s_waitcnt lgkmcnt(8)
    v_mfma_f32_16x16x32_bf16 v[112:115], a[84:87], a[76:79], v[112:115]
    s_waitcnt lgkmcnt(6)
    v_mfma_f32_16x16x32_bf16 v[132:135], a[92:95], a[76:79], v[132:135]
    s_waitcnt lgkmcnt(4)
    ds_read_b64_tr_b16 a[84:85], v8 offset:41216
    ds_read_b64_tr_b16 a[86:87], v8 offset:45312
    v_mfma_f32_16x16x32_bf16 v[132:135], a[88:91], a[56:59], v[132:135]
    ds_read_b64_tr_b16 a[80:81], v8 offset:33024
    ds_read_b64_tr_b16 a[82:83], v8 offset:37120
    v_mfma_f32_16x16x32_bf16 v[128:131], a[88:91], a[52:55], v[128:131]
    buffer_load_dwordx4 v5, s[20:23], s26 offen offset:3072 sc1 lds
    v_mfma_f32_16x16x32_bf16 v[128:131], a[92:95], a[72:75], v[128:131]
    v_mfma_f32_16x16x32_bf16 v[124:127], a[92:95], a[68:71], v[124:127]
    s_add_u32 m0, s30, 4096
    v_mfma_f32_16x16x32_bf16 v[124:127], a[88:91], a[48:51], v[124:127]
    buffer_load_dwordx4 v6, s[20:23], s26 offen sc1 lds
    v_mfma_f32_16x16x32_bf16 v[120:123], a[88:91], a[44:47], v[120:123]
    s_add_u32 s28, s25, 1
    s_and_b32 s28, s28, 7
    s_or_b32 s28, s28, 24
    s_lshl_b32 s28, s28, 1
    v_mfma_f32_16x16x32_bf16 v[120:123], a[92:95], a[64:67], v[120:123]
    s_add_u32 s28, s28, s31
    s_lshl_b32 s27, s28, 16
    s_add_u32 m0, s32, 114688
    v_mfma_f32_16x16x32_bf16 v[116:119], a[92:95], a[60:63], v[116:119]
    s_waitcnt vmcnt(18) lgkmcnt(0)
    s_barrier
    v_mfma_f32_16x16x32_bf16 v[116:119], a[88:91], a[40:43], v[116:119]
    ds_read_b128 a[0:3], v10
    ds_read_b128 a[20:23], v10 offset:10240
    v_mfma_f32_16x16x32_bf16 v[136:139], a[96:99], a[40:43], v[136:139]
    ds_read_b64_tr_b16 a[88:89], v216
    ds_read_b64_tr_b16 a[90:91], v216 offset:4096
    v_mfma_f32_16x16x32_bf16 v[136:139], a[100:103], a[60:63], v[136:139]
    ds_read_b64_tr_b16 a[92:93], v216 offset:8192
    ds_read_b64_tr_b16 a[94:95], v216 offset:12288
    v_mfma_f32_16x16x32_bf16 v[140:143], a[100:103], a[64:67], v[140:143]
    ds_read_b128 a[24:27], v10 offset:11264
    ds_read_b128 a[4:7], v10 offset:1024
    v_mfma_f32_16x16x32_bf16 v[140:143], a[96:99], a[44:47], v[140:143]
    ds_read_b128 a[8:11], v10 offset:2048
    ds_read_b128 a[28:31], v10 offset:12288
    v_mfma_f32_16x16x32_bf16 v[144:147], a[96:99], a[48:51], v[144:147]
    ds_read_b128 a[32:35], v10 offset:13312
    ds_read_b128 a[12:15], v10 offset:3072
    v_mfma_f32_16x16x32_bf16 v[144:147], a[100:103], a[68:71], v[144:147]
    ds_read_b128 a[16:19], v10 offset:4096
    ds_read_b128 a[36:39], v10 offset:14336
    v_mfma_f32_16x16x32_bf16 v[148:151], a[100:103], a[72:75], v[148:151]
    buffer_load_dwordx4 v1, s[8:11], s27 offen lds
    v_mfma_f32_16x16x32_bf16 v[148:151], a[96:99], a[52:55], v[148:151]
    buffer_load_dwordx4 v2, s[8:11], s27 offen offset:1024 lds
    v_mfma_f32_16x16x32_bf16 v[152:155], a[96:99], a[56:59], v[152:155]
    v_mfma_f32_16x16x32_bf16 v[152:155], a[100:103], a[76:79], v[152:155]
    v_mfma_f32_16x16x32_bf16 v[172:175], a[84:87], a[76:79], v[172:175]
    ds_read_b64_tr_b16 a[100:101], v217 offset:8192
    ds_read_b64_tr_b16 a[102:103], v217 offset:12288
    v_mfma_f32_16x16x32_bf16 v[172:175], a[80:83], a[56:59], v[172:175]
    ds_read_b64_tr_b16 a[96:97], v217
    ds_read_b64_tr_b16 a[98:99], v217 offset:4096
    v_mfma_f32_16x16x32_bf16 v[168:171], a[80:83], a[52:55], v[168:171]
    buffer_load_dwordx4 v3, s[8:11], s27 offen offset:2048 lds
    v_mfma_f32_16x16x32_bf16 v[168:171], a[84:87], a[72:75], v[168:171]
    v_mfma_f32_16x16x32_bf16 v[164:167], a[84:87], a[68:71], v[164:167]
    buffer_load_dwordx4 v4, s[8:11], s27 offen offset:3072 lds
    v_mfma_f32_16x16x32_bf16 v[164:167], a[80:83], a[48:51], v[164:167]
    s_add_u32 s28, s25, 1
    s_and_b32 s28, s28, 7
    s_or_b32 s28, s28, 24
    v_mfma_f32_16x16x32_bf16 v[160:163], a[80:83], a[44:47], v[160:163]
    s_lshl_b32 s28, s28, 1
    s_add_u32 s28, s28, s31
    v_mfma_f32_16x16x32_bf16 v[160:163], a[84:87], a[64:67], v[160:163]
    s_mul_i32 s26, s28, 10240
    s_add_u32 m0, s30, 20480
    v_mfma_f32_16x16x32_bf16 v[156:159], a[84:87], a[60:63], v[156:159]
    buffer_load_dwordx4 v5, s[20:23], s26 offen sc1 lds
    v_mfma_f32_16x16x32_bf16 v[156:159], a[80:83], a[40:43], v[156:159]
    s_waitcnt lgkmcnt(14)
    v_mfma_f32_16x16x32_bf16 v[96:99], a[88:91], a[0:3], v[96:99]
    s_waitcnt lgkmcnt(12)
    ds_read_b64_tr_b16 a[80:81], v216 offset:256
    ds_read_b64_tr_b16 a[82:83], v216 offset:4352
    v_mfma_f32_16x16x32_bf16 v[96:99], a[92:95], a[20:23], v[96:99]
    s_waitcnt lgkmcnt(13)
    ds_read_b64_tr_b16 a[84:85], v216 offset:8448
    ds_read_b64_tr_b16 a[86:87], v216 offset:12544
    v_mfma_f32_16x16x32_bf16 v[100:103], a[92:95], a[24:27], v[100:103]
    s_waitcnt lgkmcnt(14)
    buffer_load_dwordx4 v5, s[20:23], s26 offen offset:1024 sc1 lds
    v_mfma_f32_16x16x32_bf16 v[100:103], a[88:91], a[4:7], v[100:103]
    s_waitcnt lgkmcnt(13)
    v_mfma_f32_16x16x32_bf16 v[104:107], a[88:91], a[8:11], v[104:107]
    s_waitcnt lgkmcnt(12)
    v_mfma_f32_16x16x32_bf16 v[104:107], a[92:95], a[28:31], v[104:107]
    s_waitcnt lgkmcnt(11)
    v_mfma_f32_16x16x32_bf16 v[108:111], a[92:95], a[32:35], v[108:111]
    s_waitcnt lgkmcnt(10)
    buffer_load_dwordx4 v5, s[20:23], s26 offen offset:2048 sc1 lds
    v_mfma_f32_16x16x32_bf16 v[108:111], a[88:91], a[12:15], v[108:111]
    s_waitcnt lgkmcnt(9)
    v_mfma_f32_16x16x32_bf16 v[112:115], a[88:91], a[16:19], v[112:115]
    s_waitcnt lgkmcnt(8)
    v_mfma_f32_16x16x32_bf16 v[112:115], a[92:95], a[36:39], v[112:115]
    s_waitcnt lgkmcnt(6)
    v_mfma_f32_16x16x32_bf16 v[132:135], a[100:103], a[36:39], v[132:135]
    s_waitcnt lgkmcnt(4)
    ds_read_b64_tr_b16 a[92:93], v217 offset:8448
    ds_read_b64_tr_b16 a[94:95], v217 offset:12544
    v_mfma_f32_16x16x32_bf16 v[132:135], a[96:99], a[16:19], v[132:135]
    ds_read_b64_tr_b16 a[88:89], v217 offset:256
    ds_read_b64_tr_b16 a[90:91], v217 offset:4352
    v_mfma_f32_16x16x32_bf16 v[128:131], a[96:99], a[12:15], v[128:131]
    buffer_load_dwordx4 v5, s[20:23], s26 offen offset:3072 sc1 lds
    v_mfma_f32_16x16x32_bf16 v[128:131], a[100:103], a[32:35], v[128:131]
    v_mfma_f32_16x16x32_bf16 v[124:127], a[100:103], a[28:31], v[124:127]
    s_add_u32 m0, s30, 24576
    v_mfma_f32_16x16x32_bf16 v[124:127], a[96:99], a[8:11], v[124:127]
    buffer_load_dwordx4 v6, s[20:23], s26 offen sc1 lds
    v_mfma_f32_16x16x32_bf16 v[120:123], a[96:99], a[4:7], v[120:123]
    s_add_u32 s28, s25, 2
    s_and_b32 s28, s28, 7
    s_or_b32 s28, s28, 24
    s_lshl_b32 s28, s28, 1
    v_mfma_f32_16x16x32_bf16 v[120:123], a[100:103], a[24:27], v[120:123]
    s_add_u32 s28, s28, s31
    s_lshl_b32 s27, s28, 16
    s_add_u32 m0, s32, 131072
    v_mfma_f32_16x16x32_bf16 v[116:119], a[100:103], a[20:23], v[116:119]
    s_waitcnt vmcnt(18) lgkmcnt(0)
    s_barrier
    v_mfma_f32_16x16x32_bf16 v[116:119], a[96:99], a[0:3], v[116:119]
    ds_read_b128 a[40:43], v10 offset:20480
    ds_read_b128 a[60:63], v10 offset:30720
    v_mfma_f32_16x16x32_bf16 v[136:139], a[80:83], a[0:3], v[136:139]
    ds_read_b64_tr_b16 a[96:97], v216 offset:16384
    ds_read_b64_tr_b16 a[98:99], v216 offset:20480
    v_mfma_f32_16x16x32_bf16 v[136:139], a[84:87], a[20:23], v[136:139]
    ds_read_b64_tr_b16 a[100:101], v216 offset:24576
    ds_read_b64_tr_b16 a[102:103], v216 offset:28672
    v_mfma_f32_16x16x32_bf16 v[140:143], a[84:87], a[24:27], v[140:143]
    ds_read_b128 a[64:67], v10 offset:31744
    ds_read_b128 a[44:47], v10 offset:21504
    v_mfma_f32_16x16x32_bf16 v[140:143], a[80:83], a[4:7], v[140:143]
    ds_read_b128 a[48:51], v10 offset:22528
    ds_read_b128 a[68:71], v10 offset:32768
    v_mfma_f32_16x16x32_bf16 v[144:147], a[80:83], a[8:11], v[144:147]
    ds_read_b128 a[72:75], v10 offset:33792
    ds_read_b128 a[52:55], v10 offset:23552
    v_mfma_f32_16x16x32_bf16 v[144:147], a[84:87], a[28:31], v[144:147]
    ds_read_b128 a[56:59], v10 offset:24576
    ds_read_b128 a[76:79], v10 offset:34816
    v_mfma_f32_16x16x32_bf16 v[148:151], a[84:87], a[32:35], v[148:151]
    buffer_load_dwordx4 v1, s[8:11], s27 offen lds
    v_mfma_f32_16x16x32_bf16 v[148:151], a[80:83], a[12:15], v[148:151]
    buffer_load_dwordx4 v2, s[8:11], s27 offen offset:1024 lds
    v_mfma_f32_16x16x32_bf16 v[152:155], a[80:83], a[16:19], v[152:155]
    v_mfma_f32_16x16x32_bf16 v[152:155], a[84:87], a[36:39], v[152:155]
    v_mfma_f32_16x16x32_bf16 v[172:175], a[92:95], a[36:39], v[172:175]
    ds_read_b64_tr_b16 a[84:85], v217 offset:24576
    ds_read_b64_tr_b16 a[86:87], v217 offset:28672
    v_mfma_f32_16x16x32_bf16 v[172:175], a[88:91], a[16:19], v[172:175]
    ds_read_b64_tr_b16 a[80:81], v217 offset:16384
    ds_read_b64_tr_b16 a[82:83], v217 offset:20480
    v_mfma_f32_16x16x32_bf16 v[168:171], a[88:91], a[12:15], v[168:171]
    buffer_load_dwordx4 v3, s[8:11], s27 offen offset:2048 lds
    v_mfma_f32_16x16x32_bf16 v[168:171], a[92:95], a[32:35], v[168:171]
    v_mfma_f32_16x16x32_bf16 v[164:167], a[92:95], a[28:31], v[164:167]
    buffer_load_dwordx4 v4, s[8:11], s27 offen offset:3072 lds
    v_mfma_f32_16x16x32_bf16 v[164:167], a[88:91], a[8:11], v[164:167]
    s_add_u32 s28, s25, 2
    s_and_b32 s28, s28, 7
    s_or_b32 s28, s28, 24
    v_mfma_f32_16x16x32_bf16 v[160:163], a[88:91], a[4:7], v[160:163]
    s_lshl_b32 s28, s28, 1
    s_add_u32 s28, s28, s31
    v_mfma_f32_16x16x32_bf16 v[160:163], a[92:95], a[24:27], v[160:163]
    s_mul_i32 s26, s28, 10240
    s_add_u32 m0, s30, 40960
    v_mfma_f32_16x16x32_bf16 v[156:159], a[92:95], a[20:23], v[156:159]
    buffer_load_dwordx4 v5, s[20:23], s26 offen sc1 lds
    v_mfma_f32_16x16x32_bf16 v[156:159], a[88:91], a[0:3], v[156:159]
    s_waitcnt lgkmcnt(14)
    v_mfma_f32_16x16x32_bf16 v[96:99], a[96:99], a[40:43], v[96:99]
    s_waitcnt lgkmcnt(12)
    ds_read_b64_tr_b16 a[88:89], v216 offset:16640
    ds_read_b64_tr_b16 a[90:91], v216 offset:20736
    v_mfma_f32_16x16x32_bf16 v[96:99], a[100:103], a[60:63], v[96:99]
    s_waitcnt lgkmcnt(13)
    ds_read_b64_tr_b16 a[92:93], v216 offset:24832
    ds_read_b64_tr_b16 a[94:95], v216 offset:28928
    v_mfma_f32_16x16x32_bf16 v[100:103], a[100:103], a[64:67], v[100:103]
    s_waitcnt lgkmcnt(14)
    buffer_load_dwordx4 v5, s[20:23], s26 offen offset:1024 sc1 lds
    v_mfma_f32_16x16x32_bf16 v[100:103], a[96:99], a[44:47], v[100:103]
    s_waitcnt lgkmcnt(13)
    v_mfma_f32_16x16x32_bf16 v[104:107], a[96:99], a[48:51], v[104:107]
    s_waitcnt lgkmcnt(12)
    v_mfma_f32_16x16x32_bf16 v[104:107], a[100:103], a[68:71], v[104:107]
    s_waitcnt lgkmcnt(11)
    v_mfma_f32_16x16x32_bf16 v[108:111], a[100:103], a[72:75], v[108:111]
    s_waitcnt lgkmcnt(10)
    buffer_load_dwordx4 v5, s[20:23], s26 offen offset:2048 sc1 lds
    v_mfma_f32_16x16x32_bf16 v[108:111], a[96:99], a[52:55], v[108:111]
    s_waitcnt lgkmcnt(9)
    v_mfma_f32_16x16x32_bf16 v[112:115], a[96:99], a[56:59], v[112:115]
    s_waitcnt lgkmcnt(8)
    v_mfma_f32_16x16x32_bf16 v[112:115], a[100:103], a[76:79], v[112:115]
    s_waitcnt lgkmcnt(6)
    v_mfma_f32_16x16x32_bf16 v[132:135], a[84:87], a[76:79], v[132:135]
    s_waitcnt lgkmcnt(4)
    ds_read_b64_tr_b16 a[100:101], v217 offset:24832
    ds_read_b64_tr_b16 a[102:103], v217 offset:28928
    v_mfma_f32_16x16x32_bf16 v[132:135], a[80:83], a[56:59], v[132:135]
    ds_read_b64_tr_b16 a[96:97], v217 offset:16640
    ds_read_b64_tr_b16 a[98:99], v217 offset:20736
    v_mfma_f32_16x16x32_bf16 v[128:131], a[80:83], a[52:55], v[128:131]
    buffer_load_dwordx4 v5, s[20:23], s26 offen offset:3072 sc1 lds
    v_mfma_f32_16x16x32_bf16 v[128:131], a[84:87], a[72:75], v[128:131]
    v_mfma_f32_16x16x32_bf16 v[124:127], a[84:87], a[68:71], v[124:127]
    s_add_u32 m0, s30, 45056
    v_mfma_f32_16x16x32_bf16 v[124:127], a[80:83], a[48:51], v[124:127]
    buffer_load_dwordx4 v6, s[20:23], s26 offen sc1 lds
    v_mfma_f32_16x16x32_bf16 v[120:123], a[80:83], a[44:47], v[120:123]
    s_add_u32 s28, s25, 3
    s_and_b32 s28, s28, 7
    s_or_b32 s28, s28, 24
    s_lshl_b32 s28, s28, 1
    v_mfma_f32_16x16x32_bf16 v[120:123], a[84:87], a[64:67], v[120:123]
    s_add_u32 s28, s28, s31
    s_lshl_b32 s27, s28, 16
    s_add_u32 m0, s32, 147456
    v_mfma_f32_16x16x32_bf16 v[116:119], a[84:87], a[60:63], v[116:119]
    s_waitcnt vmcnt(18) lgkmcnt(0)
    s_barrier
    v_mfma_f32_16x16x32_bf16 v[116:119], a[80:83], a[40:43], v[116:119]
    ds_read_b128 a[0:3], v9
    ds_read_b128 a[20:23], v9 offset:10240
    v_mfma_f32_16x16x32_bf16 v[136:139], a[88:91], a[40:43], v[136:139]
    ds_read_b64_tr_b16 a[80:81], v7 offset:16384
    ds_read_b64_tr_b16 a[82:83], v7 offset:20480
    v_mfma_f32_16x16x32_bf16 v[136:139], a[92:95], a[60:63], v[136:139]
    ds_read_b64_tr_b16 a[84:85], v7 offset:24576
    ds_read_b64_tr_b16 a[86:87], v7 offset:28672
    v_mfma_f32_16x16x32_bf16 v[140:143], a[92:95], a[64:67], v[140:143]
    ds_read_b128 a[24:27], v9 offset:11264
    ds_read_b128 a[4:7], v9 offset:1024
    v_mfma_f32_16x16x32_bf16 v[140:143], a[88:91], a[44:47], v[140:143]
    ds_read_b128 a[8:11], v9 offset:2048
    ds_read_b128 a[28:31], v9 offset:12288
    v_mfma_f32_16x16x32_bf16 v[144:147], a[88:91], a[48:51], v[144:147]
    ds_read_b128 a[32:35], v9 offset:13312
    ds_read_b128 a[12:15], v9 offset:3072
    v_mfma_f32_16x16x32_bf16 v[144:147], a[92:95], a[68:71], v[144:147]
    ds_read_b128 a[16:19], v9 offset:4096
    ds_read_b128 a[36:39], v9 offset:14336
    v_mfma_f32_16x16x32_bf16 v[148:151], a[92:95], a[72:75], v[148:151]
    buffer_load_dwordx4 v1, s[8:11], s27 offen lds
    v_mfma_f32_16x16x32_bf16 v[148:151], a[88:91], a[52:55], v[148:151]
    buffer_load_dwordx4 v2, s[8:11], s27 offen offset:1024 lds
    v_mfma_f32_16x16x32_bf16 v[152:155], a[88:91], a[56:59], v[152:155]
    v_mfma_f32_16x16x32_bf16 v[152:155], a[92:95], a[76:79], v[152:155]
    v_mfma_f32_16x16x32_bf16 v[172:175], a[100:103], a[76:79], v[172:175]
    ds_read_b64_tr_b16 a[92:93], v8 offset:24576
    ds_read_b64_tr_b16 a[94:95], v8 offset:28672
    v_mfma_f32_16x16x32_bf16 v[172:175], a[96:99], a[56:59], v[172:175]
    ds_read_b64_tr_b16 a[88:89], v8 offset:16384
    ds_read_b64_tr_b16 a[90:91], v8 offset:20480
    v_mfma_f32_16x16x32_bf16 v[168:171], a[96:99], a[52:55], v[168:171]
    buffer_load_dwordx4 v3, s[8:11], s27 offen offset:2048 lds
    v_mfma_f32_16x16x32_bf16 v[168:171], a[100:103], a[72:75], v[168:171]
    v_mfma_f32_16x16x32_bf16 v[164:167], a[100:103], a[68:71], v[164:167]
    buffer_load_dwordx4 v4, s[8:11], s27 offen offset:3072 lds
    v_mfma_f32_16x16x32_bf16 v[164:167], a[96:99], a[48:51], v[164:167]
    s_add_u32 s28, s25, 3
    s_and_b32 s28, s28, 7
    s_or_b32 s28, s28, 24
    v_mfma_f32_16x16x32_bf16 v[160:163], a[96:99], a[44:47], v[160:163]
    s_lshl_b32 s28, s28, 1
    s_add_u32 s28, s28, s31
    v_mfma_f32_16x16x32_bf16 v[160:163], a[100:103], a[64:67], v[160:163]
    s_mul_i32 s26, s28, 10240
    s_add_u32 m0, s30, 61440
    v_mfma_f32_16x16x32_bf16 v[156:159], a[100:103], a[60:63], v[156:159]
    buffer_load_dwordx4 v5, s[20:23], s26 offen sc1 lds
    v_mfma_f32_16x16x32_bf16 v[156:159], a[96:99], a[40:43], v[156:159]
    s_waitcnt lgkmcnt(14)
    v_mfma_f32_16x16x32_bf16 v[96:99], a[80:83], a[0:3], v[96:99]
    s_waitcnt lgkmcnt(12)
    ds_read_b64_tr_b16 a[96:97], v7 offset:16640
    ds_read_b64_tr_b16 a[98:99], v7 offset:20736
    v_mfma_f32_16x16x32_bf16 v[96:99], a[84:87], a[20:23], v[96:99]
    s_waitcnt lgkmcnt(13)
    ds_read_b64_tr_b16 a[100:101], v7 offset:24832
    ds_read_b64_tr_b16 a[102:103], v7 offset:28928
    v_mfma_f32_16x16x32_bf16 v[100:103], a[84:87], a[24:27], v[100:103]
    s_waitcnt lgkmcnt(14)
    buffer_load_dwordx4 v5, s[20:23], s26 offen offset:1024 sc1 lds
    v_mfma_f32_16x16x32_bf16 v[100:103], a[80:83], a[4:7], v[100:103]
    s_waitcnt lgkmcnt(13)
    v_mfma_f32_16x16x32_bf16 v[104:107], a[80:83], a[8:11], v[104:107]
    s_waitcnt lgkmcnt(12)
    v_mfma_f32_16x16x32_bf16 v[104:107], a[84:87], a[28:31], v[104:107]
    s_waitcnt lgkmcnt(11)
    v_mfma_f32_16x16x32_bf16 v[108:111], a[84:87], a[32:35], v[108:111]
    s_waitcnt lgkmcnt(10)
    buffer_load_dwordx4 v5, s[20:23], s26 offen offset:2048 sc1 lds
    v_mfma_f32_16x16x32_bf16 v[108:111], a[80:83], a[12:15], v[108:111]
    s_waitcnt lgkmcnt(9)
    v_mfma_f32_16x16x32_bf16 v[112:115], a[80:83], a[16:19], v[112:115]
    s_waitcnt lgkmcnt(8)
    v_mfma_f32_16x16x32_bf16 v[112:115], a[84:87], a[36:39], v[112:115]
    s_waitcnt lgkmcnt(6)
    v_mfma_f32_16x16x32_bf16 v[132:135], a[92:95], a[36:39], v[132:135]
    s_waitcnt lgkmcnt(4)
    ds_read_b64_tr_b16 a[84:85], v8 offset:24832
    ds_read_b64_tr_b16 a[86:87], v8 offset:28928
    v_mfma_f32_16x16x32_bf16 v[132:135], a[88:91], a[16:19], v[132:135]
    ds_read_b64_tr_b16 a[80:81], v8 offset:16640
    ds_read_b64_tr_b16 a[82:83], v8 offset:20736
    v_mfma_f32_16x16x32_bf16 v[128:131], a[88:91], a[12:15], v[128:131]
    buffer_load_dwordx4 v5, s[20:23], s26 offen offset:3072 sc1 lds
    v_mfma_f32_16x16x32_bf16 v[128:131], a[92:95], a[32:35], v[128:131]
    v_mfma_f32_16x16x32_bf16 v[124:127], a[92:95], a[28:31], v[124:127]
    s_add_u32 m0, s30, 65536
    v_mfma_f32_16x16x32_bf16 v[124:127], a[88:91], a[8:11], v[124:127]
    buffer_load_dwordx4 v6, s[20:23], s26 offen sc1 lds
    v_mfma_f32_16x16x32_bf16 v[120:123], a[88:91], a[4:7], v[120:123]
    s_add_u32 s28, s25, 4
    s_and_b32 s28, s28, 7
    s_or_b32 s28, s28, 24
    s_lshl_b32 s28, s28, 1
    v_mfma_f32_16x16x32_bf16 v[120:123], a[92:95], a[24:27], v[120:123]
    s_add_u32 s28, s28, s31
    s_lshl_b32 s27, s28, 16
    s_add_u32 m0, s32, 98304
    v_mfma_f32_16x16x32_bf16 v[116:119], a[92:95], a[20:23], v[116:119]
    s_waitcnt vmcnt(18) lgkmcnt(0)
    s_barrier
    v_mfma_f32_16x16x32_bf16 v[116:119], a[88:91], a[0:3], v[116:119]
    ds_read_b128 a[40:43], v9 offset:20480
    ds_read_b128 a[60:63], v9 offset:30720
    v_mfma_f32_16x16x32_bf16 v[136:139], a[96:99], a[0:3], v[136:139]
    ds_read_b64_tr_b16 a[88:89], v7 offset:32768
    ds_read_b64_tr_b16 a[90:91], v7 offset:36864
    v_mfma_f32_16x16x32_bf16 v[136:139], a[100:103], a[20:23], v[136:139]
    ds_read_b64_tr_b16 a[92:93], v7 offset:40960
    ds_read_b64_tr_b16 a[94:95], v7 offset:45056
    v_mfma_f32_16x16x32_bf16 v[140:143], a[100:103], a[24:27], v[140:143]
    ds_read_b128 a[64:67], v9 offset:31744
    ds_read_b128 a[44:47], v9 offset:21504
    v_mfma_f32_16x16x32_bf16 v[140:143], a[96:99], a[4:7], v[140:143]
    ds_read_b128 a[48:51], v9 offset:22528
    ds_read_b128 a[68:71], v9 offset:32768
    v_mfma_f32_16x16x32_bf16 v[144:147], a[96:99], a[8:11], v[144:147]
    ds_read_b128 a[72:75], v9 offset:33792
    ds_read_b128 a[52:55], v9 offset:23552
    v_mfma_f32_16x16x32_bf16 v[144:147], a[100:103], a[28:31], v[144:147]
    ds_read_b128 a[56:59], v9 offset:24576
    ds_read_b128 a[76:79], v9 offset:34816
    v_mfma_f32_16x16x32_bf16 v[148:151], a[100:103], a[32:35], v[148:151]
    buffer_load_dwordx4 v1, s[8:11], s27 offen lds
    v_mfma_f32_16x16x32_bf16 v[148:151], a[96:99], a[12:15], v[148:151]
    buffer_load_dwordx4 v2, s[8:11], s27 offen offset:1024 lds
    v_mfma_f32_16x16x32_bf16 v[152:155], a[96:99], a[16:19], v[152:155]
    v_mfma_f32_16x16x32_bf16 v[152:155], a[100:103], a[36:39], v[152:155]
    v_mfma_f32_16x16x32_bf16 v[172:175], a[84:87], a[36:39], v[172:175]
    ds_read_b64_tr_b16 a[100:101], v8 offset:40960
    ds_read_b64_tr_b16 a[102:103], v8 offset:45056
    v_mfma_f32_16x16x32_bf16 v[172:175], a[80:83], a[16:19], v[172:175]
    ds_read_b64_tr_b16 a[96:97], v8 offset:32768
    ds_read_b64_tr_b16 a[98:99], v8 offset:36864
    v_mfma_f32_16x16x32_bf16 v[168:171], a[80:83], a[12:15], v[168:171]
    buffer_load_dwordx4 v3, s[8:11], s27 offen offset:2048 lds
    v_mfma_f32_16x16x32_bf16 v[168:171], a[84:87], a[32:35], v[168:171]
    v_mfma_f32_16x16x32_bf16 v[164:167], a[84:87], a[28:31], v[164:167]
    buffer_load_dwordx4 v4, s[8:11], s27 offen offset:3072 lds
    v_mfma_f32_16x16x32_bf16 v[164:167], a[80:83], a[8:11], v[164:167]
    s_add_u32 s28, s25, 4
    s_and_b32 s28, s28, 7
    s_or_b32 s28, s28, 24
    v_mfma_f32_16x16x32_bf16 v[160:163], a[80:83], a[4:7], v[160:163]
    s_lshl_b32 s28, s28, 1
    s_add_u32 s28, s28, s31
    v_mfma_f32_16x16x32_bf16 v[160:163], a[84:87], a[24:27], v[160:163]
    s_mul_i32 s26, s28, 10240
    s_add_u32 m0, s30, 0
    v_mfma_f32_16x16x32_bf16 v[156:159], a[84:87], a[20:23], v[156:159]
    buffer_load_dwordx4 v5, s[20:23], s26 offen sc1 lds
    v_mfma_f32_16x16x32_bf16 v[156:159], a[80:83], a[0:3], v[156:159]
    s_waitcnt lgkmcnt(14)
    v_mfma_f32_16x16x32_bf16 v[96:99], a[88:91], a[40:43], v[96:99]
    s_waitcnt lgkmcnt(12)
    ds_read_b64_tr_b16 a[80:81], v7 offset:33024
    ds_read_b64_tr_b16 a[82:83], v7 offset:37120
    v_mfma_f32_16x16x32_bf16 v[96:99], a[92:95], a[60:63], v[96:99]
    s_waitcnt lgkmcnt(13)
    ds_read_b64_tr_b16 a[84:85], v7 offset:41216
    ds_read_b64_tr_b16 a[86:87], v7 offset:45312
    v_mfma_f32_16x16x32_bf16 v[100:103], a[92:95], a[64:67], v[100:103]
    s_waitcnt lgkmcnt(14)
    buffer_load_dwordx4 v5, s[20:23], s26 offen offset:1024 sc1 lds
    v_mfma_f32_16x16x32_bf16 v[100:103], a[88:91], a[44:47], v[100:103]
    s_waitcnt lgkmcnt(13)
    v_mfma_f32_16x16x32_bf16 v[104:107], a[88:91], a[48:51], v[104:107]
    s_waitcnt lgkmcnt(12)
    v_mfma_f32_16x16x32_bf16 v[104:107], a[92:95], a[68:71], v[104:107]
    s_waitcnt lgkmcnt(11)
    v_mfma_f32_16x16x32_bf16 v[108:111], a[92:95], a[72:75], v[108:111]
    s_waitcnt lgkmcnt(10)
    buffer_load_dwordx4 v5, s[20:23], s26 offen offset:2048 sc1 lds
    v_mfma_f32_16x16x32_bf16 v[108:111], a[88:91], a[52:55], v[108:111]
    s_waitcnt lgkmcnt(9)
    v_mfma_f32_16x16x32_bf16 v[112:115], a[88:91], a[56:59], v[112:115]
    s_waitcnt lgkmcnt(8)
    v_mfma_f32_16x16x32_bf16 v[112:115], a[92:95], a[76:79], v[112:115]
    s_waitcnt lgkmcnt(6)
    v_mfma_f32_16x16x32_bf16 v[132:135], a[100:103], a[76:79], v[132:135]
    s_waitcnt lgkmcnt(4)
    ds_read_b64_tr_b16 a[92:93], v8 offset:41216
    ds_read_b64_tr_b16 a[94:95], v8 offset:45312
    v_mfma_f32_16x16x32_bf16 v[132:135], a[96:99], a[56:59], v[132:135]
    ds_read_b64_tr_b16 a[88:89], v8 offset:33024
    ds_read_b64_tr_b16 a[90:91], v8 offset:37120
    v_mfma_f32_16x16x32_bf16 v[128:131], a[96:99], a[52:55], v[128:131]
    buffer_load_dwordx4 v5, s[20:23], s26 offen offset:3072 sc1 lds
    v_mfma_f32_16x16x32_bf16 v[128:131], a[100:103], a[72:75], v[128:131]
    v_mfma_f32_16x16x32_bf16 v[124:127], a[100:103], a[68:71], v[124:127]
    s_add_u32 m0, s30, 4096
    v_mfma_f32_16x16x32_bf16 v[124:127], a[96:99], a[48:51], v[124:127]
    buffer_load_dwordx4 v6, s[20:23], s26 offen sc1 lds
    v_mfma_f32_16x16x32_bf16 v[120:123], a[96:99], a[44:47], v[120:123]
    s_add_u32 s28, s25, 5
    s_and_b32 s28, s28, 7
    s_or_b32 s28, s28, 24
    s_lshl_b32 s28, s28, 1
    v_mfma_f32_16x16x32_bf16 v[120:123], a[100:103], a[64:67], v[120:123]
    s_add_u32 s28, s28, s31
    s_lshl_b32 s27, s28, 16
    s_add_u32 m0, s32, 114688
    v_mfma_f32_16x16x32_bf16 v[116:119], a[100:103], a[60:63], v[116:119]
    s_waitcnt vmcnt(18) lgkmcnt(0)
    s_barrier
    v_mfma_f32_16x16x32_bf16 v[116:119], a[96:99], a[40:43], v[116:119]
    ds_read_b128 a[0:3], v10
    ds_read_b128 a[20:23], v10 offset:10240
    v_mfma_f32_16x16x32_bf16 v[136:139], a[80:83], a[40:43], v[136:139]
    ds_read_b64_tr_b16 a[96:97], v216
    ds_read_b64_tr_b16 a[98:99], v216 offset:4096
    v_mfma_f32_16x16x32_bf16 v[136:139], a[84:87], a[60:63], v[136:139]
    ds_read_b64_tr_b16 a[100:101], v216 offset:8192
    ds_read_b64_tr_b16 a[102:103], v216 offset:12288
    v_mfma_f32_16x16x32_bf16 v[140:143], a[84:87], a[64:67], v[140:143]
    ds_read_b128 a[24:27], v10 offset:11264
    ds_read_b128 a[4:7], v10 offset:1024
    v_mfma_f32_16x16x32_bf16 v[140:143], a[80:83], a[44:47], v[140:143]
    ds_read_b128 a[8:11], v10 offset:2048
    ds_read_b128 a[28:31], v10 offset:12288
    v_mfma_f32_16x16x32_bf16 v[144:147], a[80:83], a[48:51], v[144:147]
    ds_read_b128 a[32:35], v10 offset:13312
    ds_read_b128 a[12:15], v10 offset:3072
    v_mfma_f32_16x16x32_bf16 v[144:147], a[84:87], a[68:71], v[144:147]
    ds_read_b128 a[16:19], v10 offset:4096
    ds_read_b128 a[36:39], v10 offset:14336
    v_mfma_f32_16x16x32_bf16 v[148:151], a[84:87], a[72:75], v[148:151]
    buffer_load_dwordx4 v1, s[8:11], s27 offen lds
    v_mfma_f32_16x16x32_bf16 v[148:151], a[80:83], a[52:55], v[148:151]
    buffer_load_dwordx4 v2, s[8:11], s27 offen offset:1024 lds
    v_mfma_f32_16x16x32_bf16 v[152:155], a[80:83], a[56:59], v[152:155]
    v_mfma_f32_16x16x32_bf16 v[152:155], a[84:87], a[76:79], v[152:155]
    v_mfma_f32_16x16x32_bf16 v[172:175], a[92:95], a[76:79], v[172:175]
    ds_read_b64_tr_b16 a[84:85], v217 offset:8192
    ds_read_b64_tr_b16 a[86:87], v217 offset:12288
    v_mfma_f32_16x16x32_bf16 v[172:175], a[88:91], a[56:59], v[172:175]
    ds_read_b64_tr_b16 a[80:81], v217
    ds_read_b64_tr_b16 a[82:83], v217 offset:4096
    v_mfma_f32_16x16x32_bf16 v[168:171], a[88:91], a[52:55], v[168:171]
    buffer_load_dwordx4 v3, s[8:11], s27 offen offset:2048 lds
    v_mfma_f32_16x16x32_bf16 v[168:171], a[92:95], a[72:75], v[168:171]
    v_mfma_f32_16x16x32_bf16 v[164:167], a[92:95], a[68:71], v[164:167]
    buffer_load_dwordx4 v4, s[8:11], s27 offen offset:3072 lds
    v_mfma_f32_16x16x32_bf16 v[164:167], a[88:91], a[48:51], v[164:167]
    s_add_u32 s28, s25, 5
    s_and_b32 s28, s28, 7
    s_or_b32 s28, s28, 24
    v_mfma_f32_16x16x32_bf16 v[160:163], a[88:91], a[44:47], v[160:163]
    s_lshl_b32 s28, s28, 1
    s_add_u32 s28, s28, s31
    v_mfma_f32_16x16x32_bf16 v[160:163], a[92:95], a[64:67], v[160:163]
    s_mul_i32 s26, s28, 10240
    s_add_u32 m0, s30, 20480
    v_mfma_f32_16x16x32_bf16 v[156:159], a[92:95], a[60:63], v[156:159]
    buffer_load_dwordx4 v5, s[20:23], s26 offen sc1 lds
    v_mfma_f32_16x16x32_bf16 v[156:159], a[88:91], a[40:43], v[156:159]
    s_waitcnt lgkmcnt(14)
    v_mfma_f32_16x16x32_bf16 v[96:99], a[96:99], a[0:3], v[96:99]
    s_waitcnt lgkmcnt(12)
    ds_read_b64_tr_b16 a[88:89], v216 offset:256
    ds_read_b64_tr_b16 a[90:91], v216 offset:4352
    v_mfma_f32_16x16x32_bf16 v[96:99], a[100:103], a[20:23], v[96:99]
    s_waitcnt lgkmcnt(13)
    ds_read_b64_tr_b16 a[92:93], v216 offset:8448
    ds_read_b64_tr_b16 a[94:95], v216 offset:12544
    v_mfma_f32_16x16x32_bf16 v[100:103], a[100:103], a[24:27], v[100:103]
    s_waitcnt lgkmcnt(14)
    buffer_load_dwordx4 v5, s[20:23], s26 offen offset:1024 sc1 lds
    v_mfma_f32_16x16x32_bf16 v[100:103], a[96:99], a[4:7], v[100:103]
    s_waitcnt lgkmcnt(13)
    v_mfma_f32_16x16x32_bf16 v[104:107], a[96:99], a[8:11], v[104:107]
    s_waitcnt lgkmcnt(12)
    v_mfma_f32_16x16x32_bf16 v[104:107], a[100:103], a[28:31], v[104:107]
    s_waitcnt lgkmcnt(11)
    v_mfma_f32_16x16x32_bf16 v[108:111], a[100:103], a[32:35], v[108:111]
    s_waitcnt lgkmcnt(10)
    buffer_load_dwordx4 v5, s[20:23], s26 offen offset:2048 sc1 lds
    v_mfma_f32_16x16x32_bf16 v[108:111], a[96:99], a[12:15], v[108:111]
    s_waitcnt lgkmcnt(9)
    v_mfma_f32_16x16x32_bf16 v[112:115], a[96:99], a[16:19], v[112:115]
    s_waitcnt lgkmcnt(8)
    v_mfma_f32_16x16x32_bf16 v[112:115], a[100:103], a[36:39], v[112:115]
    s_waitcnt lgkmcnt(6)
    v_mfma_f32_16x16x32_bf16 v[132:135], a[84:87], a[36:39], v[132:135]
    s_waitcnt lgkmcnt(4)
    ds_read_b64_tr_b16 a[100:101], v217 offset:8448
    ds_read_b64_tr_b16 a[102:103], v217 offset:12544
    v_mfma_f32_16x16x32_bf16 v[132:135], a[80:83], a[16:19], v[132:135]
    ds_read_b64_tr_b16 a[96:97], v217 offset:256
    ds_read_b64_tr_b16 a[98:99], v217 offset:4352
    v_mfma_f32_16x16x32_bf16 v[128:131], a[80:83], a[12:15], v[128:131]
    buffer_load_dwordx4 v5, s[20:23], s26 offen offset:3072 sc1 lds
    v_mfma_f32_16x16x32_bf16 v[128:131], a[84:87], a[32:35], v[128:131]
    v_mfma_f32_16x16x32_bf16 v[124:127], a[84:87], a[28:31], v[124:127]
    s_add_u32 m0, s30, 24576
    v_mfma_f32_16x16x32_bf16 v[124:127], a[80:83], a[8:11], v[124:127]
    buffer_load_dwordx4 v6, s[20:23], s26 offen sc1 lds
    v_mfma_f32_16x16x32_bf16 v[120:123], a[80:83], a[4:7], v[120:123]
    s_add_u32 s28, s25, 6
    s_and_b32 s28, s28, 7
    s_or_b32 s28, s28, 24
    s_lshl_b32 s28, s28, 1
    v_mfma_f32_16x16x32_bf16 v[120:123], a[84:87], a[24:27], v[120:123]
    s_add_u32 s28, s28, s31
    s_lshl_b32 s27, s28, 16
    s_add_u32 m0, s32, 131072
    v_mfma_f32_16x16x32_bf16 v[116:119], a[84:87], a[20:23], v[116:119]
    s_waitcnt vmcnt(18) lgkmcnt(0)
    s_barrier
    v_mfma_f32_16x16x32_bf16 v[116:119], a[80:83], a[0:3], v[116:119]
    ds_read_b128 a[40:43], v10 offset:20480
    ds_read_b128 a[60:63], v10 offset:30720
    v_mfma_f32_16x16x32_bf16 v[136:139], a[88:91], a[0:3], v[136:139]
    ds_read_b64_tr_b16 a[80:81], v216 offset:16384
    ds_read_b64_tr_b16 a[82:83], v216 offset:20480
    v_mfma_f32_16x16x32_bf16 v[136:139], a[92:95], a[20:23], v[136:139]
    ds_read_b64_tr_b16 a[84:85], v216 offset:24576
    ds_read_b64_tr_b16 a[86:87], v216 offset:28672
    v_mfma_f32_16x16x32_bf16 v[140:143], a[92:95], a[24:27], v[140:143]
    ds_read_b128 a[64:67], v10 offset:31744
    ds_read_b128 a[44:47], v10 offset:21504
    v_mfma_f32_16x16x32_bf16 v[140:143], a[88:91], a[4:7], v[140:143]
    ds_read_b128 a[48:51], v10 offset:22528
    ds_read_b128 a[68:71], v10 offset:32768
    v_mfma_f32_16x16x32_bf16 v[144:147], a[88:91], a[8:11], v[144:147]
    ds_read_b128 a[72:75], v10 offset:33792
    ds_read_b128 a[52:55], v10 offset:23552
    v_mfma_f32_16x16x32_bf16 v[144:147], a[92:95], a[28:31], v[144:147]
    ds_read_b128 a[56:59], v10 offset:24576
    ds_read_b128 a[76:79], v10 offset:34816
    v_mfma_f32_16x16x32_bf16 v[148:151], a[92:95], a[32:35], v[148:151]
    buffer_load_dwordx4 v1, s[8:11], s27 offen lds
    v_mfma_f32_16x16x32_bf16 v[148:151], a[88:91], a[12:15], v[148:151]
    buffer_load_dwordx4 v2, s[8:11], s27 offen offset:1024 lds
    v_mfma_f32_16x16x32_bf16 v[152:155], a[88:91], a[16:19], v[152:155]
    v_mfma_f32_16x16x32_bf16 v[152:155], a[92:95], a[36:39], v[152:155]
    v_mfma_f32_16x16x32_bf16 v[172:175], a[100:103], a[36:39], v[172:175]
    ds_read_b64_tr_b16 a[92:93], v217 offset:24576
    ds_read_b64_tr_b16 a[94:95], v217 offset:28672
    v_mfma_f32_16x16x32_bf16 v[172:175], a[96:99], a[16:19], v[172:175]
    ds_read_b64_tr_b16 a[88:89], v217 offset:16384
    ds_read_b64_tr_b16 a[90:91], v217 offset:20480
    v_mfma_f32_16x16x32_bf16 v[168:171], a[96:99], a[12:15], v[168:171]
    buffer_load_dwordx4 v3, s[8:11], s27 offen offset:2048 lds
    v_mfma_f32_16x16x32_bf16 v[168:171], a[100:103], a[32:35], v[168:171]
    v_mfma_f32_16x16x32_bf16 v[164:167], a[100:103], a[28:31], v[164:167]
    buffer_load_dwordx4 v4, s[8:11], s27 offen offset:3072 lds
    v_mfma_f32_16x16x32_bf16 v[164:167], a[96:99], a[8:11], v[164:167]
    s_add_u32 s28, s25, 6
    s_and_b32 s28, s28, 7
    s_or_b32 s28, s28, 24
    v_mfma_f32_16x16x32_bf16 v[160:163], a[96:99], a[4:7], v[160:163]
    s_lshl_b32 s28, s28, 1
    s_add_u32 s28, s28, s31
    v_mfma_f32_16x16x32_bf16 v[160:163], a[100:103], a[24:27], v[160:163]
    s_mul_i32 s26, s28, 10240
    s_add_u32 m0, s30, 40960
    v_mfma_f32_16x16x32_bf16 v[156:159], a[100:103], a[20:23], v[156:159]
    buffer_load_dwordx4 v5, s[20:23], s26 offen sc1 lds
    v_mfma_f32_16x16x32_bf16 v[156:159], a[96:99], a[0:3], v[156:159]
    s_waitcnt lgkmcnt(14)
    v_mfma_f32_16x16x32_bf16 v[96:99], a[80:83], a[40:43], v[96:99]
    s_waitcnt lgkmcnt(12)
    ds_read_b64_tr_b16 a[96:97], v216 offset:16640
    ds_read_b64_tr_b16 a[98:99], v216 offset:20736
    v_mfma_f32_16x16x32_bf16 v[96:99], a[84:87], a[60:63], v[96:99]
    s_waitcnt lgkmcnt(13)
    ds_read_b64_tr_b16 a[100:101], v216 offset:24832
    ds_read_b64_tr_b16 a[102:103], v216 offset:28928
    v_mfma_f32_16x16x32_bf16 v[100:103], a[84:87], a[64:67], v[100:103]
    s_waitcnt lgkmcnt(14)
    buffer_load_dwordx4 v5, s[20:23], s26 offen offset:1024 sc1 lds
    v_mfma_f32_16x16x32_bf16 v[100:103], a[80:83], a[44:47], v[100:103]
    s_waitcnt lgkmcnt(13)
    v_mfma_f32_16x16x32_bf16 v[104:107], a[80:83], a[48:51], v[104:107]
    s_waitcnt lgkmcnt(12)
    v_mfma_f32_16x16x32_bf16 v[104:107], a[84:87], a[68:71], v[104:107]
    s_waitcnt lgkmcnt(11)
    v_mfma_f32_16x16x32_bf16 v[108:111], a[84:87], a[72:75], v[108:111]
    s_waitcnt lgkmcnt(10)
    buffer_load_dwordx4 v5, s[20:23], s26 offen offset:2048 sc1 lds
    v_mfma_f32_16x16x32_bf16 v[108:111], a[80:83], a[52:55], v[108:111]
    s_waitcnt lgkmcnt(9)
    v_mfma_f32_16x16x32_bf16 v[112:115], a[80:83], a[56:59], v[112:115]
    s_waitcnt lgkmcnt(8)
    v_mfma_f32_16x16x32_bf16 v[112:115], a[84:87], a[76:79], v[112:115]
    s_waitcnt lgkmcnt(6)
    v_mfma_f32_16x16x32_bf16 v[132:135], a[92:95], a[76:79], v[132:135]
    s_waitcnt lgkmcnt(4)
    ds_read_b64_tr_b16 a[84:85], v217 offset:24832
    ds_read_b64_tr_b16 a[86:87], v217 offset:28928
    v_mfma_f32_16x16x32_bf16 v[132:135], a[88:91], a[56:59], v[132:135]
    ds_read_b64_tr_b16 a[80:81], v217 offset:16640
    ds_read_b64_tr_b16 a[82:83], v217 offset:20736
    v_mfma_f32_16x16x32_bf16 v[128:131], a[88:91], a[52:55], v[128:131]
    buffer_load_dwordx4 v5, s[20:23], s26 offen offset:3072 sc1 lds
    v_mfma_f32_16x16x32_bf16 v[128:131], a[92:95], a[72:75], v[128:131]
    v_mfma_f32_16x16x32_bf16 v[124:127], a[92:95], a[68:71], v[124:127]
    s_add_u32 m0, s30, 45056
    v_mfma_f32_16x16x32_bf16 v[124:127], a[88:91], a[48:51], v[124:127]
    buffer_load_dwordx4 v6, s[20:23], s26 offen sc1 lds
    v_mfma_f32_16x16x32_bf16 v[120:123], a[88:91], a[44:47], v[120:123]
    s_add_u32 s28, s25, 7
    s_and_b32 s28, s28, 7
    s_or_b32 s28, s28, 24
    s_lshl_b32 s28, s28, 1
    v_mfma_f32_16x16x32_bf16 v[120:123], a[92:95], a[64:67], v[120:123]
    s_add_u32 s28, s28, s31
    s_lshl_b32 s27, s28, 16
    s_add_u32 m0, s32, 147456
    v_mfma_f32_16x16x32_bf16 v[116:119], a[92:95], a[60:63], v[116:119]
    s_waitcnt vmcnt(18) lgkmcnt(0)
    s_barrier
    v_mfma_f32_16x16x32_bf16 v[116:119], a[88:91], a[40:43], v[116:119]
    ds_read_b128 a[0:3], v9
    ds_read_b128 a[20:23], v9 offset:10240
    v_mfma_f32_16x16x32_bf16 v[136:139], a[96:99], a[40:43], v[136:139]
    ds_read_b64_tr_b16 a[88:89], v7 offset:16384
    ds_read_b64_tr_b16 a[90:91], v7 offset:20480
    v_mfma_f32_16x16x32_bf16 v[136:139], a[100:103], a[60:63], v[136:139]
    ds_read_b64_tr_b16 a[92:93], v7 offset:24576
    ds_read_b64_tr_b16 a[94:95], v7 offset:28672
    v_mfma_f32_16x16x32_bf16 v[140:143], a[100:103], a[64:67], v[140:143]
    ds_read_b128 a[24:27], v9 offset:11264
    ds_read_b128 a[4:7], v9 offset:1024
    v_mfma_f32_16x16x32_bf16 v[140:143], a[96:99], a[44:47], v[140:143]
    ds_read_b128 a[8:11], v9 offset:2048
    ds_read_b128 a[28:31], v9 offset:12288
    v_mfma_f32_16x16x32_bf16 v[144:147], a[96:99], a[48:51], v[144:147]
    ds_read_b128 a[32:35], v9 offset:13312
    ds_read_b128 a[12:15], v9 offset:3072
    v_mfma_f32_16x16x32_bf16 v[144:147], a[100:103], a[68:71], v[144:147]
    ds_read_b128 a[16:19], v9 offset:4096
    ds_read_b128 a[36:39], v9 offset:14336
    v_mfma_f32_16x16x32_bf16 v[148:151], a[100:103], a[72:75], v[148:151]
    buffer_load_dwordx4 v1, s[8:11], s27 offen lds
    v_mfma_f32_16x16x32_bf16 v[148:151], a[96:99], a[52:55], v[148:151]
    buffer_load_dwordx4 v2, s[8:11], s27 offen offset:1024 lds
    v_mfma_f32_16x16x32_bf16 v[152:155], a[96:99], a[56:59], v[152:155]
    v_mfma_f32_16x16x32_bf16 v[152:155], a[100:103], a[76:79], v[152:155]
    v_mfma_f32_16x16x32_bf16 v[172:175], a[84:87], a[76:79], v[172:175]
    ds_read_b64_tr_b16 a[100:101], v8 offset:24576
    ds_read_b64_tr_b16 a[102:103], v8 offset:28672
    v_mfma_f32_16x16x32_bf16 v[172:175], a[80:83], a[56:59], v[172:175]
    ds_read_b64_tr_b16 a[96:97], v8 offset:16384
    ds_read_b64_tr_b16 a[98:99], v8 offset:20480
    v_mfma_f32_16x16x32_bf16 v[168:171], a[80:83], a[52:55], v[168:171]
    buffer_load_dwordx4 v3, s[8:11], s27 offen offset:2048 lds
    v_mfma_f32_16x16x32_bf16 v[168:171], a[84:87], a[72:75], v[168:171]
    v_mfma_f32_16x16x32_bf16 v[164:167], a[84:87], a[68:71], v[164:167]
    buffer_load_dwordx4 v4, s[8:11], s27 offen offset:3072 lds
    v_mfma_f32_16x16x32_bf16 v[164:167], a[80:83], a[48:51], v[164:167]
    s_add_u32 s28, s25, 7
    s_and_b32 s28, s28, 7
    s_or_b32 s28, s28, 24
    v_mfma_f32_16x16x32_bf16 v[160:163], a[80:83], a[44:47], v[160:163]
    s_lshl_b32 s28, s28, 1
    s_add_u32 s28, s28, s31
    v_mfma_f32_16x16x32_bf16 v[160:163], a[84:87], a[64:67], v[160:163]
    s_mul_i32 s26, s28, 10240
    s_add_u32 m0, s30, 61440
    v_mfma_f32_16x16x32_bf16 v[156:159], a[84:87], a[60:63], v[156:159]
    buffer_load_dwordx4 v5, s[20:23], s26 offen sc1 lds
    v_mfma_f32_16x16x32_bf16 v[156:159], a[80:83], a[40:43], v[156:159]
    s_waitcnt lgkmcnt(14)
    v_mfma_f32_16x16x32_bf16 v[96:99], a[88:91], a[0:3], v[96:99]
    s_waitcnt lgkmcnt(12)
    ds_read_b64_tr_b16 a[80:81], v7 offset:16640
    ds_read_b64_tr_b16 a[82:83], v7 offset:20736
    v_mfma_f32_16x16x32_bf16 v[96:99], a[92:95], a[20:23], v[96:99]
    s_waitcnt lgkmcnt(13)
    ds_read_b64_tr_b16 a[84:85], v7 offset:24832
    ds_read_b64_tr_b16 a[86:87], v7 offset:28928
    v_mfma_f32_16x16x32_bf16 v[100:103], a[92:95], a[24:27], v[100:103]
    s_waitcnt lgkmcnt(14)
    buffer_load_dwordx4 v5, s[20:23], s26 offen offset:1024 sc1 lds
    v_mfma_f32_16x16x32_bf16 v[100:103], a[88:91], a[4:7], v[100:103]
    s_waitcnt lgkmcnt(13)
    v_mfma_f32_16x16x32_bf16 v[104:107], a[88:91], a[8:11], v[104:107]
    s_waitcnt lgkmcnt(12)
    v_mfma_f32_16x16x32_bf16 v[104:107], a[92:95], a[28:31], v[104:107]
    s_waitcnt lgkmcnt(11)
    v_mfma_f32_16x16x32_bf16 v[108:111], a[92:95], a[32:35], v[108:111]
    s_waitcnt lgkmcnt(10)
    buffer_load_dwordx4 v5, s[20:23], s26 offen offset:2048 sc1 lds
    v_mfma_f32_16x16x32_bf16 v[108:111], a[88:91], a[12:15], v[108:111]
    s_waitcnt lgkmcnt(9)
    v_mfma_f32_16x16x32_bf16 v[112:115], a[88:91], a[16:19], v[112:115]
    s_waitcnt lgkmcnt(8)
    v_mfma_f32_16x16x32_bf16 v[112:115], a[92:95], a[36:39], v[112:115]
    s_waitcnt lgkmcnt(6)
    v_mfma_f32_16x16x32_bf16 v[132:135], a[100:103], a[36:39], v[132:135]
    s_waitcnt lgkmcnt(4)
    ds_read_b64_tr_b16 a[92:93], v8 offset:24832
    ds_read_b64_tr_b16 a[94:95], v8 offset:28928
    v_mfma_f32_16x16x32_bf16 v[132:135], a[96:99], a[16:19], v[132:135]
    ds_read_b64_tr_b16 a[88:89], v8 offset:16640
    ds_read_b64_tr_b16 a[90:91], v8 offset:20736
    v_mfma_f32_16x16x32_bf16 v[128:131], a[96:99], a[12:15], v[128:131]
    buffer_load_dwordx4 v5, s[20:23], s26 offen offset:3072 sc1 lds
    v_mfma_f32_16x16x32_bf16 v[128:131], a[100:103], a[32:35], v[128:131]
    v_mfma_f32_16x16x32_bf16 v[124:127], a[100:103], a[28:31], v[124:127]
    s_add_u32 m0, s30, 65536
    v_mfma_f32_16x16x32_bf16 v[124:127], a[96:99], a[8:11], v[124:127]
    buffer_load_dwordx4 v6, s[20:23], s26 offen sc1 lds
    v_mfma_f32_16x16x32_bf16 v[120:123], a[96:99], a[4:7], v[120:123]
    v_mfma_f32_16x16x32_bf16 v[120:123], a[100:103], a[24:27], v[120:123]
    v_mfma_f32_16x16x32_bf16 v[116:119], a[100:103], a[20:23], v[116:119]
    s_waitcnt vmcnt(18) lgkmcnt(0)
    s_barrier
    v_mfma_f32_16x16x32_bf16 v[116:119], a[96:99], a[0:3], v[116:119]
    ds_read_b128 a[40:43], v9 offset:20480
    ds_read_b128 a[60:63], v9 offset:30720
    v_mfma_f32_16x16x32_bf16 v[136:139], a[80:83], a[0:3], v[136:139]
    ds_read_b64_tr_b16 a[96:97], v7 offset:32768
    ds_read_b64_tr_b16 a[98:99], v7 offset:36864
    buffer_load_dword v24, v23, s[36:39], s65 offen sc1
    v_mfma_f32_16x16x32_bf16 v[136:139], a[84:87], a[20:23], v[136:139]
    ds_read_b64_tr_b16 a[100:101], v7 offset:40960
    ds_read_b64_tr_b16 a[102:103], v7 offset:45056
    v_mfma_f32_16x16x32_bf16 v[140:143], a[84:87], a[24:27], v[140:143]
    ds_read_b128 a[64:67], v9 offset:31744
    ds_read_b128 a[44:47], v9 offset:21504
    v_mfma_f32_16x16x32_bf16 v[140:143], a[80:83], a[4:7], v[140:143]
    ds_read_b128 a[48:51], v9 offset:22528
    ds_read_b128 a[68:71], v9 offset:32768
    v_mfma_f32_16x16x32_bf16 v[144:147], a[80:83], a[8:11], v[144:147]
    ds_read_b128 a[72:75], v9 offset:33792
    ds_read_b128 a[52:55], v9 offset:23552
    v_mfma_f32_16x16x32_bf16 v[144:147], a[84:87], a[28:31], v[144:147]
    ds_read_b128 a[56:59], v9 offset:24576
    ds_read_b128 a[76:79], v9 offset:34816
    v_mfma_f32_16x16x32_bf16 v[148:151], a[84:87], a[32:35], v[148:151]
    v_mfma_f32_16x16x32_bf16 v[148:151], a[80:83], a[12:15], v[148:151]
    v_mfma_f32_16x16x32_bf16 v[152:155], a[80:83], a[16:19], v[152:155]
    v_mfma_f32_16x16x32_bf16 v[152:155], a[84:87], a[36:39], v[152:155]
    v_mfma_f32_16x16x32_bf16 v[172:175], a[92:95], a[36:39], v[172:175]
    ds_read_b64_tr_b16 a[84:85], v8 offset:40960
    ds_read_b64_tr_b16 a[86:87], v8 offset:45056
    v_mfma_f32_16x16x32_bf16 v[172:175], a[88:91], a[16:19], v[172:175]
    ds_read_b64_tr_b16 a[80:81], v8 offset:32768
    ds_read_b64_tr_b16 a[82:83], v8 offset:36864
    v_mfma_f32_16x16x32_bf16 v[168:171], a[88:91], a[12:15], v[168:171]
    v_mfma_f32_16x16x32_bf16 v[168:171], a[92:95], a[32:35], v[168:171]
    v_mfma_f32_16x16x32_bf16 v[164:167], a[92:95], a[28:31], v[164:167]
    v_mfma_f32_16x16x32_bf16 v[164:167], a[88:91], a[8:11], v[164:167]
    v_mfma_f32_16x16x32_bf16 v[160:163], a[88:91], a[4:7], v[160:163]
    v_mfma_f32_16x16x32_bf16 v[160:163], a[92:95], a[24:27], v[160:163]
    v_mfma_f32_16x16x32_bf16 v[156:159], a[92:95], a[20:23], v[156:159]
    v_mfma_f32_16x16x32_bf16 v[156:159], a[88:91], a[0:3], v[156:159]
    s_waitcnt lgkmcnt(14)
    v_mfma_f32_16x16x32_bf16 v[96:99], a[96:99], a[40:43], v[96:99]
    s_waitcnt lgkmcnt(12)
    ds_read_b64_tr_b16 a[88:89], v7 offset:33024
    ds_read_b64_tr_b16 a[90:91], v7 offset:37120
    v_mfma_f32_16x16x32_bf16 v[96:99], a[100:103], a[60:63], v[96:99]
    s_waitcnt lgkmcnt(13)
    ds_read_b64_tr_b16 a[92:93], v7 offset:41216
    ds_read_b64_tr_b16 a[94:95], v7 offset:45312
    v_mfma_f32_16x16x32_bf16 v[100:103], a[100:103], a[64:67], v[100:103]
    s_waitcnt lgkmcnt(14)
    v_mfma_f32_16x16x32_bf16 v[100:103], a[96:99], a[44:47], v[100:103]
    s_waitcnt lgkmcnt(13)
    v_mfma_f32_16x16x32_bf16 v[104:107], a[96:99], a[48:51], v[104:107]
    s_waitcnt lgkmcnt(12)
    v_mfma_f32_16x16x32_bf16 v[104:107], a[100:103], a[68:71], v[104:107]
    s_waitcnt lgkmcnt(11)
    v_mfma_f32_16x16x32_bf16 v[108:111], a[100:103], a[72:75], v[108:111]
    s_waitcnt lgkmcnt(10)
    v_mfma_f32_16x16x32_bf16 v[108:111], a[96:99], a[52:55], v[108:111]
    s_waitcnt lgkmcnt(9)
    v_mfma_f32_16x16x32_bf16 v[112:115], a[96:99], a[56:59], v[112:115]
    s_waitcnt lgkmcnt(8)
    v_mfma_f32_16x16x32_bf16 v[112:115], a[100:103], a[76:79], v[112:115]
    s_waitcnt lgkmcnt(6)
    v_mfma_f32_16x16x32_bf16 v[132:135], a[84:87], a[76:79], v[132:135]
    s_waitcnt lgkmcnt(4)
    ds_read_b64_tr_b16 a[100:101], v8 offset:41216
    ds_read_b64_tr_b16 a[102:103], v8 offset:45312
    v_mfma_f32_16x16x32_bf16 v[132:135], a[80:83], a[56:59], v[132:135]
    ds_read_b64_tr_b16 a[96:97], v8 offset:33024
    ds_read_b64_tr_b16 a[98:99], v8 offset:37120
    v_mfma_f32_16x16x32_bf16 v[128:131], a[80:83], a[52:55], v[128:131]
    v_mfma_f32_16x16x32_bf16 v[128:131], a[84:87], a[72:75], v[128:131]
    v_mfma_f32_16x16x32_bf16 v[124:127], a[84:87], a[68:71], v[124:127]
    v_mfma_f32_16x16x32_bf16 v[124:127], a[80:83], a[48:51], v[124:127]
    v_mfma_f32_16x16x32_bf16 v[120:123], a[80:83], a[44:47], v[120:123]
    v_mfma_f32_16x16x32_bf16 v[120:123], a[84:87], a[64:67], v[120:123]
    v_mfma_f32_16x16x32_bf16 v[116:119], a[84:87], a[60:63], v[116:119]
    s_waitcnt vmcnt(10) lgkmcnt(0)
    s_barrier
    v_mfma_f32_16x16x32_bf16 v[116:119], a[80:83], a[40:43], v[116:119]
    ds_read_b128 a[0:3], v10
    ds_read_b128 a[20:23], v10 offset:10240
    v_mfma_f32_16x16x32_bf16 v[136:139], a[88:91], a[40:43], v[136:139]
    ds_read_b64_tr_b16 a[80:81], v216
    ds_read_b64_tr_b16 a[82:83], v216 offset:4096
    v_mfma_f32_16x16x32_bf16 v[136:139], a[92:95], a[60:63], v[136:139]
    ds_read_b64_tr_b16 a[84:85], v216 offset:8192
    ds_read_b64_tr_b16 a[86:87], v216 offset:12288
    v_mfma_f32_16x16x32_bf16 v[140:143], a[92:95], a[64:67], v[140:143]
    ds_read_b128 a[24:27], v10 offset:11264
    ds_read_b128 a[4:7], v10 offset:1024
    v_mfma_f32_16x16x32_bf16 v[140:143], a[88:91], a[44:47], v[140:143]
    ds_read_b128 a[8:11], v10 offset:2048
    ds_read_b128 a[28:31], v10 offset:12288
    v_mfma_f32_16x16x32_bf16 v[144:147], a[88:91], a[48:51], v[144:147]
    ds_read_b128 a[32:35], v10 offset:13312
    ds_read_b128 a[12:15], v10 offset:3072
    v_mfma_f32_16x16x32_bf16 v[144:147], a[92:95], a[68:71], v[144:147]
    ds_read_b128 a[16:19], v10 offset:4096
    ds_read_b128 a[36:39], v10 offset:14336
    s_waitcnt vmcnt(0)
    v_readfirstlane_b32 s101, v24
    s_nop 0
    s_or_b32 s101, s101, s49
    s_cmp_ge_u32 s101, 1
    s_cbranch_scc0 L_part_slow
L_part_ok:
    v_mfma_f32_16x16x32_bf16 v[148:151], a[92:95], a[72:75], v[148:151]
    v_mfma_f32_16x16x32_bf16 v[148:151], a[88:91], a[52:55], v[148:151]
    v_mfma_f32_16x16x32_bf16 v[152:155], a[88:91], a[56:59], v[152:155]
    v_mfma_f32_16x16x32_bf16 v[152:155], a[92:95], a[76:79], v[152:155]
    s_add_u32 s29, s49, 0
    v_mfma_f32_16x16x32_bf16 v[172:175], a[100:103], a[76:79], v[172:175]
    ds_read_b64_tr_b16 a[92:93], v217 offset:8192
    ds_read_b64_tr_b16 a[94:95], v217 offset:12288
    v_mfma_f32_16x16x32_bf16 v[172:175], a[96:99], a[56:59], v[172:175]
    ds_read_b64_tr_b16 a[88:89], v217
    ds_read_b64_tr_b16 a[90:91], v217 offset:4096
    v_mfma_f32_16x16x32_bf16 v[168:171], a[96:99], a[52:55], v[168:171]
    buffer_load_dwordx4 v[176:179], v12, s[12:15], s29 offen sc1
    v_mfma_f32_16x16x32_bf16 v[168:171], a[100:103], a[72:75], v[168:171]
    v_mfma_f32_16x16x32_bf16 v[164:167], a[100:103], a[68:71], v[164:167]
    v_mfma_f32_16x16x32_bf16 v[164:167], a[96:99], a[48:51], v[164:167]
    buffer_load_dwordx4 v[180:183], v12, s[12:15], s29 offen offset:1024 sc1
    v_mfma_f32_16x16x32_bf16 v[160:163], a[96:99], a[44:47], v[160:163]
    v_mfma_f32_16x16x32_bf16 v[160:163], a[100:103], a[64:67], v[160:163]
    v_mfma_f32_16x16x32_bf16 v[156:159], a[100:103], a[60:63], v[156:159]
    v_mfma_f32_16x16x32_bf16 v[156:159], a[96:99], a[40:43], v[156:159]
    s_waitcnt lgkmcnt(14)
    v_mfma_f32_16x16x32_bf16 v[96:99], a[80:83], a[0:3], v[96:99]
    s_waitcnt lgkmcnt(12)
    ds_read_b64_tr_b16 a[96:97], v216 offset:256
    ds_read_b64_tr_b16 a[98:99], v216 offset:4352
    v_mfma_f32_16x16x32_bf16 v[96:99], a[84:87], a[20:23], v[96:99]
    s_waitcnt lgkmcnt(13)
    s_bitcmp1_b32 s62, 3
    s_cselect_b32 s4, s4, s12
    s_cselect_b32 s5, s5, s13
    s_cselect_b32 s6, s6, s14
    ds_read_b64_tr_b16 a[100:101], v216 offset:8448
    ds_read_b64_tr_b16 a[102:103], v216 offset:12544
    v_mfma_f32_16x16x32_bf16 v[100:103], a[84:87], a[24:27], v[100:103]
    s_waitcnt lgkmcnt(14)
    buffer_load_dwordx4 v[184:187], v12, s[12:15], s29 offen offset:2048 sc1
    v_mfma_f32_16x16x32_bf16 v[100:103], a[80:83], a[4:7], v[100:103]
    s_waitcnt lgkmcnt(13)
    s_bitcmp1_b32 s62, 3
    s_cselect_b64 vcc, -1, 0
    v_mfma_f32_16x16x32_bf16 v[104:107], a[80:83], a[8:11], v[104:107]
    s_waitcnt lgkmcnt(12)
    s_movk_i32 s52, 1024
    s_movk_i32 s53, 5120
    v_mfma_f32_16x16x32_bf16 v[104:107], a[84:87], a[28:31], v[104:107]
    s_waitcnt lgkmcnt(11)
    s_bitcmp1_b32 s62, 3
    s_cselect_b32 s52, 65536, s52
    s_cselect_b32 s53, 64, s53
    buffer_load_dwordx4 v[188:191], v12, s[12:15], s29 offen offset:3072 sc1
    v_mfma_f32_16x16x32_bf16 v[108:111], a[84:87], a[32:35], v[108:111]
    s_waitcnt lgkmcnt(10)
    v_cndmask_b32 v11, v12, v11
    v_mfma_f32_16x16x32_bf16 v[108:111], a[80:83], a[12:15], v[108:111]
    s_waitcnt lgkmcnt(9)
    v_mfma_f32_16x16x32_bf16 v[112:115], a[80:83], a[16:19], v[112:115]
    s_waitcnt lgkmcnt(8)
    v_mfma_f32_16x16x32_bf16 v[112:115], a[84:87], a[36:39], v[112:115]
    s_waitcnt lgkmcnt(6)
    s_add_u32 s29, s49, 4096
    v_mfma_f32_16x16x32_bf16 v[132:135], a[92:95], a[36:39], v[132:135]
    s_waitcnt lgkmcnt(4)
    ds_read_b64_tr_b16 a[84:85], v217 offset:8448
    ds_read_b64_tr_b16 a[86:87], v217 offset:12544
    v_mfma_f32_16x16x32_bf16 v[132:135], a[88:91], a[16:19], v[132:135]
    ds_read_b64_tr_b16 a[80:81], v217 offset:256
    ds_read_b64_tr_b16 a[82:83], v217 offset:4352
    v_mfma_f32_16x16x32_bf16 v[128:131], a[88:91], a[12:15], v[128:131]
    buffer_load_dwordx4 v[192:195], v12, s[12:15], s29 offen sc1
    v_mfma_f32_16x16x32_bf16 v[128:131], a[92:95], a[32:35], v[128:131]
    v_mfma_f32_16x16x32_bf16 v[124:127], a[92:95], a[28:31], v[124:127]
    v_mfma_f32_16x16x32_bf16 v[124:127], a[88:91], a[8:11], v[124:127]
    buffer_load_dwordx4 v[196:199], v12, s[12:15], s29 offen offset:1024 sc1
    v_mfma_f32_16x16x32_bf16 v[120:123], a[88:91], a[4:7], v[120:123]
    v_mfma_f32_16x16x32_bf16 v[120:123], a[92:95], a[24:27], v[120:123]
    v_mfma_f32_16x16x32_bf16 v[116:119], a[92:95], a[20:23], v[116:119]
    s_waitcnt lgkmcnt(0)
    s_barrier
    v_mfma_f32_16x16x32_bf16 v[116:119], a[88:91], a[0:3], v[116:119]
    ds_read_b128 a[40:43], v10 offset:20480
    ds_read_b128 a[60:63], v10 offset:30720
    v_mfma_f32_16x16x32_bf16 v[136:139], a[96:99], a[0:3], v[136:139]
    ds_read_b64_tr_b16 a[88:89], v216 offset:16384
    ds_read_b64_tr_b16 a[90:91], v216 offset:20480
    v_mfma_f32_16x16x32_bf16 v[136:139], a[100:103], a[20:23], v[136:139]
    ds_read_b64_tr_b16 a[92:93], v216 offset:24576
    ds_read_b64_tr_b16 a[94:95], v216 offset:28672
    v_mfma_f32_16x16x32_bf16 v[140:143], a[100:103], a[24:27], v[140:143]
    ds_read_b128 a[64:67], v10 offset:31744
    ds_read_b128 a[44:47], v10 offset:21504
    v_mfma_f32_16x16x32_bf16 v[140:143], a[96:99], a[4:7], v[140:143]
    ds_read_b128 a[48:51], v10 offset:22528
    ds_read_b128 a[68:71], v10 offset:32768
    v_mfma_f32_16x16x32_bf16 v[144:147], a[96:99], a[8:11], v[144:147]
    ds_read_b128 a[72:75], v10 offset:33792
    ds_read_b128 a[52:55], v10 offset:23552
    v_mfma_f32_16x16x32_bf16 v[144:147], a[100:103], a[28:31], v[144:147]
    ds_read_b128 a[56:59], v10 offset:24576
    ds_read_b128 a[76:79], v10 offset:34816
    v_mfma_f32_16x16x32_bf16 v[148:151], a[100:103], a[32:35], v[148:151]
    buffer_load_dwordx4 v[200:203], v12, s[12:15], s29 offen offset:2048 sc1
    v_mfma_f32_16x16x32_bf16 v[148:151], a[96:99], a[12:15], v[148:151]
    buffer_load_dwordx4 v[204:207], v12, s[12:15], s29 offen offset:3072 sc1
    v_mfma_f32_16x16x32_bf16 v[152:155], a[96:99], a[16:19], v[152:155]
    v_mfma_f32_16x16x32_bf16 v[152:155], a[100:103], a[36:39], v[152:155]
    s_add_u32 s29, s49, 8192
    v_mfma_f32_16x16x32_bf16 v[172:175], a[84:87], a[36:39], v[172:175]
    ds_read_b64_tr_b16 a[100:101], v217 offset:24576
    ds_read_b64_tr_b16 a[102:103], v217 offset:28672
    v_mfma_f32_16x16x32_bf16 v[172:175], a[80:83], a[16:19], v[172:175]
    ds_read_b64_tr_b16 a[96:97], v217 offset:16384
    ds_read_b64_tr_b16 a[98:99], v217 offset:20480
    v_mfma_f32_16x16x32_bf16 v[168:171], a[80:83], a[12:15], v[168:171]
    buffer_load_dwordx4 v[208:211], v12, s[12:15], s29 offen sc1
    v_mfma_f32_16x16x32_bf16 v[168:171], a[84:87], a[32:35], v[168:171]
    v_mfma_f32_16x16x32_bf16 v[164:167], a[84:87], a[28:31], v[164:167]
    v_mfma_f32_16x16x32_bf16 v[164:167], a[80:83], a[8:11], v[164:167]
    buffer_load_dwordx4 v[212:215], v12, s[12:15], s29 offen offset:1024 sc1
    v_mfma_f32_16x16x32_bf16 v[160:163], a[80:83], a[4:7], v[160:163]
    v_mfma_f32_16x16x32_bf16 v[160:163], a[84:87], a[24:27], v[160:163]
    v_mfma_f32_16x16x32_bf16 v[156:159], a[84:87], a[20:23], v[156:159]
    v_mfma_f32_16x16x32_bf16 v[156:159], a[80:83], a[0:3], v[156:159]
    s_waitcnt lgkmcnt(14)
    v_mfma_f32_16x16x32_bf16 v[96:99], a[88:91], a[40:43], v[96:99]
    s_waitcnt lgkmcnt(12)
    ds_read_b64_tr_b16 a[80:81], v216 offset:16640
    ds_read_b64_tr_b16 a[82:83], v216 offset:20736
    v_mfma_f32_16x16x32_bf16 v[96:99], a[92:95], a[60:63], v[96:99]
    s_waitcnt lgkmcnt(13)
    ds_read_b64_tr_b16 a[84:85], v216 offset:24832
    ds_read_b64_tr_b16 a[86:87], v216 offset:28928
    v_mfma_f32_16x16x32_bf16 v[100:103], a[92:95], a[64:67], v[100:103]
    s_waitcnt lgkmcnt(14)
    v_mfma_f32_16x16x32_bf16 v[100:103], a[88:91], a[44:47], v[100:103]
    s_waitcnt lgkmcnt(13)
    v_mfma_f32_16x16x32_bf16 v[104:107], a[88:91], a[48:51], v[104:107]
    s_waitcnt lgkmcnt(12)
    v_mfma_f32_16x16x32_bf16 v[104:107], a[92:95], a[68:71], v[104:107]
    s_waitcnt lgkmcnt(11)
    v_mfma_f32_16x16x32_bf16 v[108:111], a[92:95], a[72:75], v[108:111]
    s_waitcnt lgkmcnt(10)
    v_mfma_f32_16x16x32_bf16 v[108:111], a[88:91], a[52:55], v[108:111]
    s_waitcnt lgkmcnt(9)
    v_mfma_f32_16x16x32_bf16 v[112:115], a[88:91], a[56:59], v[112:115]
    s_waitcnt lgkmcnt(8)
    v_mfma_f32_16x16x32_bf16 v[112:115], a[92:95], a[76:79], v[112:115]
    s_waitcnt lgkmcnt(6)
    v_mfma_f32_16x16x32_bf16 v[132:135], a[100:103], a[76:79], v[132:135]
    s_waitcnt lgkmcnt(4)
    ds_read_b64_tr_b16 a[92:93], v217 offset:24832
    ds_read_b64_tr_b16 a[94:95], v217 offset:28928
    v_mfma_f32_16x16x32_bf16 v[132:135], a[96:99], a[56:59], v[132:135]
    ds_read_b64_tr_b16 a[88:89], v217 offset:16640
    ds_read_b64_tr_b16 a[90:91], v217 offset:20736
    v_mfma_f32_16x16x32_bf16 v[128:131], a[96:99], a[52:55], v[128:131]
    v_mfma_f32_16x16x32_bf16 v[128:131], a[100:103], a[72:75], v[128:131]
    v_mfma_f32_16x16x32_bf16 v[124:127], a[100:103], a[68:71], v[124:127]
    v_mfma_f32_16x16x32_bf16 v[124:127], a[96:99], a[48:51], v[124:127]
    v_mfma_f32_16x16x32_bf16 v[120:123], a[96:99], a[44:47], v[120:123]
    v_mfma_f32_16x16x32_bf16 v[120:123], a[100:103], a[64:67], v[120:123]
    v_mfma_f32_16x16x32_bf16 v[116:119], a[100:103], a[60:63], v[116:119]
    v_mfma_f32_16x16x32_bf16 v[116:119], a[96:99], a[40:43], v[116:119]
    s_waitcnt vmcnt(9)
    v_mfma_f32_16x16x32_bf16 v[96:99], a[248:251], v[176:179], v[96:99]
    v_mfma_f32_16x16x32_bf16 v[116:119], a[252:255], v[176:179], v[116:119]
    s_waitcnt vmcnt(8)
    v_mfma_f32_16x16x32_bf16 v[100:103], a[248:251], v[180:183], v[100:103]
    v_mfma_f32_16x16x32_bf16 v[120:123], a[252:255], v[180:183], v[120:123]
    s_waitcnt vmcnt(7)
    v_mfma_f32_16x16x32_bf16 v[104:107], a[248:251], v[184:187], v[104:107]
    v_mfma_f32_16x16x32_bf16 v[124:127], a[252:255], v[184:187], v[124:127]
    s_waitcnt vmcnt(6)
    v_mfma_f32_16x16x32_bf16 v[108:111], a[248:251], v[188:191], v[108:111]
    v_mfma_f32_16x16x32_bf16 v[128:131], a[252:255], v[188:191], v[128:131]
    s_waitcnt vmcnt(5)
    v_mfma_f32_16x16x32_bf16 v[112:115], a[248:251], v[192:195], v[112:115]
    v_mfma_f32_16x16x32_bf16 v[132:135], a[252:255], v[192:195], v[132:135]
    s_waitcnt lgkmcnt(6)
    v_mfma_f32_16x16x32_bf16 v[136:139], a[80:83], a[40:43], v[136:139]
    s_waitcnt lgkmcnt(4)
    v_mfma_f32_16x16x32_bf16 v[136:139], a[84:87], a[60:63], v[136:139]
    v_mfma_f32_16x16x32_bf16 v[140:143], a[84:87], a[64:67], v[140:143]
    v_mfma_f32_16x16x32_bf16 v[140:143], a[80:83], a[44:47], v[140:143]
    v_cvt_pk_bf16_f32 v32, v96, v97
    v_cvt_pk_bf16_f32 v33, v98, v99
    v_mfma_f32_16x16x32_bf16 v[144:147], a[80:83], a[48:51], v[144:147]
    v_cvt_pk_bf16_f32 v34, v116, v117
    v_cvt_pk_bf16_f32 v35, v118, v119
    v_mfma_f32_16x16x32_bf16 v[144:147], a[84:87], a[68:71], v[144:147]
    v_cvt_pk_bf16_f32 v36, v100, v101
    v_cvt_pk_bf16_f32 v37, v102, v103
    v_mfma_f32_16x16x32_bf16 v[148:151], a[84:87], a[72:75], v[148:151]
    v_cvt_pk_bf16_f32 v38, v120, v121
    v_cvt_pk_bf16_f32 v39, v122, v123
    v_mfma_f32_16x16x32_bf16 v[148:151], a[80:83], a[52:55], v[148:151]
    v_cvt_pk_bf16_f32 v40, v104, v105
    v_cvt_pk_bf16_f32 v41, v106, v107
    v_mfma_f32_16x16x32_bf16 v[152:155], a[80:83], a[56:59], v[152:155]
    v_cvt_pk_bf16_f32 v42, v124, v125
    v_cvt_pk_bf16_f32 v43, v126, v127
    v_mfma_f32_16x16x32_bf16 v[152:155], a[84:87], a[76:79], v[152:155]
    s_waitcnt lgkmcnt(2)
    v_cvt_pk_bf16_f32 v44, v108, v109
    v_cvt_pk_bf16_f32 v45, v110, v111
    v_mfma_f32_16x16x32_bf16 v[172:175], a[92:95], a[76:79], v[172:175]
    s_waitcnt lgkmcnt(0)
    v_cvt_pk_bf16_f32 v46, v128, v129
    v_cvt_pk_bf16_f32 v47, v130, v131
    v_mfma_f32_16x16x32_bf16 v[172:175], a[88:91], a[56:59], v[172:175]
    v_cvt_pk_bf16_f32 v48, v112, v113
    v_cvt_pk_bf16_f32 v49, v114, v115
    v_mfma_f32_16x16x32_bf16 v[168:171], a[88:91], a[52:55], v[168:171]
    v_cvt_pk_bf16_f32 v50, v132, v133
    v_cvt_pk_bf16_f32 v51, v134, v135
    v_mfma_f32_16x16x32_bf16 v[168:171], a[92:95], a[72:75], v[168:171]
    v_permlane32_swap_b32 v32, v34
    v_permlane32_swap_b32 v33, v35
    v_mfma_f32_16x16x32_bf16 v[164:167], a[92:95], a[68:71], v[164:167]
    v_permlane32_swap_b32 v36, v38
    v_permlane32_swap_b32 v37, v39
    v_mfma_f32_16x16x32_bf16 v[164:167], a[88:91], a[48:51], v[164:167]
    v_permlane32_swap_b32 v40, v42
    v_permlane32_swap_b32 v41, v43
    v_mfma_f32_16x16x32_bf16 v[160:163], a[88:91], a[44:47], v[160:163]
    v_permlane32_swap_b32 v44, v46
    v_permlane32_swap_b32 v45, v47
    v_mfma_f32_16x16x32_bf16 v[160:163], a[92:95], a[64:67], v[160:163]
    v_permlane32_swap_b32 v48, v50
    v_permlane32_swap_b32 v49, v51
    v_mfma_f32_16x16x32_bf16 v[156:159], a[92:95], a[60:63], v[156:159]
    v_permlane16_swap_b32 v32, v34
    v_permlane16_swap_b32 v33, v35
    v_mfma_f32_16x16x32_bf16 v[156:159], a[88:91], a[40:43], v[156:159]
    s_waitcnt vmcnt(4)
    v_permlane16_swap_b32 v36, v38
    v_permlane16_swap_b32 v37, v39
    v_mfma_f32_16x16x32_bf16 v[136:139], a[248:251], v[196:199], v[136:139]
    v_permlane16_swap_b32 v40, v42
    v_permlane16_swap_b32 v41, v43
    v_mfma_f32_16x16x32_bf16 v[156:159], a[252:255], v[196:199], v[156:159]
    s_waitcnt vmcnt(3)
    v_permlane16_swap_b32 v44, v46
    v_permlane16_swap_b32 v45, v47
    v_mfma_f32_16x16x32_bf16 v[140:143], a[248:251], v[200:203], v[140:143]
    v_permlane16_swap_b32 v48, v50
    v_permlane16_swap_b32 v49, v51
    s_mov_b32 s28, 0
    v_mfma_f32_16x16x32_bf16 v[160:163], a[252:255], v[200:203], v[160:163]
    s_waitcnt vmcnt(2)
    buffer_store_dwordx4 v[32:35], v11, s[4:7], s28 offen sc1
    s_add_u32 s28, s28, s52
    buffer_store_dwordx4 v[36:39], v11, s[4:7], s28 offen sc1
    s_add_u32 s28, s28, s52
    v_mfma_f32_16x16x32_bf16 v[144:147], a[248:251], v[204:207], v[144:147]
    buffer_store_dwordx4 v[40:43], v11, s[4:7], s28 offen sc1
    s_add_u32 s28, s28, s52
    buffer_store_dwordx4 v[44:47], v11, s[4:7], s28 offen sc1
    s_add_u32 s28, s28, s52
    v_mfma_f32_16x16x32_bf16 v[164:167], a[252:255], v[204:207], v[164:167]
    s_waitcnt vmcnt(5)
    buffer_store_dwordx4 v[48:51], v11, s[4:7], s28 offen sc1
    v_mfma_f32_16x16x32_bf16 v[148:151], a[248:251], v[208:211], v[148:151]
    v_mfma_f32_16x16x32_bf16 v[168:171], a[252:255], v[208:211], v[168:171]
    s_waitcnt vmcnt(5)
    v_mfma_f32_16x16x32_bf16 v[152:155], a[248:251], v[212:215], v[152:155]
    v_mfma_f32_16x16x32_bf16 v[172:175], a[252:255], v[212:215], v[172:175]
    v_cvt_pk_bf16_f32 v52, v136, v137
    v_cvt_pk_bf16_f32 v53, v138, v139
    v_cvt_pk_bf16_f32 v54, v156, v157
    v_cvt_pk_bf16_f32 v55, v158, v159
    v_cvt_pk_bf16_f32 v56, v140, v141
    v_cvt_pk_bf16_f32 v57, v142, v143
    v_cvt_pk_bf16_f32 v58, v160, v161
    v_cvt_pk_bf16_f32 v59, v162, v163
    v_cvt_pk_bf16_f32 v60, v144, v145
    v_cvt_pk_bf16_f32 v61, v146, v147
    v_cvt_pk_bf16_f32 v62, v164, v165
    v_cvt_pk_bf16_f32 v63, v166, v167
    v_cvt_pk_bf16_f32 v64, v148, v149
    v_cvt_pk_bf16_f32 v65, v150, v151
    v_cvt_pk_bf16_f32 v66, v168, v169
    v_cvt_pk_bf16_f32 v67, v170, v171
    v_cvt_pk_bf16_f32 v68, v152, v153
    v_cvt_pk_bf16_f32 v69, v154, v155
    v_cvt_pk_bf16_f32 v70, v172, v173
    v_cvt_pk_bf16_f32 v71, v174, v175
    v_permlane32_swap_b32 v52, v54
    v_permlane32_swap_b32 v53, v55
    v_permlane32_swap_b32 v56, v58
    v_permlane32_swap_b32 v57, v59
    v_permlane32_swap_b32 v60, v62
    v_permlane32_swap_b32 v61, v63
    v_permlane32_swap_b32 v64, v66
    v_permlane32_swap_b32 v65, v67
    v_permlane32_swap_b32 v68, v70
    v_permlane32_swap_b32 v69, v71
    v_permlane16_swap_b32 v52, v54
    v_permlane16_swap_b32 v53, v55
    v_permlane16_swap_b32 v56, v58
    v_permlane16_swap_b32 v57, v59
    v_permlane16_swap_b32 v60, v62
    v_permlane16_swap_b32 v61, v63
    v_permlane16_swap_b32 v64, v66
    v_permlane16_swap_b32 v65, v67
    v_permlane16_swap_b32 v68, v70
    v_permlane16_swap_b32 v69, v71
    s_mov_b32 s28, s53
    buffer_store_dwordx4 v[52:55], v11, s[4:7], s28 offen sc1
    s_add_u32 s28, s28, s52
    buffer_store_dwordx4 v[56:59], v11, s[4:7], s28 offen sc1
    s_add_u32 s28, s28, s52
    buffer_store_dwordx4 v[60:63], v11, s[4:7], s28 offen sc1
    s_add_u32 s28, s28, s52
    buffer_store_dwordx4 v[64:67], v11, s[4:7], s28 offen sc1
    s_add_u32 s28, s28, s52
    buffer_store_dwordx4 v[68:71], v11, s[4:7], s28 offen sc1
    s_bitcmp1_b32 s62, 3
    s_cbranch_scc1 L_done
    s_waitcnt vmcnt(0)
    buffer_store_dword v29, v31, s[36:39], s65 offen sc1
L_done:
L_end:
    s_endpgm
L_cnt_slow:
    s_mov_b32 s67, 200000
L_cnt:
    buffer_load_dword v26, v23, s[40:43], 0 offen sc1
    s_waitcnt vmcnt(0)
    v_readfirstlane_b32 s101, v26
    s_nop 0
    s_cmp_ge_u32 s101, 256
    s_cbranch_scc1 L_cnt_ok
    s_sleep 2
    s_sub_u32 s67, s67, 1
    s_cbranch_scc0 L_cnt
    s_branch L_cnt_ok
L_exact:
    s_waitcnt vmcnt(0) lgkmcnt(0)
    s_lshl_b32 s28, s24, 14
    v_and_b32 v172, 0xffffefff, v13
    v_and_b32 v173, 0xffffefff, v14
    v_and_b32 v174, 0xffffefff, v15
    v_and_b32 v175, 0xffffefff, v16
    v_and_b32 v176, 0xfff, v17
    v_add_u32 v176, 0, v176
    v_add_u32 v176, s28, v176
    v_and_b32 v177, 0xfff, v18
    v_add_u32 v177, 0, v177
    v_add_u32 v177, s28, v177
    v_and_b32 v178, 0xfff, v19
    v_add_u32 v178, 8192, v178
    v_add_u32 v178, s28, v178
    v_and_b32 v179, 0xfff, v20
    v_add_u32 v179, 8192, v179
    v_add_u32 v179, s28, v179
    v_mov_b32 v192, 0xff800000
    v_mov_b32 v196, 0xff800000
    v_mov_b32 v200, 0xff800000
    v_mov_b32 v204, 0xff800000
    v_mov_b32 v208, 0xff800000
    s_mov_b32 s100, 0
L_exact_max:
    s_add_u32 m0, s28, 0
    s_add_u32 s29, s100, 0
    buffer_load_dwordx4 v172, s[12:15], s29 offen lds
    buffer_load_dwordx4 v173, s[12:15], s29 offen offset:1024 lds
    buffer_load_dwordx4 v174, s[12:15], s29 offen offset:2048 lds
    buffer_load_dwordx4 v175, s[12:15], s29 offen offset:3072 lds
    s_add_u32 m0, s28, 4096
    s_add_u32 s29, s100, 4096
    buffer_load_dwordx4 v172, s[12:15], s29 offen lds
    buffer_load_dwordx4 v173, s[12:15], s29 offen offset:1024 lds
    buffer_load_dwordx4 v174, s[12:15], s29 offen offset:2048 lds
    buffer_load_dwordx4 v175, s[12:15], s29 offen offset:3072 lds
    s_waitcnt vmcnt(0)
    ds_read_b64 v[212:213], v176
    ds_read_b64 v[214:215], v177
    ds_read_b64 v[216:217], v176 offset:256
    ds_read_b64 v[218:219], v177 offset:256
    s_waitcnt lgkmcnt(0)
    ds_read_b64 v[220:221], v176 offset:512
    ds_read_b64 v[222:223], v177 offset:512
    ds_read_b64 v[224:225], v176 offset:768
    ds_read_b64 v[226:227], v177 offset:768
    s_waitcnt lgkmcnt(0)
    ds_read_b64 v[228:229], v176 offset:4096
    ds_read_b64 v[230:231], v177 offset:4096
    ds_read_b64 v[232:233], v176 offset:4352
    ds_read_b64 v[234:235], v177 offset:4352
    s_waitcnt lgkmcnt(0)
    ds_read_b64 v[236:237], v176 offset:4608
    ds_read_b64 v[238:239], v177 offset:4608
    ds_read_b64 v[240:241], v176 offset:4864
    ds_read_b64 v[242:243], v177 offset:4864
    s_waitcnt lgkmcnt(0)
    v_mfma_f32_16x16x32_bf16 v[112:115], v[212:215], v[32:35], 0
    v_mfma_f32_16x16x32_bf16 v[116:119], v[212:215], v[48:51], 0
    v_mfma_f32_16x16x32_bf16 v[120:123], v[212:215], v[64:67], 0
    v_mfma_f32_16x16x32_bf16 v[124:127], v[212:215], v[80:83], 0
    v_mfma_f32_16x16x32_bf16 v[128:131], v[212:215], v[96:99], 0
    v_mfma_f32_16x16x32_bf16 v[112:115], v[216:219], v[36:39], v[112:115]
    v_mfma_f32_16x16x32_bf16 v[116:119], v[216:219], v[52:55], v[116:119]
    v_mfma_f32_16x16x32_bf16 v[120:123], v[216:219], v[68:71], v[120:123]
    v_mfma_f32_16x16x32_bf16 v[124:127], v[216:219], v[84:87], v[124:127]
    v_mfma_f32_16x16x32_bf16 v[128:131], v[216:219], v[100:103], v[128:131]
    v_mfma_f32_16x16x32_bf16 v[112:115], v[220:223], v[40:43], v[112:115]
    v_mfma_f32_16x16x32_bf16 v[116:119], v[220:223], v[56:59], v[116:119]
    v_mfma_f32_16x16x32_bf16 v[120:123], v[220:223], v[72:75], v[120:123]
    v_mfma_f32_16x16x32_bf16 v[124:127], v[220:223], v[88:91], v[124:127]
    v_mfma_f32_16x16x32_bf16 v[128:131], v[220:223], v[104:107], v[128:131]
    v_mfma_f32_16x16x32_bf16 v[112:115], v[224:227], v[44:47], v[112:115]
    v_mfma_f32_16x16x32_bf16 v[116:119], v[224:227], v[60:63], v[116:119]
    v_mfma_f32_16x16x32_bf16 v[120:123], v[224:227], v[76:79], v[120:123]
    v_mfma_f32_16x16x32_bf16 v[124:127], v[224:227], v[92:95], v[124:127]
    v_mfma_f32_16x16x32_bf16 v[128:131], v[224:227], v[108:111], v[128:131]
    v_mfma_f32_16x16x32_bf16 v[132:135], v[228:231], v[32:35], 0
    v_mfma_f32_16x16x32_bf16 v[136:139], v[228:231], v[48:51], 0
    v_mfma_f32_16x16x32_bf16 v[140:143], v[228:231], v[64:67], 0
    v_mfma_f32_16x16x32_bf16 v[144:147], v[228:231], v[80:83], 0
    v_mfma_f32_16x16x32_bf16 v[148:151], v[228:231], v[96:99], 0
    v_mfma_f32_16x16x32_bf16 v[132:135], v[232:235], v[36:39], v[132:135]
    v_mfma_f32_16x16x32_bf16 v[136:139], v[232:235], v[52:55], v[136:139]
    v_mfma_f32_16x16x32_bf16 v[140:143], v[232:235], v[68:71], v[140:143]
    v_mfma_f32_16x16x32_bf16 v[144:147], v[232:235], v[84:87], v[144:147]
    v_mfma_f32_16x16x32_bf16 v[148:151], v[232:235], v[100:103], v[148:151]
    v_mfma_f32_16x16x32_bf16 v[132:135], v[236:239], v[40:43], v[132:135]
    v_mfma_f32_16x16x32_bf16 v[136:139], v[236:239], v[56:59], v[136:139]
    v_mfma_f32_16x16x32_bf16 v[140:143], v[236:239], v[72:75], v[140:143]
    v_mfma_f32_16x16x32_bf16 v[144:147], v[236:239], v[88:91], v[144:147]
    v_mfma_f32_16x16x32_bf16 v[148:151], v[236:239], v[104:107], v[148:151]
    v_mfma_f32_16x16x32_bf16 v[132:135], v[240:243], v[44:47], v[132:135]
    v_mfma_f32_16x16x32_bf16 v[136:139], v[240:243], v[60:63], v[136:139]
    v_mfma_f32_16x16x32_bf16 v[140:143], v[240:243], v[76:79], v[140:143]
    v_mfma_f32_16x16x32_bf16 v[144:147], v[240:243], v[92:95], v[144:147]
    v_mfma_f32_16x16x32_bf16 v[148:151], v[240:243], v[108:111], v[148:151]
    v_max3_f32 v192, v192, v112, v113
    v_max3_f32 v192, v192, v114, v115
    s_nop 1
    v_max3_f32 v192, v192, v132, v133
    v_max3_f32 v192, v192, v134, v135
    v_max3_f32 v196, v196, v116, v117
    v_max3_f32 v196, v196, v118, v119
    v_max3_f32 v196, v196, v136, v137
    v_max3_f32 v196, v196, v138, v139
    v_max3_f32 v200, v200, v120, v121
    v_max3_f32 v200, v200, v122, v123
    v_max3_f32 v200, v200, v140, v141
    v_max3_f32 v200, v200, v142, v143
    v_max3_f32 v204, v204, v124, v125
    v_max3_f32 v204, v204, v126, v127
    v_max3_f32 v204, v204, v144, v145
    v_max3_f32 v204, v204, v146, v147
    v_max3_f32 v208, v208, v128, v129
    v_max3_f32 v208, v208, v130, v131
    v_max3_f32 v208, v208, v148, v149
    v_max3_f32 v208, v208, v150, v151
    s_nop 7
    s_add_u32 s100, s100, 8192
    s_cmp_lt_u32 s100, 131072
    s_cbranch_scc1 L_exact_max
    v_mov_b32 v193, v192
    v_mov_b32 v197, v196
    v_mov_b32 v201, v200
    v_mov_b32 v205, v204
    v_mov_b32 v209, v208
    v_permlane32_swap_b32 v192, v193
    v_permlane32_swap_b32 v196, v197
    v_permlane32_swap_b32 v200, v201
    v_permlane32_swap_b32 v204, v205
    v_permlane32_swap_b32 v208, v209
    v_max_f32 v192, v192, v193
    v_max_f32 v196, v196, v197
    v_max_f32 v200, v200, v201
    v_max_f32 v204, v204, v205
    v_max_f32 v208, v208, v209
    v_mov_b32 v193, v192
    v_mov_b32 v197, v196
    v_mov_b32 v201, v200
    v_mov_b32 v205, v204
    v_mov_b32 v209, v208
    v_permlane16_swap_b32 v192, v193
    v_permlane16_swap_b32 v196, v197
    v_permlane16_swap_b32 v200, v201
    v_permlane16_swap_b32 v204, v205
    v_permlane16_swap_b32 v208, v209
    v_max_f32 v192, v192, v193
    v_max_f32 v196, v196, v197
    v_max_f32 v200, v200, v201
    v_max_f32 v204, v204, v205
    v_max_f32 v208, v208, v209
    v_sub_f32 v195, 0, v192
    v_sub_f32 v194, 0, v192
    v_sub_f32 v193, 0, v192
    v_sub_f32 v192, 0, v192
    v_sub_f32 v199, 0, v196
    v_sub_f32 v198, 0, v196
    v_sub_f32 v197, 0, v196
    v_sub_f32 v196, 0, v196
    v_sub_f32 v203, 0, v200
    v_sub_f32 v202, 0, v200
    v_sub_f32 v201, 0, v200
    v_sub_f32 v200, 0, v200
    v_sub_f32 v207, 0, v204
    v_sub_f32 v206, 0, v204
    v_sub_f32 v205, 0, v204
    v_sub_f32 v204, 0, v204
    v_sub_f32 v211, 0, v208
    v_sub_f32 v210, 0, v208
    v_sub_f32 v209, 0, v208
    v_sub_f32 v208, 0, v208
    v_accvgpr_write_b32 a0, 0
    v_accvgpr_write_b32 a1, 0
    v_accvgpr_write_b32 a2, 0
    v_accvgpr_write_b32 a3, 0
    v_accvgpr_write_b32 a4, 0
    v_accvgpr_write_b32 a5, 0
    v_accvgpr_write_b32 a6, 0
    v_accvgpr_write_b32 a7, 0
    v_accvgpr_write_b32 a8, 0
    v_accvgpr_write_b32 a9, 0
    v_accvgpr_write_b32 a10, 0
    v_accvgpr_write_b32 a11, 0
    v_accvgpr_write_b32 a12, 0
    v_accvgpr_write_b32 a13, 0
    v_accvgpr_write_b32 a14, 0
    v_accvgpr_write_b32 a15, 0
    v_accvgpr_write_b32 a16, 0
    v_accvgpr_write_b32 a17, 0
    v_accvgpr_write_b32 a18, 0
    v_accvgpr_write_b32 a19, 0
    v_accvgpr_write_b32 a20, 0
    v_accvgpr_write_b32 a21, 0
    v_accvgpr_write_b32 a22, 0
    v_accvgpr_write_b32 a23, 0
    v_accvgpr_write_b32 a24, 0
    v_accvgpr_write_b32 a25, 0
    v_accvgpr_write_b32 a26, 0
    v_accvgpr_write_b32 a27, 0
    v_accvgpr_write_b32 a28, 0
    v_accvgpr_write_b32 a29, 0
    v_accvgpr_write_b32 a30, 0
    v_accvgpr_write_b32 a31, 0
    v_accvgpr_write_b32 a32, 0
    v_accvgpr_write_b32 a33, 0
    v_accvgpr_write_b32 a34, 0
    v_accvgpr_write_b32 a35, 0
    v_accvgpr_write_b32 a36, 0
    v_accvgpr_write_b32 a37, 0
    v_accvgpr_write_b32 a38, 0
    v_accvgpr_write_b32 a39, 0
    v_accvgpr_write_b32 a40, 0
    v_accvgpr_write_b32 a41, 0
    v_accvgpr_write_b32 a42, 0
    v_accvgpr_write_b32 a43, 0
    v_accvgpr_write_b32 a44, 0
    v_accvgpr_write_b32 a45, 0
    v_accvgpr_write_b32 a46, 0
    v_accvgpr_write_b32 a47, 0
    v_accvgpr_write_b32 a48, 0
    v_accvgpr_write_b32 a49, 0
    v_accvgpr_write_b32 a50, 0
    v_accvgpr_write_b32 a51, 0
    v_accvgpr_write_b32 a52, 0
    v_accvgpr_write_b32 a53, 0
    v_accvgpr_write_b32 a54, 0
    v_accvgpr_write_b32 a55, 0
    v_accvgpr_write_b32 a56, 0
    v_accvgpr_write_b32 a57, 0
    v_accvgpr_write_b32 a58, 0
    v_accvgpr_write_b32 a59, 0
    v_accvgpr_write_b32 a60, 0
    v_accvgpr_write_b32 a61, 0
    v_accvgpr_write_b32 a62, 0
    v_accvgpr_write_b32 a63, 0
    v_accvgpr_write_b32 a64, 0
    v_accvgpr_write_b32 a65, 0
    v_accvgpr_write_b32 a66, 0
    v_accvgpr_write_b32 a67, 0
    v_accvgpr_write_b32 a68, 0
    v_accvgpr_write_b32 a69, 0
    v_accvgpr_write_b32 a70, 0
    v_accvgpr_write_b32 a71, 0
    v_accvgpr_write_b32 a72, 0
    v_accvgpr_write_b32 a73, 0
    v_accvgpr_write_b32 a74, 0
    v_accvgpr_write_b32 a75, 0
    v_accvgpr_write_b32 a76, 0
    v_accvgpr_write_b32 a77, 0
    v_accvgpr_write_b32 a78, 0
    v_accvgpr_write_b32 a79, 0
    v_accvgpr_write_b32 a80, 0
    v_accvgpr_write_b32 a81, 0
    v_accvgpr_write_b32 a82, 0
    v_accvgpr_write_b32 a83, 0
    v_accvgpr_write_b32 a84, 0
    v_accvgpr_write_b32 a85, 0
    v_accvgpr_write_b32 a86, 0
    v_accvgpr_write_b32 a87, 0
    v_accvgpr_write_b32 a88, 0
    v_accvgpr_write_b32 a89, 0
    v_accvgpr_write_b32 a90, 0
    v_accvgpr_write_b32 a91, 0
    v_accvgpr_write_b32 a92, 0
    v_accvgpr_write_b32 a93, 0
    v_accvgpr_write_b32 a94, 0
    v_accvgpr_write_b32 a95, 0
    v_accvgpr_write_b32 a96, 0
    v_accvgpr_write_b32 a97, 0
    v_accvgpr_write_b32 a98, 0
    v_accvgpr_write_b32 a99, 0
    v_accvgpr_write_b32 a100, 0
    v_accvgpr_write_b32 a101, 0
    v_accvgpr_write_b32 a102, 0
    v_accvgpr_write_b32 a103, 0
    v_accvgpr_write_b32 a104, 0
    v_accvgpr_write_b32 a105, 0
    v_accvgpr_write_b32 a106, 0
    v_accvgpr_write_b32 a107, 0
    v_accvgpr_write_b32 a108, 0
    v_accvgpr_write_b32 a109, 0
    v_accvgpr_write_b32 a110, 0
    v_accvgpr_write_b32 a111, 0
    v_accvgpr_write_b32 a112, 0
    v_accvgpr_write_b32 a113, 0
    v_accvgpr_write_b32 a114, 0
    v_accvgpr_write_b32 a115, 0
    v_accvgpr_write_b32 a116, 0
    v_accvgpr_write_b32 a117, 0
    v_accvgpr_write_b32 a118, 0
    v_accvgpr_write_b32 a119, 0
    v_accvgpr_write_b32 a120, 0
    v_accvgpr_write_b32 a121, 0
    v_accvgpr_write_b32 a122, 0
    v_accvgpr_write_b32 a123, 0
    v_accvgpr_write_b32 a124, 0
    v_accvgpr_write_b32 a125, 0
    v_accvgpr_write_b32 a126, 0
    v_accvgpr_write_b32 a127, 0
    v_accvgpr_write_b32 a128, 0
    v_accvgpr_write_b32 a129, 0
    v_accvgpr_write_b32 a130, 0
    v_accvgpr_write_b32 a131, 0
    v_accvgpr_write_b32 a132, 0
    v_accvgpr_write_b32 a133, 0
    v_accvgpr_write_b32 a134, 0
    v_accvgpr_write_b32 a135, 0
    v_accvgpr_write_b32 a136, 0
    v_accvgpr_write_b32 a137, 0
    v_accvgpr_write_b32 a138, 0
    v_accvgpr_write_b32 a139, 0
    v_accvgpr_write_b32 a140, 0
    v_accvgpr_write_b32 a141, 0
    v_accvgpr_write_b32 a142, 0
    v_accvgpr_write_b32 a143, 0
    v_accvgpr_write_b32 a144, 0
    v_accvgpr_write_b32 a145, 0
    v_accvgpr_write_b32 a146, 0
    v_accvgpr_write_b32 a147, 0
    v_accvgpr_write_b32 a148, 0
    v_accvgpr_write_b32 a149, 0
    v_accvgpr_write_b32 a150, 0
    v_accvgpr_write_b32 a151, 0
    v_accvgpr_write_b32 a152, 0
    v_accvgpr_write_b32 a153, 0
    v_accvgpr_write_b32 a154, 0
    v_accvgpr_write_b32 a155, 0
    v_accvgpr_write_b32 a156, 0
    v_accvgpr_write_b32 a157, 0
    v_accvgpr_write_b32 a158, 0
    v_accvgpr_write_b32 a159, 0
    v_accvgpr_write_b32 a160, 0
    v_accvgpr_write_b32 a161, 0
    v_accvgpr_write_b32 a162, 0
    v_accvgpr_write_b32 a163, 0
    v_accvgpr_write_b32 a164, 0
    v_accvgpr_write_b32 a165, 0
    v_accvgpr_write_b32 a166, 0
    v_accvgpr_write_b32 a167, 0
    v_accvgpr_write_b32 a168, 0
    v_accvgpr_write_b32 a169, 0
    v_accvgpr_write_b32 a170, 0
    v_accvgpr_write_b32 a171, 0
    v_accvgpr_write_b32 a172, 0
    v_accvgpr_write_b32 a173, 0
    v_accvgpr_write_b32 a174, 0
    v_accvgpr_write_b32 a175, 0
    v_accvgpr_write_b32 a176, 0
    v_accvgpr_write_b32 a177, 0
    v_accvgpr_write_b32 a178, 0
    v_accvgpr_write_b32 a179, 0
    s_mov_b32 s100, 0
L_exact_pv:
    s_add_u32 m0, s28, 0
    s_add_u32 s29, s100, 0
    buffer_load_dwordx4 v172, s[12:15], s29 offen lds
    buffer_load_dwordx4 v173, s[12:15], s29 offen offset:1024 lds
    buffer_load_dwordx4 v174, s[12:15], s29 offen offset:2048 lds
    buffer_load_dwordx4 v175, s[12:15], s29 offen offset:3072 lds
    s_add_u32 m0, s28, 4096
    s_add_u32 s29, s100, 4096
    buffer_load_dwordx4 v172, s[12:15], s29 offen lds
    buffer_load_dwordx4 v173, s[12:15], s29 offen offset:1024 lds
    buffer_load_dwordx4 v174, s[12:15], s29 offen offset:2048 lds
    buffer_load_dwordx4 v175, s[12:15], s29 offen offset:3072 lds
    s_add_u32 m0, s28, 8192
    s_add_u32 s29, s100, 0
    buffer_load_dwordx4 v172, s[16:19], s29 offen lds
    buffer_load_dwordx4 v174, s[16:19], s29 offen offset:1024 lds
    buffer_load_dwordx4 v172, s[16:19], s29 offen offset:2048 lds
    buffer_load_dwordx4 v174, s[16:19], s29 offen offset:3072 lds
    s_add_u32 m0, s28, 12288
    s_add_u32 s29, s100, 4096
    buffer_load_dwordx4 v172, s[16:19], s29 offen lds
    buffer_load_dwordx4 v174, s[16:19], s29 offen offset:1024 lds
    buffer_load_dwordx4 v172, s[16:19], s29 offen offset:2048 lds
    buffer_load_dwordx4 v174, s[16:19], s29 offen offset:3072 lds
    s_waitcnt vmcnt(0)
    ds_read_b64 v[212:213], v176
    ds_read_b64 v[214:215], v177
    ds_read_b64 v[216:217], v176 offset:256
    ds_read_b64 v[218:219], v177 offset:256
    s_waitcnt lgkmcnt(0)
    ds_read_b64 v[220:221], v176 offset:512
    ds_read_b64 v[222:223], v177 offset:512
    ds_read_b64 v[224:225], v176 offset:768
    ds_read_b64 v[226:227], v177 offset:768
    s_waitcnt lgkmcnt(0)
    ds_read_b64 v[228:229], v176 offset:4096
    ds_read_b64 v[230:231], v177 offset:4096
    ds_read_b64 v[232:233], v176 offset:4352
    ds_read_b64 v[234:235], v177 offset:4352
    s_waitcnt lgkmcnt(0)
    ds_read_b64 v[236:237], v176 offset:4608
    ds_read_b64 v[238:239], v177 offset:4608
    ds_read_b64 v[240:241], v176 offset:4864
    ds_read_b64 v[242:243], v177 offset:4864
    s_waitcnt lgkmcnt(0)
    v_mfma_f32_16x16x32_bf16 v[112:115], v[212:215], v[32:35], v[192:195]
    v_mfma_f32_16x16x32_bf16 v[116:119], v[212:215], v[48:51], v[196:199]
    v_mfma_f32_16x16x32_bf16 v[120:123], v[212:215], v[64:67], v[200:203]
    v_mfma_f32_16x16x32_bf16 v[124:127], v[212:215], v[80:83], v[204:207]
    v_mfma_f32_16x16x32_bf16 v[128:131], v[212:215], v[96:99], v[208:211]
    v_mfma_f32_16x16x32_bf16 v[112:115], v[216:219], v[36:39], v[112:115]
    v_mfma_f32_16x16x32_bf16 v[116:119], v[216:219], v[52:55], v[116:119]
    v_mfma_f32_16x16x32_bf16 v[120:123], v[216:219], v[68:71], v[120:123]
    v_mfma_f32_16x16x32_bf16 v[124:127], v[216:219], v[84:87], v[124:127]
    v_mfma_f32_16x16x32_bf16 v[128:131], v[216:219], v[100:103], v[128:131]
    v_mfma_f32_16x16x32_bf16 v[112:115], v[220:223], v[40:43], v[112:115]
    v_mfma_f32_16x16x32_bf16 v[116:119], v[220:223], v[56:59], v[116:119]
    v_mfma_f32_16x16x32_bf16 v[120:123], v[220:223], v[72:75], v[120:123]
    v_mfma_f32_16x16x32_bf16 v[124:127], v[220:223], v[88:91], v[124:127]
    v_mfma_f32_16x16x32_bf16 v[128:131], v[220:223], v[104:107], v[128:131]
    v_mfma_f32_16x16x32_bf16 v[112:115], v[224:227], v[44:47], v[112:115]
    v_mfma_f32_16x16x32_bf16 v[116:119], v[224:227], v[60:63], v[116:119]
    v_mfma_f32_16x16x32_bf16 v[120:123], v[224:227], v[76:79], v[120:123]
    v_mfma_f32_16x16x32_bf16 v[124:127], v[224:227], v[92:95], v[124:127]
    v_mfma_f32_16x16x32_bf16 v[128:131], v[224:227], v[108:111], v[128:131]
    v_mfma_f32_16x16x32_bf16 v[132:135], v[228:231], v[32:35], v[192:195]
    v_mfma_f32_16x16x32_bf16 v[136:139], v[228:231], v[48:51], v[196:199]
    v_mfma_f32_16x16x32_bf16 v[140:143], v[228:231], v[64:67], v[200:203]
    v_mfma_f32_16x16x32_bf16 v[144:147], v[228:231], v[80:83], v[204:207]
    v_mfma_f32_16x16x32_bf16 v[148:151], v[228:231], v[96:99], v[208:211]
    v_mfma_f32_16x16x32_bf16 v[132:135], v[232:235], v[36:39], v[132:135]
    v_mfma_f32_16x16x32_bf16 v[136:139], v[232:235], v[52:55], v[136:139]
    v_mfma_f32_16x16x32_bf16 v[140:143], v[232:235], v[68:71], v[140:143]
    v_mfma_f32_16x16x32_bf16 v[144:147], v[232:235], v[84:87], v[144:147]
    v_mfma_f32_16x16x32_bf16 v[148:151], v[232:235], v[100:103], v[148:151]
    v_mfma_f32_16x16x32_bf16 v[132:135], v[236:239], v[40:43], v[132:135]
    v_mfma_f32_16x16x32_bf16 v[136:139], v[236:239], v[56:59], v[136:139]
    v_mfma_f32_16x16x32_bf16 v[140:143], v[236:239], v[72:75], v[140:143]
    v_mfma_f32_16x16x32_bf16 v[144:147], v[236:239], v[88:91], v[144:147]
    v_mfma_f32_16x16x32_bf16 v[148:151], v[236:239], v[104:107], v[148:151]
    v_mfma_f32_16x16x32_bf16 v[132:135], v[240:243], v[44:47], v[132:135]
    v_mfma_f32_16x16x32_bf16 v[136:139], v[240:243], v[60:63], v[136:139]
    v_mfma_f32_16x16x32_bf16 v[140:143], v[240:243], v[76:79], v[140:143]
    v_mfma_f32_16x16x32_bf16 v[144:147], v[240:243], v[92:95], v[144:147]
    v_mfma_f32_16x16x32_bf16 v[148:151], v[240:243], v[108:111], v[148:151]
    v_exp_f32 v112, v112
    v_exp_f32 v113, v113
    v_exp_f32 v114, v114
    v_exp_f32 v115, v115
    v_cvt_pk_bf16_f32 v152, v112, v113
    v_cvt_pk_bf16_f32 v153, v114, v115
    v_exp_f32 v116, v116
    v_exp_f32 v117, v117
    v_exp_f32 v118, v118
    v_exp_f32 v119, v119
    v_cvt_pk_bf16_f32 v156, v116, v117
    v_cvt_pk_bf16_f32 v157, v118, v119
    v_exp_f32 v120, v120
    v_exp_f32 v121, v121
    v_exp_f32 v122, v122
    v_exp_f32 v123, v123
    v_cvt_pk_bf16_f32 v160, v120, v121
    v_cvt_pk_bf16_f32 v161, v122, v123
    v_exp_f32 v124, v124
    v_exp_f32 v125, v125
    v_exp_f32 v126, v126
    v_exp_f32 v127, v127
    v_cvt_pk_bf16_f32 v164, v124, v125
    v_cvt_pk_bf16_f32 v165, v126, v127
    v_exp_f32 v128, v128
    v_exp_f32 v129, v129
    v_exp_f32 v130, v130
    v_exp_f32 v131, v131
    v_cvt_pk_bf16_f32 v168, v128, v129
    v_cvt_pk_bf16_f32 v169, v130, v131
    v_exp_f32 v132, v132
    v_exp_f32 v133, v133
    v_exp_f32 v134, v134
    v_exp_f32 v135, v135
    v_cvt_pk_bf16_f32 v154, v132, v133
    v_cvt_pk_bf16_f32 v155, v134, v135
    v_exp_f32 v136, v136
    v_exp_f32 v137, v137
    v_exp_f32 v138, v138
    v_exp_f32 v139, v139
    v_cvt_pk_bf16_f32 v158, v136, v137
    v_cvt_pk_bf16_f32 v159, v138, v139
    v_exp_f32 v140, v140
    v_exp_f32 v141, v141
    v_exp_f32 v142, v142
    v_exp_f32 v143, v143
    v_cvt_pk_bf16_f32 v162, v140, v141
    v_cvt_pk_bf16_f32 v163, v142, v143
    v_exp_f32 v144, v144
    v_exp_f32 v145, v145
    v_exp_f32 v146, v146
    v_exp_f32 v147, v147
    v_cvt_pk_bf16_f32 v166, v144, v145
    v_cvt_pk_bf16_f32 v167, v146, v147
    v_exp_f32 v148, v148
    v_exp_f32 v149, v149
    v_exp_f32 v150, v150
    v_exp_f32 v151, v151
    v_cvt_pk_bf16_f32 v170, v148, v149
    v_cvt_pk_bf16_f32 v171, v150, v151
    ds_read_b64_tr_b16 v[212:213], v178
    ds_read_b64_tr_b16 v[214:215], v178 offset:4096
    ds_read_b64_tr_b16 v[216:217], v179
    ds_read_b64_tr_b16 v[218:219], v179 offset:4096
    s_waitcnt lgkmcnt(0)
    ds_read_b64_tr_b16 v[220:221], v178 offset:256
    ds_read_b64_tr_b16 v[222:223], v178 offset:4352
    ds_read_b64_tr_b16 v[224:225], v179 offset:256
    ds_read_b64_tr_b16 v[226:227], v179 offset:4352
    s_waitcnt lgkmcnt(0)
    ds_read_b64_tr_b16 v[228:229], v178 offset:512
    ds_read_b64_tr_b16 v[230:231], v178 offset:4608
    ds_read_b64_tr_b16 v[232:233], v179 offset:512
    ds_read_b64_tr_b16 v[234:235], v179 offset:4608
    s_waitcnt lgkmcnt(0)
    ds_read_b64_tr_b16 v[236:237], v178 offset:768
    ds_read_b64_tr_b16 v[238:239], v178 offset:4864
    ds_read_b64_tr_b16 v[240:241], v179 offset:768
    ds_read_b64_tr_b16 v[242:243], v179 offset:4864
    s_waitcnt lgkmcnt(0)
    v_mfma_f32_16x16x32_bf16 a[160:163], a[180:183], v[152:155], a[160:163]
    v_mfma_f32_16x16x32_bf16 a[164:167], a[180:183], v[156:159], a[164:167]
    v_mfma_f32_16x16x32_bf16 a[168:171], a[180:183], v[160:163], a[168:171]
    v_mfma_f32_16x16x32_bf16 a[172:175], a[180:183], v[164:167], a[172:175]
    v_mfma_f32_16x16x32_bf16 a[176:179], a[180:183], v[168:171], a[176:179]
    v_mfma_f32_16x16x32_bf16 a[0:3], v[212:215], v[152:155], a[0:3]
    v_mfma_f32_16x16x32_bf16 a[4:7], v[212:215], v[156:159], a[4:7]
    v_mfma_f32_16x16x32_bf16 a[8:11], v[212:215], v[160:163], a[8:11]
    v_mfma_f32_16x16x32_bf16 a[12:15], v[212:215], v[164:167], a[12:15]
    v_mfma_f32_16x16x32_bf16 a[16:19], v[212:215], v[168:171], a[16:19]
    v_mfma_f32_16x16x32_bf16 a[20:23], v[216:219], v[152:155], a[20:23]
    v_mfma_f32_16x16x32_bf16 a[24:27], v[216:219], v[156:159], a[24:27]
    v_mfma_f32_16x16x32_bf16 a[28:31], v[216:219], v[160:163], a[28:31]
    v_mfma_f32_16x16x32_bf16 a[32:35], v[216:219], v[164:167], a[32:35]
    v_mfma_f32_16x16x32_bf16 a[36:39], v[216:219], v[168:171], a[36:39]
    v_mfma_f32_16x16x32_bf16 a[40:43], v[220:223], v[152:155], a[40:43]
    v_mfma_f32_16x16x32_bf16 a[44:47], v[220:223], v[156:159], a[44:47]
    v_mfma_f32_16x16x32_bf16 a[48:51], v[220:223], v[160:163], a[48:51]
    v_mfma_f32_16x16x32_bf16 a[52:55], v[220:223], v[164:167], a[52:55]
    v_mfma_f32_16x16x32_bf16 a[56:59], v[220:223], v[168:171], a[56:59]
    v_mfma_f32_16x16x32_bf16 a[60:63], v[224:227], v[152:155], a[60:63]
    v_mfma_f32_16x16x32_bf16 a[64:67], v[224:227], v[156:159], a[64:67]
    v_mfma_f32_16x16x32_bf16 a[68:71], v[224:227], v[160:163], a[68:71]
    v_mfma_f32_16x16x32_bf16 a[72:75], v[224:227], v[164:167], a[72:75]
    v_mfma_f32_16x16x32_bf16 a[76:79], v[224:227], v[168:171], a[76:79]
    v_mfma_f32_16x16x32_bf16 a[80:83], v[228:231], v[152:155], a[80:83]
    v_mfma_f32_16x16x32_bf16 a[84:87], v[228:231], v[156:159], a[84:87]
    v_mfma_f32_16x16x32_bf16 a[88:91], v[228:231], v[160:163], a[88:91]
    v_mfma_f32_16x16x32_bf16 a[92:95], v[228:231], v[164:167], a[92:95]
    v_mfma_f32_16x16x32_bf16 a[96:99], v[228:231], v[168:171], a[96:99]
    v_mfma_f32_16x16x32_bf16 a[100:103], v[232:235], v[152:155], a[100:103]
    v_mfma_f32_16x16x32_bf16 a[104:107], v[232:235], v[156:159], a[104:107]
    v_mfma_f32_16x16x32_bf16 a[108:111], v[232:235], v[160:163], a[108:111]
    v_mfma_f32_16x16x32_bf16 a[112:115], v[232:235], v[164:167], a[112:115]
    v_mfma_f32_16x16x32_bf16 a[116:119], v[232:235], v[168:171], a[116:119]
    v_mfma_f32_16x16x32_bf16 a[120:123], v[236:239], v[152:155], a[120:123]
    v_mfma_f32_16x16x32_bf16 a[124:127], v[236:239], v[156:159], a[124:127]
    v_mfma_f32_16x16x32_bf16 a[128:131], v[236:239], v[160:163], a[128:131]
    v_mfma_f32_16x16x32_bf16 a[132:135], v[236:239], v[164:167], a[132:135]
    v_mfma_f32_16x16x32_bf16 a[136:139], v[236:239], v[168:171], a[136:139]
    v_mfma_f32_16x16x32_bf16 a[140:143], v[240:243], v[152:155], a[140:143]
    v_mfma_f32_16x16x32_bf16 a[144:147], v[240:243], v[156:159], a[144:147]
    v_mfma_f32_16x16x32_bf16 a[148:151], v[240:243], v[160:163], a[148:151]
    v_mfma_f32_16x16x32_bf16 a[152:155], v[240:243], v[164:167], a[152:155]
    v_mfma_f32_16x16x32_bf16 a[156:159], v[240:243], v[168:171], a[156:159]
    s_nop 7
    s_add_u32 s100, s100, 8192
    s_cmp_lt_u32 s100, 131072
    s_cbranch_scc1 L_exact_pv
    v_accvgpr_read_b32 v244, a160
    v_accvgpr_read_b32 v246, a164
    v_accvgpr_read_b32 v248, a168
    v_accvgpr_read_b32 v250, a172
    v_accvgpr_read_b32 v252, a176
    s_branch L_checked
L_flag_slow:
    s_mov_b32 s67, 200000
L_flag:
    buffer_load_dword v24, v27, s[36:39], s48 offen sc1
    s_waitcnt vmcnt(0)
    v_cmp_lt_u32 s[52:53], s29, v24
    s_nop 0
    s_cmp_eq_u64 s[52:53], -1
    s_cbranch_scc1 L_flag_ok
    s_sleep 2
    s_sub_u32 s67, s67, 1
    s_cbranch_scc0 L_flag
    s_branch L_flag_ok
L_part_slow:
    s_mov_b32 s67, 200000
L_part:
    buffer_load_dword v24, v23, s[36:39], s65 offen sc1
    s_waitcnt vmcnt(0)
    v_readfirstlane_b32 s101, v24
    s_nop 0
    s_or_b32 s101, s101, s49
    s_cmp_ge_u32 s101, 1
    s_cbranch_scc1 L_part_ok
    s_sleep 2
    s_sub_u32 s67, s67, 1
    s_cbranch_scc0 L_part
    s_branch L_part_ok
L_remote:
    v_rcp_f32 v244, v244
    v_rcp_f32 v246, v246
    v_rcp_f32 v248, v248
    v_rcp_f32 v250, v250
    v_rcp_f32 v252, v252
    s_add_u32 s29, s33, 0
    v_accvgpr_read_b32 v112, a0
    v_accvgpr_read_b32 v113, a1
    v_accvgpr_read_b32 v114, a2
    v_accvgpr_read_b32 v115, a3
    v_accvgpr_read_b32 v116, a20
    v_accvgpr_read_b32 v117, a21
    v_accvgpr_read_b32 v118, a22
    v_accvgpr_read_b32 v119, a23
    v_pk_mul_f32 v[112:113], v[112:113], v[244:245] op_sel_hi:[1,0]
    v_pk_mul_f32 v[114:115], v[114:115], v[244:245] op_sel_hi:[1,0]
    v_pk_mul_f32 v[116:117], v[116:117], v[244:245] op_sel_hi:[1,0]
    v_pk_mul_f32 v[118:119], v[118:119], v[244:245] op_sel_hi:[1,0]
    v_cvt_pk_bf16_f32 v120, v112, v113
    v_cvt_pk_bf16_f32 v121, v114, v115
    v_cvt_pk_bf16_f32 v122, v116, v117
    v_cvt_pk_bf16_f32 v123, v118, v119
    buffer_store_dwordx4 v[120:123], v21, s[20:23], s29 offen sc1
    v_accvgpr_read_b32 v124, a4
    v_accvgpr_read_b32 v125, a5
    v_accvgpr_read_b32 v126, a6
    v_accvgpr_read_b32 v127, a7
    v_accvgpr_read_b32 v128, a24
    v_accvgpr_read_b32 v129, a25
    v_accvgpr_read_b32 v130, a26
    v_accvgpr_read_b32 v131, a27
    v_pk_mul_f32 v[124:125], v[124:125], v[246:247] op_sel_hi:[1,0]
    v_pk_mul_f32 v[126:127], v[126:127], v[246:247] op_sel_hi:[1,0]
    v_pk_mul_f32 v[128:129], v[128:129], v[246:247] op_sel_hi:[1,0]
    v_pk_mul_f32 v[130:131], v[130:131], v[246:247] op_sel_hi:[1,0]
    v_cvt_pk_bf16_f32 v132, v124, v125
    v_cvt_pk_bf16_f32 v133, v126, v127
    v_cvt_pk_bf16_f32 v134, v128, v129
    v_cvt_pk_bf16_f32 v135, v130, v131
    buffer_store_dwordx4 v[132:135], v21, s[20:23], s29 offen offset:1024 sc1
    v_accvgpr_read_b32 v136, a8
    v_accvgpr_read_b32 v137, a9
    v_accvgpr_read_b32 v138, a10
    v_accvgpr_read_b32 v139, a11
    v_accvgpr_read_b32 v140, a28
    v_accvgpr_read_b32 v141, a29
    v_accvgpr_read_b32 v142, a30
    v_accvgpr_read_b32 v143, a31
    v_pk_mul_f32 v[136:137], v[136:137], v[248:249] op_sel_hi:[1,0]
    v_pk_mul_f32 v[138:139], v[138:139], v[248:249] op_sel_hi:[1,0]
    v_pk_mul_f32 v[140:141], v[140:141], v[248:249] op_sel_hi:[1,0]
    v_pk_mul_f32 v[142:143], v[142:143], v[248:249] op_sel_hi:[1,0]
    v_cvt_pk_bf16_f32 v144, v136, v137
    v_cvt_pk_bf16_f32 v145, v138, v139
    v_cvt_pk_bf16_f32 v146, v140, v141
    v_cvt_pk_bf16_f32 v147, v142, v143
    buffer_store_dwordx4 v[144:147], v21, s[20:23], s29 offen offset:2048 sc1
    v_accvgpr_read_b32 v148, a12
    v_accvgpr_read_b32 v149, a13
    v_accvgpr_read_b32 v150, a14
    v_accvgpr_read_b32 v151, a15
    v_accvgpr_read_b32 v152, a32
    v_accvgpr_read_b32 v153, a33
    v_accvgpr_read_b32 v154, a34
    v_accvgpr_read_b32 v155, a35
    v_pk_mul_f32 v[148:149], v[148:149], v[250:251] op_sel_hi:[1,0]
    v_pk_mul_f32 v[150:151], v[150:151], v[250:251] op_sel_hi:[1,0]
    v_pk_mul_f32 v[152:153], v[152:153], v[250:251] op_sel_hi:[1,0]
    v_pk_mul_f32 v[154:155], v[154:155], v[250:251] op_sel_hi:[1,0]
    v_cvt_pk_bf16_f32 v156, v148, v149
    v_cvt_pk_bf16_f32 v157, v150, v151
    v_cvt_pk_bf16_f32 v158, v152, v153
    v_cvt_pk_bf16_f32 v159, v154, v155
    buffer_store_dwordx4 v[156:159], v21, s[20:23], s29 offen offset:3072 sc1
    v_accvgpr_read_b32 v160, a16
    v_accvgpr_read_b32 v161, a17
    v_accvgpr_read_b32 v162, a18
    v_accvgpr_read_b32 v163, a19
    v_accvgpr_read_b32 v164, a36
    v_accvgpr_read_b32 v165, a37
    v_accvgpr_read_b32 v166, a38
    v_accvgpr_read_b32 v167, a39
    v_pk_mul_f32 v[160:161], v[160:161], v[252:253] op_sel_hi:[1,0]
    v_pk_mul_f32 v[162:163], v[162:163], v[252:253] op_sel_hi:[1,0]
    v_pk_mul_f32 v[164:165], v[164:165], v[252:253] op_sel_hi:[1,0]
    v_pk_mul_f32 v[166:167], v[166:167], v[252:253] op_sel_hi:[1,0]
    v_cvt_pk_bf16_f32 v168, v160, v161
    v_cvt_pk_bf16_f32 v169, v162, v163
    v_cvt_pk_bf16_f32 v170, v164, v165
    v_cvt_pk_bf16_f32 v171, v166, v167
    s_add_u32 s100, s29, 4096
    buffer_store_dwordx4 v[168:171], v21, s[20:23], s100 offen sc1
    s_add_u32 s29, s33, 10240
    v_accvgpr_read_b32 v172, a40
    v_accvgpr_read_b32 v173, a41
    v_accvgpr_read_b32 v174, a42
    v_accvgpr_read_b32 v175, a43
    v_accvgpr_read_b32 v176, a60
    v_accvgpr_read_b32 v177, a61
    v_accvgpr_read_b32 v178, a62
    v_accvgpr_read_b32 v179, a63
    v_pk_mul_f32 v[172:173], v[172:173], v[244:245] op_sel_hi:[1,0]
    v_pk_mul_f32 v[174:175], v[174:175], v[244:245] op_sel_hi:[1,0]
    v_pk_mul_f32 v[176:177], v[176:177], v[244:245] op_sel_hi:[1,0]
    v_pk_mul_f32 v[178:179], v[178:179], v[244:245] op_sel_hi:[1,0]
    v_cvt_pk_bf16_f32 v180, v172, v173
    v_cvt_pk_bf16_f32 v181, v174, v175
    v_cvt_pk_bf16_f32 v182, v176, v177
    v_cvt_pk_bf16_f32 v183, v178, v179
    buffer_store_dwordx4 v[180:183], v21, s[20:23], s29 offen sc1
    v_accvgpr_read_b32 v184, a44
    v_accvgpr_read_b32 v185, a45
    v_accvgpr_read_b32 v186, a46
    v_accvgpr_read_b32 v187, a47
    v_accvgpr_read_b32 v188, a64
    v_accvgpr_read_b32 v189, a65
    v_accvgpr_read_b32 v190, a66
    v_accvgpr_read_b32 v191, a67
    v_pk_mul_f32 v[184:185], v[184:185], v[246:247] op_sel_hi:[1,0]
    v_pk_mul_f32 v[186:187], v[186:187], v[246:247] op_sel_hi:[1,0]
    v_pk_mul_f32 v[188:189], v[188:189], v[246:247] op_sel_hi:[1,0]
    v_pk_mul_f32 v[190:191], v[190:191], v[246:247] op_sel_hi:[1,0]
    v_cvt_pk_bf16_f32 v192, v184, v185
    v_cvt_pk_bf16_f32 v193, v186, v187
    v_cvt_pk_bf16_f32 v194, v188, v189
    v_cvt_pk_bf16_f32 v195, v190, v191
    buffer_store_dwordx4 v[192:195], v21, s[20:23], s29 offen offset:1024 sc1
    v_accvgpr_read_b32 v196, a48
    v_accvgpr_read_b32 v197, a49
    v_accvgpr_read_b32 v198, a50
    v_accvgpr_read_b32 v199, a51
    v_accvgpr_read_b32 v200, a68
    v_accvgpr_read_b32 v201, a69
    v_accvgpr_read_b32 v202, a70
    v_accvgpr_read_b32 v203, a71
    v_pk_mul_f32 v[196:197], v[196:197], v[248:249] op_sel_hi:[1,0]
    v_pk_mul_f32 v[198:199], v[198:199], v[248:249] op_sel_hi:[1,0]
    v_pk_mul_f32 v[200:201], v[200:201], v[248:249] op_sel_hi:[1,0]
    v_pk_mul_f32 v[202:203], v[202:203], v[248:249] op_sel_hi:[1,0]
    v_cvt_pk_bf16_f32 v204, v196, v197
    v_cvt_pk_bf16_f32 v205, v198, v199
    v_cvt_pk_bf16_f32 v206, v200, v201
    v_cvt_pk_bf16_f32 v207, v202, v203
    buffer_store_dwordx4 v[204:207], v21, s[20:23], s29 offen offset:2048 sc1
    v_accvgpr_read_b32 v112, a52
    v_accvgpr_read_b32 v113, a53
    v_accvgpr_read_b32 v114, a54
    v_accvgpr_read_b32 v115, a55
    v_accvgpr_read_b32 v116, a72
    v_accvgpr_read_b32 v117, a73
    v_accvgpr_read_b32 v118, a74
    v_accvgpr_read_b32 v119, a75
    v_pk_mul_f32 v[112:113], v[112:113], v[250:251] op_sel_hi:[1,0]
    v_pk_mul_f32 v[114:115], v[114:115], v[250:251] op_sel_hi:[1,0]
    v_pk_mul_f32 v[116:117], v[116:117], v[250:251] op_sel_hi:[1,0]
    v_pk_mul_f32 v[118:119], v[118:119], v[250:251] op_sel_hi:[1,0]
    v_cvt_pk_bf16_f32 v120, v112, v113
    v_cvt_pk_bf16_f32 v121, v114, v115
    v_cvt_pk_bf16_f32 v122, v116, v117
    v_cvt_pk_bf16_f32 v123, v118, v119
    buffer_store_dwordx4 v[120:123], v21, s[20:23], s29 offen offset:3072 sc1
    v_accvgpr_read_b32 v124, a56
    v_accvgpr_read_b32 v125, a57
    v_accvgpr_read_b32 v126, a58
    v_accvgpr_read_b32 v127, a59
    v_accvgpr_read_b32 v128, a76
    v_accvgpr_read_b32 v129, a77
    v_accvgpr_read_b32 v130, a78
    v_accvgpr_read_b32 v131, a79
    v_pk_mul_f32 v[124:125], v[124:125], v[252:253] op_sel_hi:[1,0]
    v_pk_mul_f32 v[126:127], v[126:127], v[252:253] op_sel_hi:[1,0]
    v_pk_mul_f32 v[128:129], v[128:129], v[252:253] op_sel_hi:[1,0]
    v_pk_mul_f32 v[130:131], v[130:131], v[252:253] op_sel_hi:[1,0]
    v_cvt_pk_bf16_f32 v132, v124, v125
    v_cvt_pk_bf16_f32 v133, v126, v127
    v_cvt_pk_bf16_f32 v134, v128, v129
    v_cvt_pk_bf16_f32 v135, v130, v131
    s_add_u32 s100, s29, 4096
    buffer_store_dwordx4 v[132:135], v21, s[20:23], s100 offen sc1
    s_add_u32 s29, s33, 20480
    v_accvgpr_read_b32 v136, a80
    v_accvgpr_read_b32 v137, a81
    v_accvgpr_read_b32 v138, a82
    v_accvgpr_read_b32 v139, a83
    v_accvgpr_read_b32 v140, a100
    v_accvgpr_read_b32 v141, a101
    v_accvgpr_read_b32 v142, a102
    v_accvgpr_read_b32 v143, a103
    v_pk_mul_f32 v[136:137], v[136:137], v[244:245] op_sel_hi:[1,0]
    v_pk_mul_f32 v[138:139], v[138:139], v[244:245] op_sel_hi:[1,0]
    v_pk_mul_f32 v[140:141], v[140:141], v[244:245] op_sel_hi:[1,0]
    v_pk_mul_f32 v[142:143], v[142:143], v[244:245] op_sel_hi:[1,0]
    v_cvt_pk_bf16_f32 v144, v136, v137
    v_cvt_pk_bf16_f32 v145, v138, v139
    v_cvt_pk_bf16_f32 v146, v140, v141
    v_cvt_pk_bf16_f32 v147, v142, v143
    buffer_store_dwordx4 v[144:147], v21, s[20:23], s29 offen sc1
    v_accvgpr_read_b32 v148, a84
    v_accvgpr_read_b32 v149, a85
    v_accvgpr_read_b32 v150, a86
    v_accvgpr_read_b32 v151, a87
    v_accvgpr_read_b32 v152, a104
    v_accvgpr_read_b32 v153, a105
    v_accvgpr_read_b32 v154, a106
    v_accvgpr_read_b32 v155, a107
    v_pk_mul_f32 v[148:149], v[148:149], v[246:247] op_sel_hi:[1,0]
    v_pk_mul_f32 v[150:151], v[150:151], v[246:247] op_sel_hi:[1,0]
    v_pk_mul_f32 v[152:153], v[152:153], v[246:247] op_sel_hi:[1,0]
    v_pk_mul_f32 v[154:155], v[154:155], v[246:247] op_sel_hi:[1,0]
    v_cvt_pk_bf16_f32 v156, v148, v149
    v_cvt_pk_bf16_f32 v157, v150, v151
    v_cvt_pk_bf16_f32 v158, v152, v153
    v_cvt_pk_bf16_f32 v159, v154, v155
    buffer_store_dwordx4 v[156:159], v21, s[20:23], s29 offen offset:1024 sc1
    v_accvgpr_read_b32 v160, a88
    v_accvgpr_read_b32 v161, a89
    v_accvgpr_read_b32 v162, a90
    v_accvgpr_read_b32 v163, a91
    v_accvgpr_read_b32 v164, a108
    v_accvgpr_read_b32 v165, a109
    v_accvgpr_read_b32 v166, a110
    v_accvgpr_read_b32 v167, a111
    v_pk_mul_f32 v[160:161], v[160:161], v[248:249] op_sel_hi:[1,0]
    v_pk_mul_f32 v[162:163], v[162:163], v[248:249] op_sel_hi:[1,0]
    v_pk_mul_f32 v[164:165], v[164:165], v[248:249] op_sel_hi:[1,0]
    v_pk_mul_f32 v[166:167], v[166:167], v[248:249] op_sel_hi:[1,0]
    v_cvt_pk_bf16_f32 v168, v160, v161
    v_cvt_pk_bf16_f32 v169, v162, v163
    v_cvt_pk_bf16_f32 v170, v164, v165
    v_cvt_pk_bf16_f32 v171, v166, v167
    buffer_store_dwordx4 v[168:171], v21, s[20:23], s29 offen offset:2048 sc1
    v_accvgpr_read_b32 v172, a92
    v_accvgpr_read_b32 v173, a93
    v_accvgpr_read_b32 v174, a94
    v_accvgpr_read_b32 v175, a95
    v_accvgpr_read_b32 v176, a112
    v_accvgpr_read_b32 v177, a113
    v_accvgpr_read_b32 v178, a114
    v_accvgpr_read_b32 v179, a115
    v_pk_mul_f32 v[172:173], v[172:173], v[250:251] op_sel_hi:[1,0]
    v_pk_mul_f32 v[174:175], v[174:175], v[250:251] op_sel_hi:[1,0]
    v_pk_mul_f32 v[176:177], v[176:177], v[250:251] op_sel_hi:[1,0]
    v_pk_mul_f32 v[178:179], v[178:179], v[250:251] op_sel_hi:[1,0]
    v_cvt_pk_bf16_f32 v180, v172, v173
    v_cvt_pk_bf16_f32 v181, v174, v175
    v_cvt_pk_bf16_f32 v182, v176, v177
    v_cvt_pk_bf16_f32 v183, v178, v179
    buffer_store_dwordx4 v[180:183], v21, s[20:23], s29 offen offset:3072 sc1
    v_accvgpr_read_b32 v184, a96
    v_accvgpr_read_b32 v185, a97
    v_accvgpr_read_b32 v186, a98
    v_accvgpr_read_b32 v187, a99
    v_accvgpr_read_b32 v188, a116
    v_accvgpr_read_b32 v189, a117
    v_accvgpr_read_b32 v190, a118
    v_accvgpr_read_b32 v191, a119
    v_pk_mul_f32 v[184:185], v[184:185], v[252:253] op_sel_hi:[1,0]
    v_pk_mul_f32 v[186:187], v[186:187], v[252:253] op_sel_hi:[1,0]
    v_pk_mul_f32 v[188:189], v[188:189], v[252:253] op_sel_hi:[1,0]
    v_pk_mul_f32 v[190:191], v[190:191], v[252:253] op_sel_hi:[1,0]
    v_cvt_pk_bf16_f32 v192, v184, v185
    v_cvt_pk_bf16_f32 v193, v186, v187
    v_cvt_pk_bf16_f32 v194, v188, v189
    v_cvt_pk_bf16_f32 v195, v190, v191
    s_add_u32 s100, s29, 4096
    buffer_store_dwordx4 v[192:195], v21, s[20:23], s100 offen sc1
    s_add_u32 s29, s33, 30720
    v_accvgpr_read_b32 v196, a120
    v_accvgpr_read_b32 v197, a121
    v_accvgpr_read_b32 v198, a122
    v_accvgpr_read_b32 v199, a123
    v_accvgpr_read_b32 v200, a140
    v_accvgpr_read_b32 v201, a141
    v_accvgpr_read_b32 v202, a142
    v_accvgpr_read_b32 v203, a143
    v_pk_mul_f32 v[196:197], v[196:197], v[244:245] op_sel_hi:[1,0]
    v_pk_mul_f32 v[198:199], v[198:199], v[244:245] op_sel_hi:[1,0]
    v_pk_mul_f32 v[200:201], v[200:201], v[244:245] op_sel_hi:[1,0]
    v_pk_mul_f32 v[202:203], v[202:203], v[244:245] op_sel_hi:[1,0]
    v_cvt_pk_bf16_f32 v204, v196, v197
    v_cvt_pk_bf16_f32 v205, v198, v199
    v_cvt_pk_bf16_f32 v206, v200, v201
    v_cvt_pk_bf16_f32 v207, v202, v203
    buffer_store_dwordx4 v[204:207], v21, s[20:23], s29 offen sc1
    v_accvgpr_read_b32 v112, a124
    v_accvgpr_read_b32 v113, a125
    v_accvgpr_read_b32 v114, a126
    v_accvgpr_read_b32 v115, a127
    v_accvgpr_read_b32 v116, a144
    v_accvgpr_read_b32 v117, a145
    v_accvgpr_read_b32 v118, a146
    v_accvgpr_read_b32 v119, a147
    v_pk_mul_f32 v[112:113], v[112:113], v[246:247] op_sel_hi:[1,0]
    v_pk_mul_f32 v[114:115], v[114:115], v[246:247] op_sel_hi:[1,0]
    v_pk_mul_f32 v[116:117], v[116:117], v[246:247] op_sel_hi:[1,0]
    v_pk_mul_f32 v[118:119], v[118:119], v[246:247] op_sel_hi:[1,0]
    v_cvt_pk_bf16_f32 v120, v112, v113
    v_cvt_pk_bf16_f32 v121, v114, v115
    v_cvt_pk_bf16_f32 v122, v116, v117
    v_cvt_pk_bf16_f32 v123, v118, v119
    buffer_store_dwordx4 v[120:123], v21, s[20:23], s29 offen offset:1024 sc1
    v_accvgpr_read_b32 v124, a128
    v_accvgpr_read_b32 v125, a129
    v_accvgpr_read_b32 v126, a130
    v_accvgpr_read_b32 v127, a131
    v_accvgpr_read_b32 v128, a148
    v_accvgpr_read_b32 v129, a149
    v_accvgpr_read_b32 v130, a150
    v_accvgpr_read_b32 v131, a151
    v_pk_mul_f32 v[124:125], v[124:125], v[248:249] op_sel_hi:[1,0]
    v_pk_mul_f32 v[126:127], v[126:127], v[248:249] op_sel_hi:[1,0]
    v_pk_mul_f32 v[128:129], v[128:129], v[248:249] op_sel_hi:[1,0]
    v_pk_mul_f32 v[130:131], v[130:131], v[248:249] op_sel_hi:[1,0]
    v_cvt_pk_bf16_f32 v132, v124, v125
    v_cvt_pk_bf16_f32 v133, v126, v127
    v_cvt_pk_bf16_f32 v134, v128, v129
    v_cvt_pk_bf16_f32 v135, v130, v131
    buffer_store_dwordx4 v[132:135], v21, s[20:23], s29 offen offset:2048 sc1
    v_accvgpr_read_b32 v136, a132
    v_accvgpr_read_b32 v137, a133
    v_accvgpr_read_b32 v138, a134
    v_accvgpr_read_b32 v139, a135
    v_accvgpr_read_b32 v140, a152
    v_accvgpr_read_b32 v141, a153
    v_accvgpr_read_b32 v142, a154
    v_accvgpr_read_b32 v143, a155
    v_pk_mul_f32 v[136:137], v[136:137], v[250:251] op_sel_hi:[1,0]
    v_pk_mul_f32 v[138:139], v[138:139], v[250:251] op_sel_hi:[1,0]
    v_pk_mul_f32 v[140:141], v[140:141], v[250:251] op_sel_hi:[1,0]
    v_pk_mul_f32 v[142:143], v[142:143], v[250:251] op_sel_hi:[1,0]
    v_cvt_pk_bf16_f32 v144, v136, v137
    v_cvt_pk_bf16_f32 v145, v138, v139
    v_cvt_pk_bf16_f32 v146, v140, v141
    v_cvt_pk_bf16_f32 v147, v142, v143
    buffer_store_dwordx4 v[144:147], v21, s[20:23], s29 offen offset:3072 sc1
    v_accvgpr_read_b32 v148, a136
    v_accvgpr_read_b32 v149, a137
    v_accvgpr_read_b32 v150, a138
    v_accvgpr_read_b32 v151, a139
    v_accvgpr_read_b32 v152, a156
    v_accvgpr_read_b32 v153, a157
    v_accvgpr_read_b32 v154, a158
    v_accvgpr_read_b32 v155, a159
    v_pk_mul_f32 v[148:149], v[148:149], v[252:253] op_sel_hi:[1,0]
    v_pk_mul_f32 v[150:151], v[150:151], v[252:253] op_sel_hi:[1,0]
    v_pk_mul_f32 v[152:153], v[152:153], v[252:253] op_sel_hi:[1,0]
    v_pk_mul_f32 v[154:155], v[154:155], v[252:253] op_sel_hi:[1,0]
    v_cvt_pk_bf16_f32 v156, v148, v149
    v_cvt_pk_bf16_f32 v157, v150, v151
    v_cvt_pk_bf16_f32 v158, v152, v153
    v_cvt_pk_bf16_f32 v159, v154, v155
    s_add_u32 s100, s29, 4096
    buffer_store_dwordx4 v[156:159], v21, s[20:23], s100 offen sc1
    s_or_b32 s29, s66, 0x100
    v_mov_b32 v29, s29
    s_movk_i32 s29, 0xff
    s_mov_b32 s12, s50
    s_and_b32 s13, s51, 0xffff
    s_mov_b32 s14, 40960
    s_mov_b32 s15, 0x20000
    s_waitcnt vmcnt(0)
    buffer_store_dword v29, v31, s[36:39], s63 offen sc1
    s_branch L_published
.section .rodata,"a"
.p2align 6
.amdhsa_kernel concat_heads__mha_block_cached__mha_block_cached__near_ridge_kernel
  .amdhsa_next_free_vgpr 512
  .amdhsa_next_free_sgpr 102
  .amdhsa_accum_offset 256
  .amdhsa_group_segment_fixed_size 0
  .amdhsa_kernarg_size 104
  .amdhsa_user_sgpr_count 2
  .amdhsa_user_sgpr_kernarg_segment_ptr 1
  .amdhsa_system_sgpr_workgroup_id_x 1
.end_amdhsa_kernel
```
